```python
import torch

def _softmax(x, axis=-1):
    return torch.softmax(x, dim=axis)

def _gelu(x):
    return torch.nn.functional.gelu(x, approximate='tanh')

def _silu(x):
    return torch.nn.functional.silu(x)

def _sigmoid(x):
    return torch.sigmoid(x)

def _layernorm(x, axis=-1, eps=1e-05):
    m = x.mean(dim=axis, keepdim=True)
    v = x.var(dim=axis, keepdim=True, unbiased=False)
    return (x - m) / torch.sqrt(v + eps)

def _scatter_add(tgt, idx, src, axis=0):
    return tgt.clone().index_add_(axis, idx, src)

def _segment_sum(src, seg, n):
    out = torch.zeros((n,) + src.shape[1:], dtype=src.dtype)
    return out.index_add_(0, seg, src)

def _pad(x, pw):
    flat = tuple((v for pair in reversed(pw) for v in pair))
    return torch.nn.functional.pad(x, flat)
kernel_name = 'adaLN_cond__ssm_conv_s4__mixer_gmlp__prompt'

def setup_inputs():

    _w = lambda a: (lambda t: t.to(torch.bfloat16) if t.is_floating_point() else t)(torch.as_tensor(a))

    def _A_setup():
        B, L, D, N = (1, 2048, 576, 128)
        A_re = -(lambda _x: torch.exp(torch.as_tensor(_x)))((lambda *s: torch.randn(*s, dtype=torch.bfloat16) * 3.2)(D, N))
        A_im = torch.pi * (lambda *s: torch.randn(*s, dtype=torch.bfloat16) * 0.1)(D, N)
        B_re = (lambda *s: torch.randn(*s, dtype=torch.bfloat16) * 0.2)(D, N)
        B_im = (lambda *s: torch.randn(*s, dtype=torch.bfloat16) * 0.2)(D, N)
        C_re = (lambda *s: torch.randn(*s, dtype=torch.bfloat16) * 0.2)(D, N)
        C_im = (lambda *s: torch.randn(*s, dtype=torch.bfloat16) * 0.2)(D, N)
        log_dt = (lambda *s: torch.randn(*s, dtype=torch.bfloat16) * 0.1)(D) * 0.5 - 4.0
        Dskip = (lambda *s: torch.randn(*s, dtype=torch.bfloat16) * 0.2)(D)
        return {'u': _w((lambda *s: torch.randn(*s, dtype=torch.bfloat16) * 0.05)(B, L, D)), 'A_re': _w(A_re), 'A_im': _w(A_im), 'B_re': _w(B_re), 'B_im': _w(B_im), 'C_re': _w(C_re), 'C_im': _w(C_im), 'log_dt': _w(log_dt), 'Dskip': _w(Dskip)}
    _A_in = _A_setup()

    def _B_setup():
        B, S, D, F = (1, 2048, 576, 4608)
        Fh = F // 2
        return {'x': _w((lambda *s: torch.randn(*s, dtype=torch.bfloat16) * 0.05)(B, S, D)), 'w_in': _w((lambda *s: torch.randn(*s, dtype=torch.bfloat16) * 0.2)(D, 2 * Fh)), 'w_sp': _w(0.01 * (lambda *s: torch.randn(*s, dtype=torch.bfloat16) * 0.2)(S, S)), 'b_sp': _w(1.0 + 0.01 * (lambda *s: torch.randn(*s, dtype=torch.bfloat16) * 0.05)(S)), 'w_out': _w((lambda *s: torch.randn(*s, dtype=torch.bfloat16) * 0.05)(Fh, D))}
    _B_in = _B_setup()
    return {'A_u': _A_in['u'], 'A_A_re': _A_in['A_re'], 'A_A_im': _A_in['A_im'], 'A_B_re': _A_in['B_re'], 'A_B_im': _A_in['B_im'], 'A_C_re': _A_in['C_re'], 'A_C_im': _A_in['C_im'], 'A_log_dt': _A_in['log_dt'], 'A_Dskip': _A_in['Dskip'], 'B_x': _B_in['x'], 'B_w_in': _B_in['w_in'], 'B_w_sp': _B_in['w_sp'], 'B_b_sp': _B_in['b_sp'], 'B_w_out': _B_in['w_out'], 'c': _w((lambda *s: torch.randn(*s, dtype=torch.bfloat16) * 0.1)(1, 576) * 8.0), 'w_mod': _w((lambda *s: torch.randn(*s, dtype=torch.bfloat16) * 0.1)(576, 6 * 576) * 576 ** (-0.5) * 8.0)}

def reference(A_u, A_A_re, A_A_im, A_B_re, A_B_im, A_C_re, A_C_im, A_log_dt, A_Dskip, B_x, B_w_in, B_w_sp, B_b_sp, B_w_out, c, w_mod):

    def _A_ref(u, A_re, A_im, B_re, B_im, C_re, C_im, log_dt, Dskip):
        Bsz, L, D = u.shape
        dt = torch.exp(log_dt)[:, None]
        A = A_re + 1j * A_im
        Bc = B_re + 1j * B_im
        Cc = C_re + 1j * C_im
        logdA = dt * A
        dB = dt * Bc
        l = (lambda x, dt: x.to(dt))(torch.arange(L), A_re.dtype)
        P = torch.exp(logdA[:, :, None] * l[None, None, :])
        K = torch.einsum('dn,dnl,dn->dl', Cc, P, dB).real
        L2 = 2 * L
        Kp = _pad(K, ((0, 0), (0, L)))
        up = (lambda x, *d: x.permute(*d))(u, 0, 2, 1)
        up = _pad(up, ((0, 0), (0, 0), (0, L)))
        Kf = (lambda x, axes=(-2, -1): torch.fft.rfft2(x.float(), dim=axes))(Kp[:, None, :], axes=(-2, -1))
        Uf = (lambda x, axes=(-2, -1): torch.fft.rfft2(x.float(), dim=axes))(up[:, :, None, :], axes=(-2, -1))
        Yf = Uf * Kf[None, :, :, :]
        y = (lambda x, s, axes=(-2, -1): torch.fft.irfft2(x, s=s, dim=axes).to(torch.bfloat16))(Yf, (1, L2), axes=(-2, -1))[:, :, 0, :L]
        y = (lambda x, *d: x.permute(*d))(y, 0, 2, 1) + u * Dskip[None, None, :]
        return y

    def _B_ref(x, w_in, w_sp, b_sp, w_out):
        B, S, D = x.shape
        F = w_in.shape[-1]
        Fh = F // 2
        z = _gelu(torch.einsum('bsd,df->bsf', x, w_in))
        z1 = z[..., :Fh].clone()
        z2 = _layernorm(z[..., Fh:], axis=-1)
        g = torch.einsum('ts,bsf->btf', w_sp, z2) + b_sp[None, :, None]
        return torch.einsum('bsf,fd->bsd', z1 * g, w_out)
    x = A_u
    mod = (_silu(c) @ w_mod).reshape(c.shape[0], 6, 1, -1)
    sa, ca, ga, sb, cb, gb = (mod[:, 0].clone(), mod[:, 1].clone(), mod[:, 2].clone(), mod[:, 3].clone(), mod[:, 4].clone(), mod[:, 5].clone())
    h = _layernorm(x, axis=-1) * (1 + ca) + sa
    x = x + ga * _A_ref(h, A_A_re, A_A_im, A_B_re, A_B_im, A_C_re, A_C_im, A_log_dt, A_Dskip)
    h = _layernorm(x, axis=-1) * (1 + cb) + sb
    x = x + gb * _B_ref(h, B_w_in, B_w_sp, B_b_sp, B_w_out)
    return x
```

```asm
; @launch kernel=k0_kernel grid=(460,1,1) block=(256,1,1) lds=60192
; @launch kernel=k1_kernel grid=(936,1,1) block=(256,1,1) lds=37888
; @launch kernel=kg_kernel grid=(256,1,1) block=(256,1,1) lds=161024
.amdgcn_target "amdgcn-amd-amdhsa--gfx950"
.text
.globl k0_kernel
.p2align 8
.type k0_kernel,@function
k0_kernel:
  s_cmp_ge_u32 s2, 64
  s_cbranch_scc1 k0_kernel_pf_1
  s_getpc_b64 s[4:5]
k0_kernel_pc:
  s_mov_b32 s6, k0_kernel_codeend-k0_kernel_pc-4
  v_lshlrev_b32 v1, 7, v0
  v_min_u32 v2, s6, v1
  global_load_dword v112, v2, s[4:5]
k0_kernel_pf_1:
  s_sub_u32 s3, s2, 0
  s_cmp_lt_u32 s2, 288
  s_cbranch_scc1 k0_kgen
  s_sub_u32 s3, s2, 288
  s_cmp_lt_u32 s2, 352
  s_cbranch_scc1 k0_T
  s_sub_u32 s3, s2, 352
  s_cmp_lt_u32 s2, 460
  s_cbranch_scc1 k0_mod
  s_branch k0_kernel_exit
k0_kgen:
  s_load_dwordx8 s[4:11], s[0:1], 8
  s_load_dwordx4 s[12:15], s[0:1], 40
  s_load_dwordx2 s[16:17], s[0:1], 56
  s_load_dwordx2 s[24:25], s[0:1], 144
  s_lshl_b32 s22, s3, 8
  v_add_u32 v4, s22, v0
  v_lshlrev_b32 v4, 1, v4
  v_lshrrev_b32 v2, 7, v0
  s_lshl_b32 s23, s3, 1
  v_add_u32 v3, s23, v2
  v_lshlrev_b32 v3, 1, v3
  s_waitcnt lgkmcnt(0)
  global_load_ushort v14, v3, s[16:17]
  global_load_ushort v8, v4, s[4:5]
  global_load_ushort v9, v4, s[6:7]
  global_load_ushort v10, v4, s[8:9]
  global_load_ushort v11, v4, s[10:11]
  global_load_ushort v12, v4, s[12:13]
  global_load_ushort v13, v4, s[14:15]
  s_and_b32 s25, s25, 0xffff
  s_mov_b32 s26, 67108864
  s_mov_b32 s27, 0x20000
  v_and_b32 v1, 127, v0
  v_lshlrev_b32 v5, 2, v1
  v_mul_u32_u24 v6, 30096, v2
  v_add_u32 v5, v5, v6
  s_waitcnt vmcnt(0)
  v_lshlrev_b32 v14, 16, v14
  v_mul_f32 v15, 0x3fb8aa3b, v14
  s_mov_b32 s22, 0x3fb8aa3b
  v_fma_f32 v16, v14, s22, -v15
  v_fmac_f32 v16, 0x32a57060, v14
  v_exp_f32 v15, v15
  v_mul_f32 v16, 0x3f317218, v16
  v_lshlrev_b32 v8, 16, v8
  v_lshlrev_b32 v9, 16, v9
  v_lshlrev_b32 v10, 16, v10
  v_lshlrev_b32 v11, 16, v11
  v_lshlrev_b32 v12, 16, v12
  v_lshlrev_b32 v13, 16, v13
  v_fma_f32 v15, v15, v16, v15
  v_cvt_pk_bf16_f32 v15, v15, v15
  v_and_b32 v15, 0xffff0000, v15
  v_mul_f32 v8, v15, v8
  v_mul_f32 v9, v15, v9
  v_mul_f32 v8, 0x3fb8aa3b, v8
  v_mul_f32 v9, 0x3e22f983, v9
  v_mul_f32 v10, v15, v10
  v_mul_f32 v11, v15, v11
  v_mul_f32 v18, v12, v10
  v_fma_f32 v18, -v13, v11, v18
  v_mul_f32 v19, v12, v11
  v_fma_f32 v19, v13, v10, v19
  v_exp_f32 v26, v8
  v_fract_f32 v27, v9
  v_cos_f32 v20, v27
  v_sin_f32 v21, v27
  v_mul_f32 v20, v26, v20
  v_mul_f32 v21, v26, v21
  v_mul_f32 v16, 0x41000000, v8
  v_mul_f32 v17, 0x41000000, v9
  v_exp_f32 v26, v16
  v_fract_f32 v27, v17
  v_cos_f32 v22, v27
  v_sin_f32 v23, v27
  v_mul_f32 v22, v26, v22
  v_mul_f32 v23, v26, v23
  v_mul_f32 v16, 0x43000000, v8
  v_mul_f32 v17, 0x43000000, v9
  v_exp_f32 v26, v16
  v_fract_f32 v27, v17
  v_cos_f32 v24, v27
  v_sin_f32 v25, v27
  v_mul_f32 v24, v26, v24
  v_mul_f32 v25, v26, v25
  v_mov_b32 v68, 0x00003f80
  ds_write_b32 v5, v68 offset:0
  v_cvt_pk_bf16_f32 v60, v20, v21
  v_cvt_pk_bf16_f32 v61, v18, -v19
  v_cvt_pk_bf16_f32 v62, v24, v25
  ds_write_b32 v5, v60 offset:528
  ds_write_b32 v5, v61 offset:21648
  ds_write_b32 v5, v62 offset:4224
  v_pk_mul_f32 v[30:31], v[20:21], v[20:21] op_sel:[0,0] op_sel_hi:[0,1]
  v_pk_mul_f32 v[28:29], v[18:19], v[22:23] op_sel:[0,0] op_sel_hi:[0,1]
  v_pk_mul_f32 v[42:43], v[24:25], v[24:25] op_sel:[0,0] op_sel_hi:[0,1]
  v_pk_fma_f32 v[30:31], v[20:21], v[20:21], v[30:31] op_sel:[1,1,0] op_sel_hi:[1,0,1] neg_lo:[0,1,0]
  v_pk_fma_f32 v[28:29], v[18:19], v[22:23], v[28:29] op_sel:[1,1,0] op_sel_hi:[1,0,1] neg_lo:[0,1,0]
  v_pk_fma_f32 v[42:43], v[24:25], v[24:25], v[42:43] op_sel:[1,1,0] op_sel_hi:[1,0,1] neg_lo:[0,1,0]
  v_cvt_pk_bf16_f32 v60, v30, v31
  v_cvt_pk_bf16_f32 v61, v28, -v29
  v_cvt_pk_bf16_f32 v62, v42, v43
  ds_write_b32 v5, v60 offset:1056
  ds_write_b32 v5, v61 offset:22176
  ds_write_b32 v5, v62 offset:8448
  v_pk_mul_f32 v[32:33], v[30:31], v[20:21] op_sel:[0,0] op_sel_hi:[0,1]
  v_pk_mul_f32 v[18:19], v[28:29], v[22:23] op_sel:[0,0] op_sel_hi:[0,1]
  v_pk_mul_f32 v[44:45], v[42:43], v[24:25] op_sel:[0,0] op_sel_hi:[0,1]
  v_pk_fma_f32 v[32:33], v[30:31], v[20:21], v[32:33] op_sel:[1,1,0] op_sel_hi:[1,0,1] neg_lo:[0,1,0]
  v_pk_fma_f32 v[18:19], v[28:29], v[22:23], v[18:19] op_sel:[1,1,0] op_sel_hi:[1,0,1] neg_lo:[0,1,0]
  v_pk_fma_f32 v[44:45], v[42:43], v[24:25], v[44:45] op_sel:[1,1,0] op_sel_hi:[1,0,1] neg_lo:[0,1,0]
  v_cvt_pk_bf16_f32 v60, v32, v33
  v_cvt_pk_bf16_f32 v61, v18, -v19
  v_cvt_pk_bf16_f32 v62, v44, v45
  ds_write_b32 v5, v60 offset:1584
  ds_write_b32 v5, v61 offset:22704
  ds_write_b32 v5, v62 offset:10560
  v_pk_mul_f32 v[34:35], v[32:33], v[20:21] op_sel:[0,0] op_sel_hi:[0,1]
  v_pk_mul_f32 v[28:29], v[18:19], v[22:23] op_sel:[0,0] op_sel_hi:[0,1]
  v_pk_mul_f32 v[46:47], v[44:45], v[24:25] op_sel:[0,0] op_sel_hi:[0,1]
  v_pk_fma_f32 v[34:35], v[32:33], v[20:21], v[34:35] op_sel:[1,1,0] op_sel_hi:[1,0,1] neg_lo:[0,1,0]
  v_pk_fma_f32 v[28:29], v[18:19], v[22:23], v[28:29] op_sel:[1,1,0] op_sel_hi:[1,0,1] neg_lo:[0,1,0]
  v_pk_fma_f32 v[46:47], v[44:45], v[24:25], v[46:47] op_sel:[1,1,0] op_sel_hi:[1,0,1] neg_lo:[0,1,0]
  v_cvt_pk_bf16_f32 v60, v34, v35
  v_cvt_pk_bf16_f32 v61, v28, -v29
  v_cvt_pk_bf16_f32 v62, v46, v47
  ds_write_b32 v5, v60 offset:2112
  ds_write_b32 v5, v61 offset:23232
  ds_write_b32 v5, v62 offset:12672
  v_pk_mul_f32 v[36:37], v[34:35], v[20:21] op_sel:[0,0] op_sel_hi:[0,1]
  v_pk_mul_f32 v[18:19], v[28:29], v[22:23] op_sel:[0,0] op_sel_hi:[0,1]
  v_pk_mul_f32 v[48:49], v[46:47], v[24:25] op_sel:[0,0] op_sel_hi:[0,1]
  v_pk_fma_f32 v[36:37], v[34:35], v[20:21], v[36:37] op_sel:[1,1,0] op_sel_hi:[1,0,1] neg_lo:[0,1,0]
  v_pk_fma_f32 v[18:19], v[28:29], v[22:23], v[18:19] op_sel:[1,1,0] op_sel_hi:[1,0,1] neg_lo:[0,1,0]
  v_pk_fma_f32 v[48:49], v[46:47], v[24:25], v[48:49] op_sel:[1,1,0] op_sel_hi:[1,0,1] neg_lo:[0,1,0]
  v_cvt_pk_bf16_f32 v60, v36, v37
  v_cvt_pk_bf16_f32 v61, v18, -v19
  v_cvt_pk_bf16_f32 v62, v48, v49
  ds_write_b32 v5, v60 offset:2640
  ds_write_b32 v5, v61 offset:23760
  ds_write_b32 v5, v62 offset:13728
  v_pk_mul_f32 v[38:39], v[36:37], v[20:21] op_sel:[0,0] op_sel_hi:[0,1]
  v_pk_mul_f32 v[28:29], v[18:19], v[22:23] op_sel:[0,0] op_sel_hi:[0,1]
  v_pk_mul_f32 v[50:51], v[48:49], v[24:25] op_sel:[0,0] op_sel_hi:[0,1]
  v_pk_fma_f32 v[38:39], v[36:37], v[20:21], v[38:39] op_sel:[1,1,0] op_sel_hi:[1,0,1] neg_lo:[0,1,0]
  v_pk_fma_f32 v[28:29], v[18:19], v[22:23], v[28:29] op_sel:[1,1,0] op_sel_hi:[1,0,1] neg_lo:[0,1,0]
  v_pk_fma_f32 v[50:51], v[48:49], v[24:25], v[50:51] op_sel:[1,1,0] op_sel_hi:[1,0,1] neg_lo:[0,1,0]
  v_cvt_pk_bf16_f32 v60, v38, v39
  v_cvt_pk_bf16_f32 v61, v28, -v29
  v_cvt_pk_bf16_f32 v62, v50, v51
  ds_write_b32 v5, v60 offset:3168
  ds_write_b32 v5, v61 offset:24288
  ds_write_b32 v5, v62 offset:14784
  v_pk_mul_f32 v[40:41], v[38:39], v[20:21] op_sel:[0,0] op_sel_hi:[0,1]
  v_pk_mul_f32 v[18:19], v[28:29], v[22:23] op_sel:[0,0] op_sel_hi:[0,1]
  v_pk_mul_f32 v[52:53], v[50:51], v[24:25] op_sel:[0,0] op_sel_hi:[0,1]
  v_pk_fma_f32 v[40:41], v[38:39], v[20:21], v[40:41] op_sel:[1,1,0] op_sel_hi:[1,0,1] neg_lo:[0,1,0]
  v_pk_fma_f32 v[18:19], v[28:29], v[22:23], v[18:19] op_sel:[1,1,0] op_sel_hi:[1,0,1] neg_lo:[0,1,0]
  v_pk_fma_f32 v[52:53], v[50:51], v[24:25], v[52:53] op_sel:[1,1,0] op_sel_hi:[1,0,1] neg_lo:[0,1,0]
  v_cvt_pk_bf16_f32 v60, v40, v41
  v_cvt_pk_bf16_f32 v61, v18, -v19
  v_cvt_pk_bf16_f32 v62, v52, v53
  ds_write_b32 v5, v60 offset:3696
  ds_write_b32 v5, v61 offset:24816
  ds_write_b32 v5, v62 offset:15840
  v_pk_mul_f32 v[28:29], v[18:19], v[22:23] op_sel:[0,0] op_sel_hi:[0,1]
  v_pk_fma_f32 v[28:29], v[18:19], v[22:23], v[28:29] op_sel:[1,1,0] op_sel_hi:[1,0,1] neg_lo:[0,1,0]
  v_cvt_pk_bf16_f32 v61, v28, -v29
  ds_write_b32 v5, v61 offset:25344
  v_pk_mul_f32 v[18:19], v[28:29], v[22:23] op_sel:[0,0] op_sel_hi:[0,1]
  v_pk_mul_f32 v[54:55], v[52:53], v[24:25] op_sel:[0,0] op_sel_hi:[0,1]
  v_pk_mul_f32 v[58:59], v[24:25], v[20:21] op_sel:[0,0] op_sel_hi:[0,1]
  v_pk_mul_f32 v[64:65], v[24:25], v[30:31] op_sel:[0,0] op_sel_hi:[0,1]
  v_pk_fma_f32 v[18:19], v[28:29], v[22:23], v[18:19] op_sel:[1,1,0] op_sel_hi:[1,0,1] neg_lo:[0,1,0]
  v_pk_fma_f32 v[54:55], v[52:53], v[24:25], v[54:55] op_sel:[1,1,0] op_sel_hi:[1,0,1] neg_lo:[0,1,0]
  v_pk_fma_f32 v[58:59], v[24:25], v[20:21], v[58:59] op_sel:[1,1,0] op_sel_hi:[1,0,1] neg_lo:[0,1,0]
  v_pk_fma_f32 v[64:65], v[24:25], v[30:31], v[64:65] op_sel:[1,1,0] op_sel_hi:[1,0,1] neg_lo:[0,1,0]
  v_cvt_pk_bf16_f32 v61, v18, -v19
  v_cvt_pk_bf16_f32 v62, v54, v55
  v_cvt_pk_bf16_f32 v63, v58, v59
  v_cvt_pk_bf16_f32 v66, v64, v65
  ds_write_b32 v5, v61 offset:25872
  ds_write_b32 v5, v62 offset:16896
  ds_write_b32 v5, v63 offset:4752
  ds_write_b32 v5, v66 offset:5280
  v_pk_mul_f32 v[28:29], v[18:19], v[22:23] op_sel:[0,0] op_sel_hi:[0,1]
  v_pk_mul_f32 v[56:57], v[54:55], v[24:25] op_sel:[0,0] op_sel_hi:[0,1]
  v_pk_mul_f32 v[58:59], v[24:25], v[32:33] op_sel:[0,0] op_sel_hi:[0,1]
  v_pk_mul_f32 v[64:65], v[24:25], v[34:35] op_sel:[0,0] op_sel_hi:[0,1]
  v_pk_fma_f32 v[28:29], v[18:19], v[22:23], v[28:29] op_sel:[1,1,0] op_sel_hi:[1,0,1] neg_lo:[0,1,0]
  v_pk_fma_f32 v[56:57], v[54:55], v[24:25], v[56:57] op_sel:[1,1,0] op_sel_hi:[1,0,1] neg_lo:[0,1,0]
  v_pk_fma_f32 v[58:59], v[24:25], v[32:33], v[58:59] op_sel:[1,1,0] op_sel_hi:[1,0,1] neg_lo:[0,1,0]
  v_pk_fma_f32 v[64:65], v[24:25], v[34:35], v[64:65] op_sel:[1,1,0] op_sel_hi:[1,0,1] neg_lo:[0,1,0]
  v_cvt_pk_bf16_f32 v61, v28, -v29
  v_cvt_pk_bf16_f32 v62, v56, v57
  v_cvt_pk_bf16_f32 v63, v58, v59
  v_cvt_pk_bf16_f32 v66, v64, v65
  ds_write_b32 v5, v61 offset:26400
  ds_write_b32 v5, v62 offset:17424
  ds_write_b32 v5, v63 offset:5808
  ds_write_b32 v5, v66 offset:6336
  v_pk_mul_f32 v[18:19], v[28:29], v[22:23] op_sel:[0,0] op_sel_hi:[0,1]
  v_pk_mul_f32 v[54:55], v[56:57], v[24:25] op_sel:[0,0] op_sel_hi:[0,1]
  v_pk_mul_f32 v[58:59], v[24:25], v[36:37] op_sel:[0,0] op_sel_hi:[0,1]
  v_pk_mul_f32 v[64:65], v[24:25], v[38:39] op_sel:[0,0] op_sel_hi:[0,1]
  v_pk_fma_f32 v[18:19], v[28:29], v[22:23], v[18:19] op_sel:[1,1,0] op_sel_hi:[1,0,1] neg_lo:[0,1,0]
  v_pk_fma_f32 v[54:55], v[56:57], v[24:25], v[54:55] op_sel:[1,1,0] op_sel_hi:[1,0,1] neg_lo:[0,1,0]
  v_pk_fma_f32 v[58:59], v[24:25], v[36:37], v[58:59] op_sel:[1,1,0] op_sel_hi:[1,0,1] neg_lo:[0,1,0]
  v_pk_fma_f32 v[64:65], v[24:25], v[38:39], v[64:65] op_sel:[1,1,0] op_sel_hi:[1,0,1] neg_lo:[0,1,0]
  v_cvt_pk_bf16_f32 v61, v18, -v19
  v_cvt_pk_bf16_f32 v62, v54, v55
  v_cvt_pk_bf16_f32 v63, v58, v59
  v_cvt_pk_bf16_f32 v66, v64, v65
  ds_write_b32 v5, v61 offset:26928
  ds_write_b32 v5, v62 offset:17952
  ds_write_b32 v5, v63 offset:6864
  ds_write_b32 v5, v66 offset:7392
  v_pk_mul_f32 v[28:29], v[18:19], v[22:23] op_sel:[0,0] op_sel_hi:[0,1]
  v_pk_mul_f32 v[56:57], v[54:55], v[24:25] op_sel:[0,0] op_sel_hi:[0,1]
  v_pk_mul_f32 v[58:59], v[24:25], v[40:41] op_sel:[0,0] op_sel_hi:[0,1]
  v_pk_mul_f32 v[64:65], v[42:43], v[30:31] op_sel:[0,0] op_sel_hi:[0,1]
  v_pk_fma_f32 v[28:29], v[18:19], v[22:23], v[28:29] op_sel:[1,1,0] op_sel_hi:[1,0,1] neg_lo:[0,1,0]
  v_pk_fma_f32 v[56:57], v[54:55], v[24:25], v[56:57] op_sel:[1,1,0] op_sel_hi:[1,0,1] neg_lo:[0,1,0]
  v_pk_fma_f32 v[58:59], v[24:25], v[40:41], v[58:59] op_sel:[1,1,0] op_sel_hi:[1,0,1] neg_lo:[0,1,0]
  v_pk_fma_f32 v[64:65], v[42:43], v[30:31], v[64:65] op_sel:[1,1,0] op_sel_hi:[1,0,1] neg_lo:[0,1,0]
  v_cvt_pk_bf16_f32 v61, v28, -v29
  v_cvt_pk_bf16_f32 v62, v56, v57
  v_cvt_pk_bf16_f32 v63, v58, v59
  v_cvt_pk_bf16_f32 v66, v64, v65
  ds_write_b32 v5, v61 offset:27456
  ds_write_b32 v5, v62 offset:18480
  ds_write_b32 v5, v63 offset:7920
  ds_write_b32 v5, v66 offset:8976
  v_pk_mul_f32 v[18:19], v[28:29], v[22:23] op_sel:[0,0] op_sel_hi:[0,1]
  v_pk_mul_f32 v[54:55], v[56:57], v[24:25] op_sel:[0,0] op_sel_hi:[0,1]
  v_pk_mul_f32 v[58:59], v[42:43], v[34:35] op_sel:[0,0] op_sel_hi:[0,1]
  v_pk_mul_f32 v[64:65], v[42:43], v[38:39] op_sel:[0,0] op_sel_hi:[0,1]
  v_pk_fma_f32 v[18:19], v[28:29], v[22:23], v[18:19] op_sel:[1,1,0] op_sel_hi:[1,0,1] neg_lo:[0,1,0]
  v_pk_fma_f32 v[54:55], v[56:57], v[24:25], v[54:55] op_sel:[1,1,0] op_sel_hi:[1,0,1] neg_lo:[0,1,0]
  v_pk_fma_f32 v[58:59], v[42:43], v[34:35], v[58:59] op_sel:[1,1,0] op_sel_hi:[1,0,1] neg_lo:[0,1,0]
  v_pk_fma_f32 v[64:65], v[42:43], v[38:39], v[64:65] op_sel:[1,1,0] op_sel_hi:[1,0,1] neg_lo:[0,1,0]
  v_cvt_pk_bf16_f32 v61, v18, -v19
  v_cvt_pk_bf16_f32 v62, v54, v55
  v_cvt_pk_bf16_f32 v63, v58, v59
  v_cvt_pk_bf16_f32 v66, v64, v65
  ds_write_b32 v5, v61 offset:27984
  ds_write_b32 v5, v62 offset:19008
  ds_write_b32 v5, v63 offset:9504
  ds_write_b32 v5, v66 offset:10032
  v_pk_mul_f32 v[28:29], v[18:19], v[22:23] op_sel:[0,0] op_sel_hi:[0,1]
  v_pk_mul_f32 v[56:57], v[54:55], v[24:25] op_sel:[0,0] op_sel_hi:[0,1]
  v_pk_mul_f32 v[58:59], v[44:45], v[30:31] op_sel:[0,0] op_sel_hi:[0,1]
  v_pk_mul_f32 v[64:65], v[44:45], v[34:35] op_sel:[0,0] op_sel_hi:[0,1]
  v_pk_fma_f32 v[28:29], v[18:19], v[22:23], v[28:29] op_sel:[1,1,0] op_sel_hi:[1,0,1] neg_lo:[0,1,0]
  v_pk_fma_f32 v[56:57], v[54:55], v[24:25], v[56:57] op_sel:[1,1,0] op_sel_hi:[1,0,1] neg_lo:[0,1,0]
  v_pk_fma_f32 v[58:59], v[44:45], v[30:31], v[58:59] op_sel:[1,1,0] op_sel_hi:[1,0,1] neg_lo:[0,1,0]
  v_pk_fma_f32 v[64:65], v[44:45], v[34:35], v[64:65] op_sel:[1,1,0] op_sel_hi:[1,0,1] neg_lo:[0,1,0]
  v_cvt_pk_bf16_f32 v61, v28, -v29
  v_cvt_pk_bf16_f32 v62, v56, v57
  v_cvt_pk_bf16_f32 v63, v58, v59
  v_cvt_pk_bf16_f32 v66, v64, v65
  ds_write_b32 v5, v61 offset:28512
  ds_write_b32 v5, v62 offset:19536
  ds_write_b32 v5, v63 offset:11088
  ds_write_b32 v5, v66 offset:11616
  v_pk_mul_f32 v[18:19], v[28:29], v[22:23] op_sel:[0,0] op_sel_hi:[0,1]
  v_pk_mul_f32 v[54:55], v[56:57], v[24:25] op_sel:[0,0] op_sel_hi:[0,1]
  v_pk_mul_f32 v[58:59], v[44:45], v[38:39] op_sel:[0,0] op_sel_hi:[0,1]
  v_pk_mul_f32 v[64:65], v[46:47], v[34:35] op_sel:[0,0] op_sel_hi:[0,1]
  v_pk_fma_f32 v[18:19], v[28:29], v[22:23], v[18:19] op_sel:[1,1,0] op_sel_hi:[1,0,1] neg_lo:[0,1,0]
  v_pk_fma_f32 v[54:55], v[56:57], v[24:25], v[54:55] op_sel:[1,1,0] op_sel_hi:[1,0,1] neg_lo:[0,1,0]
  v_pk_fma_f32 v[58:59], v[44:45], v[38:39], v[58:59] op_sel:[1,1,0] op_sel_hi:[1,0,1] neg_lo:[0,1,0]
  v_pk_fma_f32 v[64:65], v[46:47], v[34:35], v[64:65] op_sel:[1,1,0] op_sel_hi:[1,0,1] neg_lo:[0,1,0]
  v_cvt_pk_bf16_f32 v61, v18, -v19
  v_cvt_pk_bf16_f32 v62, v54, v55
  v_cvt_pk_bf16_f32 v63, v58, v59
  v_cvt_pk_bf16_f32 v66, v64, v65
  ds_write_b32 v5, v61 offset:29040
  ds_write_b32 v5, v62 offset:20064
  ds_write_b32 v5, v63 offset:12144
  ds_write_b32 v5, v66 offset:13200
  v_pk_mul_f32 v[28:29], v[18:19], v[22:23] op_sel:[0,0] op_sel_hi:[0,1]
  v_pk_mul_f32 v[56:57], v[54:55], v[24:25] op_sel:[0,0] op_sel_hi:[0,1]
  v_pk_mul_f32 v[58:59], v[48:49], v[34:35] op_sel:[0,0] op_sel_hi:[0,1]
  v_pk_mul_f32 v[64:65], v[50:51], v[34:35] op_sel:[0,0] op_sel_hi:[0,1]
  v_pk_fma_f32 v[28:29], v[18:19], v[22:23], v[28:29] op_sel:[1,1,0] op_sel_hi:[1,0,1] neg_lo:[0,1,0]
  v_pk_fma_f32 v[56:57], v[54:55], v[24:25], v[56:57] op_sel:[1,1,0] op_sel_hi:[1,0,1] neg_lo:[0,1,0]
  v_pk_fma_f32 v[58:59], v[48:49], v[34:35], v[58:59] op_sel:[1,1,0] op_sel_hi:[1,0,1] neg_lo:[0,1,0]
  v_pk_fma_f32 v[64:65], v[50:51], v[34:35], v[64:65] op_sel:[1,1,0] op_sel_hi:[1,0,1] neg_lo:[0,1,0]
  v_cvt_pk_bf16_f32 v61, v28, -v29
  v_cvt_pk_bf16_f32 v62, v56, v57
  v_cvt_pk_bf16_f32 v63, v58, v59
  v_cvt_pk_bf16_f32 v66, v64, v65
  ds_write_b32 v5, v61 offset:29568
  ds_write_b32 v5, v62 offset:20592
  ds_write_b32 v5, v63 offset:14256
  ds_write_b32 v5, v66 offset:15312
  v_pk_mul_f32 v[54:55], v[56:57], v[24:25] op_sel:[0,0] op_sel_hi:[0,1]
  v_pk_mul_f32 v[58:59], v[52:53], v[34:35] op_sel:[0,0] op_sel_hi:[0,1]
  v_pk_fma_f32 v[54:55], v[56:57], v[24:25], v[54:55] op_sel:[1,1,0] op_sel_hi:[1,0,1] neg_lo:[0,1,0]
  v_pk_fma_f32 v[58:59], v[52:53], v[34:35], v[58:59] op_sel:[1,1,0] op_sel_hi:[1,0,1] neg_lo:[0,1,0]
  v_cvt_pk_bf16_f32 v62, v54, v55
  v_cvt_pk_bf16_f32 v63, v58, v59
  ds_write_b32 v5, v62 offset:21120
  ds_write_b32 v5, v63 offset:16368
  s_waitcnt lgkmcnt(0)
  s_barrier
  v_and_b32 v1, 63, v0
  v_and_b32 v7, 15, v1
  v_lshrrev_b32 v3, 4, v1
  v_mul_u32_u24 v4, 528, v7
  v_lshl_add_u32 v4, v3, 4, v4
  v_add_u32 v4, v4, v6
  v_lshrrev_b32 v5, 6, v0
  s_nop 0
  v_readfirstlane_b32 s22, v5
  s_nop 0
  s_and_b32 s23, s22, 1
  ds_read_b128 v[8:11], v4 offset:21648
  ds_read_b128 v[12:15], v4 offset:21712
  ds_read_b128 v[16:19], v4 offset:21776
  ds_read_b128 v[20:23], v4 offset:21840
  ds_read_b128 v[24:27], v4 offset:21904
  ds_read_b128 v[28:31], v4 offset:21968
  ds_read_b128 v[32:35], v4 offset:22032
  ds_read_b128 v[36:39], v4 offset:22096
  s_cmp_eq_u32 s23, 1
  s_cbranch_scc1 kg_t2_2
  ds_read_b128 v[40:43], v4 offset:0
  ds_read_b128 v[44:47], v4 offset:64
  ds_read_b128 v[48:51], v4 offset:128
  ds_read_b128 v[52:55], v4 offset:192
  ds_read_b128 v[56:59], v4 offset:256
  ds_read_b128 v[60:63], v4 offset:320
  ds_read_b128 v[64:67], v4 offset:384
  ds_read_b128 v[68:71], v4 offset:448
  ds_read_b128 v[72:75], v4 offset:8448
  ds_read_b128 v[76:79], v4 offset:8512
  ds_read_b128 v[80:83], v4 offset:8576
  ds_read_b128 v[84:87], v4 offset:8640
  ds_read_b128 v[88:91], v4 offset:8704
  ds_read_b128 v[92:95], v4 offset:8768
  ds_read_b128 v[96:99], v4 offset:8832
  ds_read_b128 v[100:103], v4 offset:8896
  v_mov_b32 v104, 0
  v_mov_b32 v105, 0
  v_mov_b32 v106, 0
  v_mov_b32 v107, 0
  v_mov_b32 v108, 0
  v_mov_b32 v109, 0
  v_mov_b32 v110, 0
  v_mov_b32 v111, 0
  s_waitcnt lgkmcnt(15)
  v_mfma_f32_16x16x32_bf16 v[104:107], v[40:43], v[8:11], v[104:107]
  s_waitcnt lgkmcnt(14)
  v_mfma_f32_16x16x32_bf16 v[104:107], v[44:47], v[12:15], v[104:107]
  s_waitcnt lgkmcnt(13)
  v_mfma_f32_16x16x32_bf16 v[104:107], v[48:51], v[16:19], v[104:107]
  s_waitcnt lgkmcnt(12)
  v_mfma_f32_16x16x32_bf16 v[104:107], v[52:55], v[20:23], v[104:107]
  s_waitcnt lgkmcnt(11)
  v_mfma_f32_16x16x32_bf16 v[104:107], v[56:59], v[24:27], v[104:107]
  s_waitcnt lgkmcnt(10)
  v_mfma_f32_16x16x32_bf16 v[104:107], v[60:63], v[28:31], v[104:107]
  s_waitcnt lgkmcnt(9)
  v_mfma_f32_16x16x32_bf16 v[104:107], v[64:67], v[32:35], v[104:107]
  s_waitcnt lgkmcnt(8)
  v_mfma_f32_16x16x32_bf16 v[104:107], v[68:71], v[36:39], v[104:107]
  s_waitcnt lgkmcnt(7)
  v_mfma_f32_16x16x32_bf16 v[108:111], v[72:75], v[8:11], v[108:111]
  s_waitcnt lgkmcnt(6)
  v_mfma_f32_16x16x32_bf16 v[108:111], v[76:79], v[12:15], v[108:111]
  s_waitcnt lgkmcnt(5)
  v_mfma_f32_16x16x32_bf16 v[108:111], v[80:83], v[16:19], v[108:111]
  s_waitcnt lgkmcnt(4)
  v_mfma_f32_16x16x32_bf16 v[108:111], v[84:87], v[20:23], v[108:111]
  s_waitcnt lgkmcnt(3)
  v_mfma_f32_16x16x32_bf16 v[108:111], v[88:91], v[24:27], v[108:111]
  s_waitcnt lgkmcnt(2)
  v_mfma_f32_16x16x32_bf16 v[108:111], v[92:95], v[28:31], v[108:111]
  s_waitcnt lgkmcnt(1)
  v_mfma_f32_16x16x32_bf16 v[108:111], v[96:99], v[32:35], v[108:111]
  s_waitcnt lgkmcnt(0)
  v_mfma_f32_16x16x32_bf16 v[108:111], v[100:103], v[36:39], v[108:111]
  s_barrier
  v_lshrrev_b32 v8, 1, v3
  v_lshlrev_b32 v8, 7, v8
  v_and_b32 v9, 1, v3
  v_lshl_add_u32 v8, v9, 2, v8
  v_lshl_add_u32 v8, v7, 3, v8
  v_lshl_add_u32 v8, v8, 2, v6
  ds_write_b128 v8, v[104:107]
  v_lshlrev_b32 v9, 7, v3
  v_add_u32 v9, 256, v9
  v_lshlrev_b32 v10, 8, v3
  v_cmp_gt_u32 vcc, 2, v3
  s_nop 1
  v_cndmask_b32 v9, v10, v9, vcc
  v_lshl_add_u32 v9, v7, 3, v9
  v_lshl_add_u32 v9, v9, 2, v6
  v_mov_b32 v10, 0
  v_cndmask_b32 v10, v10, 0, vcc
  v_add_u32 v10, v10, v9
  ds_write_b32 v10, v108
  v_mov_b32 v10, 16
  v_cndmask_b32 v10, v10, 8, vcc
  v_add_u32 v10, v10, v9
  ds_write_b32 v10, v109
  v_mov_b32 v10, 512
  v_cndmask_b32 v10, v10, 16, vcc
  v_add_u32 v10, v10, v9
  ds_write_b32 v10, v110
  v_mov_b32 v10, 528
  v_cndmask_b32 v10, v10, 24, vcc
  v_add_u32 v10, v10, v9
  ds_write_b32 v10, v111
  s_branch kg_join_3
kg_t2_2:
  ds_read_b128 v[40:43], v4 offset:16896
  ds_read_b128 v[44:47], v4 offset:16960
  ds_read_b128 v[48:51], v4 offset:17024
  ds_read_b128 v[52:55], v4 offset:17088
  ds_read_b128 v[56:59], v4 offset:17152
  ds_read_b128 v[60:63], v4 offset:17216
  ds_read_b128 v[64:67], v4 offset:17280
  ds_read_b128 v[68:71], v4 offset:17344
  v_mov_b32 v104, 0
  v_mov_b32 v105, 0
  v_mov_b32 v106, 0
  v_mov_b32 v107, 0
  s_waitcnt lgkmcnt(7)
  s_nop 0
  v_mfma_f32_16x16x32_bf16 v[104:107], v[40:43], v[8:11], v[104:107]
  s_waitcnt lgkmcnt(6)
  v_mfma_f32_16x16x32_bf16 v[104:107], v[44:47], v[12:15], v[104:107]
  s_waitcnt lgkmcnt(5)
  v_mfma_f32_16x16x32_bf16 v[104:107], v[48:51], v[16:19], v[104:107]
  s_waitcnt lgkmcnt(4)
  v_mfma_f32_16x16x32_bf16 v[104:107], v[52:55], v[20:23], v[104:107]
  s_waitcnt lgkmcnt(3)
  v_mfma_f32_16x16x32_bf16 v[104:107], v[56:59], v[24:27], v[104:107]
  s_waitcnt lgkmcnt(2)
  v_mfma_f32_16x16x32_bf16 v[104:107], v[60:63], v[28:31], v[104:107]
  s_waitcnt lgkmcnt(1)
  v_mfma_f32_16x16x32_bf16 v[104:107], v[64:67], v[32:35], v[104:107]
  s_waitcnt lgkmcnt(0)
  v_mfma_f32_16x16x32_bf16 v[104:107], v[68:71], v[36:39], v[104:107]
  s_barrier
  v_lshlrev_b32 v8, 9, v3
  v_lshl_add_u32 v8, v7, 3, v8
  v_add_u32 v8, 1024, v8
  v_lshl_add_u32 v8, v8, 2, v6
  s_nop 2
  ds_write_b32 v8, v104 offset:0
  ds_write_b32 v8, v105 offset:512
  ds_write_b32 v8, v106 offset:1024
  ds_write_b32 v8, v107 offset:1536
kg_join_3:
  s_waitcnt lgkmcnt(0)
  s_barrier
  v_and_b32 v1, 127, v0
  s_lshl_b32 s22, s3, 13
  s_add_u32 s22, s22, 4194304
  v_lshlrev_b32 v4, 12, v2
  v_lshl_add_u32 v4, v1, 4, v4
  v_lshlrev_b32 v9, 5, v1
  v_add_u32 v9, v9, v6
  v_add_u32 v9, 4096, v9
  ds_read_b32 v24, v9
  ds_read_b32 v25, v9 offset:32
  v_cmp_lt_u32 vcc, 31, v1
  s_nop 1
  v_cndmask_b32 v8, 0, 1, vcc
  v_cmp_lt_u32 vcc, 63, v1
  s_nop 1
  v_cndmask_b32 v8, v8, 2, vcc
  v_lshlrev_b32 v9, 3, v1
  v_lshlrev_b32 v10, v8, -1
  v_min_u32 v11, 1, v8
  v_not_b32 v12, v10
  v_lshrrev_b32 v12, 1, v12
  v_add_u32 v13, 0, v9
  v_bfe_u32 v26, v13, v8, v11
  v_add3_u32 v13, v13, v12, v26
  v_and_b32 v13, v13, v10
  v_lshl_add_u32 v13, v13, 2, v6
  ds_read_b32 v16, v13
  v_add_u32 v14, 1, v9
  v_bfe_u32 v27, v14, v8, v11
  v_add3_u32 v14, v14, v12, v27
  v_and_b32 v14, v14, v10
  v_lshl_add_u32 v14, v14, 2, v6
  ds_read_b32 v17, v14
  v_add_u32 v13, 2, v9
  v_bfe_u32 v26, v13, v8, v11
  v_add3_u32 v13, v13, v12, v26
  v_and_b32 v13, v13, v10
  v_lshl_add_u32 v13, v13, 2, v6
  ds_read_b32 v18, v13
  v_add_u32 v14, 3, v9
  v_bfe_u32 v27, v14, v8, v11
  v_add3_u32 v14, v14, v12, v27
  v_and_b32 v14, v14, v10
  v_lshl_add_u32 v14, v14, 2, v6
  ds_read_b32 v19, v14
  v_add_u32 v13, 4, v9
  v_bfe_u32 v26, v13, v8, v11
  v_add3_u32 v13, v13, v12, v26
  v_and_b32 v13, v13, v10
  v_lshl_add_u32 v13, v13, 2, v6
  ds_read_b32 v20, v13
  v_add_u32 v14, 5, v9
  v_bfe_u32 v27, v14, v8, v11
  v_add3_u32 v14, v14, v12, v27
  v_and_b32 v14, v14, v10
  v_lshl_add_u32 v14, v14, 2, v6
  ds_read_b32 v21, v14
  v_add_u32 v13, 6, v9
  v_bfe_u32 v26, v13, v8, v11
  v_add3_u32 v13, v13, v12, v26
  v_and_b32 v13, v13, v10
  v_lshl_add_u32 v13, v13, 2, v6
  ds_read_b32 v22, v13
  v_add_u32 v14, 7, v9
  v_bfe_u32 v27, v14, v8, v11
  v_add3_u32 v14, v14, v12, v27
  v_and_b32 v14, v14, v10
  v_lshl_add_u32 v14, v14, 2, v6
  ds_read_b32 v23, v14
  v_and_b32 v8, 1, v1
  v_cmp_eq_u32 vcc, 0, v8
  s_waitcnt lgkmcnt(8)
  v_cvt_pk_bf16_f32 v36, v24, v24
  v_cvt_pk_bf16_f32 v39, v25, v25
  v_cndmask_b32 v26, v25, v24, vcc
  v_mov_b32 v37, v36
  v_cvt_pk_bf16_f32 v38, v26, v25
  buffer_store_dwordx4 v[36:39], v4, s[24:27], s22 offen offset:2048 sc1
  s_waitcnt lgkmcnt(0)
  v_cvt_pk_bf16_f32 v32, v16, v17
  v_cvt_pk_bf16_f32 v33, v18, v19
  v_cvt_pk_bf16_f32 v34, v20, v21
  v_cvt_pk_bf16_f32 v35, v22, v23
  buffer_store_dwordx4 v[32:35], v4, s[24:27], s22 offen sc1
  s_branch k0_kernel_exit
k0_T:
  s_setprio 2
  s_load_dwordx2 s[4:5], s[0:1], 0
  s_load_dwordx2 s[8:9], s[0:1], 144
  s_waitcnt lgkmcnt(0)
  s_and_b32 s5, s5, 0xffff
  s_mov_b32 s6, 2359296
  s_mov_b32 s7, 0x20000
  s_and_b32 s9, s9, 0xffff
  s_mov_b32 s10, 67108864
  s_mov_b32 s11, 0x20000
  s_mul_i32 s12, s3, 36864
  v_lshrrev_b32 v1, 3, v0
  v_and_b32 v2, 7, v0
  v_mul_u32_u24 v3, 1152, v1
  v_lshl_add_u32 v3, v2, 4, v3
  buffer_load_dwordx4 v[8:11], v3, s[4:7], s12 offen
  buffer_load_dwordx4 v[12:15], v3, s[4:7], s12 offen offset:128
  buffer_load_dwordx4 v[16:19], v3, s[4:7], s12 offen offset:256
  buffer_load_dwordx4 v[20:23], v3, s[4:7], s12 offen offset:384
  buffer_load_dwordx4 v[24:27], v3, s[4:7], s12 offen offset:512
  buffer_load_dwordx4 v[28:31], v3, s[4:7], s12 offen offset:640
  buffer_load_dwordx4 v[32:35], v3, s[4:7], s12 offen offset:768
  buffer_load_dwordx4 v[36:39], v3, s[4:7], s12 offen offset:896
  buffer_load_dwordx4 v[40:43], v3, s[4:7], s12 offen offset:1024
  s_lshl_b32 s13, s3, 8
  s_add_u32 s13, s13, 81920
  v_mov_b32 v45, 0
  buffer_store_dword v45, v45, s[8:11], s13 offen sc1
  v_mov_b32 v44, 0x3f803f80
  v_mov_b32 v45, 0
  v_mov_b32 v46, 0
  s_waitcnt vmcnt(0)
  v_mul_u32_u24 v3, 1168, v1
  v_lshl_add_u32 v3, v2, 4, v3
  ds_write_b128 v3, v[8:11] offset:0
  ds_write_b128 v3, v[12:15] offset:128
  ds_write_b128 v3, v[16:19] offset:256
  ds_write_b128 v3, v[20:23] offset:384
  ds_write_b128 v3, v[24:27] offset:512
  ds_write_b128 v3, v[28:31] offset:640
  ds_write_b128 v3, v[32:35] offset:768
  ds_write_b128 v3, v[36:39] offset:896
  ds_write_b128 v3, v[40:43] offset:1024
  s_waitcnt lgkmcnt(0)
  s_barrier
  v_and_b32 v4, 63, v0
  v_lshrrev_b32 v5, 6, v0
  v_lshrrev_b32 v6, 4, v4
  v_bfe_u32 v7, v4, 2, 2
  v_lshl_add_u32 v7, v6, 3, v7
  v_mul_u32_u24 v7, 1168, v7
  v_and_b32 v50, 3, v4
  v_lshl_add_u32 v7, v50, 3, v7
  v_lshl_add_u32 v7, v5, 5, v7
  ds_read_b64_tr_b16 v[52:53], v7 offset:0
  ds_read_b64_tr_b16 v[54:55], v7 offset:4672
  ds_read_b64_tr_b16 v[56:57], v7 offset:128
  ds_read_b64_tr_b16 v[58:59], v7 offset:4800
  ds_read_b64_tr_b16 v[60:61], v7 offset:256
  ds_read_b64_tr_b16 v[62:63], v7 offset:4928
  ds_read_b64_tr_b16 v[64:65], v7 offset:384
  ds_read_b64_tr_b16 v[66:67], v7 offset:5056
  ds_read_b64_tr_b16 v[68:69], v7 offset:512
  ds_read_b64_tr_b16 v[70:71], v7 offset:5184
  ds_read_b64_tr_b16 v[72:73], v7 offset:640
  ds_read_b64_tr_b16 v[74:75], v7 offset:5312
  ds_read_b64_tr_b16 v[76:77], v7 offset:768
  ds_read_b64_tr_b16 v[78:79], v7 offset:5440
  ds_read_b64_tr_b16 v[80:81], v7 offset:896
  ds_read_b64_tr_b16 v[82:83], v7 offset:5568
  ds_read_b64_tr_b16 v[84:85], v7 offset:1024
  ds_read_b64_tr_b16 v[86:87], v7 offset:5696
  v_dot2c_f32_bf16 v45, v8, v44
  v_dot2c_f32_bf16 v46, v8, v8
  v_dot2c_f32_bf16 v45, v9, v44
  v_dot2c_f32_bf16 v46, v9, v9
  v_dot2c_f32_bf16 v45, v10, v44
  v_dot2c_f32_bf16 v46, v10, v10
  v_dot2c_f32_bf16 v45, v11, v44
  v_dot2c_f32_bf16 v46, v11, v11
  v_dot2c_f32_bf16 v45, v12, v44
  v_dot2c_f32_bf16 v46, v12, v12
  v_dot2c_f32_bf16 v45, v13, v44
  v_dot2c_f32_bf16 v46, v13, v13
  v_dot2c_f32_bf16 v45, v14, v44
  v_dot2c_f32_bf16 v46, v14, v14
  v_dot2c_f32_bf16 v45, v15, v44
  v_dot2c_f32_bf16 v46, v15, v15
  v_dot2c_f32_bf16 v45, v16, v44
  v_dot2c_f32_bf16 v46, v16, v16
  v_dot2c_f32_bf16 v45, v17, v44
  v_dot2c_f32_bf16 v46, v17, v17
  v_dot2c_f32_bf16 v45, v18, v44
  v_dot2c_f32_bf16 v46, v18, v18
  v_dot2c_f32_bf16 v45, v19, v44
  v_dot2c_f32_bf16 v46, v19, v19
  v_dot2c_f32_bf16 v45, v20, v44
  v_dot2c_f32_bf16 v46, v20, v20
  v_dot2c_f32_bf16 v45, v21, v44
  v_dot2c_f32_bf16 v46, v21, v21
  v_dot2c_f32_bf16 v45, v22, v44
  v_dot2c_f32_bf16 v46, v22, v22
  v_dot2c_f32_bf16 v45, v23, v44
  v_dot2c_f32_bf16 v46, v23, v23
  v_dot2c_f32_bf16 v45, v24, v44
  v_dot2c_f32_bf16 v46, v24, v24
  v_dot2c_f32_bf16 v45, v25, v44
  v_dot2c_f32_bf16 v46, v25, v25
  v_dot2c_f32_bf16 v45, v26, v44
  v_dot2c_f32_bf16 v46, v26, v26
  v_dot2c_f32_bf16 v45, v27, v44
  v_dot2c_f32_bf16 v46, v27, v27
  v_dot2c_f32_bf16 v45, v28, v44
  v_dot2c_f32_bf16 v46, v28, v28
  v_dot2c_f32_bf16 v45, v29, v44
  v_dot2c_f32_bf16 v46, v29, v29
  v_dot2c_f32_bf16 v45, v30, v44
  v_dot2c_f32_bf16 v46, v30, v30
  v_dot2c_f32_bf16 v45, v31, v44
  v_dot2c_f32_bf16 v46, v31, v31
  v_dot2c_f32_bf16 v45, v32, v44
  v_dot2c_f32_bf16 v46, v32, v32
  v_dot2c_f32_bf16 v45, v33, v44
  v_dot2c_f32_bf16 v46, v33, v33
  v_dot2c_f32_bf16 v45, v34, v44
  v_dot2c_f32_bf16 v46, v34, v34
  v_dot2c_f32_bf16 v45, v35, v44
  v_dot2c_f32_bf16 v46, v35, v35
  v_dot2c_f32_bf16 v45, v36, v44
  v_dot2c_f32_bf16 v46, v36, v36
  v_dot2c_f32_bf16 v45, v37, v44
  v_dot2c_f32_bf16 v46, v37, v37
  v_dot2c_f32_bf16 v45, v38, v44
  v_dot2c_f32_bf16 v46, v38, v38
  v_dot2c_f32_bf16 v45, v39, v44
  v_dot2c_f32_bf16 v46, v39, v39
  v_dot2c_f32_bf16 v45, v40, v44
  v_dot2c_f32_bf16 v46, v40, v40
  v_dot2c_f32_bf16 v45, v41, v44
  v_dot2c_f32_bf16 v46, v41, v41
  v_dot2c_f32_bf16 v45, v42, v44
  v_dot2c_f32_bf16 v46, v42, v42
  v_dot2c_f32_bf16 v45, v43, v44
  v_dot2c_f32_bf16 v46, v43, v43
  v_and_b32 v50, 15, v4
  v_lshl_add_u32 v50, v5, 4, v50
  v_lshlrev_b32 v50, 6, v50
  v_lshl_add_u32 v50, v6, 4, v50
  s_mul_i32 s13, s3, 36864
  s_add_u32 s13, s13, 1048576
  s_waitcnt lgkmcnt(15)
  buffer_store_dwordx4 v[52:55], v50, s[8:11], s13 offen sc1
  s_add_u32 s13, s13, 4096
  s_waitcnt lgkmcnt(14)
  buffer_store_dwordx4 v[56:59], v50, s[8:11], s13 offen sc1
  s_add_u32 s13, s13, 4096
  s_waitcnt lgkmcnt(12)
  buffer_store_dwordx4 v[60:63], v50, s[8:11], s13 offen sc1
  s_add_u32 s13, s13, 4096
  s_waitcnt lgkmcnt(10)
  buffer_store_dwordx4 v[64:67], v50, s[8:11], s13 offen sc1
  s_add_u32 s13, s13, 4096
  s_waitcnt lgkmcnt(8)
  buffer_store_dwordx4 v[68:71], v50, s[8:11], s13 offen sc1
  s_add_u32 s13, s13, 4096
  s_waitcnt lgkmcnt(6)
  buffer_store_dwordx4 v[72:75], v50, s[8:11], s13 offen sc1
  s_add_u32 s13, s13, 4096
  s_waitcnt lgkmcnt(4)
  buffer_store_dwordx4 v[76:79], v50, s[8:11], s13 offen sc1
  s_add_u32 s13, s13, 4096
  s_waitcnt lgkmcnt(2)
  buffer_store_dwordx4 v[80:83], v50, s[8:11], s13 offen sc1
  s_add_u32 s13, s13, 4096
  s_waitcnt lgkmcnt(0)
  buffer_store_dwordx4 v[84:87], v50, s[8:11], s13 offen sc1
  v_add_f32_dpp v45, v45, v45 quad_perm:[1,0,3,2] row_mask:0xf bank_mask:0xf
  v_add_f32_dpp v46, v46, v46 quad_perm:[1,0,3,2] row_mask:0xf bank_mask:0xf
  s_nop 0
  v_add_f32_dpp v45, v45, v45 quad_perm:[2,3,0,1] row_mask:0xf bank_mask:0xf
  v_add_f32_dpp v46, v46, v46 quad_perm:[2,3,0,1] row_mask:0xf bank_mask:0xf
  s_nop 0
  v_add_f32_dpp v45, v45, v45 row_half_mirror row_mask:0xf bank_mask:0xf
  v_add_f32_dpp v46, v46, v46 row_half_mirror row_mask:0xf bank_mask:0xf
  v_mul_f32 v45, 0x3ae38e39, v45
  v_mul_f32 v46, 0x3ae38e39, v46
  v_fma_f32 v46, -v45, v45, v46
  v_max_f32 v46, 0, v46
  v_add_f32 v46, 0x3727c5ac, v46
  v_rsq_f32 v48, v46
  s_nop 0
  v_mul_f32 v49, v45, v48
  s_lshl_b32 s13, s3, 7
  s_add_u32 s14, s13, 24576
  s_add_u32 s13, s13, 16384
  v_lshlrev_b32 v3, 2, v1
  v_cmp_eq_u32 vcc, 0, v2
  s_nop 0
  s_and_saveexec_b64 s[16:17], vcc
  buffer_store_dword v48, v3, s[8:11], s13 offen sc1
  buffer_store_dword v49, v3, s[8:11], s14 offen sc1
  s_branch k0_kernel_exit
k0_mod:
  s_setprio 2
  s_and_b32 s13, s3, 7
  s_lshl_b32 s13, s13, 1
  s_bfe_u32 s14, s3, 0x10003
  s_or_b32 s13, s13, s14
  s_andn2_b32 s15, s3, 15
  s_or_b32 s13, s13, s15
  s_cmp_lt_u32 s3, 96
  s_cselect_b32 s3, s13, s3
  s_load_dwordx4 s[4:7], s[0:1], 112
  s_load_dwordx2 s[16:17], s[0:1], 144
  v_and_b32 v1, 3, v0
  v_lshrrev_b32 v2, 2, v0
  v_mul_u32_u24 v3, 6912, v2
  v_lshl_add_u32 v3, v1, 4, v3
  s_lshl_b32 s13, s3, 6
  v_lshlrev_b32 v4, 1, v2
  s_waitcnt lgkmcnt(0)
  s_mov_b32 s8, s6
  s_and_b32 s9, s7, 0xffff
  s_mov_b32 s10, 3981312
  s_mov_b32 s11, 0x20000
  s_and_b32 s5, s5, 0xffff
  s_mov_b32 s6, 1152
  s_mov_b32 s7, 0x20000
  s_and_b32 s17, s17, 0xffff
  s_mov_b32 s18, 67108864
  s_mov_b32 s19, 0x20000
  buffer_load_ushort v48, v4, s[4:7], 0 offen offset:0
  buffer_load_ushort v49, v4, s[4:7], 0 offen offset:128
  buffer_load_ushort v50, v4, s[4:7], 0 offen offset:256
  buffer_load_ushort v51, v4, s[4:7], 0 offen offset:384
  buffer_load_ushort v52, v4, s[4:7], 0 offen offset:512
  buffer_load_ushort v53, v4, s[4:7], 0 offen offset:640
  buffer_load_ushort v54, v4, s[4:7], 0 offen offset:768
  buffer_load_ushort v55, v4, s[4:7], 0 offen offset:896
  buffer_load_ushort v56, v4, s[4:7], 0 offen offset:1024
  buffer_load_dwordx4 v[8:11], v3, s[8:11], s13 offen
  s_add_u32 s13, s13, 442368
  buffer_load_dwordx4 v[12:15], v3, s[8:11], s13 offen
  s_add_u32 s13, s13, 442368
  buffer_load_dwordx4 v[16:19], v3, s[8:11], s13 offen
  s_add_u32 s13, s13, 442368
  buffer_load_dwordx4 v[20:23], v3, s[8:11], s13 offen
  s_add_u32 s13, s13, 442368
  buffer_load_dwordx4 v[24:27], v3, s[8:11], s13 offen
  s_add_u32 s13, s13, 442368
  buffer_load_dwordx4 v[28:31], v3, s[8:11], s13 offen
  s_add_u32 s13, s13, 442368
  buffer_load_dwordx4 v[32:35], v3, s[8:11], s13 offen
  s_add_u32 s13, s13, 442368
  buffer_load_dwordx4 v[36:39], v3, s[8:11], s13 offen
  s_add_u32 s13, s13, 442368
  buffer_load_dwordx4 v[40:43], v3, s[8:11], s13 offen
  v_mov_b32 v70, 0
  v_mov_b32 v71, 0
  v_mov_b32 v72, 0
  v_mov_b32 v73, 0
  v_mov_b32 v74, 0
  v_mov_b32 v75, 0
  v_mov_b32 v76, 0
  v_mov_b32 v77, 0
  s_waitcnt vmcnt(9)
  v_lshlrev_b32 v48, 16, v48
  v_mul_f32 v68, 0xbfb8aa3b, v48
  v_exp_f32 v68, v68
  s_nop 0
  v_add_f32 v68, 1.0, v68
  v_rcp_f32 v68, v68
  s_nop 0
  v_mul_f32 v48, v48, v68
  v_cvt_pk_bf16_f32 v58, 0, v48
  v_lshrrev_b32 v48, 16, v58
  v_lshlrev_b32 v49, 16, v49
  v_mul_f32 v68, 0xbfb8aa3b, v49
  v_exp_f32 v68, v68
  s_nop 0
  v_add_f32 v68, 1.0, v68
  v_rcp_f32 v68, v68
  s_nop 0
  v_mul_f32 v49, v49, v68
  v_cvt_pk_bf16_f32 v59, 0, v49
  v_lshrrev_b32 v49, 16, v59
  v_lshlrev_b32 v50, 16, v50
  v_mul_f32 v68, 0xbfb8aa3b, v50
  v_exp_f32 v68, v68
  s_nop 0
  v_add_f32 v68, 1.0, v68
  v_rcp_f32 v68, v68
  s_nop 0
  v_mul_f32 v50, v50, v68
  v_cvt_pk_bf16_f32 v60, 0, v50
  v_lshrrev_b32 v50, 16, v60
  v_lshlrev_b32 v51, 16, v51
  v_mul_f32 v68, 0xbfb8aa3b, v51
  v_exp_f32 v68, v68
  s_nop 0
  v_add_f32 v68, 1.0, v68
  v_rcp_f32 v68, v68
  s_nop 0
  v_mul_f32 v51, v51, v68
  v_cvt_pk_bf16_f32 v61, 0, v51
  v_lshrrev_b32 v51, 16, v61
  v_lshlrev_b32 v52, 16, v52
  v_mul_f32 v68, 0xbfb8aa3b, v52
  v_exp_f32 v68, v68
  s_nop 0
  v_add_f32 v68, 1.0, v68
  v_rcp_f32 v68, v68
  s_nop 0
  v_mul_f32 v52, v52, v68
  v_cvt_pk_bf16_f32 v62, 0, v52
  v_lshrrev_b32 v52, 16, v62
  v_lshlrev_b32 v53, 16, v53
  v_mul_f32 v68, 0xbfb8aa3b, v53
  v_exp_f32 v68, v68
  s_nop 0
  v_add_f32 v68, 1.0, v68
  v_rcp_f32 v68, v68
  s_nop 0
  v_mul_f32 v53, v53, v68
  v_cvt_pk_bf16_f32 v63, 0, v53
  v_lshrrev_b32 v53, 16, v63
  v_lshlrev_b32 v54, 16, v54
  v_mul_f32 v68, 0xbfb8aa3b, v54
  v_exp_f32 v68, v68
  s_nop 0
  v_add_f32 v68, 1.0, v68
  v_rcp_f32 v68, v68
  s_nop 0
  v_mul_f32 v54, v54, v68
  v_cvt_pk_bf16_f32 v64, 0, v54
  v_lshrrev_b32 v54, 16, v64
  v_lshlrev_b32 v55, 16, v55
  v_mul_f32 v68, 0xbfb8aa3b, v55
  v_exp_f32 v68, v68
  s_nop 0
  v_add_f32 v68, 1.0, v68
  v_rcp_f32 v68, v68
  s_nop 0
  v_mul_f32 v55, v55, v68
  v_cvt_pk_bf16_f32 v65, 0, v55
  v_lshrrev_b32 v55, 16, v65
  v_lshlrev_b32 v56, 16, v56
  v_mul_f32 v68, 0xbfb8aa3b, v56
  v_exp_f32 v68, v68
  s_nop 0
  v_add_f32 v68, 1.0, v68
  v_rcp_f32 v68, v68
  s_nop 0
  v_mul_f32 v56, v56, v68
  v_cvt_pk_bf16_f32 v66, 0, v56
  v_lshrrev_b32 v56, 16, v66
  s_waitcnt vmcnt(8)
  v_dot2c_f32_bf16 v70, v8, v48
  v_dot2c_f32_bf16 v71, v8, v58
  v_dot2c_f32_bf16 v72, v9, v48
  v_dot2c_f32_bf16 v73, v9, v58
  v_dot2c_f32_bf16 v74, v10, v48
  v_dot2c_f32_bf16 v75, v10, v58
  v_dot2c_f32_bf16 v76, v11, v48
  v_dot2c_f32_bf16 v77, v11, v58
  s_waitcnt vmcnt(7)
  v_dot2c_f32_bf16 v70, v12, v49
  v_dot2c_f32_bf16 v71, v12, v59
  v_dot2c_f32_bf16 v72, v13, v49
  v_dot2c_f32_bf16 v73, v13, v59
  v_dot2c_f32_bf16 v74, v14, v49
  v_dot2c_f32_bf16 v75, v14, v59
  v_dot2c_f32_bf16 v76, v15, v49
  v_dot2c_f32_bf16 v77, v15, v59
  s_waitcnt vmcnt(6)
  v_dot2c_f32_bf16 v70, v16, v50
  v_dot2c_f32_bf16 v71, v16, v60
  v_dot2c_f32_bf16 v72, v17, v50
  v_dot2c_f32_bf16 v73, v17, v60
  v_dot2c_f32_bf16 v74, v18, v50
  v_dot2c_f32_bf16 v75, v18, v60
  v_dot2c_f32_bf16 v76, v19, v50
  v_dot2c_f32_bf16 v77, v19, v60
  s_waitcnt vmcnt(5)
  v_dot2c_f32_bf16 v70, v20, v51
  v_dot2c_f32_bf16 v71, v20, v61
  v_dot2c_f32_bf16 v72, v21, v51
  v_dot2c_f32_bf16 v73, v21, v61
  v_dot2c_f32_bf16 v74, v22, v51
  v_dot2c_f32_bf16 v75, v22, v61
  v_dot2c_f32_bf16 v76, v23, v51
  v_dot2c_f32_bf16 v77, v23, v61
  s_waitcnt vmcnt(4)
  v_dot2c_f32_bf16 v70, v24, v52
  v_dot2c_f32_bf16 v71, v24, v62
  v_dot2c_f32_bf16 v72, v25, v52
  v_dot2c_f32_bf16 v73, v25, v62
  v_dot2c_f32_bf16 v74, v26, v52
  v_dot2c_f32_bf16 v75, v26, v62
  v_dot2c_f32_bf16 v76, v27, v52
  v_dot2c_f32_bf16 v77, v27, v62
  s_waitcnt vmcnt(3)
  v_dot2c_f32_bf16 v70, v28, v53
  v_dot2c_f32_bf16 v71, v28, v63
  v_dot2c_f32_bf16 v72, v29, v53
  v_dot2c_f32_bf16 v73, v29, v63
  v_dot2c_f32_bf16 v74, v30, v53
  v_dot2c_f32_bf16 v75, v30, v63
  v_dot2c_f32_bf16 v76, v31, v53
  v_dot2c_f32_bf16 v77, v31, v63
  s_waitcnt vmcnt(2)
  v_dot2c_f32_bf16 v70, v32, v54
  v_dot2c_f32_bf16 v71, v32, v64
  v_dot2c_f32_bf16 v72, v33, v54
  v_dot2c_f32_bf16 v73, v33, v64
  v_dot2c_f32_bf16 v74, v34, v54
  v_dot2c_f32_bf16 v75, v34, v64
  v_dot2c_f32_bf16 v76, v35, v54
  v_dot2c_f32_bf16 v77, v35, v64
  s_waitcnt vmcnt(1)
  v_dot2c_f32_bf16 v70, v36, v55
  v_dot2c_f32_bf16 v71, v36, v65
  v_dot2c_f32_bf16 v72, v37, v55
  v_dot2c_f32_bf16 v73, v37, v65
  v_dot2c_f32_bf16 v74, v38, v55
  v_dot2c_f32_bf16 v75, v38, v65
  v_dot2c_f32_bf16 v76, v39, v55
  v_dot2c_f32_bf16 v77, v39, v65
  s_waitcnt vmcnt(0)
  v_dot2c_f32_bf16 v70, v40, v56
  v_dot2c_f32_bf16 v71, v40, v66
  v_dot2c_f32_bf16 v72, v41, v56
  v_dot2c_f32_bf16 v73, v41, v66
  v_dot2c_f32_bf16 v74, v42, v56
  v_dot2c_f32_bf16 v75, v42, v66
  v_dot2c_f32_bf16 v76, v43, v56
  v_dot2c_f32_bf16 v77, v43, v66
  v_add_f32_dpp v70, v70, v70 row_ror:4 row_mask:0xf bank_mask:0xf
  v_add_f32_dpp v71, v71, v71 row_ror:4 row_mask:0xf bank_mask:0xf
  v_add_f32_dpp v72, v72, v72 row_ror:4 row_mask:0xf bank_mask:0xf
  v_add_f32_dpp v73, v73, v73 row_ror:4 row_mask:0xf bank_mask:0xf
  v_add_f32_dpp v74, v74, v74 row_ror:4 row_mask:0xf bank_mask:0xf
  v_add_f32_dpp v75, v75, v75 row_ror:4 row_mask:0xf bank_mask:0xf
  v_add_f32_dpp v76, v76, v76 row_ror:4 row_mask:0xf bank_mask:0xf
  v_add_f32_dpp v77, v77, v77 row_ror:4 row_mask:0xf bank_mask:0xf
  v_add_f32_dpp v70, v70, v70 row_ror:8 row_mask:0xf bank_mask:0xf
  v_add_f32_dpp v71, v71, v71 row_ror:8 row_mask:0xf bank_mask:0xf
  v_add_f32_dpp v72, v72, v72 row_ror:8 row_mask:0xf bank_mask:0xf
  v_add_f32_dpp v73, v73, v73 row_ror:8 row_mask:0xf bank_mask:0xf
  v_add_f32_dpp v74, v74, v74 row_ror:8 row_mask:0xf bank_mask:0xf
  v_add_f32_dpp v75, v75, v75 row_ror:8 row_mask:0xf bank_mask:0xf
  v_add_f32_dpp v76, v76, v76 row_ror:8 row_mask:0xf bank_mask:0xf
  v_add_f32_dpp v77, v77, v77 row_ror:8 row_mask:0xf bank_mask:0xf
  v_lshrrev_b32 v5, 4, v0
  v_lshlrev_b32 v5, 7, v5
  v_lshl_add_u32 v5, v1, 5, v5
  v_bfe_u32 v6, v0, 2, 2
  v_cmp_eq_u32 vcc, 0, v6
  s_nop 0
  s_and_saveexec_b64 s[14:15], vcc
  ds_write_b128 v5, v[70:73]
  ds_write_b128 v5, v[74:77] offset:16
  s_mov_b64 exec, s[14:15]
  s_waitcnt lgkmcnt(0)
  s_barrier
  v_cmp_gt_u32 vcc, 32, v0
  s_nop 0
  s_and_saveexec_b64 s[14:15], vcc
  s_cbranch_execz k0_kernel_exit
  v_lshlrev_b32 v5, 2, v0
  ds_read_b32 v8, v5 offset:0
  ds_read_b32 v9, v5 offset:128
  ds_read_b32 v10, v5 offset:256
  ds_read_b32 v11, v5 offset:384
  ds_read_b32 v12, v5 offset:512
  ds_read_b32 v13, v5 offset:640
  ds_read_b32 v14, v5 offset:768
  ds_read_b32 v15, v5 offset:896
  ds_read_b32 v16, v5 offset:1024
  ds_read_b32 v17, v5 offset:1152
  ds_read_b32 v18, v5 offset:1280
  ds_read_b32 v19, v5 offset:1408
  ds_read_b32 v20, v5 offset:1536
  ds_read_b32 v21, v5 offset:1664
  ds_read_b32 v22, v5 offset:1792
  ds_read_b32 v23, v5 offset:1920
  s_waitcnt lgkmcnt(0)
  v_add_f32 v8, v8, v16
  v_add_f32 v9, v9, v17
  v_add_f32 v10, v10, v18
  v_add_f32 v11, v11, v19
  v_add_f32 v12, v12, v20
  v_add_f32 v13, v13, v21
  v_add_f32 v14, v14, v22
  v_add_f32 v15, v15, v23
  v_add_f32 v8, v8, v12
  v_add_f32 v9, v9, v13
  v_add_f32 v10, v10, v14
  v_add_f32 v11, v11, v15
  v_add_f32 v8, v8, v10
  v_add_f32 v9, v9, v11
  v_add_f32 v8, v8, v9
  v_cvt_pk_bf16_f32 v6, v8, v8
  v_and_b32 v6, 0xffff0000, v6
  s_lshl_b32 s13, s3, 7
  s_add_u32 s13, s13, 0
  buffer_store_dword v6, v5, s[16:19], s13 offen sc1
  s_branch k0_kernel_exit
k0_kernel_exit:
  s_endpgm
k0_kernel_codeend:
.globl k1_kernel
.p2align 8
.type k1_kernel,@function
k1_kernel:
  s_cmp_ge_u32 s2, 64
  s_cbranch_scc1 k1_kernel_pf_4
  s_getpc_b64 s[4:5]
k1_kernel_pc:
  s_mov_b32 s6, k1_kernel_codeend-k1_kernel_pc-4
  v_lshlrev_b32 v1, 7, v0
  v_min_u32 v2, s6, v1
  global_load_dword v14, v2, s[4:5]
k1_kernel_pf_4:
  s_sub_u32 s3, s2, 0
  s_cmp_lt_u32 s2, 576
  s_cbranch_scc1 k1_conv
  s_sub_u32 s3, s2, 576
  s_cmp_lt_u32 s2, 720
  s_cbranch_scc1 k1_P1
  s_sub_u32 s3, s2, 720
  s_cmp_lt_u32 s2, 864
  s_cbranch_scc1 k1_CS
  s_sub_u32 s3, s2, 864
  s_cmp_lt_u32 s2, 936
  s_cbranch_scc1 k1_P2
  s_branch k1_kernel_exit
k1_conv:
  s_load_dwordx2 s[8:9], s[0:1], 144
  s_load_dwordx2 s[6:7], s[0:1], 64
  s_lshr_b32 s12, s3, 1
  s_lshl_b32 s12, s12, 2
  s_lshl_b32 s13, s3, 2
  v_lshlrev_b32 v1, 4, v0
  v_and_b32 v2, 63, v0
  v_lshrrev_b32 v3, 6, v0
  v_and_b32 v4, 15, v2
  v_lshrrev_b32 v5, 4, v2
  v_subrev_u32 v16, 16, v1
  v_max_i32 v16, 0, v16
  v_lshrrev_b32 v17, 2, v0
  v_mul_u32_u24 v17, 36864, v17
  v_and_b32 v18, 3, v0
  v_lshl_add_u32 v17, v18, 4, v17
  v_lshlrev_b32 v18, 5, v0
  v_lshlrev_b32 v6, 9, v3
  v_lshl_add_u32 v6, v4, 4, v6
  v_lshl_add_u32 v6, v5, 2, v6
  v_lshrrev_b32 v19, 5, v6
  v_mul_u32_u24 v19, 36864, v19
  v_and_b32 v20, 31, v6
  v_lshl_add_u32 v19, v20, 1, v19
  s_lshl_b32 s19, s3, 12
  s_add_u32 s19, s19, 4194304
  s_lshl_b32 s20, s3, 6
  s_add_u32 s20, s20, 1048576
  s_mov_b32 s21, 16384
  s_mov_b32 s22, 24576
  s_add_u32 s23, s20, 294912
  s_waitcnt lgkmcnt(0)
  s_load_dword s14, s[6:7], s12
  s_add_u32 s15, s13, 0
  s_load_dword s16, s[8:9], s15
  s_add_u32 s15, s13, 2304
  s_load_dword s17, s[8:9], s15
  s_add_u32 s15, s13, 4608
  s_load_dword s18, s[8:9], s15
  s_and_b32 s9, s9, 0xffff
  s_mov_b32 s10, 67108864
  s_mov_b32 s11, 0x20000
  buffer_load_dwordx4 v[32:35], v16, s[8:11], s19 offen
  buffer_load_dwordx4 v[36:39], v1, s[8:11], s19 offen
  buffer_load_dwordx4 v[40:43], v17, s[8:11], s20 offen
  buffer_load_dwordx4 v[44:47], v18, s[8:11], s21 offen
  buffer_load_dwordx4 v[48:51], v18, s[8:11], s21 offen offset:16
  buffer_load_dwordx4 v[52:55], v18, s[8:11], s22 offen
  buffer_load_dwordx4 v[56:59], v18, s[8:11], s22 offen offset:16
  buffer_load_dwordx2 v[8:9], v19, s[8:11], s20 offen
  buffer_load_dwordx2 v[10:11], v19, s[8:11], s23 offen
  v_mov_b32 v64, 0
  v_mov_b32 v65, 0
  v_mov_b32 v66, 0
  v_mov_b32 v67, 0
  v_mul_u32_u24 v21, 4160, v0
  v_add_u32 v22, 37248, v1
  v_cmp_gt_u32 vcc, 8, v0
  s_nop 1
  v_cndmask_b32 v21, v22, v21, vcc
  v_cmp_gt_u32 vcc, 38, v0
  s_nop 0
  s_and_saveexec_b64 s[24:25], vcc
  ds_write_b128 v21, v[64:67]
  s_mov_b64 exec, s[24:25]
  v_and_b32 v12, 7, v4
  v_mul_u32_u24 v12, 4160, v12
  v_and_b32 v23, 8, v4
  v_lshl_add_u32 v23, v5, 3, v23
  v_lshl_add_u32 v23, v3, 6, v23
  v_lshl_add_u32 v12, v23, 1, v12
  v_lshlrev_b32 v13, 4, v4
  v_sub_u32 v13, 240, v13
  v_lshl_add_u32 v13, v5, 3, v13
  v_lshl_add_u32 v13, v3, 6, v13
  v_lshlrev_b32 v13, 1, v13
  v_add_u32 v13, 33280, v13
  s_waitcnt lgkmcnt(0)
  s_and_b32 s15, s3, 1
  s_cmp_eq_u32 s15, 0
  s_cselect_b32 s15, 16, 0
  s_lshl_b32 s14, s14, s15
  s_and_b32 s14, s14, 0xffff0000
  v_mov_b32 v60, s17
  v_add_f32 v60, 1.0, v60
  v_cvt_pk_bf16_f32 v60, v60, v60
  v_and_b32 v60, 0xffff0000, v60
  v_mov_b32 v61, v60
  v_mov_b32 v62, s16
  v_mov_b32 v63, s16
  v_add_u32 v24, 16, v1
  s_waitcnt vmcnt(7)
  v_cmp_eq_u32 vcc, 0, v0
  s_nop 1
  v_cndmask_b32 v32, v32, 0, vcc
  v_cndmask_b32 v33, v33, 0, vcc
  v_cndmask_b32 v34, v34, 0, vcc
  v_cndmask_b32 v35, v35, 0, vcc
  v_alignbit_b32 v76, v33, v32, 16
  v_alignbit_b32 v77, v34, v33, 16
  v_alignbit_b32 v78, v35, v34, 16
  v_alignbit_b32 v79, v36, v35, 16
  ds_write_b128 v24, v[76:79] offset:0
  v_mov_b32 v68, v33
  v_mov_b32 v69, v34
  v_mov_b32 v70, v35
  v_mov_b32 v71, v36
  ds_write_b128 v24, v[68:71] offset:4160
  v_alignbit_b32 v80, v34, v33, 16
  v_alignbit_b32 v81, v35, v34, 16
  v_alignbit_b32 v82, v36, v35, 16
  v_alignbit_b32 v83, v37, v36, 16
  ds_write_b128 v24, v[80:83] offset:8320
  ds_write_b128 v24, v[34:37] offset:12480
  v_alignbit_b32 v76, v35, v34, 16
  v_alignbit_b32 v77, v36, v35, 16
  v_alignbit_b32 v78, v37, v36, 16
  v_alignbit_b32 v79, v38, v37, 16
  ds_write_b128 v24, v[76:79] offset:16640
  v_mov_b32 v68, v35
  v_mov_b32 v69, v36
  v_mov_b32 v70, v37
  v_mov_b32 v71, v38
  ds_write_b128 v24, v[68:71] offset:20800
  v_alignbit_b32 v80, v36, v35, 16
  v_alignbit_b32 v81, v37, v36, 16
  v_alignbit_b32 v82, v38, v37, 16
  v_alignbit_b32 v83, v39, v38, 16
  ds_write_b128 v24, v[80:83] offset:24960
  ds_write_b128 v24, v[36:39] offset:29120
  s_waitcnt vmcnt(2)
  v_lshlrev_b32 v84, 16, v40
  v_and_b32 v85, 0xffff0000, v40
  v_lshlrev_b32 v86, 16, v41
  v_and_b32 v87, 0xffff0000, v41
  v_lshlrev_b32 v88, 16, v42
  v_and_b32 v89, 0xffff0000, v42
  v_lshlrev_b32 v90, 16, v43
  v_and_b32 v91, 0xffff0000, v43
  v_pk_fma_f32 v[84:85], v[84:85], v[44:45], v[52:53] neg_lo:[0,0,1] neg_hi:[0,0,1]
  v_pk_fma_f32 v[86:87], v[86:87], v[46:47], v[54:55] neg_lo:[0,0,1] neg_hi:[0,0,1]
  v_pk_fma_f32 v[88:89], v[88:89], v[48:49], v[56:57] neg_lo:[0,0,1] neg_hi:[0,0,1]
  v_pk_fma_f32 v[90:91], v[90:91], v[50:51], v[58:59] neg_lo:[0,0,1] neg_hi:[0,0,1]
  v_pk_fma_f32 v[84:85], v[84:85], v[60:61], v[62:63]
  v_pk_fma_f32 v[86:87], v[86:87], v[60:61], v[62:63]
  v_pk_fma_f32 v[88:89], v[88:89], v[60:61], v[62:63]
  v_pk_fma_f32 v[90:91], v[90:91], v[60:61], v[62:63]
  v_cvt_pk_bf16_f32 v92, v91, v90
  v_cvt_pk_bf16_f32 v93, v89, v88
  v_cvt_pk_bf16_f32 v94, v87, v86
  v_cvt_pk_bf16_f32 v95, v85, v84
  v_sub_u32 v25, 37360, v1
  ds_write_b128 v25, v[92:95]
  s_waitcnt lgkmcnt(0)
  s_barrier
  ds_read_b128 v[64:67], v13 offset:3584
  ds_read_b128 v[32:35], v12 offset:0
  ds_read_b128 v[68:71], v13 offset:3072
  ds_read_b128 v[36:39], v12 offset:512
  ds_read_b128 v[72:75], v13 offset:2560
  ds_read_b128 v[40:43], v12 offset:1024
  ds_read_b128 v[76:79], v13 offset:2048
  ds_read_b128 v[44:47], v12 offset:1536
  ds_read_b128 v[80:83], v13 offset:1536
  ds_read_b128 v[48:51], v12 offset:2048
  ds_read_b128 v[84:87], v13 offset:1024
  ds_read_b128 v[52:55], v12 offset:2560
  ds_read_b128 v[88:91], v13 offset:512
  ds_read_b128 v[56:59], v12 offset:3072
  ds_read_b128 v[92:95], v13 offset:0
  ds_read_b128 v[60:63], v12 offset:3584
  s_waitcnt lgkmcnt(14)
  v_mfma_f32_16x16x32_bf16 v[96:99], v[32:35], v[64:67], 0
  s_waitcnt lgkmcnt(12)
  v_mfma_f32_16x16x32_bf16 v[100:103], v[32:35], v[68:71], 0
  v_mfma_f32_16x16x32_bf16 v[100:103], v[36:39], v[64:67], v[100:103]
  v_mfma_f32_16x16x32_bf16 v[104:107], v[36:39], v[68:71], 0
  s_waitcnt lgkmcnt(10)
  v_mfma_f32_16x16x32_bf16 v[104:107], v[32:35], v[72:75], v[104:107]
  v_mfma_f32_16x16x32_bf16 v[108:111], v[36:39], v[72:75], 0
  v_mfma_f32_16x16x32_bf16 v[104:107], v[40:43], v[64:67], v[104:107]
  v_mfma_f32_16x16x32_bf16 v[108:111], v[40:43], v[68:71], v[108:111]
  v_mfma_f32_16x16x32_bf16 v[112:115], v[40:43], v[72:75], 0
  s_waitcnt lgkmcnt(8)
  v_mfma_f32_16x16x32_bf16 v[108:111], v[32:35], v[76:79], v[108:111]
  v_mfma_f32_16x16x32_bf16 v[112:115], v[36:39], v[76:79], v[112:115]
  v_mfma_f32_16x16x32_bf16 v[116:119], v[40:43], v[76:79], 0
  v_mfma_f32_16x16x32_bf16 v[108:111], v[44:47], v[64:67], v[108:111]
  v_mfma_f32_16x16x32_bf16 v[112:115], v[44:47], v[68:71], v[112:115]
  v_mfma_f32_16x16x32_bf16 v[116:119], v[44:47], v[72:75], v[116:119]
  v_mfma_f32_16x16x32_bf16 v[120:123], v[44:47], v[76:79], 0
  s_waitcnt lgkmcnt(6)
  v_mfma_f32_16x16x32_bf16 v[112:115], v[32:35], v[80:83], v[112:115]
  v_mfma_f32_16x16x32_bf16 v[116:119], v[36:39], v[80:83], v[116:119]
  v_mfma_f32_16x16x32_bf16 v[120:123], v[40:43], v[80:83], v[120:123]
  v_mfma_f32_16x16x32_bf16 v[124:127], v[44:47], v[80:83], 0
  v_mfma_f32_16x16x32_bf16 v[112:115], v[48:51], v[64:67], v[112:115]
  v_mfma_f32_16x16x32_bf16 v[116:119], v[48:51], v[68:71], v[116:119]
  v_mfma_f32_16x16x32_bf16 v[120:123], v[48:51], v[72:75], v[120:123]
  v_mfma_f32_16x16x32_bf16 v[124:127], v[48:51], v[76:79], v[124:127]
  s_waitcnt lgkmcnt(4)
  v_mfma_f32_16x16x32_bf16 v[116:119], v[32:35], v[84:87], v[116:119]
  v_mfma_f32_16x16x32_bf16 v[120:123], v[36:39], v[84:87], v[120:123]
  v_mfma_f32_16x16x32_bf16 v[124:127], v[40:43], v[84:87], v[124:127]
  v_mfma_f32_16x16x32_bf16 v[116:119], v[52:55], v[64:67], v[116:119]
  v_mfma_f32_16x16x32_bf16 v[120:123], v[52:55], v[68:71], v[120:123]
  v_mfma_f32_16x16x32_bf16 v[124:127], v[52:55], v[72:75], v[124:127]
  s_waitcnt lgkmcnt(2)
  v_mfma_f32_16x16x32_bf16 v[120:123], v[32:35], v[88:91], v[120:123]
  v_mfma_f32_16x16x32_bf16 v[124:127], v[36:39], v[88:91], v[124:127]
  v_mfma_f32_16x16x32_bf16 v[120:123], v[56:59], v[64:67], v[120:123]
  v_mfma_f32_16x16x32_bf16 v[124:127], v[56:59], v[68:71], v[124:127]
  s_waitcnt lgkmcnt(0)
  v_mfma_f32_16x16x32_bf16 v[124:127], v[32:35], v[92:95], v[124:127]
  v_mfma_f32_16x16x32_bf16 v[124:127], v[60:63], v[64:67], v[124:127]
  ds_read_b128 v[64:67], v13 offset:3648
  ds_read_b128 v[32:35], v12 offset:64
  ds_read_b128 v[68:71], v13 offset:3136
  ds_read_b128 v[36:39], v12 offset:576
  ds_read_b128 v[72:75], v13 offset:2624
  ds_read_b128 v[40:43], v12 offset:1088
  ds_read_b128 v[76:79], v13 offset:2112
  ds_read_b128 v[44:47], v12 offset:1600
  ds_read_b128 v[80:83], v13 offset:1600
  ds_read_b128 v[48:51], v12 offset:2112
  ds_read_b128 v[84:87], v13 offset:1088
  ds_read_b128 v[52:55], v12 offset:2624
  ds_read_b128 v[88:91], v13 offset:576
  ds_read_b128 v[56:59], v12 offset:3136
  ds_read_b128 v[92:95], v13 offset:64
  ds_read_b128 v[60:63], v12 offset:3648
  s_waitcnt lgkmcnt(14)
  v_mfma_f32_16x16x32_bf16 v[96:99], v[32:35], v[64:67], v[96:99]
  s_waitcnt lgkmcnt(12)
  v_mfma_f32_16x16x32_bf16 v[100:103], v[32:35], v[68:71], v[100:103]
  v_mfma_f32_16x16x32_bf16 v[100:103], v[36:39], v[64:67], v[100:103]
  v_mfma_f32_16x16x32_bf16 v[104:107], v[36:39], v[68:71], v[104:107]
  s_waitcnt lgkmcnt(10)
  v_mfma_f32_16x16x32_bf16 v[104:107], v[32:35], v[72:75], v[104:107]
  v_mfma_f32_16x16x32_bf16 v[108:111], v[36:39], v[72:75], v[108:111]
  v_mfma_f32_16x16x32_bf16 v[104:107], v[40:43], v[64:67], v[104:107]
  v_mfma_f32_16x16x32_bf16 v[108:111], v[40:43], v[68:71], v[108:111]
  v_mfma_f32_16x16x32_bf16 v[112:115], v[40:43], v[72:75], v[112:115]
  s_waitcnt lgkmcnt(8)
  v_mfma_f32_16x16x32_bf16 v[108:111], v[32:35], v[76:79], v[108:111]
  v_mfma_f32_16x16x32_bf16 v[112:115], v[36:39], v[76:79], v[112:115]
  v_mfma_f32_16x16x32_bf16 v[116:119], v[40:43], v[76:79], v[116:119]
  v_mfma_f32_16x16x32_bf16 v[108:111], v[44:47], v[64:67], v[108:111]
  v_mfma_f32_16x16x32_bf16 v[112:115], v[44:47], v[68:71], v[112:115]
  v_mfma_f32_16x16x32_bf16 v[116:119], v[44:47], v[72:75], v[116:119]
  v_mfma_f32_16x16x32_bf16 v[120:123], v[44:47], v[76:79], v[120:123]
  s_waitcnt lgkmcnt(6)
  v_mfma_f32_16x16x32_bf16 v[112:115], v[32:35], v[80:83], v[112:115]
  v_mfma_f32_16x16x32_bf16 v[116:119], v[36:39], v[80:83], v[116:119]
  v_mfma_f32_16x16x32_bf16 v[120:123], v[40:43], v[80:83], v[120:123]
  v_mfma_f32_16x16x32_bf16 v[124:127], v[44:47], v[80:83], v[124:127]
  v_mfma_f32_16x16x32_bf16 v[112:115], v[48:51], v[64:67], v[112:115]
  v_mfma_f32_16x16x32_bf16 v[116:119], v[48:51], v[68:71], v[116:119]
  v_mfma_f32_16x16x32_bf16 v[120:123], v[48:51], v[72:75], v[120:123]
  v_mfma_f32_16x16x32_bf16 v[124:127], v[48:51], v[76:79], v[124:127]
  s_waitcnt lgkmcnt(4)
  v_mfma_f32_16x16x32_bf16 v[116:119], v[32:35], v[84:87], v[116:119]
  v_mfma_f32_16x16x32_bf16 v[120:123], v[36:39], v[84:87], v[120:123]
  v_mfma_f32_16x16x32_bf16 v[124:127], v[40:43], v[84:87], v[124:127]
  v_mfma_f32_16x16x32_bf16 v[116:119], v[52:55], v[64:67], v[116:119]
  v_mfma_f32_16x16x32_bf16 v[120:123], v[52:55], v[68:71], v[120:123]
  v_mfma_f32_16x16x32_bf16 v[124:127], v[52:55], v[72:75], v[124:127]
  s_waitcnt lgkmcnt(2)
  v_mfma_f32_16x16x32_bf16 v[120:123], v[32:35], v[88:91], v[120:123]
  v_mfma_f32_16x16x32_bf16 v[124:127], v[36:39], v[88:91], v[124:127]
  v_mfma_f32_16x16x32_bf16 v[120:123], v[56:59], v[64:67], v[120:123]
  v_mfma_f32_16x16x32_bf16 v[124:127], v[56:59], v[68:71], v[124:127]
  s_waitcnt lgkmcnt(0)
  v_mfma_f32_16x16x32_bf16 v[124:127], v[32:35], v[92:95], v[124:127]
  v_mfma_f32_16x16x32_bf16 v[124:127], v[60:63], v[64:67], v[124:127]
  v_lshlrev_b32 v16, 4, v2
  v_lshl_add_u32 v17, v3, 13, v16
  v_lshl_add_u32 v18, v3, 11, v16
  v_lshlrev_b32 v19, 1, v6
  v_sub_u32 v19, 37368, v19
  v_subrev_u32 v20, 512, v19
  s_and_b32 s24, s3, 3
  s_lshr_b32 s25, s3, 3
  s_and_b32 s25, s25, 1
  s_lshl_b32 s25, s25, 2
  s_add_u32 s24, s24, s25
  s_lshl_b32 s24, s24, 1
  v_and_b32 v21, 7, v4
  v_lshlrev_b32 v21, 1, v21
  v_lshrrev_b32 v22, 1, v5
  v_add_u32 v21, v21, v22
  v_xor_b32 v21, s24, v21
  v_lshlrev_b32 v21, 4, v21
  v_and_b32 v22, 1, v5
  v_lshl_add_u32 v21, v22, 3, v21
  v_lshrrev_b32 v22, 3, v4
  v_lshl_add_u32 v22, v3, 2, v22
  v_mul_u32_u24 v22, 147456, v22
  v_add_u32 v21, v21, v22
  s_lshl_b32 s25, s3, 8
  s_add_u32 s25, s25, 7340032
  s_add_u32 s26, s25, 294912
  s_barrier
  ds_write_b128 v17, v[96:99] offset:0
  ds_write_b128 v17, v[100:103] offset:1024
  ds_write_b128 v17, v[104:107] offset:2048
  ds_write_b128 v17, v[108:111] offset:3072
  ds_write_b128 v17, v[112:115] offset:4096
  ds_write_b128 v17, v[116:119] offset:5120
  ds_write_b128 v17, v[120:123] offset:6144
  ds_write_b128 v17, v[124:127] offset:7168
  s_waitcnt lgkmcnt(0)
  s_barrier
  ds_read_b128 v[32:35], v18 offset:0
  ds_read_b128 v[48:51], v18 offset:1024
  ds_read_b128 v[36:39], v18 offset:8192
  ds_read_b128 v[52:55], v18 offset:9216
  ds_read_b128 v[40:43], v18 offset:16384
  ds_read_b128 v[56:59], v18 offset:17408
  ds_read_b128 v[44:47], v18 offset:24576
  ds_read_b128 v[60:63], v18 offset:25600
  ds_read_b64 v[64:65], v19
  ds_read_b64 v[66:67], v20
  s_waitcnt vmcnt(0) lgkmcnt(0)
  v_pk_add_f32 v[32:33], v[32:33], v[36:37]
  v_pk_add_f32 v[40:41], v[40:41], v[44:45]
  v_pk_add_f32 v[34:35], v[34:35], v[38:39]
  v_pk_add_f32 v[42:43], v[42:43], v[46:47]
  v_pk_add_f32 v[32:33], v[32:33], v[40:41]
  v_pk_add_f32 v[34:35], v[34:35], v[42:43]
  v_and_b32 v68, 0xffff0000, v65
  v_lshlrev_b32 v69, 16, v65
  v_and_b32 v70, 0xffff0000, v64
  v_lshlrev_b32 v71, 16, v64
  v_fma_f32 v32, v68, s14, v32
  v_fma_f32 v33, v69, s14, v33
  v_fma_f32 v34, v70, s14, v34
  v_fma_f32 v35, v71, s14, v35
  v_lshlrev_b32 v72, 16, v8
  v_and_b32 v73, 0xffff0000, v8
  v_lshlrev_b32 v74, 16, v9
  v_and_b32 v75, 0xffff0000, v9
  v_fma_f32 v32, v32, s18, v72
  v_fma_f32 v33, v33, s18, v73
  v_fma_f32 v34, v34, s18, v74
  v_fma_f32 v35, v35, s18, v75
  v_cvt_pk_bf16_f32 v84, v32, v33
  v_cvt_pk_bf16_f32 v85, v34, v35
  buffer_store_dwordx2 v[84:85], v21, s[8:11], s25 offen sc1
  v_pk_add_f32 v[48:49], v[48:49], v[52:53]
  v_pk_add_f32 v[56:57], v[56:57], v[60:61]
  v_pk_add_f32 v[50:51], v[50:51], v[54:55]
  v_pk_add_f32 v[58:59], v[58:59], v[62:63]
  v_pk_add_f32 v[48:49], v[48:49], v[56:57]
  v_pk_add_f32 v[50:51], v[50:51], v[58:59]
  v_and_b32 v76, 0xffff0000, v67
  v_lshlrev_b32 v77, 16, v67
  v_and_b32 v78, 0xffff0000, v66
  v_lshlrev_b32 v79, 16, v66
  v_fma_f32 v48, v76, s14, v48
  v_fma_f32 v49, v77, s14, v49
  v_fma_f32 v50, v78, s14, v50
  v_fma_f32 v51, v79, s14, v51
  v_lshlrev_b32 v80, 16, v10
  v_and_b32 v81, 0xffff0000, v10
  v_lshlrev_b32 v82, 16, v11
  v_and_b32 v83, 0xffff0000, v11
  v_fma_f32 v48, v48, s18, v80
  v_fma_f32 v49, v49, s18, v81
  v_fma_f32 v50, v50, s18, v82
  v_fma_f32 v51, v51, s18, v83
  v_cvt_pk_bf16_f32 v86, v48, v49
  v_cvt_pk_bf16_f32 v87, v50, v51
  buffer_store_dwordx2 v[86:87], v21, s[8:11], s26 offen sc1
  s_branch k1_kernel_exit
k1_P1:
  s_load_dwordx2 s[4:5], s[0:1], 80
  s_load_dwordx2 s[8:9], s[0:1], 144
  s_waitcnt lgkmcnt(0)
  s_and_b32 s5, s5, 0xffff
  s_mov_b32 s6, 5308416
  s_mov_b32 s7, 0x20000
  s_and_b32 s9, s9, 0xffff
  s_mov_b32 s10, 67108864
  s_mov_b32 s11, 0x20000
  s_lshr_b32 s20, s3, 3
  s_and_b32 s21, s3, 7
  s_mul_i32 s12, s20, 294912
  s_mul_i32 s13, s21, 1152
  s_add_u32 s12, s12, s13
  v_lshrrev_b32 v1, 3, v0
  v_and_b32 v2, 7, v0
  v_mul_u32_u24 v3, 9216, v1
  v_lshl_add_u32 v3, v2, 4, v3
  buffer_load_dwordx4 v[8:11], v3, s[4:7], s12 offen
  buffer_load_dwordx4 v[12:15], v3, s[4:7], s12 offen offset:128
  buffer_load_dwordx4 v[16:19], v3, s[4:7], s12 offen offset:256
  buffer_load_dwordx4 v[20:23], v3, s[4:7], s12 offen offset:384
  buffer_load_dwordx4 v[24:27], v3, s[4:7], s12 offen offset:512
  buffer_load_dwordx4 v[28:31], v3, s[4:7], s12 offen offset:640
  buffer_load_dwordx4 v[32:35], v3, s[4:7], s12 offen offset:768
  buffer_load_dwordx4 v[36:39], v3, s[4:7], s12 offen offset:896
  buffer_load_dwordx4 v[40:43], v3, s[4:7], s12 offen offset:1024
  v_lshlrev_b32 v4, 2, v1
  s_lshl_b32 s13, s20, 7
  s_add_u32 s13, s13, 9216
  buffer_load_dword v48, v4, s[8:11], s13 offen
  s_waitcnt vmcnt(0)
  v_add_f32 v48, 1.0, v48
  v_cvt_pk_bf16_f32 v48, v48, v48
  v_and_b32 v48, 0xffff0000, v48
  v_mov_b32 v49, v48
  v_lshlrev_b32 v52, 16, v8
  v_and_b32 v53, 0xffff0000, v8
  v_pk_mul_f32 v[52:53], v[52:53], v[48:49]
  v_cvt_pk_bf16_f32 v8, v52, v53
  v_lshlrev_b32 v54, 16, v9
  v_and_b32 v55, 0xffff0000, v9
  v_pk_mul_f32 v[54:55], v[54:55], v[48:49]
  v_cvt_pk_bf16_f32 v9, v54, v55
  v_lshlrev_b32 v56, 16, v10
  v_and_b32 v57, 0xffff0000, v10
  v_pk_mul_f32 v[56:57], v[56:57], v[48:49]
  v_cvt_pk_bf16_f32 v10, v56, v57
  v_lshlrev_b32 v58, 16, v11
  v_and_b32 v59, 0xffff0000, v11
  v_pk_mul_f32 v[58:59], v[58:59], v[48:49]
  v_cvt_pk_bf16_f32 v11, v58, v59
  v_lshlrev_b32 v52, 16, v12
  v_and_b32 v53, 0xffff0000, v12
  v_pk_mul_f32 v[52:53], v[52:53], v[48:49]
  v_cvt_pk_bf16_f32 v12, v52, v53
  v_lshlrev_b32 v54, 16, v13
  v_and_b32 v55, 0xffff0000, v13
  v_pk_mul_f32 v[54:55], v[54:55], v[48:49]
  v_cvt_pk_bf16_f32 v13, v54, v55
  v_lshlrev_b32 v56, 16, v14
  v_and_b32 v57, 0xffff0000, v14
  v_pk_mul_f32 v[56:57], v[56:57], v[48:49]
  v_cvt_pk_bf16_f32 v14, v56, v57
  v_lshlrev_b32 v58, 16, v15
  v_and_b32 v59, 0xffff0000, v15
  v_pk_mul_f32 v[58:59], v[58:59], v[48:49]
  v_cvt_pk_bf16_f32 v15, v58, v59
  v_lshlrev_b32 v52, 16, v16
  v_and_b32 v53, 0xffff0000, v16
  v_pk_mul_f32 v[52:53], v[52:53], v[48:49]
  v_cvt_pk_bf16_f32 v16, v52, v53
  v_lshlrev_b32 v54, 16, v17
  v_and_b32 v55, 0xffff0000, v17
  v_pk_mul_f32 v[54:55], v[54:55], v[48:49]
  v_cvt_pk_bf16_f32 v17, v54, v55
  v_lshlrev_b32 v56, 16, v18
  v_and_b32 v57, 0xffff0000, v18
  v_pk_mul_f32 v[56:57], v[56:57], v[48:49]
  v_cvt_pk_bf16_f32 v18, v56, v57
  v_lshlrev_b32 v58, 16, v19
  v_and_b32 v59, 0xffff0000, v19
  v_pk_mul_f32 v[58:59], v[58:59], v[48:49]
  v_cvt_pk_bf16_f32 v19, v58, v59
  v_lshlrev_b32 v52, 16, v20
  v_and_b32 v53, 0xffff0000, v20
  v_pk_mul_f32 v[52:53], v[52:53], v[48:49]
  v_cvt_pk_bf16_f32 v20, v52, v53
  v_lshlrev_b32 v54, 16, v21
  v_and_b32 v55, 0xffff0000, v21
  v_pk_mul_f32 v[54:55], v[54:55], v[48:49]
  v_cvt_pk_bf16_f32 v21, v54, v55
  v_lshlrev_b32 v56, 16, v22
  v_and_b32 v57, 0xffff0000, v22
  v_pk_mul_f32 v[56:57], v[56:57], v[48:49]
  v_cvt_pk_bf16_f32 v22, v56, v57
  v_lshlrev_b32 v58, 16, v23
  v_and_b32 v59, 0xffff0000, v23
  v_pk_mul_f32 v[58:59], v[58:59], v[48:49]
  v_cvt_pk_bf16_f32 v23, v58, v59
  v_lshlrev_b32 v52, 16, v24
  v_and_b32 v53, 0xffff0000, v24
  v_pk_mul_f32 v[52:53], v[52:53], v[48:49]
  v_cvt_pk_bf16_f32 v24, v52, v53
  v_lshlrev_b32 v54, 16, v25
  v_and_b32 v55, 0xffff0000, v25
  v_pk_mul_f32 v[54:55], v[54:55], v[48:49]
  v_cvt_pk_bf16_f32 v25, v54, v55
  v_lshlrev_b32 v56, 16, v26
  v_and_b32 v57, 0xffff0000, v26
  v_pk_mul_f32 v[56:57], v[56:57], v[48:49]
  v_cvt_pk_bf16_f32 v26, v56, v57
  v_lshlrev_b32 v58, 16, v27
  v_and_b32 v59, 0xffff0000, v27
  v_pk_mul_f32 v[58:59], v[58:59], v[48:49]
  v_cvt_pk_bf16_f32 v27, v58, v59
  v_lshlrev_b32 v52, 16, v28
  v_and_b32 v53, 0xffff0000, v28
  v_pk_mul_f32 v[52:53], v[52:53], v[48:49]
  v_cvt_pk_bf16_f32 v28, v52, v53
  v_lshlrev_b32 v54, 16, v29
  v_and_b32 v55, 0xffff0000, v29
  v_pk_mul_f32 v[54:55], v[54:55], v[48:49]
  v_cvt_pk_bf16_f32 v29, v54, v55
  v_lshlrev_b32 v56, 16, v30
  v_and_b32 v57, 0xffff0000, v30
  v_pk_mul_f32 v[56:57], v[56:57], v[48:49]
  v_cvt_pk_bf16_f32 v30, v56, v57
  v_lshlrev_b32 v58, 16, v31
  v_and_b32 v59, 0xffff0000, v31
  v_pk_mul_f32 v[58:59], v[58:59], v[48:49]
  v_cvt_pk_bf16_f32 v31, v58, v59
  v_lshlrev_b32 v52, 16, v32
  v_and_b32 v53, 0xffff0000, v32
  v_pk_mul_f32 v[52:53], v[52:53], v[48:49]
  v_cvt_pk_bf16_f32 v32, v52, v53
  v_lshlrev_b32 v54, 16, v33
  v_and_b32 v55, 0xffff0000, v33
  v_pk_mul_f32 v[54:55], v[54:55], v[48:49]
  v_cvt_pk_bf16_f32 v33, v54, v55
  v_lshlrev_b32 v56, 16, v34
  v_and_b32 v57, 0xffff0000, v34
  v_pk_mul_f32 v[56:57], v[56:57], v[48:49]
  v_cvt_pk_bf16_f32 v34, v56, v57
  v_lshlrev_b32 v58, 16, v35
  v_and_b32 v59, 0xffff0000, v35
  v_pk_mul_f32 v[58:59], v[58:59], v[48:49]
  v_cvt_pk_bf16_f32 v35, v58, v59
  v_lshlrev_b32 v52, 16, v36
  v_and_b32 v53, 0xffff0000, v36
  v_pk_mul_f32 v[52:53], v[52:53], v[48:49]
  v_cvt_pk_bf16_f32 v36, v52, v53
  v_lshlrev_b32 v54, 16, v37
  v_and_b32 v55, 0xffff0000, v37
  v_pk_mul_f32 v[54:55], v[54:55], v[48:49]
  v_cvt_pk_bf16_f32 v37, v54, v55
  v_lshlrev_b32 v56, 16, v38
  v_and_b32 v57, 0xffff0000, v38
  v_pk_mul_f32 v[56:57], v[56:57], v[48:49]
  v_cvt_pk_bf16_f32 v38, v56, v57
  v_lshlrev_b32 v58, 16, v39
  v_and_b32 v59, 0xffff0000, v39
  v_pk_mul_f32 v[58:59], v[58:59], v[48:49]
  v_cvt_pk_bf16_f32 v39, v58, v59
  v_lshlrev_b32 v52, 16, v40
  v_and_b32 v53, 0xffff0000, v40
  v_pk_mul_f32 v[52:53], v[52:53], v[48:49]
  v_cvt_pk_bf16_f32 v40, v52, v53
  v_lshlrev_b32 v54, 16, v41
  v_and_b32 v55, 0xffff0000, v41
  v_pk_mul_f32 v[54:55], v[54:55], v[48:49]
  v_cvt_pk_bf16_f32 v41, v54, v55
  v_lshlrev_b32 v56, 16, v42
  v_and_b32 v57, 0xffff0000, v42
  v_pk_mul_f32 v[56:57], v[56:57], v[48:49]
  v_cvt_pk_bf16_f32 v42, v56, v57
  v_lshlrev_b32 v58, 16, v43
  v_and_b32 v59, 0xffff0000, v43
  v_pk_mul_f32 v[58:59], v[58:59], v[48:49]
  v_cvt_pk_bf16_f32 v43, v58, v59
  v_mul_u32_u24 v3, 1168, v1
  v_lshl_add_u32 v3, v2, 4, v3
  ds_write_b128 v3, v[8:11] offset:0
  ds_write_b128 v3, v[12:15] offset:128
  ds_write_b128 v3, v[16:19] offset:256
  ds_write_b128 v3, v[20:23] offset:384
  ds_write_b128 v3, v[24:27] offset:512
  ds_write_b128 v3, v[28:31] offset:640
  ds_write_b128 v3, v[32:35] offset:768
  ds_write_b128 v3, v[36:39] offset:896
  ds_write_b128 v3, v[40:43] offset:1024
  s_waitcnt lgkmcnt(0)
  s_barrier
  v_and_b32 v4, 63, v0
  v_lshrrev_b32 v5, 6, v0
  v_lshrrev_b32 v6, 4, v4
  v_bfe_u32 v7, v4, 2, 2
  v_lshl_add_u32 v7, v6, 3, v7
  v_mul_u32_u24 v7, 1168, v7
  v_and_b32 v50, 3, v4
  v_lshl_add_u32 v7, v50, 3, v7
  v_mul_u32_u24 v50, 288, v5
  v_add_u32 v7, v7, v50
  ds_read_b64_tr_b16 v[8:9], v7 offset:0
  ds_read_b64_tr_b16 v[10:11], v7 offset:4672
  ds_read_b64_tr_b16 v[12:13], v7 offset:32
  ds_read_b64_tr_b16 v[14:15], v7 offset:4704
  ds_read_b64_tr_b16 v[16:17], v7 offset:64
  ds_read_b64_tr_b16 v[18:19], v7 offset:4736
  ds_read_b64_tr_b16 v[20:21], v7 offset:96
  ds_read_b64_tr_b16 v[22:23], v7 offset:4768
  ds_read_b64_tr_b16 v[24:25], v7 offset:128
  ds_read_b64_tr_b16 v[26:27], v7 offset:4800
  ds_read_b64_tr_b16 v[28:29], v7 offset:160
  ds_read_b64_tr_b16 v[30:31], v7 offset:4832
  ds_read_b64_tr_b16 v[32:33], v7 offset:192
  ds_read_b64_tr_b16 v[34:35], v7 offset:4864
  ds_read_b64_tr_b16 v[36:37], v7 offset:224
  ds_read_b64_tr_b16 v[38:39], v7 offset:4896
  ds_read_b64_tr_b16 v[40:41], v7 offset:256
  ds_read_b64_tr_b16 v[42:43], v7 offset:4928
  v_lshlrev_b32 v50, 4, v4
  v_readfirstlane_b32 s14, v5
  s_lshl_b32 s22, s21, 2
  s_add_u32 s22, s22, s14
  s_cmp_lt_u32 s22, 16
  s_cselect_b32 s16, 1, 0
  s_and_b32 s22, s22, 15
  s_lshl_b32 s17, s22, 1
  s_add_u32 s17, s17, s16
  s_mul_i32 s17, s17, 18
  s_add_u32 s17, s17, s20
  s_mul_i32 s17, s17, 9216
  s_add_u32 s17, s17, 16777216
  s_add_u32 s18, s17, 4096
  s_add_u32 s19, s17, 8192
  s_waitcnt lgkmcnt(15)
  buffer_store_dwordx4 v[8:11], v50, s[8:11], s17 offen sc1
  s_waitcnt lgkmcnt(14)
  buffer_store_dwordx4 v[12:15], v50, s[8:11], s17 offen offset:1024 sc1
  s_waitcnt lgkmcnt(12)
  buffer_store_dwordx4 v[16:19], v50, s[8:11], s17 offen offset:2048 sc1
  s_waitcnt lgkmcnt(10)
  buffer_store_dwordx4 v[20:23], v50, s[8:11], s17 offen offset:3072 sc1
  s_waitcnt lgkmcnt(8)
  buffer_store_dwordx4 v[24:27], v50, s[8:11], s18 offen sc1
  s_waitcnt lgkmcnt(6)
  buffer_store_dwordx4 v[28:31], v50, s[8:11], s18 offen offset:1024 sc1
  s_waitcnt lgkmcnt(4)
  buffer_store_dwordx4 v[32:35], v50, s[8:11], s18 offen offset:2048 sc1
  s_waitcnt lgkmcnt(2)
  buffer_store_dwordx4 v[36:39], v50, s[8:11], s18 offen offset:3072 sc1
  s_waitcnt lgkmcnt(0)
  buffer_store_dwordx4 v[40:43], v50, s[8:11], s19 offen sc1
  s_branch k1_kernel_exit
k1_CS:
  s_and_b32 s13, s3, 7
  s_lshl_b32 s13, s13, 1
  s_bfe_u32 s14, s3, 0x10003
  s_or_b32 s13, s13, s14
  s_andn2_b32 s3, s3, 15
  s_or_b32 s3, s3, s13
  s_load_dwordx2 s[6:7], s[0:1], 80
  s_load_dwordx2 s[16:17], s[0:1], 144
  v_and_b32 v1, 3, v0
  v_lshrrev_b32 v2, 2, v0
  v_mul_u32_u24 v3, 9216, v2
  v_lshl_add_u32 v3, v1, 4, v3
  s_lshl_b32 s13, s3, 6
  v_lshlrev_b32 v4, 2, v2
  s_mov_b32 s20, 6912
  s_mov_b32 s21, 9216
  s_waitcnt lgkmcnt(0)
  s_mov_b32 s8, s6
  s_and_b32 s9, s7, 0xffff
  s_mov_b32 s10, 5308416
  s_mov_b32 s11, 0x20000
  s_and_b32 s17, s17, 0xffff
  s_mov_b32 s18, 67108864
  s_mov_b32 s19, 0x20000
  buffer_load_dword v48, v4, s[16:19], s20 offen offset:0
  buffer_load_dword v58, v4, s[16:19], s21 offen offset:0
  buffer_load_dword v49, v4, s[16:19], s20 offen offset:256
  buffer_load_dword v59, v4, s[16:19], s21 offen offset:256
  buffer_load_dword v50, v4, s[16:19], s20 offen offset:512
  buffer_load_dword v60, v4, s[16:19], s21 offen offset:512
  buffer_load_dword v51, v4, s[16:19], s20 offen offset:768
  buffer_load_dword v61, v4, s[16:19], s21 offen offset:768
  buffer_load_dword v52, v4, s[16:19], s20 offen offset:1024
  buffer_load_dword v62, v4, s[16:19], s21 offen offset:1024
  buffer_load_dword v53, v4, s[16:19], s20 offen offset:1280
  buffer_load_dword v63, v4, s[16:19], s21 offen offset:1280
  buffer_load_dword v54, v4, s[16:19], s20 offen offset:1536
  buffer_load_dword v64, v4, s[16:19], s21 offen offset:1536
  buffer_load_dword v55, v4, s[16:19], s20 offen offset:1792
  buffer_load_dword v65, v4, s[16:19], s21 offen offset:1792
  buffer_load_dword v56, v4, s[16:19], s20 offen offset:2048
  buffer_load_dword v66, v4, s[16:19], s21 offen offset:2048
  buffer_load_dwordx4 v[8:11], v3, s[8:11], s13 offen
  s_add_u32 s13, s13, 589824
  buffer_load_dwordx4 v[12:15], v3, s[8:11], s13 offen
  s_add_u32 s13, s13, 589824
  buffer_load_dwordx4 v[16:19], v3, s[8:11], s13 offen
  s_add_u32 s13, s13, 589824
  buffer_load_dwordx4 v[20:23], v3, s[8:11], s13 offen
  s_add_u32 s13, s13, 589824
  buffer_load_dwordx4 v[24:27], v3, s[8:11], s13 offen
  s_add_u32 s13, s13, 589824
  buffer_load_dwordx4 v[28:31], v3, s[8:11], s13 offen
  s_add_u32 s13, s13, 589824
  buffer_load_dwordx4 v[32:35], v3, s[8:11], s13 offen
  s_add_u32 s13, s13, 589824
  buffer_load_dwordx4 v[36:39], v3, s[8:11], s13 offen
  s_add_u32 s13, s13, 589824
  buffer_load_dwordx4 v[40:43], v3, s[8:11], s13 offen
  v_mov_b32 v70, 0
  v_mov_b32 v71, 0
  v_mov_b32 v72, 0
  v_mov_b32 v73, 0
  v_mov_b32 v74, 0
  v_mov_b32 v75, 0
  v_mov_b32 v76, 0
  v_mov_b32 v77, 0
  v_mov_b32 v78, 0
  v_mov_b32 v79, 0
  v_mov_b32 v80, 0
  v_mov_b32 v81, 0
  v_mov_b32 v82, 0
  v_mov_b32 v83, 0
  v_mov_b32 v84, 0
  v_mov_b32 v85, 0
  s_waitcnt vmcnt(9)
  v_add_f32 v58, 1.0, v58
  v_lshrrev_b32 v88, 16, v48
  v_cvt_pk_bf16_f32 v58, 0, v58
  v_lshrrev_b32 v98, 16, v58
  v_add_f32 v59, 1.0, v59
  v_lshrrev_b32 v89, 16, v49
  v_cvt_pk_bf16_f32 v59, 0, v59
  v_lshrrev_b32 v99, 16, v59
  v_add_f32 v60, 1.0, v60
  v_lshrrev_b32 v90, 16, v50
  v_cvt_pk_bf16_f32 v60, 0, v60
  v_lshrrev_b32 v100, 16, v60
  v_add_f32 v61, 1.0, v61
  v_lshrrev_b32 v91, 16, v51
  v_cvt_pk_bf16_f32 v61, 0, v61
  v_lshrrev_b32 v101, 16, v61
  v_add_f32 v62, 1.0, v62
  v_lshrrev_b32 v92, 16, v52
  v_cvt_pk_bf16_f32 v62, 0, v62
  v_lshrrev_b32 v102, 16, v62
  v_add_f32 v63, 1.0, v63
  v_lshrrev_b32 v93, 16, v53
  v_cvt_pk_bf16_f32 v63, 0, v63
  v_lshrrev_b32 v103, 16, v63
  v_add_f32 v64, 1.0, v64
  v_lshrrev_b32 v94, 16, v54
  v_cvt_pk_bf16_f32 v64, 0, v64
  v_lshrrev_b32 v104, 16, v64
  v_add_f32 v65, 1.0, v65
  v_lshrrev_b32 v95, 16, v55
  v_cvt_pk_bf16_f32 v65, 0, v65
  v_lshrrev_b32 v105, 16, v65
  v_add_f32 v66, 1.0, v66
  v_lshrrev_b32 v96, 16, v56
  v_cvt_pk_bf16_f32 v66, 0, v66
  v_lshrrev_b32 v106, 16, v66
  s_waitcnt vmcnt(8)
  v_dot2c_f32_bf16 v70, v8, v98
  v_dot2c_f32_bf16 v71, v8, v58
  v_dot2c_f32_bf16 v78, v8, v88
  v_dot2c_f32_bf16 v79, v8, v48
  v_dot2c_f32_bf16 v72, v9, v98
  v_dot2c_f32_bf16 v73, v9, v58
  v_dot2c_f32_bf16 v80, v9, v88
  v_dot2c_f32_bf16 v81, v9, v48
  v_dot2c_f32_bf16 v74, v10, v98
  v_dot2c_f32_bf16 v75, v10, v58
  v_dot2c_f32_bf16 v82, v10, v88
  v_dot2c_f32_bf16 v83, v10, v48
  v_dot2c_f32_bf16 v76, v11, v98
  v_dot2c_f32_bf16 v77, v11, v58
  v_dot2c_f32_bf16 v84, v11, v88
  v_dot2c_f32_bf16 v85, v11, v48
  s_waitcnt vmcnt(7)
  v_dot2c_f32_bf16 v70, v12, v99
  v_dot2c_f32_bf16 v71, v12, v59
  v_dot2c_f32_bf16 v78, v12, v89
  v_dot2c_f32_bf16 v79, v12, v49
  v_dot2c_f32_bf16 v72, v13, v99
  v_dot2c_f32_bf16 v73, v13, v59
  v_dot2c_f32_bf16 v80, v13, v89
  v_dot2c_f32_bf16 v81, v13, v49
  v_dot2c_f32_bf16 v74, v14, v99
  v_dot2c_f32_bf16 v75, v14, v59
  v_dot2c_f32_bf16 v82, v14, v89
  v_dot2c_f32_bf16 v83, v14, v49
  v_dot2c_f32_bf16 v76, v15, v99
  v_dot2c_f32_bf16 v77, v15, v59
  v_dot2c_f32_bf16 v84, v15, v89
  v_dot2c_f32_bf16 v85, v15, v49
  s_waitcnt vmcnt(6)
  v_dot2c_f32_bf16 v70, v16, v100
  v_dot2c_f32_bf16 v71, v16, v60
  v_dot2c_f32_bf16 v78, v16, v90
  v_dot2c_f32_bf16 v79, v16, v50
  v_dot2c_f32_bf16 v72, v17, v100
  v_dot2c_f32_bf16 v73, v17, v60
  v_dot2c_f32_bf16 v80, v17, v90
  v_dot2c_f32_bf16 v81, v17, v50
  v_dot2c_f32_bf16 v74, v18, v100
  v_dot2c_f32_bf16 v75, v18, v60
  v_dot2c_f32_bf16 v82, v18, v90
  v_dot2c_f32_bf16 v83, v18, v50
  v_dot2c_f32_bf16 v76, v19, v100
  v_dot2c_f32_bf16 v77, v19, v60
  v_dot2c_f32_bf16 v84, v19, v90
  v_dot2c_f32_bf16 v85, v19, v50
  s_waitcnt vmcnt(5)
  v_dot2c_f32_bf16 v70, v20, v101
  v_dot2c_f32_bf16 v71, v20, v61
  v_dot2c_f32_bf16 v78, v20, v91
  v_dot2c_f32_bf16 v79, v20, v51
  v_dot2c_f32_bf16 v72, v21, v101
  v_dot2c_f32_bf16 v73, v21, v61
  v_dot2c_f32_bf16 v80, v21, v91
  v_dot2c_f32_bf16 v81, v21, v51
  v_dot2c_f32_bf16 v74, v22, v101
  v_dot2c_f32_bf16 v75, v22, v61
  v_dot2c_f32_bf16 v82, v22, v91
  v_dot2c_f32_bf16 v83, v22, v51
  v_dot2c_f32_bf16 v76, v23, v101
  v_dot2c_f32_bf16 v77, v23, v61
  v_dot2c_f32_bf16 v84, v23, v91
  v_dot2c_f32_bf16 v85, v23, v51
  s_waitcnt vmcnt(4)
  v_dot2c_f32_bf16 v70, v24, v102
  v_dot2c_f32_bf16 v71, v24, v62
  v_dot2c_f32_bf16 v78, v24, v92
  v_dot2c_f32_bf16 v79, v24, v52
  v_dot2c_f32_bf16 v72, v25, v102
  v_dot2c_f32_bf16 v73, v25, v62
  v_dot2c_f32_bf16 v80, v25, v92
  v_dot2c_f32_bf16 v81, v25, v52
  v_dot2c_f32_bf16 v74, v26, v102
  v_dot2c_f32_bf16 v75, v26, v62
  v_dot2c_f32_bf16 v82, v26, v92
  v_dot2c_f32_bf16 v83, v26, v52
  v_dot2c_f32_bf16 v76, v27, v102
  v_dot2c_f32_bf16 v77, v27, v62
  v_dot2c_f32_bf16 v84, v27, v92
  v_dot2c_f32_bf16 v85, v27, v52
  s_waitcnt vmcnt(3)
  v_dot2c_f32_bf16 v70, v28, v103
  v_dot2c_f32_bf16 v71, v28, v63
  v_dot2c_f32_bf16 v78, v28, v93
  v_dot2c_f32_bf16 v79, v28, v53
  v_dot2c_f32_bf16 v72, v29, v103
  v_dot2c_f32_bf16 v73, v29, v63
  v_dot2c_f32_bf16 v80, v29, v93
  v_dot2c_f32_bf16 v81, v29, v53
  v_dot2c_f32_bf16 v74, v30, v103
  v_dot2c_f32_bf16 v75, v30, v63
  v_dot2c_f32_bf16 v82, v30, v93
  v_dot2c_f32_bf16 v83, v30, v53
  v_dot2c_f32_bf16 v76, v31, v103
  v_dot2c_f32_bf16 v77, v31, v63
  v_dot2c_f32_bf16 v84, v31, v93
  v_dot2c_f32_bf16 v85, v31, v53
  s_waitcnt vmcnt(2)
  v_dot2c_f32_bf16 v70, v32, v104
  v_dot2c_f32_bf16 v71, v32, v64
  v_dot2c_f32_bf16 v78, v32, v94
  v_dot2c_f32_bf16 v79, v32, v54
  v_dot2c_f32_bf16 v72, v33, v104
  v_dot2c_f32_bf16 v73, v33, v64
  v_dot2c_f32_bf16 v80, v33, v94
  v_dot2c_f32_bf16 v81, v33, v54
  v_dot2c_f32_bf16 v74, v34, v104
  v_dot2c_f32_bf16 v75, v34, v64
  v_dot2c_f32_bf16 v82, v34, v94
  v_dot2c_f32_bf16 v83, v34, v54
  v_dot2c_f32_bf16 v76, v35, v104
  v_dot2c_f32_bf16 v77, v35, v64
  v_dot2c_f32_bf16 v84, v35, v94
  v_dot2c_f32_bf16 v85, v35, v54
  s_waitcnt vmcnt(1)
  v_dot2c_f32_bf16 v70, v36, v105
  v_dot2c_f32_bf16 v71, v36, v65
  v_dot2c_f32_bf16 v78, v36, v95
  v_dot2c_f32_bf16 v79, v36, v55
  v_dot2c_f32_bf16 v72, v37, v105
  v_dot2c_f32_bf16 v73, v37, v65
  v_dot2c_f32_bf16 v80, v37, v95
  v_dot2c_f32_bf16 v81, v37, v55
  v_dot2c_f32_bf16 v74, v38, v105
  v_dot2c_f32_bf16 v75, v38, v65
  v_dot2c_f32_bf16 v82, v38, v95
  v_dot2c_f32_bf16 v83, v38, v55
  v_dot2c_f32_bf16 v76, v39, v105
  v_dot2c_f32_bf16 v77, v39, v65
  v_dot2c_f32_bf16 v84, v39, v95
  v_dot2c_f32_bf16 v85, v39, v55
  s_waitcnt vmcnt(0)
  v_dot2c_f32_bf16 v70, v40, v106
  v_dot2c_f32_bf16 v71, v40, v66
  v_dot2c_f32_bf16 v78, v40, v96
  v_dot2c_f32_bf16 v79, v40, v56
  v_dot2c_f32_bf16 v72, v41, v106
  v_dot2c_f32_bf16 v73, v41, v66
  v_dot2c_f32_bf16 v80, v41, v96
  v_dot2c_f32_bf16 v81, v41, v56
  v_dot2c_f32_bf16 v74, v42, v106
  v_dot2c_f32_bf16 v75, v42, v66
  v_dot2c_f32_bf16 v82, v42, v96
  v_dot2c_f32_bf16 v83, v42, v56
  v_dot2c_f32_bf16 v76, v43, v106
  v_dot2c_f32_bf16 v77, v43, v66
  v_dot2c_f32_bf16 v84, v43, v96
  v_dot2c_f32_bf16 v85, v43, v56
  v_add_f32_dpp v70, v70, v70 row_ror:4 row_mask:0xf bank_mask:0xf
  v_add_f32_dpp v71, v71, v71 row_ror:4 row_mask:0xf bank_mask:0xf
  v_add_f32_dpp v72, v72, v72 row_ror:4 row_mask:0xf bank_mask:0xf
  v_add_f32_dpp v73, v73, v73 row_ror:4 row_mask:0xf bank_mask:0xf
  v_add_f32_dpp v74, v74, v74 row_ror:4 row_mask:0xf bank_mask:0xf
  v_add_f32_dpp v75, v75, v75 row_ror:4 row_mask:0xf bank_mask:0xf
  v_add_f32_dpp v76, v76, v76 row_ror:4 row_mask:0xf bank_mask:0xf
  v_add_f32_dpp v77, v77, v77 row_ror:4 row_mask:0xf bank_mask:0xf
  v_add_f32_dpp v78, v78, v78 row_ror:4 row_mask:0xf bank_mask:0xf
  v_add_f32_dpp v79, v79, v79 row_ror:4 row_mask:0xf bank_mask:0xf
  v_add_f32_dpp v80, v80, v80 row_ror:4 row_mask:0xf bank_mask:0xf
  v_add_f32_dpp v81, v81, v81 row_ror:4 row_mask:0xf bank_mask:0xf
  v_add_f32_dpp v82, v82, v82 row_ror:4 row_mask:0xf bank_mask:0xf
  v_add_f32_dpp v83, v83, v83 row_ror:4 row_mask:0xf bank_mask:0xf
  v_add_f32_dpp v84, v84, v84 row_ror:4 row_mask:0xf bank_mask:0xf
  v_add_f32_dpp v85, v85, v85 row_ror:4 row_mask:0xf bank_mask:0xf
  v_add_f32_dpp v70, v70, v70 row_ror:8 row_mask:0xf bank_mask:0xf
  v_add_f32_dpp v71, v71, v71 row_ror:8 row_mask:0xf bank_mask:0xf
  v_add_f32_dpp v72, v72, v72 row_ror:8 row_mask:0xf bank_mask:0xf
  v_add_f32_dpp v73, v73, v73 row_ror:8 row_mask:0xf bank_mask:0xf
  v_add_f32_dpp v74, v74, v74 row_ror:8 row_mask:0xf bank_mask:0xf
  v_add_f32_dpp v75, v75, v75 row_ror:8 row_mask:0xf bank_mask:0xf
  v_add_f32_dpp v76, v76, v76 row_ror:8 row_mask:0xf bank_mask:0xf
  v_add_f32_dpp v77, v77, v77 row_ror:8 row_mask:0xf bank_mask:0xf
  v_add_f32_dpp v78, v78, v78 row_ror:8 row_mask:0xf bank_mask:0xf
  v_add_f32_dpp v79, v79, v79 row_ror:8 row_mask:0xf bank_mask:0xf
  v_add_f32_dpp v80, v80, v80 row_ror:8 row_mask:0xf bank_mask:0xf
  v_add_f32_dpp v81, v81, v81 row_ror:8 row_mask:0xf bank_mask:0xf
  v_add_f32_dpp v82, v82, v82 row_ror:8 row_mask:0xf bank_mask:0xf
  v_add_f32_dpp v83, v83, v83 row_ror:8 row_mask:0xf bank_mask:0xf
  v_add_f32_dpp v84, v84, v84 row_ror:8 row_mask:0xf bank_mask:0xf
  v_add_f32_dpp v85, v85, v85 row_ror:8 row_mask:0xf bank_mask:0xf
  v_lshrrev_b32 v5, 4, v0
  v_lshlrev_b32 v5, 7, v5
  v_lshl_add_u32 v5, v1, 5, v5
  v_bfe_u32 v6, v0, 2, 2
  v_cmp_eq_u32 vcc, 0, v6
  s_nop 0
  s_and_saveexec_b64 s[14:15], vcc
  ds_write_b128 v5, v[70:73]
  ds_write_b128 v5, v[74:77] offset:16
  ds_write_b128 v5, v[78:81] offset:2048
  ds_write_b128 v5, v[82:85] offset:2064
  s_mov_b64 exec, s[14:15]
  s_waitcnt lgkmcnt(0)
  s_barrier
  v_cmp_gt_u32 vcc, 64, v0
  s_nop 0
  s_and_saveexec_b64 s[14:15], vcc
  s_cbranch_execz k1_kernel_exit
  v_and_b32 v5, 31, v0
  v_lshlrev_b32 v5, 2, v5
  v_lshrrev_b32 v6, 5, v0
  v_lshl_add_u32 v7, v6, 11, v5
  ds_read_b32 v8, v7 offset:0
  ds_read_b32 v9, v7 offset:128
  ds_read_b32 v10, v7 offset:256
  ds_read_b32 v11, v7 offset:384
  ds_read_b32 v12, v7 offset:512
  ds_read_b32 v13, v7 offset:640
  ds_read_b32 v14, v7 offset:768
  ds_read_b32 v15, v7 offset:896
  ds_read_b32 v16, v7 offset:1024
  ds_read_b32 v17, v7 offset:1152
  ds_read_b32 v18, v7 offset:1280
  ds_read_b32 v19, v7 offset:1408
  ds_read_b32 v20, v7 offset:1536
  ds_read_b32 v21, v7 offset:1664
  ds_read_b32 v22, v7 offset:1792
  ds_read_b32 v23, v7 offset:1920
  s_waitcnt lgkmcnt(0)
  v_add_f32 v8, v8, v16
  v_add_f32 v9, v9, v17
  v_add_f32 v10, v10, v18
  v_add_f32 v11, v11, v19
  v_add_f32 v12, v12, v20
  v_add_f32 v13, v13, v21
  v_add_f32 v14, v14, v22
  v_add_f32 v15, v15, v23
  v_add_f32 v8, v8, v12
  v_add_f32 v9, v9, v13
  v_add_f32 v10, v10, v14
  v_add_f32 v11, v11, v15
  v_add_f32 v8, v8, v10
  v_add_f32 v9, v9, v11
  v_add_f32 v8, v8, v9
  v_mul_u32_u24 v6, 20480, v6
  v_add_u32 v5, v5, v6
  s_lshl_b32 s13, s3, 7
  s_add_u32 s13, s13, 32768
  buffer_store_dword v8, v5, s[16:19], s13 offen sc1
  s_branch k1_kernel_exit
k1_P2:
  s_load_dwordx2 s[4:5], s[0:1], 104
  s_load_dwordx2 s[8:9], s[0:1], 144
  s_waitcnt lgkmcnt(0)
  s_and_b32 s5, s5, 0xffff
  s_mov_b32 s6, 2654208
  s_mov_b32 s7, 0x20000
  s_and_b32 s9, s9, 0xffff
  s_mov_b32 s10, 67108864
  s_mov_b32 s11, 0x20000
  s_mul_i32 s12, s3, 36864
  v_lshrrev_b32 v1, 3, v0
  v_and_b32 v2, 7, v0
  v_mul_u32_u24 v3, 1152, v1
  v_lshl_add_u32 v3, v2, 4, v3
  buffer_load_dwordx4 v[8:11], v3, s[4:7], s12 offen
  buffer_load_dwordx4 v[12:15], v3, s[4:7], s12 offen offset:128
  buffer_load_dwordx4 v[16:19], v3, s[4:7], s12 offen offset:256
  buffer_load_dwordx4 v[20:23], v3, s[4:7], s12 offen offset:384
  buffer_load_dwordx4 v[24:27], v3, s[4:7], s12 offen offset:512
  buffer_load_dwordx4 v[28:31], v3, s[4:7], s12 offen offset:640
  buffer_load_dwordx4 v[32:35], v3, s[4:7], s12 offen offset:768
  buffer_load_dwordx4 v[36:39], v3, s[4:7], s12 offen offset:896
  buffer_load_dwordx4 v[40:43], v3, s[4:7], s12 offen offset:1024
  s_waitcnt vmcnt(0)
  v_mul_u32_u24 v3, 1168, v1
  v_lshl_add_u32 v3, v2, 4, v3
  ds_write_b128 v3, v[8:11] offset:0
  ds_write_b128 v3, v[12:15] offset:128
  ds_write_b128 v3, v[16:19] offset:256
  ds_write_b128 v3, v[20:23] offset:384
  ds_write_b128 v3, v[24:27] offset:512
  ds_write_b128 v3, v[28:31] offset:640
  ds_write_b128 v3, v[32:35] offset:768
  ds_write_b128 v3, v[36:39] offset:896
  ds_write_b128 v3, v[40:43] offset:1024
  s_waitcnt lgkmcnt(0)
  s_barrier
  v_and_b32 v4, 63, v0
  v_lshrrev_b32 v5, 6, v0
  v_lshrrev_b32 v6, 4, v4
  v_bfe_u32 v7, v4, 2, 2
  v_lshl_add_u32 v7, v6, 2, v7
  v_mul_u32_u24 v7, 1168, v7
  v_and_b32 v50, 3, v4
  v_lshl_add_u32 v7, v50, 3, v7
  v_mul_u32_u24 v50, 288, v5
  v_add_u32 v7, v7, v50
  ds_read_b64_tr_b16 v[8:9], v7 offset:0
  ds_read_b64_tr_b16 v[10:11], v7 offset:18688
  ds_read_b64_tr_b16 v[12:13], v7 offset:32
  ds_read_b64_tr_b16 v[14:15], v7 offset:18720
  ds_read_b64_tr_b16 v[16:17], v7 offset:64
  ds_read_b64_tr_b16 v[18:19], v7 offset:18752
  ds_read_b64_tr_b16 v[20:21], v7 offset:96
  ds_read_b64_tr_b16 v[22:23], v7 offset:18784
  ds_read_b64_tr_b16 v[24:25], v7 offset:128
  ds_read_b64_tr_b16 v[26:27], v7 offset:18816
  ds_read_b64_tr_b16 v[28:29], v7 offset:160
  ds_read_b64_tr_b16 v[30:31], v7 offset:18848
  ds_read_b64_tr_b16 v[32:33], v7 offset:192
  ds_read_b64_tr_b16 v[34:35], v7 offset:18880
  ds_read_b64_tr_b16 v[36:37], v7 offset:224
  ds_read_b64_tr_b16 v[38:39], v7 offset:18912
  ds_read_b64_tr_b16 v[40:41], v7 offset:256
  ds_read_b64_tr_b16 v[42:43], v7 offset:18944
  v_lshlrev_b32 v50, 4, v4
  v_readfirstlane_b32 s14, v5
  s_mul_i32 s16, s3, 36864
  s_mul_i32 s17, s14, 9216
  s_add_u32 s16, s16, s17
  s_add_u32 s16, s16, 23068672
  s_add_u32 s17, s16, 4096
  s_add_u32 s18, s16, 8192
  s_waitcnt lgkmcnt(15)
  buffer_store_dwordx4 v[8:11], v50, s[8:11], s16 offen sc1
  s_waitcnt lgkmcnt(14)
  buffer_store_dwordx4 v[12:15], v50, s[8:11], s16 offen offset:1024 sc1
  s_waitcnt lgkmcnt(12)
  buffer_store_dwordx4 v[16:19], v50, s[8:11], s16 offen offset:2048 sc1
  s_waitcnt lgkmcnt(10)
  buffer_store_dwordx4 v[20:23], v50, s[8:11], s16 offen offset:3072 sc1
  s_waitcnt lgkmcnt(8)
  buffer_store_dwordx4 v[24:27], v50, s[8:11], s17 offen sc1
  s_waitcnt lgkmcnt(6)
  buffer_store_dwordx4 v[28:31], v50, s[8:11], s17 offen offset:1024 sc1
  s_waitcnt lgkmcnt(4)
  buffer_store_dwordx4 v[32:35], v50, s[8:11], s17 offen offset:2048 sc1
  s_waitcnt lgkmcnt(2)
  buffer_store_dwordx4 v[36:39], v50, s[8:11], s17 offen offset:3072 sc1
  s_waitcnt lgkmcnt(0)
  buffer_store_dwordx4 v[40:43], v50, s[8:11], s18 offen sc1
  s_branch k1_kernel_exit
k1_kernel_exit:
  s_endpgm
k1_kernel_codeend:
.globl kg_kernel
.p2align 8
.type kg_kernel,@function
kg_kernel:
  s_cmp_ge_u32 s2, 64
  s_cbranch_scc1 kg_kernel_pf_5
  s_getpc_b64 s[4:5]
kg_kernel_pc:
  s_mov_b32 s6, kg_kernel_codeend-kg_kernel_pc-4
  v_lshlrev_b32 v1, 7, v0
  v_min_u32 v2, s6, v1
  global_load_dword v252, v2, s[4:5]
  v_add_u32 v1, 0x8000, v1
  v_min_u32 v2, s6, v1
  global_load_dword v252, v2, s[4:5]
  v_add_u32 v1, 0x8000, v1
  v_min_u32 v2, s6, v1
  global_load_dword v252, v2, s[4:5]
kg_kernel_pf_5:
  s_cmp_ge_u32 s2, 256
  s_cbranch_scc1 kg_kernel_exit
  s_load_dwordx2 s[8:9], s[0:1], 144
  s_load_dwordx2 s[4:5], s[0:1], 88
  s_and_b32 s18, s2, 7
  s_lshr_b32 s19, s2, 3
  s_and_b32 s16, s18, 1
  s_lshl_b32 s16, s16, 3
  s_and_b32 s17, s19, 7
  s_add_u32 s16, s16, s17
  s_lshr_b32 s17, s18, 1
  s_lshl_b32 s17, s17, 2
  s_lshr_b32 s19, s19, 3
  s_add_u32 s17, s17, s19
  v_and_b32 v1, 63, v0
  v_lshrrev_b32 v2, 6, v0
  s_nop 0
  v_readfirstlane_b32 s20, v2
  v_lshlrev_b32 v3, 4, v1
  v_add_u32 v4, 0x10000, v3
  v_add_u32 v5, 0x20000, v3
  v_and_b32 v6, 15, v1
  v_lshrrev_b32 v7, 4, v1
  s_mul_i32 s21, s20, 5
  s_lshl_b32 s22, s20, 2
  s_add_u32 s22, s22, 2
  s_movk_i32 s23, 3072
  s_cmp_lt_u32 s20, 2
  s_cselect_b32 s21, s21, s22
  s_cselect_b32 s23, 4096, s23
  s_cselect_b32 s24, 1, 0
  s_lshl_b32 s21, s21, 10
  s_mul_i32 s26, s17, 331776
  s_add_u32 s26, s26, 16777216
  s_add_u32 s26, s26, s21
  s_add_u32 s27, s21, s23
  s_cmp_eq_u32 s24, 1
  s_cselect_b32 s27, s27, 160000
  s_mul_i32 s28, s16, 147456
  s_add_u32 s28, s28, 7340032
  s_lshl_b32 s29, s20, 12
  s_add_u32 s28, s28, s29
  s_mul_i32 s33, s17, 576
  s_cmp_lt_u32 s20, 2
  s_cselect_b32 s34, 9216, 0
  s_add_u32 s33, s33, s34
  s_and_b32 s34, s20, 1
  s_mul_i32 s34, s34, 20480
  s_add_u32 s33, s33, s34
  s_add_u32 s33, s33, 32768
  s_mul_i32 s34, s20, 576
  s_waitcnt lgkmcnt(0)
  s_and_b32 s9, s9, 0xffff
  s_mov_b32 s10, 67108864
  s_mov_b32 s11, 0x20000
  s_add_u32 m0, s29, 0
  s_add_u32 s32, s28, 0
  buffer_load_dwordx4 v3, s[8:11], s32 offen lds
  buffer_load_dwordx4 v3, s[8:11], s32 offen offset:1024 lds
  buffer_load_dwordx4 v3, s[8:11], s32 offen offset:2048 lds
  buffer_load_dwordx4 v3, s[8:11], s32 offen offset:3072 lds
  s_add_u32 m0, s21, 65536
  s_add_u32 s30, s26, 0
  buffer_load_dwordx4 v3, s[8:11], s30 offen lds
  buffer_load_dwordx4 v3, s[8:11], s30 offen offset:1024 lds
  buffer_load_dwordx4 v3, s[8:11], s30 offen offset:2048 lds
  buffer_load_dwordx4 v3, s[8:11], s30 offen offset:3072 lds
  s_mul_i32 s31, s24, 65536
  s_add_u32 m0, s27, s31
  s_add_u32 s31, s30, s23
  buffer_load_dwordx4 v3, s[8:11], s31 offen lds
  s_add_u32 m0, s34, 157696
  s_mov_b32 exec_hi, 0xf
  buffer_load_dwordx4 v3, s[8:11], s33 offen lds
  s_mov_b64 exec, -1
  s_add_u32 m0, s29, 16384
  s_add_u32 s32, s28, 16384
  buffer_load_dwordx4 v3, s[8:11], s32 offen lds
  buffer_load_dwordx4 v3, s[8:11], s32 offen offset:1024 lds
  buffer_load_dwordx4 v3, s[8:11], s32 offen offset:2048 lds
  buffer_load_dwordx4 v3, s[8:11], s32 offen offset:3072 lds
  s_add_u32 m0, s21, 83968
  s_add_u32 s30, s26, 18432
  buffer_load_dwordx4 v3, s[8:11], s30 offen lds
  buffer_load_dwordx4 v3, s[8:11], s30 offen offset:1024 lds
  buffer_load_dwordx4 v3, s[8:11], s30 offen offset:2048 lds
  buffer_load_dwordx4 v3, s[8:11], s30 offen offset:3072 lds
  s_mul_i32 s31, s24, 83968
  s_add_u32 m0, s27, s31
  s_add_u32 s31, s30, s23
  buffer_load_dwordx4 v3, s[8:11], s31 offen lds
  s_and_b32 s5, s5, 0xffff
  s_mov_b32 s6, 8388608
  s_mov_b32 s7, 0x20000
  v_lshrrev_b32 v10, 2, v6
  v_and_b32 v11, 3, v1
  v_and_b32 v12, 1, v7
  v_lshl_add_u32 v12, v12, 2, v10
  v_lshlrev_b32 v12, 1, v12
  v_lshl_add_u32 v13, v7, 3, v10
  v_lshlrev_b32 v13, 8, v13
  v_and_b32 v14, 1, v11
  v_lshl_add_u32 v13, v14, 3, v13
  v_lshrrev_b32 v14, 1, v11
  v_lshl_add_u32 v14, v2, 2, v14
  v_xor_b32 v15, v14, v12
  v_lshl_add_u32 v8, v15, 4, v13
  v_add_u32 v14, 2, v14
  v_xor_b32 v15, v14, v12
  v_lshl_add_u32 v9, v15, 4, v13
  v_lshrrev_b32 v16, 4, v1
  v_xor_b32 v17, v6, v16
  v_lshlrev_b32 v17, 4, v17
  v_lshl_add_u32 v16, v16, 12, v17
  s_lshl_b32 s38, s16, 19
  s_lshl_b32 s39, s20, 17
  s_add_u32 s38, s38, s39
  s_lshl_b32 s40, s17, 8
  s_add_u32 s38, s38, s40
  s_lshl_b32 s39, s16, 2
  s_add_u32 s39, s39, s20
  s_lshl_b32 s39, s39, 17
  s_lshl_b32 s40, s17, 13
  s_add_u32 s39, s39, s40
  s_add_u32 s39, s39, 27262976
  s_lshl_b32 s54, s20, 13
  v_xor_b32 v17, v7, v6
  v_lshlrev_b32 v17, 4, v17
  v_lshl_add_u32 v17, v6, 8, v17
  v_add_u32 v17, s54, v17
  v_mov_b32 v36, 0x3f803f80
  v_mov_b32 v37, 0x3f803f80
  v_mov_b32 v38, 0x3f803f80
  v_mov_b32 v39, 0x3f803f80
  v_mov_b32 v84, 0xc0135761
  v_mov_b32 v85, 0xbdd2d3e8
  s_mov_b32 s46, 1.0
  s_mov_b32 s47, 1.0
  v_mov_b32 v76, 0
  v_mov_b32 v77, 0
  v_mov_b32 v78, 0
  v_mov_b32 v79, 0
  v_mov_b32 v80, 0
  v_mov_b32 v81, 0
  v_mov_b32 v82, 0
  v_mov_b32 v83, 0
  v_lshlrev_b32 v18, 4, v7
  v_add_u32 v18, 26624, v18
  v_add_u32 v18, 0x20000, v18
  s_waitcnt vmcnt(9)
  s_barrier
  ds_read_b64_tr_b16 a[0:1], v8 offset:0
  ds_read_b64_tr_b16 a[2:3], v8 offset:1024
  ds_read_b64_tr_b16 a[4:5], v9 offset:0
  ds_read_b64_tr_b16 a[6:7], v9 offset:1024
  ds_read_b128 a[144:147], v4 offset:0
  ds_read_b128 a[148:151], v4 offset:1024
  ds_read_b128 a[152:155], v4 offset:2048
  ds_read_b128 a[156:159], v4 offset:3072
  ds_read_b128 a[160:163], v4 offset:4096
  ds_read_b128 a[164:167], v4 offset:5120
  ds_read_b128 a[168:171], v4 offset:6144
  ds_read_b128 a[172:175], v4 offset:7168
  ds_read_b128 a[176:179], v4 offset:8192
  s_waitcnt lgkmcnt(9)
  s_waitcnt lgkmcnt(6)
  v_mfma_f32_16x16x32_bf16 v[96:99], a[144:147], a[0:3], 0
  ds_read_b64_tr_b16 a[8:9], v8 offset:8192
  s_add_u32 m0, s29, 32768
  v_mfma_f32_16x16x32_bf16 v[100:103], a[144:147], a[4:7], 0
  ds_read_b128 a[144:147], v4 offset:9216
  s_add_u32 s32, s28, 32768
  v_mfma_f32_16x16x32_bf16 v[104:107], a[148:151], a[0:3], 0
  ds_read_b64_tr_b16 a[10:11], v8 offset:9216
  v_mfma_f32_16x16x32_bf16 v[108:111], a[148:151], a[4:7], 0
  ds_read_b128 a[148:151], v4 offset:10240
  v_mfma_f32_16x16x32_bf16 v[20:23], v[36:39], a[0:3], 0
  buffer_load_dwordx4 v3, s[8:11], s32 offen lds
  v_mfma_f32_16x16x32_bf16 v[112:115], a[152:155], a[0:3], 0
  ds_read_b64_tr_b16 a[12:13], v9 offset:8192
  v_mfma_f32_16x16x32_bf16 v[116:119], a[152:155], a[4:7], 0
  ds_read_b128 a[152:155], v4 offset:11264
  s_waitcnt lgkmcnt(9)
  v_mfma_f32_16x16x32_bf16 v[120:123], a[156:159], a[0:3], 0
  ds_read_b64_tr_b16 a[14:15], v9 offset:9216
  v_mfma_f32_16x16x32_bf16 v[124:127], a[156:159], a[4:7], 0
  ds_read_b128 a[156:159], v4 offset:12288
  v_mfma_f32_16x16x32_bf16 v[24:27], v[36:39], a[4:7], 0
  buffer_load_dwordx4 v3, s[8:11], s32 offen offset:1024 lds
  v_mfma_f32_16x16x32_bf16 v[128:131], a[160:163], a[0:3], 0
  v_mfma_f32_16x16x32_bf16 v[132:135], a[160:163], a[4:7], 0
  ds_read_b128 a[160:163], v4 offset:13312
  v_mfma_f32_16x16x32_bf16 v[136:139], a[164:167], a[0:3], 0
  buffer_load_dwordx4 v3, s[8:11], s32 offen offset:2048 lds
  v_mfma_f32_16x16x32_bf16 v[140:143], a[164:167], a[4:7], 0
  ds_read_b128 a[164:167], v4 offset:14336
  v_mfma_f32_16x16x32_bf16 v[28:31], a[0:3], a[0:3], 0
  s_waitcnt lgkmcnt(10)
  v_mfma_f32_16x16x32_bf16 v[144:147], a[168:171], a[0:3], 0
  buffer_load_dwordx4 v3, s[8:11], s32 offen offset:3072 lds
  v_mfma_f32_16x16x32_bf16 v[148:151], a[168:171], a[4:7], 0
  ds_read_b128 a[168:171], v4 offset:15360
  s_add_u32 m0, s21, 102400
  v_mfma_f32_16x16x32_bf16 v[152:155], a[172:175], a[0:3], 0
  s_add_u32 s30, s26, 36864
  v_mfma_f32_16x16x32_bf16 v[156:159], a[172:175], a[4:7], 0
  ds_read_b128 a[172:175], v4 offset:16384
  v_mfma_f32_16x16x32_bf16 v[32:35], a[4:7], a[4:7], 0
  buffer_load_dwordx4 v3, s[8:11], s30 offen lds
  v_mfma_f32_16x16x32_bf16 v[160:163], a[176:179], a[0:3], 0
  v_mfma_f32_16x16x32_bf16 v[164:167], a[176:179], a[4:7], 0
  ds_read_b128 a[176:179], v4 offset:17408
  s_waitcnt vmcnt(5)
  s_barrier
  s_waitcnt lgkmcnt(6)
  v_mfma_f32_16x16x32_bf16 v[96:99], a[144:147], a[8:11], v[96:99]
  ds_read_b64_tr_b16 a[16:17], v8 offset:16384
  v_mfma_f32_16x16x32_bf16 v[100:103], a[144:147], a[12:15], v[100:103]
  ds_read_b128 a[144:147], v4 offset:18432
  v_mfma_f32_16x16x32_bf16 v[104:107], a[148:151], a[8:11], v[104:107]
  ds_read_b64_tr_b16 a[18:19], v8 offset:17408
  v_mfma_f32_16x16x32_bf16 v[108:111], a[148:151], a[12:15], v[108:111]
  ds_read_b128 a[148:151], v4 offset:19456
  v_mfma_f32_16x16x32_bf16 v[20:23], v[36:39], a[8:11], v[20:23]
  buffer_load_dwordx4 v3, s[8:11], s30 offen offset:1024 lds
  v_mfma_f32_16x16x32_bf16 v[112:115], a[152:155], a[8:11], v[112:115]
  ds_read_b64_tr_b16 a[20:21], v9 offset:16384
  v_mfma_f32_16x16x32_bf16 v[116:119], a[152:155], a[12:15], v[116:119]
  ds_read_b128 a[152:155], v4 offset:20480
  s_waitcnt lgkmcnt(9)
  v_mfma_f32_16x16x32_bf16 v[120:123], a[156:159], a[8:11], v[120:123]
  ds_read_b64_tr_b16 a[22:23], v9 offset:17408
  v_mfma_f32_16x16x32_bf16 v[124:127], a[156:159], a[12:15], v[124:127]
  ds_read_b128 a[156:159], v4 offset:21504
  v_mfma_f32_16x16x32_bf16 v[24:27], v[36:39], a[12:15], v[24:27]
  buffer_load_dwordx4 v3, s[8:11], s30 offen offset:2048 lds
  v_mfma_f32_16x16x32_bf16 v[128:131], a[160:163], a[8:11], v[128:131]
  v_mfma_f32_16x16x32_bf16 v[132:135], a[160:163], a[12:15], v[132:135]
  ds_read_b128 a[160:163], v4 offset:22528
  v_mfma_f32_16x16x32_bf16 v[136:139], a[164:167], a[8:11], v[136:139]
  buffer_load_dwordx4 v3, s[8:11], s30 offen offset:3072 lds
  v_mfma_f32_16x16x32_bf16 v[140:143], a[164:167], a[12:15], v[140:143]
  ds_read_b128 a[164:167], v4 offset:23552
  s_mul_i32 s31, s24, 102400
  v_mfma_f32_16x16x32_bf16 v[28:31], a[8:11], a[8:11], v[28:31]
  s_add_u32 m0, s27, s31
  s_add_u32 s31, s30, s23
  s_waitcnt lgkmcnt(10)
  v_mfma_f32_16x16x32_bf16 v[144:147], a[168:171], a[8:11], v[144:147]
  buffer_load_dwordx4 v3, s[8:11], s31 offen lds
  v_mfma_f32_16x16x32_bf16 v[148:151], a[168:171], a[12:15], v[148:151]
  ds_read_b128 a[168:171], v4 offset:24576
  s_add_u32 m0, s21, 120832
  v_mfma_f32_16x16x32_bf16 v[152:155], a[172:175], a[8:11], v[152:155]
  s_add_u32 s30, s26, 55296
  v_mfma_f32_16x16x32_bf16 v[156:159], a[172:175], a[12:15], v[156:159]
  ds_read_b128 a[172:175], v4 offset:25600
  v_mfma_f32_16x16x32_bf16 v[32:35], a[12:15], a[12:15], v[32:35]
  buffer_load_dwordx4 v3, s[8:11], s30 offen lds
  v_mfma_f32_16x16x32_bf16 v[160:163], a[176:179], a[8:11], v[160:163]
  v_mfma_f32_16x16x32_bf16 v[164:167], a[176:179], a[12:15], v[164:167]
  ds_read_b128 a[176:179], v4 offset:26624
  s_waitcnt lgkmcnt(6)
  v_mfma_f32_16x16x32_bf16 v[96:99], a[144:147], a[16:19], v[96:99]
  ds_read_b64_tr_b16 a[24:25], v8 offset:24576
  v_mfma_f32_16x16x32_bf16 v[100:103], a[144:147], a[20:23], v[100:103]
  ds_read_b128 a[144:147], v4 offset:27648
  v_mfma_f32_16x16x32_bf16 v[104:107], a[148:151], a[16:19], v[104:107]
  ds_read_b64_tr_b16 a[26:27], v8 offset:25600
  v_mfma_f32_16x16x32_bf16 v[108:111], a[148:151], a[20:23], v[108:111]
  ds_read_b128 a[148:151], v4 offset:28672
  v_mfma_f32_16x16x32_bf16 v[20:23], v[36:39], a[16:19], v[20:23]
  buffer_load_dwordx4 v3, s[8:11], s30 offen offset:1024 lds
  v_mfma_f32_16x16x32_bf16 v[112:115], a[152:155], a[16:19], v[112:115]
  ds_read_b64_tr_b16 a[28:29], v9 offset:24576
  v_mfma_f32_16x16x32_bf16 v[116:119], a[152:155], a[20:23], v[116:119]
  ds_read_b128 a[152:155], v4 offset:29696
  s_waitcnt lgkmcnt(9)
  v_mfma_f32_16x16x32_bf16 v[120:123], a[156:159], a[16:19], v[120:123]
  ds_read_b64_tr_b16 a[30:31], v9 offset:25600
  v_mfma_f32_16x16x32_bf16 v[124:127], a[156:159], a[20:23], v[124:127]
  ds_read_b128 a[156:159], v4 offset:30720
  v_mfma_f32_16x16x32_bf16 v[24:27], v[36:39], a[20:23], v[24:27]
  buffer_load_dwordx4 v3, s[8:11], s30 offen offset:2048 lds
  v_mfma_f32_16x16x32_bf16 v[128:131], a[160:163], a[16:19], v[128:131]
  v_mfma_f32_16x16x32_bf16 v[132:135], a[160:163], a[20:23], v[132:135]
  ds_read_b128 a[160:163], v4 offset:31744
  v_mfma_f32_16x16x32_bf16 v[136:139], a[164:167], a[16:19], v[136:139]
  buffer_load_dwordx4 v3, s[8:11], s30 offen offset:3072 lds
  v_mfma_f32_16x16x32_bf16 v[140:143], a[164:167], a[20:23], v[140:143]
  ds_read_b128 a[164:167], v4 offset:32768
  s_mul_i32 s31, s24, 120832
  v_mfma_f32_16x16x32_bf16 v[28:31], a[16:19], a[16:19], v[28:31]
  s_add_u32 m0, s27, s31
  s_add_u32 s31, s30, s23
  s_waitcnt lgkmcnt(10)
  v_mfma_f32_16x16x32_bf16 v[144:147], a[168:171], a[16:19], v[144:147]
  buffer_load_dwordx4 v3, s[8:11], s31 offen lds
  v_mfma_f32_16x16x32_bf16 v[148:151], a[168:171], a[20:23], v[148:151]
  ds_read_b128 a[168:171], v4 offset:33792
  s_add_u32 m0, s29, 49152
  v_mfma_f32_16x16x32_bf16 v[152:155], a[172:175], a[16:19], v[152:155]
  s_add_u32 s32, s28, 49152
  v_mfma_f32_16x16x32_bf16 v[156:159], a[172:175], a[20:23], v[156:159]
  ds_read_b128 a[172:175], v4 offset:34816
  v_mfma_f32_16x16x32_bf16 v[32:35], a[20:23], a[20:23], v[32:35]
  buffer_load_dwordx4 v3, s[8:11], s32 offen lds
  v_mfma_f32_16x16x32_bf16 v[160:163], a[176:179], a[16:19], v[160:163]
  v_mfma_f32_16x16x32_bf16 v[164:167], a[176:179], a[20:23], v[164:167]
  ds_read_b128 a[176:179], v4 offset:35840
  s_waitcnt vmcnt(6)
  s_barrier
  s_waitcnt lgkmcnt(6)
  v_mfma_f32_16x16x32_bf16 v[96:99], a[144:147], a[24:27], v[96:99]
  ds_read_b64_tr_b16 a[32:33], v8 offset:32768
  v_mfma_f32_16x16x32_bf16 v[100:103], a[144:147], a[28:31], v[100:103]
  ds_read_b128 a[144:147], v4 offset:36864
  v_mfma_f32_16x16x32_bf16 v[104:107], a[148:151], a[24:27], v[104:107]
  ds_read_b64_tr_b16 a[34:35], v8 offset:33792
  v_mfma_f32_16x16x32_bf16 v[108:111], a[148:151], a[28:31], v[108:111]
  ds_read_b128 a[148:151], v4 offset:37888
  v_mfma_f32_16x16x32_bf16 v[20:23], v[36:39], a[24:27], v[20:23]
  buffer_load_dwordx4 v3, s[8:11], s32 offen offset:1024 lds
  v_mfma_f32_16x16x32_bf16 v[112:115], a[152:155], a[24:27], v[112:115]
  ds_read_b64_tr_b16 a[36:37], v9 offset:32768
  v_mfma_f32_16x16x32_bf16 v[116:119], a[152:155], a[28:31], v[116:119]
  ds_read_b128 a[152:155], v4 offset:38912
  s_waitcnt lgkmcnt(9)
  v_mfma_f32_16x16x32_bf16 v[120:123], a[156:159], a[24:27], v[120:123]
  ds_read_b64_tr_b16 a[38:39], v9 offset:33792
  v_mfma_f32_16x16x32_bf16 v[124:127], a[156:159], a[28:31], v[124:127]
  ds_read_b128 a[156:159], v4 offset:39936
  v_mfma_f32_16x16x32_bf16 v[24:27], v[36:39], a[28:31], v[24:27]
  buffer_load_dwordx4 v3, s[8:11], s32 offen offset:2048 lds
  v_mfma_f32_16x16x32_bf16 v[128:131], a[160:163], a[24:27], v[128:131]
  v_mfma_f32_16x16x32_bf16 v[132:135], a[160:163], a[28:31], v[132:135]
  ds_read_b128 a[160:163], v4 offset:40960
  v_mfma_f32_16x16x32_bf16 v[136:139], a[164:167], a[24:27], v[136:139]
  buffer_load_dwordx4 v3, s[8:11], s32 offen offset:3072 lds
  v_mfma_f32_16x16x32_bf16 v[140:143], a[164:167], a[28:31], v[140:143]
  ds_read_b128 a[164:167], v4 offset:41984
  s_add_u32 m0, s21, 139264
  v_mfma_f32_16x16x32_bf16 v[28:31], a[24:27], a[24:27], v[28:31]
  s_add_u32 s30, s26, 73728
  s_waitcnt lgkmcnt(10)
  v_mfma_f32_16x16x32_bf16 v[144:147], a[168:171], a[24:27], v[144:147]
  buffer_load_dwordx4 v3, s[8:11], s30 offen lds
  v_mfma_f32_16x16x32_bf16 v[148:151], a[168:171], a[28:31], v[148:151]
  ds_read_b128 a[168:171], v4 offset:43008
  v_mfma_f32_16x16x32_bf16 v[152:155], a[172:175], a[24:27], v[152:155]
  v_mfma_f32_16x16x32_bf16 v[156:159], a[172:175], a[28:31], v[156:159]
  ds_read_b128 a[172:175], v4 offset:44032
  v_mfma_f32_16x16x32_bf16 v[32:35], a[28:31], a[28:31], v[32:35]
  buffer_load_dwordx4 v3, s[8:11], s30 offen offset:1024 lds
  v_mfma_f32_16x16x32_bf16 v[160:163], a[176:179], a[24:27], v[160:163]
  v_mfma_f32_16x16x32_bf16 v[164:167], a[176:179], a[28:31], v[164:167]
  ds_read_b128 a[176:179], v4 offset:45056
  s_waitcnt lgkmcnt(6)
  v_mfma_f32_16x16x32_bf16 v[96:99], a[144:147], a[32:35], v[96:99]
  ds_read_b64_tr_b16 a[40:41], v8 offset:40960
  v_mfma_f32_16x16x32_bf16 v[100:103], a[144:147], a[36:39], v[100:103]
  ds_read_b128 a[144:147], v4 offset:46080
  v_mfma_f32_16x16x32_bf16 v[104:107], a[148:151], a[32:35], v[104:107]
  ds_read_b64_tr_b16 a[42:43], v8 offset:41984
  v_mfma_f32_16x16x32_bf16 v[108:111], a[148:151], a[36:39], v[108:111]
  ds_read_b128 a[148:151], v4 offset:47104
  v_mfma_f32_16x16x32_bf16 v[20:23], v[36:39], a[32:35], v[20:23]
  buffer_load_dwordx4 v3, s[8:11], s30 offen offset:2048 lds
  v_mfma_f32_16x16x32_bf16 v[112:115], a[152:155], a[32:35], v[112:115]
  ds_read_b64_tr_b16 a[44:45], v9 offset:40960
  v_mfma_f32_16x16x32_bf16 v[116:119], a[152:155], a[36:39], v[116:119]
  ds_read_b128 a[152:155], v4 offset:48128
  s_waitcnt lgkmcnt(9)
  v_mfma_f32_16x16x32_bf16 v[120:123], a[156:159], a[32:35], v[120:123]
  ds_read_b64_tr_b16 a[46:47], v9 offset:41984
  v_mfma_f32_16x16x32_bf16 v[124:127], a[156:159], a[36:39], v[124:127]
  ds_read_b128 a[156:159], v4 offset:49152
  v_mfma_f32_16x16x32_bf16 v[24:27], v[36:39], a[36:39], v[24:27]
  buffer_load_dwordx4 v3, s[8:11], s30 offen offset:3072 lds
  v_mfma_f32_16x16x32_bf16 v[128:131], a[160:163], a[32:35], v[128:131]
  s_mul_i32 s31, s24, 139264
  s_add_u32 m0, s27, s31
  v_mfma_f32_16x16x32_bf16 v[132:135], a[160:163], a[36:39], v[132:135]
  ds_read_b128 a[160:163], v4 offset:50176
  s_add_u32 s31, s30, s23
  v_mfma_f32_16x16x32_bf16 v[136:139], a[164:167], a[32:35], v[136:139]
  buffer_load_dwordx4 v3, s[8:11], s31 offen lds
  v_mfma_f32_16x16x32_bf16 v[140:143], a[164:167], a[36:39], v[140:143]
  ds_read_b128 a[164:167], v4 offset:51200
  s_add_u32 m0, s29, 0
  v_mfma_f32_16x16x32_bf16 v[28:31], a[32:35], a[32:35], v[28:31]
  s_add_u32 s32, s28, 65536
  s_waitcnt lgkmcnt(10)
  v_mfma_f32_16x16x32_bf16 v[144:147], a[168:171], a[32:35], v[144:147]
  buffer_load_dwordx4 v3, s[8:11], s32 offen lds
  v_mfma_f32_16x16x32_bf16 v[148:151], a[168:171], a[36:39], v[148:151]
  ds_read_b128 a[168:171], v4 offset:52224
  v_mfma_f32_16x16x32_bf16 v[152:155], a[172:175], a[32:35], v[152:155]
  v_mfma_f32_16x16x32_bf16 v[156:159], a[172:175], a[36:39], v[156:159]
  ds_read_b128 a[172:175], v4 offset:53248
  v_mfma_f32_16x16x32_bf16 v[32:35], a[36:39], a[36:39], v[32:35]
  buffer_load_dwordx4 v3, s[8:11], s32 offen offset:1024 lds
  v_mfma_f32_16x16x32_bf16 v[160:163], a[176:179], a[32:35], v[160:163]
  v_mfma_f32_16x16x32_bf16 v[164:167], a[176:179], a[36:39], v[164:167]
  ds_read_b128 a[176:179], v4 offset:54272
  s_waitcnt vmcnt(7)
  s_barrier
  s_waitcnt lgkmcnt(6)
  v_mfma_f32_16x16x32_bf16 v[96:99], a[144:147], a[40:43], v[96:99]
  ds_read_b64_tr_b16 a[48:49], v8 offset:49152
  v_mfma_f32_16x16x32_bf16 v[100:103], a[144:147], a[44:47], v[100:103]
  ds_read_b128 a[144:147], v4 offset:55296
  v_mfma_f32_16x16x32_bf16 v[104:107], a[148:151], a[40:43], v[104:107]
  ds_read_b64_tr_b16 a[50:51], v8 offset:50176
  v_mfma_f32_16x16x32_bf16 v[108:111], a[148:151], a[44:47], v[108:111]
  ds_read_b128 a[148:151], v4 offset:56320
  v_mfma_f32_16x16x32_bf16 v[20:23], v[36:39], a[40:43], v[20:23]
  buffer_load_dwordx4 v3, s[8:11], s32 offen offset:2048 lds
  v_mfma_f32_16x16x32_bf16 v[112:115], a[152:155], a[40:43], v[112:115]
  ds_read_b64_tr_b16 a[52:53], v9 offset:49152
  v_mfma_f32_16x16x32_bf16 v[116:119], a[152:155], a[44:47], v[116:119]
  ds_read_b128 a[152:155], v4 offset:57344
  s_waitcnt lgkmcnt(9)
  v_mfma_f32_16x16x32_bf16 v[120:123], a[156:159], a[40:43], v[120:123]
  ds_read_b64_tr_b16 a[54:55], v9 offset:50176
  v_mfma_f32_16x16x32_bf16 v[124:127], a[156:159], a[44:47], v[124:127]
  ds_read_b128 a[156:159], v4 offset:58368
  v_mfma_f32_16x16x32_bf16 v[24:27], v[36:39], a[44:47], v[24:27]
  buffer_load_dwordx4 v3, s[8:11], s32 offen offset:3072 lds
  v_mfma_f32_16x16x32_bf16 v[128:131], a[160:163], a[40:43], v[128:131]
  s_add_u32 m0, s21, 65536
  s_add_u32 s30, s26, 92160
  v_mfma_f32_16x16x32_bf16 v[132:135], a[160:163], a[44:47], v[132:135]
  ds_read_b128 a[160:163], v4 offset:59392
  v_mfma_f32_16x16x32_bf16 v[136:139], a[164:167], a[40:43], v[136:139]
  buffer_load_dwordx4 v3, s[8:11], s30 offen lds
  v_mfma_f32_16x16x32_bf16 v[140:143], a[164:167], a[44:47], v[140:143]
  ds_read_b128 a[164:167], v4 offset:60416
  v_mfma_f32_16x16x32_bf16 v[28:31], a[40:43], a[40:43], v[28:31]
  s_waitcnt lgkmcnt(10)
  v_mfma_f32_16x16x32_bf16 v[144:147], a[168:171], a[40:43], v[144:147]
  buffer_load_dwordx4 v3, s[8:11], s30 offen offset:1024 lds
  v_mfma_f32_16x16x32_bf16 v[148:151], a[168:171], a[44:47], v[148:151]
  ds_read_b128 a[168:171], v4 offset:61440
  v_mfma_f32_16x16x32_bf16 v[152:155], a[172:175], a[40:43], v[152:155]
  v_mfma_f32_16x16x32_bf16 v[156:159], a[172:175], a[44:47], v[156:159]
  ds_read_b128 a[172:175], v4 offset:62464
  v_mfma_f32_16x16x32_bf16 v[32:35], a[44:47], a[44:47], v[32:35]
  buffer_load_dwordx4 v3, s[8:11], s30 offen offset:2048 lds
  v_mfma_f32_16x16x32_bf16 v[160:163], a[176:179], a[40:43], v[160:163]
  v_mfma_f32_16x16x32_bf16 v[164:167], a[176:179], a[44:47], v[164:167]
  ds_read_b128 a[176:179], v4 offset:63488
  s_waitcnt lgkmcnt(6)
  v_mfma_f32_16x16x32_bf16 v[96:99], a[144:147], a[48:51], v[96:99]
  ds_read_b64_tr_b16 a[56:57], v8 offset:57344
  v_mfma_f32_16x16x32_bf16 v[100:103], a[144:147], a[52:55], v[100:103]
  ds_read_b128 a[144:147], v4 offset:64512
  v_mfma_f32_16x16x32_bf16 v[104:107], a[148:151], a[48:51], v[104:107]
  ds_read_b64_tr_b16 a[58:59], v8 offset:58368
  v_mfma_f32_16x16x32_bf16 v[108:111], a[148:151], a[52:55], v[108:111]
  ds_read_b128 a[148:151], v5 offset:0
  v_mfma_f32_16x16x32_bf16 v[20:23], v[36:39], a[48:51], v[20:23]
  buffer_load_dwordx4 v3, s[8:11], s30 offen offset:3072 lds
  v_mfma_f32_16x16x32_bf16 v[112:115], a[152:155], a[48:51], v[112:115]
  ds_read_b64_tr_b16 a[60:61], v9 offset:57344
  s_mul_i32 s31, s24, 65536
  v_mfma_f32_16x16x32_bf16 v[116:119], a[152:155], a[52:55], v[116:119]
  ds_read_b128 a[152:155], v5 offset:1024
  s_waitcnt lgkmcnt(9)
  v_mfma_f32_16x16x32_bf16 v[120:123], a[156:159], a[48:51], v[120:123]
  ds_read_b64_tr_b16 a[62:63], v9 offset:58368
  s_add_u32 m0, s27, s31
  v_mfma_f32_16x16x32_bf16 v[124:127], a[156:159], a[52:55], v[124:127]
  ds_read_b128 a[156:159], v5 offset:2048
  s_add_u32 s31, s30, s23
  v_mfma_f32_16x16x32_bf16 v[24:27], v[36:39], a[52:55], v[24:27]
  buffer_load_dwordx4 v3, s[8:11], s31 offen lds
  v_mfma_f32_16x16x32_bf16 v[128:131], a[160:163], a[48:51], v[128:131]
  s_add_u32 m0, s29, 16384
  s_add_u32 s32, s28, 81920
  v_mfma_f32_16x16x32_bf16 v[132:135], a[160:163], a[52:55], v[132:135]
  ds_read_b128 a[160:163], v5 offset:3072
  v_mfma_f32_16x16x32_bf16 v[136:139], a[164:167], a[48:51], v[136:139]
  buffer_load_dwordx4 v3, s[8:11], s32 offen lds
  v_mfma_f32_16x16x32_bf16 v[140:143], a[164:167], a[52:55], v[140:143]
  ds_read_b128 a[164:167], v5 offset:4096
  v_mfma_f32_16x16x32_bf16 v[28:31], a[48:51], a[48:51], v[28:31]
  s_waitcnt lgkmcnt(10)
  v_mfma_f32_16x16x32_bf16 v[144:147], a[168:171], a[48:51], v[144:147]
  buffer_load_dwordx4 v3, s[8:11], s32 offen offset:1024 lds
  v_mfma_f32_16x16x32_bf16 v[148:151], a[168:171], a[52:55], v[148:151]
  ds_read_b128 a[168:171], v5 offset:5120
  v_mfma_f32_16x16x32_bf16 v[152:155], a[172:175], a[48:51], v[152:155]
  v_mfma_f32_16x16x32_bf16 v[156:159], a[172:175], a[52:55], v[156:159]
  ds_read_b128 a[172:175], v5 offset:6144
  v_mfma_f32_16x16x32_bf16 v[32:35], a[52:55], a[52:55], v[32:35]
  buffer_load_dwordx4 v3, s[8:11], s32 offen offset:2048 lds
  v_mfma_f32_16x16x32_bf16 v[160:163], a[176:179], a[48:51], v[160:163]
  v_mfma_f32_16x16x32_bf16 v[164:167], a[176:179], a[52:55], v[164:167]
  ds_read_b128 a[176:179], v5 offset:7168
  s_waitcnt vmcnt(8)
  s_barrier
  s_waitcnt lgkmcnt(6)
  v_mfma_f32_16x16x32_bf16 v[96:99], a[144:147], a[56:59], v[96:99]
  ds_read_b64_tr_b16 a[64:65], v8 offset:0
  v_mfma_f32_16x16x32_bf16 v[100:103], a[144:147], a[60:63], v[100:103]
  ds_read_b128 a[144:147], v5 offset:8192
  v_mfma_f32_16x16x32_bf16 v[104:107], a[148:151], a[56:59], v[104:107]
  ds_read_b64_tr_b16 a[66:67], v8 offset:1024
  v_mfma_f32_16x16x32_bf16 v[108:111], a[148:151], a[60:63], v[108:111]
  ds_read_b128 a[148:151], v5 offset:9216
  v_mfma_f32_16x16x32_bf16 v[20:23], v[36:39], a[56:59], v[20:23]
  buffer_load_dwordx4 v3, s[8:11], s32 offen offset:3072 lds
  v_mfma_f32_16x16x32_bf16 v[112:115], a[152:155], a[56:59], v[112:115]
  ds_read_b64_tr_b16 a[68:69], v9 offset:0
  s_add_u32 m0, s21, 83968
  v_mfma_f32_16x16x32_bf16 v[116:119], a[152:155], a[60:63], v[116:119]
  ds_read_b128 a[152:155], v5 offset:10240
  s_waitcnt lgkmcnt(9)
  v_mfma_f32_16x16x32_bf16 v[120:123], a[156:159], a[56:59], v[120:123]
  ds_read_b64_tr_b16 a[70:71], v9 offset:1024
  s_add_u32 s30, s26, 110592
  v_mfma_f32_16x16x32_bf16 v[124:127], a[156:159], a[60:63], v[124:127]
  ds_read_b128 a[156:159], v5 offset:11264
  v_mfma_f32_16x16x32_bf16 v[24:27], v[36:39], a[60:63], v[24:27]
  buffer_load_dwordx4 v3, s[8:11], s30 offen lds
  v_mfma_f32_16x16x32_bf16 v[128:131], a[160:163], a[56:59], v[128:131]
  v_mfma_f32_16x16x32_bf16 v[132:135], a[160:163], a[60:63], v[132:135]
  ds_read_b128 a[160:163], v5 offset:12288
  v_mfma_f32_16x16x32_bf16 v[136:139], a[164:167], a[56:59], v[136:139]
  buffer_load_dwordx4 v3, s[8:11], s30 offen offset:1024 lds
  v_mfma_f32_16x16x32_bf16 v[140:143], a[164:167], a[60:63], v[140:143]
  ds_read_b128 a[164:167], v5 offset:13312
  v_mfma_f32_16x16x32_bf16 v[28:31], a[56:59], a[56:59], v[28:31]
  s_waitcnt lgkmcnt(10)
  v_mfma_f32_16x16x32_bf16 v[144:147], a[168:171], a[56:59], v[144:147]
  buffer_load_dwordx4 v3, s[8:11], s30 offen offset:2048 lds
  v_mfma_f32_16x16x32_bf16 v[148:151], a[168:171], a[60:63], v[148:151]
  ds_read_b128 a[168:171], v5 offset:14336
  v_mfma_f32_16x16x32_bf16 v[152:155], a[172:175], a[56:59], v[152:155]
  v_mfma_f32_16x16x32_bf16 v[156:159], a[172:175], a[60:63], v[156:159]
  ds_read_b128 a[172:175], v5 offset:15360
  v_mfma_f32_16x16x32_bf16 v[32:35], a[60:63], a[60:63], v[32:35]
  buffer_load_dwordx4 v3, s[8:11], s30 offen offset:3072 lds
  v_mfma_f32_16x16x32_bf16 v[160:163], a[176:179], a[56:59], v[160:163]
  s_mul_i32 s31, s24, 83968
  s_add_u32 m0, s27, s31
  v_mfma_f32_16x16x32_bf16 v[164:167], a[176:179], a[60:63], v[164:167]
  ds_read_b128 a[176:179], v5 offset:16384
  s_waitcnt lgkmcnt(6)
  v_mfma_f32_16x16x32_bf16 v[96:99], a[144:147], a[64:67], v[96:99]
  ds_read_b64_tr_b16 a[72:73], v8 offset:8192
  s_add_u32 s31, s30, s23
  v_mfma_f32_16x16x32_bf16 v[100:103], a[144:147], a[68:71], v[100:103]
  ds_read_b128 a[144:147], v5 offset:17408
  v_mfma_f32_16x16x32_bf16 v[104:107], a[148:151], a[64:67], v[104:107]
  ds_read_b64_tr_b16 a[74:75], v8 offset:9216
  v_mfma_f32_16x16x32_bf16 v[108:111], a[148:151], a[68:71], v[108:111]
  ds_read_b128 a[148:151], v5 offset:18432
  v_mfma_f32_16x16x32_bf16 v[20:23], v[36:39], a[64:67], v[20:23]
  buffer_load_dwordx4 v3, s[8:11], s31 offen lds
  v_mfma_f32_16x16x32_bf16 v[112:115], a[152:155], a[64:67], v[112:115]
  ds_read_b64_tr_b16 a[76:77], v9 offset:8192
  s_add_u32 m0, s29, 32768
  v_mfma_f32_16x16x32_bf16 v[116:119], a[152:155], a[68:71], v[116:119]
  ds_read_b128 a[152:155], v5 offset:19456
  s_waitcnt lgkmcnt(9)
  v_mfma_f32_16x16x32_bf16 v[120:123], a[156:159], a[64:67], v[120:123]
  ds_read_b64_tr_b16 a[78:79], v9 offset:9216
  s_add_u32 s32, s28, 98304
  v_mfma_f32_16x16x32_bf16 v[124:127], a[156:159], a[68:71], v[124:127]
  ds_read_b128 a[156:159], v5 offset:20480
  v_mfma_f32_16x16x32_bf16 v[24:27], v[36:39], a[68:71], v[24:27]
  buffer_load_dwordx4 v3, s[8:11], s32 offen lds
  v_mfma_f32_16x16x32_bf16 v[128:131], a[160:163], a[64:67], v[128:131]
  v_mfma_f32_16x16x32_bf16 v[132:135], a[160:163], a[68:71], v[132:135]
  ds_read_b128 a[160:163], v5 offset:21504
  v_mfma_f32_16x16x32_bf16 v[136:139], a[164:167], a[64:67], v[136:139]
  buffer_load_dwordx4 v3, s[8:11], s32 offen offset:1024 lds
  v_mfma_f32_16x16x32_bf16 v[140:143], a[164:167], a[68:71], v[140:143]
  ds_read_b128 a[164:167], v5 offset:22528
  v_mfma_f32_16x16x32_bf16 v[28:31], a[64:67], a[64:67], v[28:31]
  s_waitcnt lgkmcnt(10)
  v_mfma_f32_16x16x32_bf16 v[144:147], a[168:171], a[64:67], v[144:147]
  buffer_load_dwordx4 v3, s[8:11], s32 offen offset:2048 lds
  v_mfma_f32_16x16x32_bf16 v[148:151], a[168:171], a[68:71], v[148:151]
  ds_read_b128 a[168:171], v5 offset:23552
  v_mfma_f32_16x16x32_bf16 v[152:155], a[172:175], a[64:67], v[152:155]
  v_mfma_f32_16x16x32_bf16 v[156:159], a[172:175], a[68:71], v[156:159]
  ds_read_b128 a[172:175], v5 offset:24576
  v_mfma_f32_16x16x32_bf16 v[32:35], a[68:71], a[68:71], v[32:35]
  buffer_load_dwordx4 v3, s[8:11], s32 offen offset:3072 lds
  v_mfma_f32_16x16x32_bf16 v[160:163], a[176:179], a[64:67], v[160:163]
  s_add_u32 m0, s21, 102400
  s_add_u32 s30, s26, 129024
  v_mfma_f32_16x16x32_bf16 v[164:167], a[176:179], a[68:71], v[164:167]
  ds_read_b128 a[176:179], v5 offset:25600
  s_waitcnt vmcnt(9)
  s_barrier
  s_waitcnt lgkmcnt(6)
  v_mfma_f32_16x16x32_bf16 v[96:99], a[144:147], a[72:75], v[96:99]
  ds_read_b64_tr_b16 a[80:81], v8 offset:16384
  v_mfma_f32_16x16x32_bf16 v[100:103], a[144:147], a[76:79], v[100:103]
  ds_read_b128 a[144:147], v4 offset:0
  v_mfma_f32_16x16x32_bf16 v[104:107], a[148:151], a[72:75], v[104:107]
  ds_read_b64_tr_b16 a[82:83], v8 offset:17408
  v_mfma_f32_16x16x32_bf16 v[108:111], a[148:151], a[76:79], v[108:111]
  ds_read_b128 a[148:151], v4 offset:1024
  v_mfma_f32_16x16x32_bf16 v[20:23], v[36:39], a[72:75], v[20:23]
  buffer_load_dwordx4 v3, s[8:11], s30 offen lds
  v_mfma_f32_16x16x32_bf16 v[112:115], a[152:155], a[72:75], v[112:115]
  ds_read_b64_tr_b16 a[84:85], v9 offset:16384
  v_mfma_f32_16x16x32_bf16 v[116:119], a[152:155], a[76:79], v[116:119]
  ds_read_b128 a[152:155], v4 offset:2048
  s_waitcnt lgkmcnt(9)
  v_mfma_f32_16x16x32_bf16 v[120:123], a[156:159], a[72:75], v[120:123]
  ds_read_b64_tr_b16 a[86:87], v9 offset:17408
  v_mfma_f32_16x16x32_bf16 v[124:127], a[156:159], a[76:79], v[124:127]
  ds_read_b128 a[156:159], v4 offset:3072
  v_mfma_f32_16x16x32_bf16 v[24:27], v[36:39], a[76:79], v[24:27]
  buffer_load_dwordx4 v3, s[8:11], s30 offen offset:1024 lds
  v_mfma_f32_16x16x32_bf16 v[128:131], a[160:163], a[72:75], v[128:131]
  v_mfma_f32_16x16x32_bf16 v[132:135], a[160:163], a[76:79], v[132:135]
  ds_read_b128 a[160:163], v4 offset:4096
  v_mfma_f32_16x16x32_bf16 v[136:139], a[164:167], a[72:75], v[136:139]
  buffer_load_dwordx4 v3, s[8:11], s30 offen offset:2048 lds
  v_mfma_f32_16x16x32_bf16 v[140:143], a[164:167], a[76:79], v[140:143]
  ds_read_b128 a[164:167], v4 offset:5120
  v_mfma_f32_16x16x32_bf16 v[28:31], a[72:75], a[72:75], v[28:31]
  s_waitcnt lgkmcnt(10)
  v_mfma_f32_16x16x32_bf16 v[144:147], a[168:171], a[72:75], v[144:147]
  buffer_load_dwordx4 v3, s[8:11], s30 offen offset:3072 lds
  v_mfma_f32_16x16x32_bf16 v[148:151], a[168:171], a[76:79], v[148:151]
  ds_read_b128 a[168:171], v4 offset:6144
  s_mul_i32 s31, s24, 102400
  v_mfma_f32_16x16x32_bf16 v[152:155], a[172:175], a[72:75], v[152:155]
  s_add_u32 m0, s27, s31
  s_add_u32 s31, s30, s23
  v_mfma_f32_16x16x32_bf16 v[156:159], a[172:175], a[76:79], v[156:159]
  ds_read_b128 a[172:175], v4 offset:7168
  v_mfma_f32_16x16x32_bf16 v[32:35], a[76:79], a[76:79], v[32:35]
  buffer_load_dwordx4 v3, s[8:11], s31 offen lds
  v_mfma_f32_16x16x32_bf16 v[160:163], a[176:179], a[72:75], v[160:163]
  s_add_u32 m0, s29, 49152
  s_add_u32 s32, s28, 114688
  v_mfma_f32_16x16x32_bf16 v[164:167], a[176:179], a[76:79], v[164:167]
  ds_read_b128 a[176:179], v4 offset:8192
  s_waitcnt lgkmcnt(6)
  v_mfma_f32_16x16x32_bf16 v[96:99], a[144:147], a[80:83], v[96:99]
  ds_read_b64_tr_b16 a[88:89], v8 offset:24576
  v_mfma_f32_16x16x32_bf16 v[100:103], a[144:147], a[84:87], v[100:103]
  ds_read_b128 a[144:147], v4 offset:9216
  v_mfma_f32_16x16x32_bf16 v[104:107], a[148:151], a[80:83], v[104:107]
  ds_read_b64_tr_b16 a[90:91], v8 offset:25600
  v_mfma_f32_16x16x32_bf16 v[108:111], a[148:151], a[84:87], v[108:111]
  ds_read_b128 a[148:151], v4 offset:10240
  v_mfma_f32_16x16x32_bf16 v[20:23], v[36:39], a[80:83], v[20:23]
  buffer_load_dwordx4 v3, s[8:11], s32 offen lds
  v_mfma_f32_16x16x32_bf16 v[112:115], a[152:155], a[80:83], v[112:115]
  ds_read_b64_tr_b16 a[92:93], v9 offset:24576
  v_mfma_f32_16x16x32_bf16 v[116:119], a[152:155], a[84:87], v[116:119]
  ds_read_b128 a[152:155], v4 offset:11264
  s_waitcnt lgkmcnt(9)
  v_mfma_f32_16x16x32_bf16 v[120:123], a[156:159], a[80:83], v[120:123]
  ds_read_b64_tr_b16 a[94:95], v9 offset:25600
  v_mfma_f32_16x16x32_bf16 v[124:127], a[156:159], a[84:87], v[124:127]
  ds_read_b128 a[156:159], v4 offset:12288
  v_mfma_f32_16x16x32_bf16 v[24:27], v[36:39], a[84:87], v[24:27]
  buffer_load_dwordx4 v3, s[8:11], s32 offen offset:1024 lds
  v_mfma_f32_16x16x32_bf16 v[128:131], a[160:163], a[80:83], v[128:131]
  v_mfma_f32_16x16x32_bf16 v[132:135], a[160:163], a[84:87], v[132:135]
  ds_read_b128 a[160:163], v4 offset:13312
  v_mfma_f32_16x16x32_bf16 v[136:139], a[164:167], a[80:83], v[136:139]
  buffer_load_dwordx4 v3, s[8:11], s32 offen offset:2048 lds
  v_mfma_f32_16x16x32_bf16 v[140:143], a[164:167], a[84:87], v[140:143]
  ds_read_b128 a[164:167], v4 offset:14336
  v_mfma_f32_16x16x32_bf16 v[28:31], a[80:83], a[80:83], v[28:31]
  s_waitcnt lgkmcnt(10)
  v_mfma_f32_16x16x32_bf16 v[144:147], a[168:171], a[80:83], v[144:147]
  buffer_load_dwordx4 v3, s[8:11], s32 offen offset:3072 lds
  v_mfma_f32_16x16x32_bf16 v[148:151], a[168:171], a[84:87], v[148:151]
  ds_read_b128 a[168:171], v4 offset:15360
  s_add_u32 m0, s21, 120832
  v_mfma_f32_16x16x32_bf16 v[152:155], a[172:175], a[80:83], v[152:155]
  s_add_u32 s30, s26, 147456
  v_mfma_f32_16x16x32_bf16 v[156:159], a[172:175], a[84:87], v[156:159]
  ds_read_b128 a[172:175], v4 offset:16384
  v_mfma_f32_16x16x32_bf16 v[32:35], a[84:87], a[84:87], v[32:35]
  buffer_load_dwordx4 v3, s[8:11], s30 offen lds
  v_mfma_f32_16x16x32_bf16 v[160:163], a[176:179], a[80:83], v[160:163]
  v_mfma_f32_16x16x32_bf16 v[164:167], a[176:179], a[84:87], v[164:167]
  ds_read_b128 a[176:179], v4 offset:17408
  s_waitcnt vmcnt(10)
  s_barrier
  s_waitcnt lgkmcnt(6)
  v_mfma_f32_16x16x32_bf16 v[96:99], a[144:147], a[88:91], v[96:99]
  ds_read_b64_tr_b16 a[96:97], v8 offset:32768
  v_mfma_f32_16x16x32_bf16 v[100:103], a[144:147], a[92:95], v[100:103]
  ds_read_b128 a[144:147], v4 offset:18432
  v_mfma_f32_16x16x32_bf16 v[104:107], a[148:151], a[88:91], v[104:107]
  ds_read_b64_tr_b16 a[98:99], v8 offset:33792
  v_mfma_f32_16x16x32_bf16 v[108:111], a[148:151], a[92:95], v[108:111]
  ds_read_b128 a[148:151], v4 offset:19456
  v_mfma_f32_16x16x32_bf16 v[20:23], v[36:39], a[88:91], v[20:23]
  buffer_load_dwordx4 v3, s[8:11], s30 offen offset:1024 lds
  v_mfma_f32_16x16x32_bf16 v[112:115], a[152:155], a[88:91], v[112:115]
  ds_read_b64_tr_b16 a[100:101], v9 offset:32768
  v_mfma_f32_16x16x32_bf16 v[116:119], a[152:155], a[92:95], v[116:119]
  ds_read_b128 a[152:155], v4 offset:20480
  s_waitcnt lgkmcnt(9)
  v_mfma_f32_16x16x32_bf16 v[120:123], a[156:159], a[88:91], v[120:123]
  ds_read_b64_tr_b16 a[102:103], v9 offset:33792
  v_mfma_f32_16x16x32_bf16 v[124:127], a[156:159], a[92:95], v[124:127]
  ds_read_b128 a[156:159], v4 offset:21504
  v_mfma_f32_16x16x32_bf16 v[24:27], v[36:39], a[92:95], v[24:27]
  buffer_load_dwordx4 v3, s[8:11], s30 offen offset:2048 lds
  v_mfma_f32_16x16x32_bf16 v[128:131], a[160:163], a[88:91], v[128:131]
  v_mfma_f32_16x16x32_bf16 v[132:135], a[160:163], a[92:95], v[132:135]
  ds_read_b128 a[160:163], v4 offset:22528
  v_mfma_f32_16x16x32_bf16 v[136:139], a[164:167], a[88:91], v[136:139]
  buffer_load_dwordx4 v3, s[8:11], s30 offen offset:3072 lds
  v_mfma_f32_16x16x32_bf16 v[140:143], a[164:167], a[92:95], v[140:143]
  ds_read_b128 a[164:167], v4 offset:23552
  s_mul_i32 s31, s24, 120832
  v_mfma_f32_16x16x32_bf16 v[28:31], a[88:91], a[88:91], v[28:31]
  s_add_u32 m0, s27, s31
  s_add_u32 s31, s30, s23
  s_waitcnt lgkmcnt(10)
  v_mfma_f32_16x16x32_bf16 v[144:147], a[168:171], a[88:91], v[144:147]
  buffer_load_dwordx4 v3, s[8:11], s31 offen lds
  v_mfma_f32_16x16x32_bf16 v[148:151], a[168:171], a[92:95], v[148:151]
  ds_read_b128 a[168:171], v4 offset:24576
  s_add_u32 m0, s29, 0
  v_mfma_f32_16x16x32_bf16 v[152:155], a[172:175], a[88:91], v[152:155]
  s_add_u32 s32, s28, 131072
  v_mfma_f32_16x16x32_bf16 v[156:159], a[172:175], a[92:95], v[156:159]
  ds_read_b128 a[172:175], v4 offset:25600
  v_mfma_f32_16x16x32_bf16 v[32:35], a[92:95], a[92:95], v[32:35]
  buffer_load_dwordx4 v3, s[8:11], s32 offen lds
  v_mfma_f32_16x16x32_bf16 v[160:163], a[176:179], a[88:91], v[160:163]
  v_mfma_f32_16x16x32_bf16 v[164:167], a[176:179], a[92:95], v[164:167]
  ds_read_b128 a[176:179], v4 offset:26624
  s_waitcnt lgkmcnt(6)
  v_mfma_f32_16x16x32_bf16 v[96:99], a[144:147], a[96:99], v[96:99]
  ds_read_b64_tr_b16 a[104:105], v8 offset:40960
  v_mfma_f32_16x16x32_bf16 v[100:103], a[144:147], a[100:103], v[100:103]
  ds_read_b128 a[144:147], v4 offset:27648
  v_mfma_f32_16x16x32_bf16 v[104:107], a[148:151], a[96:99], v[104:107]
  ds_read_b64_tr_b16 a[106:107], v8 offset:41984
  v_mfma_f32_16x16x32_bf16 v[108:111], a[148:151], a[100:103], v[108:111]
  ds_read_b128 a[148:151], v4 offset:28672
  v_mfma_f32_16x16x32_bf16 v[20:23], v[36:39], a[96:99], v[20:23]
  buffer_load_dwordx4 v3, s[8:11], s32 offen offset:1024 lds
  v_mfma_f32_16x16x32_bf16 v[112:115], a[152:155], a[96:99], v[112:115]
  ds_read_b64_tr_b16 a[108:109], v9 offset:40960
  v_mfma_f32_16x16x32_bf16 v[116:119], a[152:155], a[100:103], v[116:119]
  ds_read_b128 a[152:155], v4 offset:29696
  s_waitcnt lgkmcnt(9)
  v_mfma_f32_16x16x32_bf16 v[120:123], a[156:159], a[96:99], v[120:123]
  ds_read_b64_tr_b16 a[110:111], v9 offset:41984
  v_mfma_f32_16x16x32_bf16 v[124:127], a[156:159], a[100:103], v[124:127]
  ds_read_b128 a[156:159], v4 offset:30720
  v_mfma_f32_16x16x32_bf16 v[24:27], v[36:39], a[100:103], v[24:27]
  buffer_load_dwordx4 v3, s[8:11], s32 offen offset:2048 lds
  v_mfma_f32_16x16x32_bf16 v[128:131], a[160:163], a[96:99], v[128:131]
  v_mfma_f32_16x16x32_bf16 v[132:135], a[160:163], a[100:103], v[132:135]
  ds_read_b128 a[160:163], v4 offset:31744
  v_mfma_f32_16x16x32_bf16 v[136:139], a[164:167], a[96:99], v[136:139]
  buffer_load_dwordx4 v3, s[8:11], s32 offen offset:3072 lds
  v_mfma_f32_16x16x32_bf16 v[140:143], a[164:167], a[100:103], v[140:143]
  ds_read_b128 a[164:167], v4 offset:32768
  s_add_u32 m0, s21, 139264
  v_mfma_f32_16x16x32_bf16 v[28:31], a[96:99], a[96:99], v[28:31]
  s_add_u32 s30, s26, 165888
  s_waitcnt lgkmcnt(10)
  v_mfma_f32_16x16x32_bf16 v[144:147], a[168:171], a[96:99], v[144:147]
  buffer_load_dwordx4 v3, s[8:11], s30 offen lds
  v_mfma_f32_16x16x32_bf16 v[148:151], a[168:171], a[100:103], v[148:151]
  ds_read_b128 a[168:171], v4 offset:33792
  v_mfma_f32_16x16x32_bf16 v[152:155], a[172:175], a[96:99], v[152:155]
  v_mfma_f32_16x16x32_bf16 v[156:159], a[172:175], a[100:103], v[156:159]
  ds_read_b128 a[172:175], v4 offset:34816
  v_mfma_f32_16x16x32_bf16 v[32:35], a[100:103], a[100:103], v[32:35]
  buffer_load_dwordx4 v3, s[8:11], s30 offen offset:1024 lds
  v_mfma_f32_16x16x32_bf16 v[160:163], a[176:179], a[96:99], v[160:163]
  v_mfma_f32_16x16x32_bf16 v[164:167], a[176:179], a[100:103], v[164:167]
  ds_read_b128 a[176:179], v4 offset:35840
  s_waitcnt vmcnt(11)
  s_barrier
  s_waitcnt lgkmcnt(6)
  v_mfma_f32_16x16x32_bf16 v[96:99], a[144:147], a[104:107], v[96:99]
  ds_read_b64_tr_b16 a[112:113], v8 offset:49152
  v_mfma_f32_16x16x32_bf16 v[100:103], a[144:147], a[108:111], v[100:103]
  ds_read_b128 a[144:147], v4 offset:36864
  v_mfma_f32_16x16x32_bf16 v[104:107], a[148:151], a[104:107], v[104:107]
  ds_read_b64_tr_b16 a[114:115], v8 offset:50176
  v_mfma_f32_16x16x32_bf16 v[108:111], a[148:151], a[108:111], v[108:111]
  ds_read_b128 a[148:151], v4 offset:37888
  v_mfma_f32_16x16x32_bf16 v[20:23], v[36:39], a[104:107], v[20:23]
  buffer_load_dwordx4 v3, s[8:11], s30 offen offset:2048 lds
  v_mfma_f32_16x16x32_bf16 v[112:115], a[152:155], a[104:107], v[112:115]
  ds_read_b64_tr_b16 a[116:117], v9 offset:49152
  v_mfma_f32_16x16x32_bf16 v[116:119], a[152:155], a[108:111], v[116:119]
  ds_read_b128 a[152:155], v4 offset:38912
  s_waitcnt lgkmcnt(9)
  v_mfma_f32_16x16x32_bf16 v[120:123], a[156:159], a[104:107], v[120:123]
  ds_read_b64_tr_b16 a[118:119], v9 offset:50176
  v_mfma_f32_16x16x32_bf16 v[124:127], a[156:159], a[108:111], v[124:127]
  ds_read_b128 a[156:159], v4 offset:39936
  v_mfma_f32_16x16x32_bf16 v[24:27], v[36:39], a[108:111], v[24:27]
  buffer_load_dwordx4 v3, s[8:11], s30 offen offset:3072 lds
  v_mfma_f32_16x16x32_bf16 v[128:131], a[160:163], a[104:107], v[128:131]
  s_mul_i32 s31, s24, 139264
  s_add_u32 m0, s27, s31
  v_mfma_f32_16x16x32_bf16 v[132:135], a[160:163], a[108:111], v[132:135]
  ds_read_b128 a[160:163], v4 offset:40960
  s_add_u32 s31, s30, s23
  v_mfma_f32_16x16x32_bf16 v[136:139], a[164:167], a[104:107], v[136:139]
  buffer_load_dwordx4 v3, s[8:11], s31 offen lds
  v_mfma_f32_16x16x32_bf16 v[140:143], a[164:167], a[108:111], v[140:143]
  ds_read_b128 a[164:167], v4 offset:41984
  s_add_u32 m0, s21, 65536
  v_mfma_f32_16x16x32_bf16 v[28:31], a[104:107], a[104:107], v[28:31]
  s_add_u32 s30, s26, 184320
  s_waitcnt lgkmcnt(10)
  v_mfma_f32_16x16x32_bf16 v[144:147], a[168:171], a[104:107], v[144:147]
  buffer_load_dwordx4 v3, s[8:11], s30 offen lds
  v_mfma_f32_16x16x32_bf16 v[148:151], a[168:171], a[108:111], v[148:151]
  ds_read_b128 a[168:171], v4 offset:43008
  v_mfma_f32_16x16x32_bf16 v[152:155], a[172:175], a[104:107], v[152:155]
  v_mfma_f32_16x16x32_bf16 v[156:159], a[172:175], a[108:111], v[156:159]
  ds_read_b128 a[172:175], v4 offset:44032
  v_mfma_f32_16x16x32_bf16 v[32:35], a[108:111], a[108:111], v[32:35]
  buffer_load_dwordx4 v3, s[8:11], s30 offen offset:1024 lds
  v_mfma_f32_16x16x32_bf16 v[160:163], a[176:179], a[104:107], v[160:163]
  v_mfma_f32_16x16x32_bf16 v[164:167], a[176:179], a[108:111], v[164:167]
  ds_read_b128 a[176:179], v4 offset:45056
  s_waitcnt lgkmcnt(6)
  v_mfma_f32_16x16x32_bf16 v[96:99], a[144:147], a[112:115], v[96:99]
  ds_read_b64_tr_b16 a[120:121], v8 offset:57344
  v_mfma_f32_16x16x32_bf16 v[100:103], a[144:147], a[116:119], v[100:103]
  ds_read_b128 a[144:147], v4 offset:46080
  v_mfma_f32_16x16x32_bf16 v[104:107], a[148:151], a[112:115], v[104:107]
  ds_read_b64_tr_b16 a[122:123], v8 offset:58368
  v_mfma_f32_16x16x32_bf16 v[108:111], a[148:151], a[116:119], v[108:111]
  ds_read_b128 a[148:151], v4 offset:47104
  v_mfma_f32_16x16x32_bf16 v[20:23], v[36:39], a[112:115], v[20:23]
  buffer_load_dwordx4 v3, s[8:11], s30 offen offset:2048 lds
  v_mfma_f32_16x16x32_bf16 v[112:115], a[152:155], a[112:115], v[112:115]
  ds_read_b64_tr_b16 a[124:125], v9 offset:57344
  v_mfma_f32_16x16x32_bf16 v[116:119], a[152:155], a[116:119], v[116:119]
  ds_read_b128 a[152:155], v4 offset:48128
  s_waitcnt lgkmcnt(9)
  v_mfma_f32_16x16x32_bf16 v[120:123], a[156:159], a[112:115], v[120:123]
  ds_read_b64_tr_b16 a[126:127], v9 offset:58368
  v_mfma_f32_16x16x32_bf16 v[124:127], a[156:159], a[116:119], v[124:127]
  ds_read_b128 a[156:159], v4 offset:49152
  v_mfma_f32_16x16x32_bf16 v[24:27], v[36:39], a[116:119], v[24:27]
  buffer_load_dwordx4 v3, s[8:11], s30 offen offset:3072 lds
  v_mfma_f32_16x16x32_bf16 v[128:131], a[160:163], a[112:115], v[128:131]
  s_mul_i32 s31, s24, 65536
  s_add_u32 m0, s27, s31
  v_mfma_f32_16x16x32_bf16 v[132:135], a[160:163], a[116:119], v[132:135]
  ds_read_b128 a[160:163], v4 offset:50176
  s_add_u32 s31, s30, s23
  v_mfma_f32_16x16x32_bf16 v[136:139], a[164:167], a[112:115], v[136:139]
  buffer_load_dwordx4 v3, s[8:11], s31 offen lds
  v_mfma_f32_16x16x32_bf16 v[140:143], a[164:167], a[116:119], v[140:143]
  ds_read_b128 a[164:167], v4 offset:51200
  v_mfma_f32_16x16x32_bf16 v[28:31], a[112:115], a[112:115], v[28:31]
  s_waitcnt lgkmcnt(10)
  v_mfma_f32_16x16x32_bf16 v[144:147], a[168:171], a[112:115], v[144:147]
  v_mfma_f32_16x16x32_bf16 v[148:151], a[168:171], a[116:119], v[148:151]
  ds_read_b128 a[168:171], v4 offset:52224
  v_mfma_f32_16x16x32_bf16 v[152:155], a[172:175], a[112:115], v[152:155]
  v_mfma_f32_16x16x32_bf16 v[156:159], a[172:175], a[116:119], v[156:159]
  ds_read_b128 a[172:175], v4 offset:53248
  v_mfma_f32_16x16x32_bf16 v[32:35], a[116:119], a[116:119], v[32:35]
  v_mfma_f32_16x16x32_bf16 v[160:163], a[176:179], a[112:115], v[160:163]
  v_mfma_f32_16x16x32_bf16 v[164:167], a[176:179], a[116:119], v[164:167]
  ds_read_b128 a[176:179], v4 offset:54272
  s_waitcnt vmcnt(10)
  s_barrier
  s_waitcnt lgkmcnt(6)
  v_mfma_f32_16x16x32_bf16 v[96:99], a[144:147], a[120:123], v[96:99]
  ds_read_b64_tr_b16 a[128:129], v8 offset:0
  s_add_u32 m0, s21, 83968
  v_mfma_f32_16x16x32_bf16 v[100:103], a[144:147], a[124:127], v[100:103]
  ds_read_b128 a[144:147], v4 offset:55296
  s_add_u32 s30, s26, 202752
  v_mfma_f32_16x16x32_bf16 v[104:107], a[148:151], a[120:123], v[104:107]
  ds_read_b64_tr_b16 a[130:131], v8 offset:1024
  v_mfma_f32_16x16x32_bf16 v[108:111], a[148:151], a[124:127], v[108:111]
  ds_read_b128 a[148:151], v4 offset:56320
  v_mfma_f32_16x16x32_bf16 v[20:23], v[36:39], a[120:123], v[20:23]
  buffer_load_dwordx4 v3, s[8:11], s30 offen lds
  v_mfma_f32_16x16x32_bf16 v[112:115], a[152:155], a[120:123], v[112:115]
  ds_read_b64_tr_b16 a[132:133], v9 offset:0
  v_mfma_f32_16x16x32_bf16 v[116:119], a[152:155], a[124:127], v[116:119]
  ds_read_b128 a[152:155], v4 offset:57344
  s_waitcnt lgkmcnt(9)
  v_mfma_f32_16x16x32_bf16 v[120:123], a[156:159], a[120:123], v[120:123]
  ds_read_b64_tr_b16 a[134:135], v9 offset:1024
  v_mfma_f32_16x16x32_bf16 v[124:127], a[156:159], a[124:127], v[124:127]
  ds_read_b128 a[156:159], v4 offset:58368
  v_mfma_f32_16x16x32_bf16 v[24:27], v[36:39], a[124:127], v[24:27]
  buffer_load_dwordx4 v3, s[8:11], s30 offen offset:1024 lds
  v_mfma_f32_16x16x32_bf16 v[128:131], a[160:163], a[120:123], v[128:131]
  v_mfma_f32_16x16x32_bf16 v[132:135], a[160:163], a[124:127], v[132:135]
  ds_read_b128 a[160:163], v4 offset:59392
  v_mfma_f32_16x16x32_bf16 v[136:139], a[164:167], a[120:123], v[136:139]
  buffer_load_dwordx4 v3, s[8:11], s30 offen offset:2048 lds
  v_mfma_f32_16x16x32_bf16 v[140:143], a[164:167], a[124:127], v[140:143]
  ds_read_b128 a[164:167], v4 offset:60416
  v_mfma_f32_16x16x32_bf16 v[28:31], a[120:123], a[120:123], v[28:31]
  s_waitcnt lgkmcnt(10)
  v_mfma_f32_16x16x32_bf16 v[144:147], a[168:171], a[120:123], v[144:147]
  buffer_load_dwordx4 v3, s[8:11], s30 offen offset:3072 lds
  v_mfma_f32_16x16x32_bf16 v[148:151], a[168:171], a[124:127], v[148:151]
  ds_read_b128 a[168:171], v4 offset:61440
  s_mul_i32 s31, s24, 83968
  v_mfma_f32_16x16x32_bf16 v[152:155], a[172:175], a[120:123], v[152:155]
  s_add_u32 m0, s27, s31
  s_add_u32 s31, s30, s23
  v_mfma_f32_16x16x32_bf16 v[156:159], a[172:175], a[124:127], v[156:159]
  ds_read_b128 a[172:175], v4 offset:62464
  v_mfma_f32_16x16x32_bf16 v[32:35], a[124:127], a[124:127], v[32:35]
  buffer_load_dwordx4 v3, s[8:11], s31 offen lds
  v_mfma_f32_16x16x32_bf16 v[160:163], a[176:179], a[120:123], v[160:163]
  v_mfma_f32_16x16x32_bf16 v[164:167], a[176:179], a[124:127], v[164:167]
  ds_read_b128 a[176:179], v4 offset:63488
  s_waitcnt lgkmcnt(6)
  v_mfma_f32_16x16x32_bf16 v[96:99], a[144:147], a[128:131], v[96:99]
  ds_read_b64_tr_b16 a[136:137], v8 offset:8192
  v_mfma_f32_16x16x32_bf16 v[100:103], a[144:147], a[132:135], v[100:103]
  ds_read_b128 a[144:147], v4 offset:64512
  v_mfma_f32_16x16x32_bf16 v[104:107], a[148:151], a[128:131], v[104:107]
  ds_read_b64_tr_b16 a[138:139], v8 offset:9216
  v_mfma_f32_16x16x32_bf16 v[108:111], a[148:151], a[132:135], v[108:111]
  ds_read_b128 a[148:151], v5 offset:0
  v_mfma_f32_16x16x32_bf16 v[20:23], v[36:39], a[128:131], v[20:23]
  v_mfma_f32_16x16x32_bf16 v[112:115], a[152:155], a[128:131], v[112:115]
  ds_read_b64_tr_b16 a[140:141], v9 offset:8192
  v_mfma_f32_16x16x32_bf16 v[116:119], a[152:155], a[132:135], v[116:119]
  ds_read_b128 a[152:155], v5 offset:1024
  s_waitcnt lgkmcnt(9)
  v_mfma_f32_16x16x32_bf16 v[120:123], a[156:159], a[128:131], v[120:123]
  ds_read_b64_tr_b16 a[142:143], v9 offset:9216
  v_mfma_f32_16x16x32_bf16 v[124:127], a[156:159], a[132:135], v[124:127]
  ds_read_b128 a[156:159], v5 offset:2048
  v_mfma_f32_16x16x32_bf16 v[24:27], v[36:39], a[132:135], v[24:27]
  v_mfma_f32_16x16x32_bf16 v[128:131], a[160:163], a[128:131], v[128:131]
  v_mfma_f32_16x16x32_bf16 v[132:135], a[160:163], a[132:135], v[132:135]
  ds_read_b128 a[160:163], v5 offset:3072
  v_mfma_f32_16x16x32_bf16 v[136:139], a[164:167], a[128:131], v[136:139]
  v_mfma_f32_16x16x32_bf16 v[140:143], a[164:167], a[132:135], v[140:143]
  ds_read_b128 a[164:167], v5 offset:4096
  v_mfma_f32_16x16x32_bf16 v[28:31], a[128:131], a[128:131], v[28:31]
  s_waitcnt lgkmcnt(10)
  v_mfma_f32_16x16x32_bf16 v[144:147], a[168:171], a[128:131], v[144:147]
  v_mfma_f32_16x16x32_bf16 v[148:151], a[168:171], a[132:135], v[148:151]
  ds_read_b128 a[168:171], v5 offset:5120
  v_mfma_f32_16x16x32_bf16 v[152:155], a[172:175], a[128:131], v[152:155]
  v_mfma_f32_16x16x32_bf16 v[156:159], a[172:175], a[132:135], v[156:159]
  ds_read_b128 a[172:175], v5 offset:6144
  v_mfma_f32_16x16x32_bf16 v[32:35], a[132:135], a[132:135], v[32:35]
  v_mfma_f32_16x16x32_bf16 v[160:163], a[176:179], a[128:131], v[160:163]
  v_mfma_f32_16x16x32_bf16 v[164:167], a[176:179], a[132:135], v[164:167]
  ds_read_b128 a[176:179], v5 offset:7168
  s_waitcnt vmcnt(10)
  s_barrier
  s_waitcnt lgkmcnt(6)
  v_mfma_f32_16x16x32_bf16 v[96:99], a[144:147], a[136:139], v[96:99]
  s_add_u32 m0, s21, 102400
  s_add_u32 s30, s26, 221184
  v_mfma_f32_16x16x32_bf16 v[100:103], a[144:147], a[140:143], v[100:103]
  ds_read_b128 a[144:147], v5 offset:8192
  v_mfma_f32_16x16x32_bf16 v[104:107], a[148:151], a[136:139], v[104:107]
  buffer_load_dwordx4 v3, s[8:11], s30 offen lds
  v_mfma_f32_16x16x32_bf16 v[108:111], a[148:151], a[140:143], v[108:111]
  ds_read_b128 a[148:151], v5 offset:9216
  v_mfma_f32_16x16x32_bf16 v[20:23], v[36:39], a[136:139], v[20:23]
  v_mfma_f32_16x16x32_bf16 v[112:115], a[152:155], a[136:139], v[112:115]
  buffer_load_dwordx4 v3, s[8:11], s30 offen offset:1024 lds
  v_mfma_f32_16x16x32_bf16 v[116:119], a[152:155], a[140:143], v[116:119]
  ds_read_b128 a[152:155], v5 offset:10240
  s_waitcnt lgkmcnt(6)
  v_mfma_f32_16x16x32_bf16 v[120:123], a[156:159], a[136:139], v[120:123]
  v_mfma_f32_16x16x32_bf16 v[124:127], a[156:159], a[140:143], v[124:127]
  ds_read_b128 a[156:159], v5 offset:11264
  v_mfma_f32_16x16x32_bf16 v[24:27], v[36:39], a[140:143], v[24:27]
  buffer_load_dwordx4 v3, s[8:11], s30 offen offset:2048 lds
  v_mfma_f32_16x16x32_bf16 v[128:131], a[160:163], a[136:139], v[128:131]
  v_mfma_f32_16x16x32_bf16 v[132:135], a[160:163], a[140:143], v[132:135]
  ds_read_b128 a[160:163], v5 offset:12288
  v_mfma_f32_16x16x32_bf16 v[136:139], a[164:167], a[136:139], v[136:139]
  buffer_load_dwordx4 v3, s[8:11], s30 offen offset:3072 lds
  v_mfma_f32_16x16x32_bf16 v[140:143], a[164:167], a[140:143], v[140:143]
  ds_read_b128 a[164:167], v5 offset:13312
  s_mul_i32 s31, s24, 102400
  v_mfma_f32_16x16x32_bf16 v[28:31], a[136:139], a[136:139], v[28:31]
  s_add_u32 m0, s27, s31
  s_add_u32 s31, s30, s23
  s_waitcnt lgkmcnt(6)
  v_mfma_f32_16x16x32_bf16 v[144:147], a[168:171], a[136:139], v[144:147]
  buffer_load_dwordx4 v3, s[8:11], s31 offen lds
  v_mfma_f32_16x16x32_bf16 v[148:151], a[168:171], a[140:143], v[148:151]
  ds_read_b128 a[168:171], v5 offset:14336
  v_mfma_f32_16x16x32_bf16 v[152:155], a[172:175], a[136:139], v[152:155]
  v_mfma_f32_16x16x32_bf16 v[156:159], a[172:175], a[140:143], v[156:159]
  ds_read_b128 a[172:175], v5 offset:15360
  v_mfma_f32_16x16x32_bf16 v[32:35], a[140:143], a[140:143], v[32:35]
  v_mfma_f32_16x16x32_bf16 v[160:163], a[176:179], a[136:139], v[160:163]
  v_mfma_f32_16x16x32_bf16 v[164:167], a[176:179], a[140:143], v[164:167]
  ds_read_b128 a[176:179], v5 offset:16384
  s_barrier
  s_nop 7
  v_and_b32 v60, 3, v6
  v_lshrrev_b32 v61, 2, v6
  v_cmp_eq_u32 s[40:41], 1, v60
  v_cmp_eq_u32 s[42:43], 2, v60
  v_cmp_eq_u32 s[44:45], 3, v60
  v_cmp_eq_u32 s[48:49], v61, v7
  v_cndmask_b32 v28, v28, v29, s[40:41]
  v_cndmask_b32 v28, v28, v30, s[42:43]
  v_cndmask_b32 v28, v28, v31, s[44:45]
  v_cndmask_b32 v28, 0, v28, s[48:49]
  v_cndmask_b32 v32, v32, v33, s[40:41]
  v_cndmask_b32 v32, v32, v34, s[42:43]
  v_cndmask_b32 v32, v32, v35, s[44:45]
  v_cndmask_b32 v32, 0, v32, s[48:49]
  ds_read_b128 v[44:47], v18 offset:0
  ds_read_b128 v[48:51], v18 offset:576
  v_mov_b32 v62, v28
  s_nop 1
  v_permlane32_swap_b32 v28, v62
  v_add_f32 v28, v28, v62
  v_mov_b32 v62, v28
  s_nop 1
  v_permlane16_swap_b32 v28, v62
  v_add_f32 v28, v28, v62
  v_mov_b32 v63, v32
  s_nop 1
  v_permlane32_swap_b32 v32, v63
  v_add_f32 v32, v32, v63
  v_mov_b32 v63, v32
  s_nop 1
  v_permlane16_swap_b32 v32, v63
  v_add_f32 v32, v32, v63
  v_mul_f32 v20, 0x3ae38e39, v20
  v_mul_f32 v28, 0x3ae38e39, v28
  v_fma_f32 v28, -v20, v20, v28
  v_max_f32 v28, 0, v28
  v_add_f32 v28, 0x3727c5ac, v28
  v_rsq_f32 v40, v28
  s_nop 0
  v_mul_f32 v41, v20, v40
  v_mul_f32 v24, 0x3ae38e39, v24
  v_mul_f32 v32, 0x3ae38e39, v32
  v_fma_f32 v32, -v24, v24, v32
  v_max_f32 v32, 0, v32
  v_add_f32 v32, 0x3727c5ac, v32
  v_rsq_f32 v42, v32
  s_nop 0
  v_mul_f32 v43, v24, v42
  ds_read_b128 v[52:55], v18 offset:64
  ds_read_b128 v[56:59], v18 offset:640
  v_xor_b32 v19, 0, v16
  s_add_u32 m0, s54, 0
  s_add_u32 s55, s38, 0
  buffer_load_dwordx4 v19, s[4:7], s55 offen lds
  s_waitcnt lgkmcnt(2)
  v_pk_fma_f32 v[60:61], v[40:41], v[44:45], v[48:49] op_sel:[1,0,0] op_sel_hi:[1,1,1] neg_lo:[1,0,0] neg_hi:[1,0,0]
  v_pk_fma_f32 v[68:69], v[42:43], v[44:45], v[48:49] op_sel:[1,0,0] op_sel_hi:[1,1,1] neg_lo:[1,0,0] neg_hi:[1,0,0]
  v_pk_fma_f32 v[62:63], v[40:41], v[46:47], v[50:51] op_sel:[1,0,0] op_sel_hi:[1,1,1] neg_lo:[1,0,0] neg_hi:[1,0,0]
  v_pk_fma_f32 v[70:71], v[42:43], v[46:47], v[50:51] op_sel:[1,0,0] op_sel_hi:[1,1,1] neg_lo:[1,0,0] neg_hi:[1,0,0]
  v_pk_fma_f32 v[96:97], v[96:97], v[40:41], v[60:61] op_sel:[0,0,0] op_sel_hi:[1,0,1]
  v_pk_fma_f32 v[100:101], v[100:101], v[42:43], v[68:69] op_sel:[0,0,0] op_sel_hi:[1,0,1]
  v_pk_fma_f32 v[98:99], v[98:99], v[40:41], v[62:63] op_sel:[0,0,0] op_sel_hi:[1,0,1]
  v_pk_fma_f32 v[102:103], v[102:103], v[42:43], v[70:71] op_sel:[0,0,0] op_sel_hi:[1,0,1]
  v_pk_mul_f32 v[64:65], v[96:97], v[96:97]
  v_pk_mul_f32 v[72:73], v[100:101], v[100:101]
  v_pk_mul_f32 v[66:67], v[98:99], v[98:99]
  v_pk_mul_f32 v[74:75], v[102:103], v[102:103]
  v_pk_fma_f32 v[64:65], v[64:65], v[84:85], v[84:85] op_sel:[0,1,0] op_sel_hi:[1,1,0]
  v_pk_fma_f32 v[72:73], v[72:73], v[84:85], v[84:85] op_sel:[0,1,0] op_sel_hi:[1,1,0]
  v_pk_fma_f32 v[66:67], v[66:67], v[84:85], v[84:85] op_sel:[0,1,0] op_sel_hi:[1,1,0]
  v_pk_fma_f32 v[74:75], v[74:75], v[84:85], v[84:85] op_sel:[0,1,0] op_sel_hi:[1,1,0]
  v_pk_mul_f32 v[64:65], v[64:65], v[96:97]
  v_pk_mul_f32 v[72:73], v[72:73], v[100:101]
  v_pk_mul_f32 v[66:67], v[66:67], v[98:99]
  v_pk_mul_f32 v[74:75], v[74:75], v[102:103]
  v_exp_f32 v64, v64
  v_exp_f32 v72, v72
  v_exp_f32 v65, v65
  v_exp_f32 v73, v73
  v_exp_f32 v66, v66
  v_exp_f32 v74, v74
  v_exp_f32 v67, v67
  v_exp_f32 v75, v75
  v_pk_add_f32 v[64:65], v[64:65], s[46:47]
  v_pk_add_f32 v[72:73], v[72:73], s[46:47]
  v_pk_add_f32 v[66:67], v[66:67], s[46:47]
  v_pk_add_f32 v[74:75], v[74:75], s[46:47]
  v_rcp_f32 v64, v64
  v_rcp_f32 v72, v72
  v_rcp_f32 v65, v65
  v_rcp_f32 v73, v73
  v_rcp_f32 v66, v66
  v_rcp_f32 v74, v74
  v_rcp_f32 v67, v67
  v_rcp_f32 v75, v75
  v_pk_mul_f32 v[96:97], v[96:97], v[64:65]
  v_pk_mul_f32 v[100:101], v[100:101], v[72:73]
  v_pk_mul_f32 v[98:99], v[98:99], v[66:67]
  v_pk_mul_f32 v[102:103], v[102:103], v[74:75]
  v_pk_add_f32 v[76:77], v[76:77], v[96:97]
  v_pk_add_f32 v[78:79], v[78:79], v[100:101]
  v_pk_fma_f32 v[80:81], v[96:97], v[96:97], v[80:81]
  v_pk_fma_f32 v[82:83], v[100:101], v[100:101], v[82:83]
  v_pk_add_f32 v[76:77], v[76:77], v[98:99]
  v_pk_add_f32 v[78:79], v[78:79], v[102:103]
  v_pk_fma_f32 v[80:81], v[98:99], v[98:99], v[80:81]
  v_pk_fma_f32 v[82:83], v[102:103], v[102:103], v[82:83]
  ds_read_b128 v[44:47], v18 offset:128
  ds_read_b128 v[48:51], v18 offset:704
  v_xor_b32 v19, 64, v16
  s_add_u32 m0, s54, 1024
  s_add_u32 s55, s38, 16384
  buffer_load_dwordx4 v19, s[4:7], s55 offen lds
  s_waitcnt lgkmcnt(2)
  v_pk_fma_f32 v[60:61], v[40:41], v[52:53], v[56:57] op_sel:[1,0,0] op_sel_hi:[1,1,1] neg_lo:[1,0,0] neg_hi:[1,0,0]
  v_pk_fma_f32 v[68:69], v[42:43], v[52:53], v[56:57] op_sel:[1,0,0] op_sel_hi:[1,1,1] neg_lo:[1,0,0] neg_hi:[1,0,0]
  v_pk_fma_f32 v[62:63], v[40:41], v[54:55], v[58:59] op_sel:[1,0,0] op_sel_hi:[1,1,1] neg_lo:[1,0,0] neg_hi:[1,0,0]
  v_pk_fma_f32 v[70:71], v[42:43], v[54:55], v[58:59] op_sel:[1,0,0] op_sel_hi:[1,1,1] neg_lo:[1,0,0] neg_hi:[1,0,0]
  v_pk_fma_f32 v[104:105], v[104:105], v[40:41], v[60:61] op_sel:[0,0,0] op_sel_hi:[1,0,1]
  v_pk_fma_f32 v[108:109], v[108:109], v[42:43], v[68:69] op_sel:[0,0,0] op_sel_hi:[1,0,1]
  v_pk_fma_f32 v[106:107], v[106:107], v[40:41], v[62:63] op_sel:[0,0,0] op_sel_hi:[1,0,1]
  v_pk_fma_f32 v[110:111], v[110:111], v[42:43], v[70:71] op_sel:[0,0,0] op_sel_hi:[1,0,1]
  v_pk_mul_f32 v[64:65], v[104:105], v[104:105]
  v_pk_mul_f32 v[72:73], v[108:109], v[108:109]
  v_pk_mul_f32 v[66:67], v[106:107], v[106:107]
  v_pk_mul_f32 v[74:75], v[110:111], v[110:111]
  v_pk_fma_f32 v[64:65], v[64:65], v[84:85], v[84:85] op_sel:[0,1,0] op_sel_hi:[1,1,0]
  v_pk_fma_f32 v[72:73], v[72:73], v[84:85], v[84:85] op_sel:[0,1,0] op_sel_hi:[1,1,0]
  v_pk_fma_f32 v[66:67], v[66:67], v[84:85], v[84:85] op_sel:[0,1,0] op_sel_hi:[1,1,0]
  v_pk_fma_f32 v[74:75], v[74:75], v[84:85], v[84:85] op_sel:[0,1,0] op_sel_hi:[1,1,0]
  v_pk_mul_f32 v[64:65], v[64:65], v[104:105]
  v_pk_mul_f32 v[72:73], v[72:73], v[108:109]
  v_pk_mul_f32 v[66:67], v[66:67], v[106:107]
  v_pk_mul_f32 v[74:75], v[74:75], v[110:111]
  v_exp_f32 v64, v64
  v_exp_f32 v72, v72
  v_exp_f32 v65, v65
  v_exp_f32 v73, v73
  v_exp_f32 v66, v66
  v_exp_f32 v74, v74
  v_exp_f32 v67, v67
  v_exp_f32 v75, v75
  v_pk_add_f32 v[64:65], v[64:65], s[46:47]
  v_pk_add_f32 v[72:73], v[72:73], s[46:47]
  v_pk_add_f32 v[66:67], v[66:67], s[46:47]
  v_pk_add_f32 v[74:75], v[74:75], s[46:47]
  v_rcp_f32 v64, v64
  v_rcp_f32 v72, v72
  v_rcp_f32 v65, v65
  v_rcp_f32 v73, v73
  v_rcp_f32 v66, v66
  v_rcp_f32 v74, v74
  v_rcp_f32 v67, v67
  v_rcp_f32 v75, v75
  v_pk_mul_f32 v[104:105], v[104:105], v[64:65]
  v_pk_mul_f32 v[108:109], v[108:109], v[72:73]
  v_pk_mul_f32 v[106:107], v[106:107], v[66:67]
  v_pk_mul_f32 v[110:111], v[110:111], v[74:75]
  v_pk_add_f32 v[76:77], v[76:77], v[104:105]
  v_pk_add_f32 v[78:79], v[78:79], v[108:109]
  v_pk_fma_f32 v[80:81], v[104:105], v[104:105], v[80:81]
  v_pk_fma_f32 v[82:83], v[108:109], v[108:109], v[82:83]
  v_pk_add_f32 v[76:77], v[76:77], v[106:107]
  v_pk_add_f32 v[78:79], v[78:79], v[110:111]
  v_pk_fma_f32 v[80:81], v[106:107], v[106:107], v[80:81]
  v_pk_fma_f32 v[82:83], v[110:111], v[110:111], v[82:83]
  ds_read_b128 v[52:55], v18 offset:192
  ds_read_b128 v[56:59], v18 offset:768
  v_xor_b32 v19, 128, v16
  s_add_u32 m0, s54, 2048
  s_add_u32 s55, s38, 32768
  buffer_load_dwordx4 v19, s[4:7], s55 offen lds
  s_waitcnt lgkmcnt(2)
  v_pk_fma_f32 v[60:61], v[40:41], v[44:45], v[48:49] op_sel:[1,0,0] op_sel_hi:[1,1,1] neg_lo:[1,0,0] neg_hi:[1,0,0]
  v_pk_fma_f32 v[68:69], v[42:43], v[44:45], v[48:49] op_sel:[1,0,0] op_sel_hi:[1,1,1] neg_lo:[1,0,0] neg_hi:[1,0,0]
  v_pk_fma_f32 v[62:63], v[40:41], v[46:47], v[50:51] op_sel:[1,0,0] op_sel_hi:[1,1,1] neg_lo:[1,0,0] neg_hi:[1,0,0]
  v_pk_fma_f32 v[70:71], v[42:43], v[46:47], v[50:51] op_sel:[1,0,0] op_sel_hi:[1,1,1] neg_lo:[1,0,0] neg_hi:[1,0,0]
  v_pk_fma_f32 v[112:113], v[112:113], v[40:41], v[60:61] op_sel:[0,0,0] op_sel_hi:[1,0,1]
  v_pk_fma_f32 v[116:117], v[116:117], v[42:43], v[68:69] op_sel:[0,0,0] op_sel_hi:[1,0,1]
  v_pk_fma_f32 v[114:115], v[114:115], v[40:41], v[62:63] op_sel:[0,0,0] op_sel_hi:[1,0,1]
  v_pk_fma_f32 v[118:119], v[118:119], v[42:43], v[70:71] op_sel:[0,0,0] op_sel_hi:[1,0,1]
  v_pk_mul_f32 v[64:65], v[112:113], v[112:113]
  v_pk_mul_f32 v[72:73], v[116:117], v[116:117]
  v_pk_mul_f32 v[66:67], v[114:115], v[114:115]
  v_pk_mul_f32 v[74:75], v[118:119], v[118:119]
  v_pk_fma_f32 v[64:65], v[64:65], v[84:85], v[84:85] op_sel:[0,1,0] op_sel_hi:[1,1,0]
  v_pk_fma_f32 v[72:73], v[72:73], v[84:85], v[84:85] op_sel:[0,1,0] op_sel_hi:[1,1,0]
  v_pk_fma_f32 v[66:67], v[66:67], v[84:85], v[84:85] op_sel:[0,1,0] op_sel_hi:[1,1,0]
  v_pk_fma_f32 v[74:75], v[74:75], v[84:85], v[84:85] op_sel:[0,1,0] op_sel_hi:[1,1,0]
  v_pk_mul_f32 v[64:65], v[64:65], v[112:113]
  v_pk_mul_f32 v[72:73], v[72:73], v[116:117]
  v_pk_mul_f32 v[66:67], v[66:67], v[114:115]
  v_pk_mul_f32 v[74:75], v[74:75], v[118:119]
  v_exp_f32 v64, v64
  v_exp_f32 v72, v72
  v_exp_f32 v65, v65
  v_exp_f32 v73, v73
  v_exp_f32 v66, v66
  v_exp_f32 v74, v74
  v_exp_f32 v67, v67
  v_exp_f32 v75, v75
  v_pk_add_f32 v[64:65], v[64:65], s[46:47]
  v_pk_add_f32 v[72:73], v[72:73], s[46:47]
  v_pk_add_f32 v[66:67], v[66:67], s[46:47]
  v_pk_add_f32 v[74:75], v[74:75], s[46:47]
  v_rcp_f32 v64, v64
  v_rcp_f32 v72, v72
  v_rcp_f32 v65, v65
  v_rcp_f32 v73, v73
  v_rcp_f32 v66, v66
  v_rcp_f32 v74, v74
  v_rcp_f32 v67, v67
  v_rcp_f32 v75, v75
  v_pk_mul_f32 v[112:113], v[112:113], v[64:65]
  v_pk_mul_f32 v[116:117], v[116:117], v[72:73]
  v_pk_mul_f32 v[114:115], v[114:115], v[66:67]
  v_pk_mul_f32 v[118:119], v[118:119], v[74:75]
  v_pk_add_f32 v[76:77], v[76:77], v[112:113]
  v_pk_add_f32 v[78:79], v[78:79], v[116:117]
  v_pk_fma_f32 v[80:81], v[112:113], v[112:113], v[80:81]
  v_pk_fma_f32 v[82:83], v[116:117], v[116:117], v[82:83]
  v_pk_add_f32 v[76:77], v[76:77], v[114:115]
  v_pk_add_f32 v[78:79], v[78:79], v[118:119]
  v_pk_fma_f32 v[80:81], v[114:115], v[114:115], v[80:81]
  v_pk_fma_f32 v[82:83], v[118:119], v[118:119], v[82:83]
  ds_read_b128 v[44:47], v18 offset:256
  ds_read_b128 v[48:51], v18 offset:832
  v_xor_b32 v19, 192, v16
  s_add_u32 m0, s54, 3072
  s_add_u32 s55, s38, 49152
  buffer_load_dwordx4 v19, s[4:7], s55 offen lds
  s_waitcnt lgkmcnt(2)
  v_pk_fma_f32 v[60:61], v[40:41], v[52:53], v[56:57] op_sel:[1,0,0] op_sel_hi:[1,1,1] neg_lo:[1,0,0] neg_hi:[1,0,0]
  v_pk_fma_f32 v[68:69], v[42:43], v[52:53], v[56:57] op_sel:[1,0,0] op_sel_hi:[1,1,1] neg_lo:[1,0,0] neg_hi:[1,0,0]
  v_pk_fma_f32 v[62:63], v[40:41], v[54:55], v[58:59] op_sel:[1,0,0] op_sel_hi:[1,1,1] neg_lo:[1,0,0] neg_hi:[1,0,0]
  v_pk_fma_f32 v[70:71], v[42:43], v[54:55], v[58:59] op_sel:[1,0,0] op_sel_hi:[1,1,1] neg_lo:[1,0,0] neg_hi:[1,0,0]
  v_pk_fma_f32 v[120:121], v[120:121], v[40:41], v[60:61] op_sel:[0,0,0] op_sel_hi:[1,0,1]
  v_pk_fma_f32 v[124:125], v[124:125], v[42:43], v[68:69] op_sel:[0,0,0] op_sel_hi:[1,0,1]
  v_pk_fma_f32 v[122:123], v[122:123], v[40:41], v[62:63] op_sel:[0,0,0] op_sel_hi:[1,0,1]
  v_pk_fma_f32 v[126:127], v[126:127], v[42:43], v[70:71] op_sel:[0,0,0] op_sel_hi:[1,0,1]
  v_pk_mul_f32 v[64:65], v[120:121], v[120:121]
  v_pk_mul_f32 v[72:73], v[124:125], v[124:125]
  v_pk_mul_f32 v[66:67], v[122:123], v[122:123]
  v_pk_mul_f32 v[74:75], v[126:127], v[126:127]
  v_pk_fma_f32 v[64:65], v[64:65], v[84:85], v[84:85] op_sel:[0,1,0] op_sel_hi:[1,1,0]
  v_pk_fma_f32 v[72:73], v[72:73], v[84:85], v[84:85] op_sel:[0,1,0] op_sel_hi:[1,1,0]
  v_pk_fma_f32 v[66:67], v[66:67], v[84:85], v[84:85] op_sel:[0,1,0] op_sel_hi:[1,1,0]
  v_pk_fma_f32 v[74:75], v[74:75], v[84:85], v[84:85] op_sel:[0,1,0] op_sel_hi:[1,1,0]
  v_pk_mul_f32 v[64:65], v[64:65], v[120:121]
  v_pk_mul_f32 v[72:73], v[72:73], v[124:125]
  v_pk_mul_f32 v[66:67], v[66:67], v[122:123]
  v_pk_mul_f32 v[74:75], v[74:75], v[126:127]
  v_exp_f32 v64, v64
  v_exp_f32 v72, v72
  v_exp_f32 v65, v65
  v_exp_f32 v73, v73
  v_exp_f32 v66, v66
  v_exp_f32 v74, v74
  v_exp_f32 v67, v67
  v_exp_f32 v75, v75
  v_pk_add_f32 v[64:65], v[64:65], s[46:47]
  v_pk_add_f32 v[72:73], v[72:73], s[46:47]
  v_pk_add_f32 v[66:67], v[66:67], s[46:47]
  v_pk_add_f32 v[74:75], v[74:75], s[46:47]
  v_rcp_f32 v64, v64
  v_rcp_f32 v72, v72
  v_rcp_f32 v65, v65
  v_rcp_f32 v73, v73
  v_rcp_f32 v66, v66
  v_rcp_f32 v74, v74
  v_rcp_f32 v67, v67
  v_rcp_f32 v75, v75
  v_pk_mul_f32 v[120:121], v[120:121], v[64:65]
  v_pk_mul_f32 v[124:125], v[124:125], v[72:73]
  v_pk_mul_f32 v[122:123], v[122:123], v[66:67]
  v_pk_mul_f32 v[126:127], v[126:127], v[74:75]
  v_pk_add_f32 v[76:77], v[76:77], v[120:121]
  v_pk_add_f32 v[78:79], v[78:79], v[124:125]
  v_pk_fma_f32 v[80:81], v[120:121], v[120:121], v[80:81]
  v_pk_fma_f32 v[82:83], v[124:125], v[124:125], v[82:83]
  v_pk_add_f32 v[76:77], v[76:77], v[122:123]
  v_pk_add_f32 v[78:79], v[78:79], v[126:127]
  v_pk_fma_f32 v[80:81], v[122:123], v[122:123], v[80:81]
  v_pk_fma_f32 v[82:83], v[126:127], v[126:127], v[82:83]
  ds_read_b128 v[52:55], v18 offset:320
  ds_read_b128 v[56:59], v18 offset:896
  v_xor_b32 v19, 0, v16
  s_add_u32 m0, s54, 4096
  s_add_u32 s55, s38, 65536
  buffer_load_dwordx4 v19, s[4:7], s55 offen lds
  s_waitcnt lgkmcnt(2)
  v_pk_fma_f32 v[60:61], v[40:41], v[44:45], v[48:49] op_sel:[1,0,0] op_sel_hi:[1,1,1] neg_lo:[1,0,0] neg_hi:[1,0,0]
  v_pk_fma_f32 v[68:69], v[42:43], v[44:45], v[48:49] op_sel:[1,0,0] op_sel_hi:[1,1,1] neg_lo:[1,0,0] neg_hi:[1,0,0]
  v_pk_fma_f32 v[62:63], v[40:41], v[46:47], v[50:51] op_sel:[1,0,0] op_sel_hi:[1,1,1] neg_lo:[1,0,0] neg_hi:[1,0,0]
  v_pk_fma_f32 v[70:71], v[42:43], v[46:47], v[50:51] op_sel:[1,0,0] op_sel_hi:[1,1,1] neg_lo:[1,0,0] neg_hi:[1,0,0]
  v_pk_fma_f32 v[128:129], v[128:129], v[40:41], v[60:61] op_sel:[0,0,0] op_sel_hi:[1,0,1]
  v_pk_fma_f32 v[132:133], v[132:133], v[42:43], v[68:69] op_sel:[0,0,0] op_sel_hi:[1,0,1]
  v_pk_fma_f32 v[130:131], v[130:131], v[40:41], v[62:63] op_sel:[0,0,0] op_sel_hi:[1,0,1]
  v_pk_fma_f32 v[134:135], v[134:135], v[42:43], v[70:71] op_sel:[0,0,0] op_sel_hi:[1,0,1]
  v_pk_mul_f32 v[64:65], v[128:129], v[128:129]
  v_pk_mul_f32 v[72:73], v[132:133], v[132:133]
  v_pk_mul_f32 v[66:67], v[130:131], v[130:131]
  v_pk_mul_f32 v[74:75], v[134:135], v[134:135]
  v_pk_fma_f32 v[64:65], v[64:65], v[84:85], v[84:85] op_sel:[0,1,0] op_sel_hi:[1,1,0]
  v_pk_fma_f32 v[72:73], v[72:73], v[84:85], v[84:85] op_sel:[0,1,0] op_sel_hi:[1,1,0]
  v_pk_fma_f32 v[66:67], v[66:67], v[84:85], v[84:85] op_sel:[0,1,0] op_sel_hi:[1,1,0]
  v_pk_fma_f32 v[74:75], v[74:75], v[84:85], v[84:85] op_sel:[0,1,0] op_sel_hi:[1,1,0]
  v_pk_mul_f32 v[64:65], v[64:65], v[128:129]
  v_pk_mul_f32 v[72:73], v[72:73], v[132:133]
  v_pk_mul_f32 v[66:67], v[66:67], v[130:131]
  v_pk_mul_f32 v[74:75], v[74:75], v[134:135]
  v_exp_f32 v64, v64
  v_exp_f32 v72, v72
  v_exp_f32 v65, v65
  v_exp_f32 v73, v73
  v_exp_f32 v66, v66
  v_exp_f32 v74, v74
  v_exp_f32 v67, v67
  v_exp_f32 v75, v75
  v_pk_add_f32 v[64:65], v[64:65], s[46:47]
  v_pk_add_f32 v[72:73], v[72:73], s[46:47]
  v_pk_add_f32 v[66:67], v[66:67], s[46:47]
  v_pk_add_f32 v[74:75], v[74:75], s[46:47]
  v_rcp_f32 v64, v64
  v_rcp_f32 v72, v72
  v_rcp_f32 v65, v65
  v_rcp_f32 v73, v73
  v_rcp_f32 v66, v66
  v_rcp_f32 v74, v74
  v_rcp_f32 v67, v67
  v_rcp_f32 v75, v75
  v_pk_mul_f32 v[128:129], v[128:129], v[64:65]
  v_pk_mul_f32 v[132:133], v[132:133], v[72:73]
  v_pk_mul_f32 v[130:131], v[130:131], v[66:67]
  v_pk_mul_f32 v[134:135], v[134:135], v[74:75]
  v_pk_add_f32 v[76:77], v[76:77], v[128:129]
  v_pk_add_f32 v[78:79], v[78:79], v[132:133]
  v_pk_fma_f32 v[80:81], v[128:129], v[128:129], v[80:81]
  v_pk_fma_f32 v[82:83], v[132:133], v[132:133], v[82:83]
  v_pk_add_f32 v[76:77], v[76:77], v[130:131]
  v_pk_add_f32 v[78:79], v[78:79], v[134:135]
  v_pk_fma_f32 v[80:81], v[130:131], v[130:131], v[80:81]
  v_pk_fma_f32 v[82:83], v[134:135], v[134:135], v[82:83]
  ds_read_b128 v[44:47], v18 offset:384
  ds_read_b128 v[48:51], v18 offset:960
  v_xor_b32 v19, 64, v16
  s_add_u32 m0, s54, 5120
  s_add_u32 s55, s38, 81920
  buffer_load_dwordx4 v19, s[4:7], s55 offen lds
  s_waitcnt lgkmcnt(2)
  v_pk_fma_f32 v[60:61], v[40:41], v[52:53], v[56:57] op_sel:[1,0,0] op_sel_hi:[1,1,1] neg_lo:[1,0,0] neg_hi:[1,0,0]
  v_pk_fma_f32 v[68:69], v[42:43], v[52:53], v[56:57] op_sel:[1,0,0] op_sel_hi:[1,1,1] neg_lo:[1,0,0] neg_hi:[1,0,0]
  v_pk_fma_f32 v[62:63], v[40:41], v[54:55], v[58:59] op_sel:[1,0,0] op_sel_hi:[1,1,1] neg_lo:[1,0,0] neg_hi:[1,0,0]
  v_pk_fma_f32 v[70:71], v[42:43], v[54:55], v[58:59] op_sel:[1,0,0] op_sel_hi:[1,1,1] neg_lo:[1,0,0] neg_hi:[1,0,0]
  v_pk_fma_f32 v[136:137], v[136:137], v[40:41], v[60:61] op_sel:[0,0,0] op_sel_hi:[1,0,1]
  v_pk_fma_f32 v[140:141], v[140:141], v[42:43], v[68:69] op_sel:[0,0,0] op_sel_hi:[1,0,1]
  v_pk_fma_f32 v[138:139], v[138:139], v[40:41], v[62:63] op_sel:[0,0,0] op_sel_hi:[1,0,1]
  v_pk_fma_f32 v[142:143], v[142:143], v[42:43], v[70:71] op_sel:[0,0,0] op_sel_hi:[1,0,1]
  v_pk_mul_f32 v[64:65], v[136:137], v[136:137]
  v_pk_mul_f32 v[72:73], v[140:141], v[140:141]
  v_pk_mul_f32 v[66:67], v[138:139], v[138:139]
  v_pk_mul_f32 v[74:75], v[142:143], v[142:143]
  v_pk_fma_f32 v[64:65], v[64:65], v[84:85], v[84:85] op_sel:[0,1,0] op_sel_hi:[1,1,0]
  v_pk_fma_f32 v[72:73], v[72:73], v[84:85], v[84:85] op_sel:[0,1,0] op_sel_hi:[1,1,0]
  v_pk_fma_f32 v[66:67], v[66:67], v[84:85], v[84:85] op_sel:[0,1,0] op_sel_hi:[1,1,0]
  v_pk_fma_f32 v[74:75], v[74:75], v[84:85], v[84:85] op_sel:[0,1,0] op_sel_hi:[1,1,0]
  v_pk_mul_f32 v[64:65], v[64:65], v[136:137]
  v_pk_mul_f32 v[72:73], v[72:73], v[140:141]
  v_pk_mul_f32 v[66:67], v[66:67], v[138:139]
  v_pk_mul_f32 v[74:75], v[74:75], v[142:143]
  v_exp_f32 v64, v64
  v_exp_f32 v72, v72
  v_exp_f32 v65, v65
  v_exp_f32 v73, v73
  v_exp_f32 v66, v66
  v_exp_f32 v74, v74
  v_exp_f32 v67, v67
  v_exp_f32 v75, v75
  v_pk_add_f32 v[64:65], v[64:65], s[46:47]
  v_pk_add_f32 v[72:73], v[72:73], s[46:47]
  v_pk_add_f32 v[66:67], v[66:67], s[46:47]
  v_pk_add_f32 v[74:75], v[74:75], s[46:47]
  v_rcp_f32 v64, v64
  v_rcp_f32 v72, v72
  v_rcp_f32 v65, v65
  v_rcp_f32 v73, v73
  v_rcp_f32 v66, v66
  v_rcp_f32 v74, v74
  v_rcp_f32 v67, v67
  v_rcp_f32 v75, v75
  v_pk_mul_f32 v[136:137], v[136:137], v[64:65]
  v_pk_mul_f32 v[140:141], v[140:141], v[72:73]
  v_pk_mul_f32 v[138:139], v[138:139], v[66:67]
  v_pk_mul_f32 v[142:143], v[142:143], v[74:75]
  v_pk_add_f32 v[76:77], v[76:77], v[136:137]
  v_pk_add_f32 v[78:79], v[78:79], v[140:141]
  v_pk_fma_f32 v[80:81], v[136:137], v[136:137], v[80:81]
  v_pk_fma_f32 v[82:83], v[140:141], v[140:141], v[82:83]
  v_pk_add_f32 v[76:77], v[76:77], v[138:139]
  v_pk_add_f32 v[78:79], v[78:79], v[142:143]
  v_pk_fma_f32 v[80:81], v[138:139], v[138:139], v[80:81]
  v_pk_fma_f32 v[82:83], v[142:143], v[142:143], v[82:83]
  ds_read_b128 v[52:55], v18 offset:448
  ds_read_b128 v[56:59], v18 offset:1024
  v_xor_b32 v19, 128, v16
  s_add_u32 m0, s54, 6144
  s_add_u32 s55, s38, 98304
  buffer_load_dwordx4 v19, s[4:7], s55 offen lds
  s_waitcnt lgkmcnt(2)
  v_pk_fma_f32 v[60:61], v[40:41], v[44:45], v[48:49] op_sel:[1,0,0] op_sel_hi:[1,1,1] neg_lo:[1,0,0] neg_hi:[1,0,0]
  v_pk_fma_f32 v[68:69], v[42:43], v[44:45], v[48:49] op_sel:[1,0,0] op_sel_hi:[1,1,1] neg_lo:[1,0,0] neg_hi:[1,0,0]
  v_pk_fma_f32 v[62:63], v[40:41], v[46:47], v[50:51] op_sel:[1,0,0] op_sel_hi:[1,1,1] neg_lo:[1,0,0] neg_hi:[1,0,0]
  v_pk_fma_f32 v[70:71], v[42:43], v[46:47], v[50:51] op_sel:[1,0,0] op_sel_hi:[1,1,1] neg_lo:[1,0,0] neg_hi:[1,0,0]
  v_pk_fma_f32 v[144:145], v[144:145], v[40:41], v[60:61] op_sel:[0,0,0] op_sel_hi:[1,0,1]
  v_pk_fma_f32 v[148:149], v[148:149], v[42:43], v[68:69] op_sel:[0,0,0] op_sel_hi:[1,0,1]
  v_pk_fma_f32 v[146:147], v[146:147], v[40:41], v[62:63] op_sel:[0,0,0] op_sel_hi:[1,0,1]
  v_pk_fma_f32 v[150:151], v[150:151], v[42:43], v[70:71] op_sel:[0,0,0] op_sel_hi:[1,0,1]
  v_pk_mul_f32 v[64:65], v[144:145], v[144:145]
  v_pk_mul_f32 v[72:73], v[148:149], v[148:149]
  v_pk_mul_f32 v[66:67], v[146:147], v[146:147]
  v_pk_mul_f32 v[74:75], v[150:151], v[150:151]
  v_pk_fma_f32 v[64:65], v[64:65], v[84:85], v[84:85] op_sel:[0,1,0] op_sel_hi:[1,1,0]
  v_pk_fma_f32 v[72:73], v[72:73], v[84:85], v[84:85] op_sel:[0,1,0] op_sel_hi:[1,1,0]
  v_pk_fma_f32 v[66:67], v[66:67], v[84:85], v[84:85] op_sel:[0,1,0] op_sel_hi:[1,1,0]
  v_pk_fma_f32 v[74:75], v[74:75], v[84:85], v[84:85] op_sel:[0,1,0] op_sel_hi:[1,1,0]
  v_pk_mul_f32 v[64:65], v[64:65], v[144:145]
  v_pk_mul_f32 v[72:73], v[72:73], v[148:149]
  v_pk_mul_f32 v[66:67], v[66:67], v[146:147]
  v_pk_mul_f32 v[74:75], v[74:75], v[150:151]
  v_exp_f32 v64, v64
  v_exp_f32 v72, v72
  v_exp_f32 v65, v65
  v_exp_f32 v73, v73
  v_exp_f32 v66, v66
  v_exp_f32 v74, v74
  v_exp_f32 v67, v67
  v_exp_f32 v75, v75
  v_pk_add_f32 v[64:65], v[64:65], s[46:47]
  v_pk_add_f32 v[72:73], v[72:73], s[46:47]
  v_pk_add_f32 v[66:67], v[66:67], s[46:47]
  v_pk_add_f32 v[74:75], v[74:75], s[46:47]
  v_rcp_f32 v64, v64
  v_rcp_f32 v72, v72
  v_rcp_f32 v65, v65
  v_rcp_f32 v73, v73
  v_rcp_f32 v66, v66
  v_rcp_f32 v74, v74
  v_rcp_f32 v67, v67
  v_rcp_f32 v75, v75
  v_pk_mul_f32 v[144:145], v[144:145], v[64:65]
  v_pk_mul_f32 v[148:149], v[148:149], v[72:73]
  v_pk_mul_f32 v[146:147], v[146:147], v[66:67]
  v_pk_mul_f32 v[150:151], v[150:151], v[74:75]
  v_pk_add_f32 v[76:77], v[76:77], v[144:145]
  v_pk_add_f32 v[78:79], v[78:79], v[148:149]
  v_pk_fma_f32 v[80:81], v[144:145], v[144:145], v[80:81]
  v_pk_fma_f32 v[82:83], v[148:149], v[148:149], v[82:83]
  v_pk_add_f32 v[76:77], v[76:77], v[146:147]
  v_pk_add_f32 v[78:79], v[78:79], v[150:151]
  v_pk_fma_f32 v[80:81], v[146:147], v[146:147], v[80:81]
  v_pk_fma_f32 v[82:83], v[150:151], v[150:151], v[82:83]
  ds_read_b128 v[44:47], v18 offset:512
  ds_read_b128 v[48:51], v18 offset:1088
  v_xor_b32 v19, 192, v16
  s_add_u32 m0, s54, 7168
  s_add_u32 s55, s38, 114688
  buffer_load_dwordx4 v19, s[4:7], s55 offen lds
  s_waitcnt lgkmcnt(2)
  v_pk_fma_f32 v[60:61], v[40:41], v[52:53], v[56:57] op_sel:[1,0,0] op_sel_hi:[1,1,1] neg_lo:[1,0,0] neg_hi:[1,0,0]
  v_pk_fma_f32 v[68:69], v[42:43], v[52:53], v[56:57] op_sel:[1,0,0] op_sel_hi:[1,1,1] neg_lo:[1,0,0] neg_hi:[1,0,0]
  v_pk_fma_f32 v[62:63], v[40:41], v[54:55], v[58:59] op_sel:[1,0,0] op_sel_hi:[1,1,1] neg_lo:[1,0,0] neg_hi:[1,0,0]
  v_pk_fma_f32 v[70:71], v[42:43], v[54:55], v[58:59] op_sel:[1,0,0] op_sel_hi:[1,1,1] neg_lo:[1,0,0] neg_hi:[1,0,0]
  v_pk_fma_f32 v[152:153], v[152:153], v[40:41], v[60:61] op_sel:[0,0,0] op_sel_hi:[1,0,1]
  v_pk_fma_f32 v[156:157], v[156:157], v[42:43], v[68:69] op_sel:[0,0,0] op_sel_hi:[1,0,1]
  v_pk_fma_f32 v[154:155], v[154:155], v[40:41], v[62:63] op_sel:[0,0,0] op_sel_hi:[1,0,1]
  v_pk_fma_f32 v[158:159], v[158:159], v[42:43], v[70:71] op_sel:[0,0,0] op_sel_hi:[1,0,1]
  v_pk_mul_f32 v[64:65], v[152:153], v[152:153]
  v_pk_mul_f32 v[72:73], v[156:157], v[156:157]
  v_pk_mul_f32 v[66:67], v[154:155], v[154:155]
  v_pk_mul_f32 v[74:75], v[158:159], v[158:159]
  v_pk_fma_f32 v[64:65], v[64:65], v[84:85], v[84:85] op_sel:[0,1,0] op_sel_hi:[1,1,0]
  v_pk_fma_f32 v[72:73], v[72:73], v[84:85], v[84:85] op_sel:[0,1,0] op_sel_hi:[1,1,0]
  v_pk_fma_f32 v[66:67], v[66:67], v[84:85], v[84:85] op_sel:[0,1,0] op_sel_hi:[1,1,0]
  v_pk_fma_f32 v[74:75], v[74:75], v[84:85], v[84:85] op_sel:[0,1,0] op_sel_hi:[1,1,0]
  v_pk_mul_f32 v[64:65], v[64:65], v[152:153]
  v_pk_mul_f32 v[72:73], v[72:73], v[156:157]
  v_pk_mul_f32 v[66:67], v[66:67], v[154:155]
  v_pk_mul_f32 v[74:75], v[74:75], v[158:159]
  v_exp_f32 v64, v64
  v_exp_f32 v72, v72
  v_exp_f32 v65, v65
  v_exp_f32 v73, v73
  v_exp_f32 v66, v66
  v_exp_f32 v74, v74
  v_exp_f32 v67, v67
  v_exp_f32 v75, v75
  v_pk_add_f32 v[64:65], v[64:65], s[46:47]
  v_pk_add_f32 v[72:73], v[72:73], s[46:47]
  v_pk_add_f32 v[66:67], v[66:67], s[46:47]
  v_pk_add_f32 v[74:75], v[74:75], s[46:47]
  v_rcp_f32 v64, v64
  v_rcp_f32 v72, v72
  v_rcp_f32 v65, v65
  v_rcp_f32 v73, v73
  v_rcp_f32 v66, v66
  v_rcp_f32 v74, v74
  v_rcp_f32 v67, v67
  v_rcp_f32 v75, v75
  v_pk_mul_f32 v[152:153], v[152:153], v[64:65]
  v_pk_mul_f32 v[156:157], v[156:157], v[72:73]
  v_pk_mul_f32 v[154:155], v[154:155], v[66:67]
  v_pk_mul_f32 v[158:159], v[158:159], v[74:75]
  v_pk_add_f32 v[76:77], v[76:77], v[152:153]
  v_pk_add_f32 v[78:79], v[78:79], v[156:157]
  v_pk_fma_f32 v[80:81], v[152:153], v[152:153], v[80:81]
  v_pk_fma_f32 v[82:83], v[156:157], v[156:157], v[82:83]
  v_pk_add_f32 v[76:77], v[76:77], v[154:155]
  v_pk_add_f32 v[78:79], v[78:79], v[158:159]
  v_pk_fma_f32 v[80:81], v[154:155], v[154:155], v[80:81]
  v_pk_fma_f32 v[82:83], v[158:159], v[158:159], v[82:83]
  s_waitcnt lgkmcnt(0)
  v_pk_fma_f32 v[60:61], v[40:41], v[44:45], v[48:49] op_sel:[1,0,0] op_sel_hi:[1,1,1] neg_lo:[1,0,0] neg_hi:[1,0,0]
  v_pk_fma_f32 v[68:69], v[42:43], v[44:45], v[48:49] op_sel:[1,0,0] op_sel_hi:[1,1,1] neg_lo:[1,0,0] neg_hi:[1,0,0]
  v_pk_fma_f32 v[62:63], v[40:41], v[46:47], v[50:51] op_sel:[1,0,0] op_sel_hi:[1,1,1] neg_lo:[1,0,0] neg_hi:[1,0,0]
  v_pk_fma_f32 v[70:71], v[42:43], v[46:47], v[50:51] op_sel:[1,0,0] op_sel_hi:[1,1,1] neg_lo:[1,0,0] neg_hi:[1,0,0]
  v_pk_fma_f32 v[160:161], v[160:161], v[40:41], v[60:61] op_sel:[0,0,0] op_sel_hi:[1,0,1]
  v_pk_fma_f32 v[164:165], v[164:165], v[42:43], v[68:69] op_sel:[0,0,0] op_sel_hi:[1,0,1]
  v_pk_fma_f32 v[162:163], v[162:163], v[40:41], v[62:63] op_sel:[0,0,0] op_sel_hi:[1,0,1]
  v_pk_fma_f32 v[166:167], v[166:167], v[42:43], v[70:71] op_sel:[0,0,0] op_sel_hi:[1,0,1]
  v_pk_mul_f32 v[64:65], v[160:161], v[160:161]
  v_pk_mul_f32 v[72:73], v[164:165], v[164:165]
  v_pk_mul_f32 v[66:67], v[162:163], v[162:163]
  v_pk_mul_f32 v[74:75], v[166:167], v[166:167]
  v_pk_fma_f32 v[64:65], v[64:65], v[84:85], v[84:85] op_sel:[0,1,0] op_sel_hi:[1,1,0]
  v_pk_fma_f32 v[72:73], v[72:73], v[84:85], v[84:85] op_sel:[0,1,0] op_sel_hi:[1,1,0]
  v_pk_fma_f32 v[66:67], v[66:67], v[84:85], v[84:85] op_sel:[0,1,0] op_sel_hi:[1,1,0]
  v_pk_fma_f32 v[74:75], v[74:75], v[84:85], v[84:85] op_sel:[0,1,0] op_sel_hi:[1,1,0]
  v_pk_mul_f32 v[64:65], v[64:65], v[160:161]
  v_pk_mul_f32 v[72:73], v[72:73], v[164:165]
  v_pk_mul_f32 v[66:67], v[66:67], v[162:163]
  v_pk_mul_f32 v[74:75], v[74:75], v[166:167]
  v_exp_f32 v64, v64
  v_exp_f32 v72, v72
  v_exp_f32 v65, v65
  v_exp_f32 v73, v73
  v_exp_f32 v66, v66
  v_exp_f32 v74, v74
  v_exp_f32 v67, v67
  v_exp_f32 v75, v75
  v_pk_add_f32 v[64:65], v[64:65], s[46:47]
  v_pk_add_f32 v[72:73], v[72:73], s[46:47]
  v_pk_add_f32 v[66:67], v[66:67], s[46:47]
  v_pk_add_f32 v[74:75], v[74:75], s[46:47]
  v_rcp_f32 v64, v64
  v_rcp_f32 v72, v72
  v_rcp_f32 v65, v65
  v_rcp_f32 v73, v73
  v_rcp_f32 v66, v66
  v_rcp_f32 v74, v74
  v_rcp_f32 v67, v67
  v_rcp_f32 v75, v75
  v_pk_mul_f32 v[160:161], v[160:161], v[64:65]
  v_pk_mul_f32 v[164:165], v[164:165], v[72:73]
  v_pk_mul_f32 v[162:163], v[162:163], v[66:67]
  v_pk_mul_f32 v[166:167], v[166:167], v[74:75]
  v_pk_add_f32 v[76:77], v[76:77], v[160:161]
  v_pk_add_f32 v[78:79], v[78:79], v[164:165]
  v_pk_fma_f32 v[80:81], v[160:161], v[160:161], v[80:81]
  v_pk_fma_f32 v[82:83], v[164:165], v[164:165], v[82:83]
  v_pk_add_f32 v[76:77], v[76:77], v[162:163]
  v_pk_add_f32 v[78:79], v[78:79], v[166:167]
  v_pk_fma_f32 v[80:81], v[162:163], v[162:163], v[80:81]
  v_pk_fma_f32 v[82:83], v[166:167], v[166:167], v[82:83]
  v_add_f32 v76, v76, v77
  v_add_f32 v80, v80, v81
  v_add_f32 v78, v78, v79
  v_add_f32 v82, v82, v83
  v_mov_b32 v60, v76
  s_nop 1
  v_permlane32_swap_b32 v76, v60
  v_add_f32 v76, v76, v60
  v_mov_b32 v60, v76
  s_nop 1
  v_permlane16_swap_b32 v76, v60
  v_add_f32 v76, v76, v60
  v_mov_b32 v60, v78
  s_nop 1
  v_permlane32_swap_b32 v78, v60
  v_add_f32 v78, v78, v60
  v_mov_b32 v60, v78
  s_nop 1
  v_permlane16_swap_b32 v78, v60
  v_add_f32 v78, v78, v60
  v_mov_b32 v60, v80
  s_nop 1
  v_permlane32_swap_b32 v80, v60
  v_add_f32 v80, v80, v60
  v_mov_b32 v60, v80
  s_nop 1
  v_permlane16_swap_b32 v80, v60
  v_add_f32 v80, v80, v60
  v_mov_b32 v60, v82
  s_nop 1
  v_permlane32_swap_b32 v82, v60
  v_add_f32 v82, v82, v60
  v_mov_b32 v60, v82
  s_nop 1
  v_permlane16_swap_b32 v82, v60
  v_add_f32 v82, v82, v60
  v_mov_b32 v77, v80
  v_mov_b32 v79, v82
  v_lshl_add_u32 v60, v2, 5, v6
  v_lshlrev_b32 v60, 7, v60
  s_lshl_b32 s48, s16, 14
  s_lshl_b32 s49, s17, 3
  s_add_u32 s48, s48, s49
  s_add_u32 s48, s48, 131072
  s_mov_b64 exec, 0xffff
  buffer_store_dwordx2 v[76:77], v60, s[8:11], s48 offen sc1
  buffer_store_dwordx2 v[78:79], v60, s[8:11], s48 offen offset:2048 sc1
  s_mov_b64 exec, -1
  v_mfma_f32_16x16x32_bf16 a[180:183], a[144:147], a[0:3], 0
  v_mfma_f32_16x16x32_bf16 a[184:187], a[144:147], a[4:7], 0
  ds_read_b128 a[144:147], v5 offset:17408
  v_mfma_f32_16x16x32_bf16 a[188:191], a[148:151], a[0:3], 0
  v_mfma_f32_16x16x32_bf16 a[192:195], a[148:151], a[4:7], 0
  ds_read_b128 a[148:151], v5 offset:18432
  v_mfma_f32_16x16x32_bf16 a[196:199], a[152:155], a[0:3], 0
  v_mfma_f32_16x16x32_bf16 a[200:203], a[152:155], a[4:7], 0
  ds_read_b128 a[152:155], v5 offset:19456
  v_mfma_f32_16x16x32_bf16 a[204:207], a[156:159], a[0:3], 0
  v_mfma_f32_16x16x32_bf16 a[208:211], a[156:159], a[4:7], 0
  ds_read_b128 a[156:159], v5 offset:20480
  v_mfma_f32_16x16x32_bf16 a[212:215], a[160:163], a[0:3], 0
  v_mfma_f32_16x16x32_bf16 a[216:219], a[160:163], a[4:7], 0
  ds_read_b128 a[160:163], v5 offset:21504
  v_mfma_f32_16x16x32_bf16 a[220:223], a[164:167], a[0:3], 0
  v_mfma_f32_16x16x32_bf16 a[224:227], a[164:167], a[4:7], 0
  ds_read_b128 a[164:167], v5 offset:22528
  v_mfma_f32_16x16x32_bf16 a[228:231], a[168:171], a[0:3], 0
  v_mfma_f32_16x16x32_bf16 a[232:235], a[168:171], a[4:7], 0
  ds_read_b128 a[168:171], v5 offset:23552
  v_mfma_f32_16x16x32_bf16 a[236:239], a[172:175], a[0:3], 0
  v_mfma_f32_16x16x32_bf16 a[240:243], a[172:175], a[4:7], 0
  ds_read_b128 a[172:175], v5 offset:24576
  v_mfma_f32_16x16x32_bf16 a[244:247], a[176:179], a[0:3], 0
  v_mfma_f32_16x16x32_bf16 a[248:251], a[176:179], a[4:7], 0
  ds_read_b128 a[176:179], v5 offset:25600
  s_waitcnt vmcnt(20)
  s_barrier
  s_waitcnt lgkmcnt(6)
  v_mfma_f32_16x16x32_bf16 a[180:183], a[144:147], a[8:11], a[180:183]
  s_add_u32 m0, s21, 120832
  s_add_u32 s30, s26, 239616
  v_mfma_f32_16x16x32_bf16 a[184:187], a[144:147], a[12:15], a[184:187]
  ds_read_b128 a[144:147], v4 offset:0
  v_mfma_f32_16x16x32_bf16 a[188:191], a[148:151], a[8:11], a[188:191]
  buffer_load_dwordx4 v3, s[8:11], s30 offen lds
  v_mfma_f32_16x16x32_bf16 a[192:195], a[148:151], a[12:15], a[192:195]
  ds_read_b128 a[148:151], v4 offset:1024
  v_mfma_f32_16x16x32_bf16 a[196:199], a[152:155], a[8:11], a[196:199]
  v_mfma_f32_16x16x32_bf16 a[200:203], a[152:155], a[12:15], a[200:203]
  ds_read_b128 a[152:155], v4 offset:2048
  s_waitcnt lgkmcnt(6)
  v_mfma_f32_16x16x32_bf16 a[204:207], a[156:159], a[8:11], a[204:207]
  buffer_load_dwordx4 v3, s[8:11], s30 offen offset:1024 lds
  v_mfma_f32_16x16x32_bf16 a[208:211], a[156:159], a[12:15], a[208:211]
  ds_read_b128 a[156:159], v4 offset:3072
  v_mfma_f32_16x16x32_bf16 a[212:215], a[160:163], a[8:11], a[212:215]
  v_mfma_f32_16x16x32_bf16 a[216:219], a[160:163], a[12:15], a[216:219]
  ds_read_b128 a[160:163], v4 offset:4096
  v_mfma_f32_16x16x32_bf16 a[220:223], a[164:167], a[8:11], a[220:223]
  buffer_load_dwordx4 v3, s[8:11], s30 offen offset:2048 lds
  v_mfma_f32_16x16x32_bf16 a[224:227], a[164:167], a[12:15], a[224:227]
  ds_read_b128 a[164:167], v4 offset:5120
  s_waitcnt lgkmcnt(6)
  v_mfma_f32_16x16x32_bf16 a[228:231], a[168:171], a[8:11], a[228:231]
  v_mfma_f32_16x16x32_bf16 a[232:235], a[168:171], a[12:15], a[232:235]
  ds_read_b128 a[168:171], v4 offset:6144
  v_mfma_f32_16x16x32_bf16 a[236:239], a[172:175], a[8:11], a[236:239]
  buffer_load_dwordx4 v3, s[8:11], s30 offen offset:3072 lds
  v_mfma_f32_16x16x32_bf16 a[240:243], a[172:175], a[12:15], a[240:243]
  ds_read_b128 a[172:175], v4 offset:7168
  s_mul_i32 s31, s24, 120832
  v_mfma_f32_16x16x32_bf16 a[244:247], a[176:179], a[8:11], a[244:247]
  s_add_u32 m0, s27, s31
  s_add_u32 s31, s30, s23
  v_mfma_f32_16x16x32_bf16 a[248:251], a[176:179], a[12:15], a[248:251]
  ds_read_b128 a[176:179], v4 offset:8192
  s_waitcnt lgkmcnt(6)
  v_mfma_f32_16x16x32_bf16 a[180:183], a[144:147], a[16:19], a[180:183]
  buffer_load_dwordx4 v3, s[8:11], s31 offen lds
  v_mfma_f32_16x16x32_bf16 a[184:187], a[144:147], a[20:23], a[184:187]
  ds_read_b128 a[144:147], v4 offset:9216
  v_mfma_f32_16x16x32_bf16 a[188:191], a[148:151], a[16:19], a[188:191]
  v_mfma_f32_16x16x32_bf16 a[192:195], a[148:151], a[20:23], a[192:195]
  ds_read_b128 a[148:151], v4 offset:10240
  v_mfma_f32_16x16x32_bf16 a[196:199], a[152:155], a[16:19], a[196:199]
  v_mfma_f32_16x16x32_bf16 a[200:203], a[152:155], a[20:23], a[200:203]
  ds_read_b128 a[152:155], v4 offset:11264
  s_waitcnt lgkmcnt(6)
  v_mfma_f32_16x16x32_bf16 a[204:207], a[156:159], a[16:19], a[204:207]
  v_mfma_f32_16x16x32_bf16 a[208:211], a[156:159], a[20:23], a[208:211]
  ds_read_b128 a[156:159], v4 offset:12288
  v_mfma_f32_16x16x32_bf16 a[212:215], a[160:163], a[16:19], a[212:215]
  v_mfma_f32_16x16x32_bf16 a[216:219], a[160:163], a[20:23], a[216:219]
  ds_read_b128 a[160:163], v4 offset:13312
  v_mfma_f32_16x16x32_bf16 a[220:223], a[164:167], a[16:19], a[220:223]
  v_mfma_f32_16x16x32_bf16 a[224:227], a[164:167], a[20:23], a[224:227]
  ds_read_b128 a[164:167], v4 offset:14336
  s_waitcnt lgkmcnt(6)
  v_mfma_f32_16x16x32_bf16 a[228:231], a[168:171], a[16:19], a[228:231]
  v_mfma_f32_16x16x32_bf16 a[232:235], a[168:171], a[20:23], a[232:235]
  ds_read_b128 a[168:171], v4 offset:15360
  v_mfma_f32_16x16x32_bf16 a[236:239], a[172:175], a[16:19], a[236:239]
  v_mfma_f32_16x16x32_bf16 a[240:243], a[172:175], a[20:23], a[240:243]
  ds_read_b128 a[172:175], v4 offset:16384
  v_mfma_f32_16x16x32_bf16 a[244:247], a[176:179], a[16:19], a[244:247]
  v_mfma_f32_16x16x32_bf16 a[248:251], a[176:179], a[20:23], a[248:251]
  ds_read_b128 a[176:179], v4 offset:17408
  s_waitcnt vmcnt(20)
  s_barrier
  s_waitcnt lgkmcnt(6)
  v_mfma_f32_16x16x32_bf16 a[180:183], a[144:147], a[24:27], a[180:183]
  s_add_u32 m0, s21, 139264
  s_add_u32 s30, s26, 258048
  v_mfma_f32_16x16x32_bf16 a[184:187], a[144:147], a[28:31], a[184:187]
  ds_read_b128 a[144:147], v4 offset:18432
  v_mfma_f32_16x16x32_bf16 a[188:191], a[148:151], a[24:27], a[188:191]
  buffer_load_dwordx4 v3, s[8:11], s30 offen lds
  v_mfma_f32_16x16x32_bf16 a[192:195], a[148:151], a[28:31], a[192:195]
  ds_read_b128 a[148:151], v4 offset:19456
  v_mfma_f32_16x16x32_bf16 a[196:199], a[152:155], a[24:27], a[196:199]
  v_mfma_f32_16x16x32_bf16 a[200:203], a[152:155], a[28:31], a[200:203]
  ds_read_b128 a[152:155], v4 offset:20480
  s_waitcnt lgkmcnt(6)
  v_mfma_f32_16x16x32_bf16 a[204:207], a[156:159], a[24:27], a[204:207]
  buffer_load_dwordx4 v3, s[8:11], s30 offen offset:1024 lds
  v_mfma_f32_16x16x32_bf16 a[208:211], a[156:159], a[28:31], a[208:211]
  ds_read_b128 a[156:159], v4 offset:21504
  v_mfma_f32_16x16x32_bf16 a[212:215], a[160:163], a[24:27], a[212:215]
  v_mfma_f32_16x16x32_bf16 a[216:219], a[160:163], a[28:31], a[216:219]
  ds_read_b128 a[160:163], v4 offset:22528
  v_mfma_f32_16x16x32_bf16 a[220:223], a[164:167], a[24:27], a[220:223]
  buffer_load_dwordx4 v3, s[8:11], s30 offen offset:2048 lds
  v_mfma_f32_16x16x32_bf16 a[224:227], a[164:167], a[28:31], a[224:227]
  ds_read_b128 a[164:167], v4 offset:23552
  s_waitcnt lgkmcnt(6)
  v_mfma_f32_16x16x32_bf16 a[228:231], a[168:171], a[24:27], a[228:231]
  v_mfma_f32_16x16x32_bf16 a[232:235], a[168:171], a[28:31], a[232:235]
  ds_read_b128 a[168:171], v4 offset:24576
  v_mfma_f32_16x16x32_bf16 a[236:239], a[172:175], a[24:27], a[236:239]
  buffer_load_dwordx4 v3, s[8:11], s30 offen offset:3072 lds
  v_mfma_f32_16x16x32_bf16 a[240:243], a[172:175], a[28:31], a[240:243]
  ds_read_b128 a[172:175], v4 offset:25600
  s_mul_i32 s31, s24, 139264
  v_mfma_f32_16x16x32_bf16 a[244:247], a[176:179], a[24:27], a[244:247]
  s_add_u32 m0, s27, s31
  s_add_u32 s31, s30, s23
  v_mfma_f32_16x16x32_bf16 a[248:251], a[176:179], a[28:31], a[248:251]
  ds_read_b128 a[176:179], v4 offset:26624
  s_waitcnt lgkmcnt(6)
  v_mfma_f32_16x16x32_bf16 a[180:183], a[144:147], a[32:35], a[180:183]
  buffer_load_dwordx4 v3, s[8:11], s31 offen lds
  v_mfma_f32_16x16x32_bf16 a[184:187], a[144:147], a[36:39], a[184:187]
  ds_read_b128 a[144:147], v4 offset:27648
  v_mfma_f32_16x16x32_bf16 a[188:191], a[148:151], a[32:35], a[188:191]
  v_mfma_f32_16x16x32_bf16 a[192:195], a[148:151], a[36:39], a[192:195]
  ds_read_b128 a[148:151], v4 offset:28672
  v_mfma_f32_16x16x32_bf16 a[196:199], a[152:155], a[32:35], a[196:199]
  v_mfma_f32_16x16x32_bf16 a[200:203], a[152:155], a[36:39], a[200:203]
  ds_read_b128 a[152:155], v4 offset:29696
  s_waitcnt lgkmcnt(6)
  v_mfma_f32_16x16x32_bf16 a[204:207], a[156:159], a[32:35], a[204:207]
  v_mfma_f32_16x16x32_bf16 a[208:211], a[156:159], a[36:39], a[208:211]
  ds_read_b128 a[156:159], v4 offset:30720
  v_mfma_f32_16x16x32_bf16 a[212:215], a[160:163], a[32:35], a[212:215]
  v_mfma_f32_16x16x32_bf16 a[216:219], a[160:163], a[36:39], a[216:219]
  ds_read_b128 a[160:163], v4 offset:31744
  v_mfma_f32_16x16x32_bf16 a[220:223], a[164:167], a[32:35], a[220:223]
  v_mfma_f32_16x16x32_bf16 a[224:227], a[164:167], a[36:39], a[224:227]
  ds_read_b128 a[164:167], v4 offset:32768
  s_waitcnt lgkmcnt(6)
  v_mfma_f32_16x16x32_bf16 a[228:231], a[168:171], a[32:35], a[228:231]
  v_mfma_f32_16x16x32_bf16 a[232:235], a[168:171], a[36:39], a[232:235]
  ds_read_b128 a[168:171], v4 offset:33792
  v_mfma_f32_16x16x32_bf16 a[236:239], a[172:175], a[32:35], a[236:239]
  v_mfma_f32_16x16x32_bf16 a[240:243], a[172:175], a[36:39], a[240:243]
  ds_read_b128 a[172:175], v4 offset:34816
  v_mfma_f32_16x16x32_bf16 a[244:247], a[176:179], a[32:35], a[244:247]
  v_mfma_f32_16x16x32_bf16 a[248:251], a[176:179], a[36:39], a[248:251]
  ds_read_b128 a[176:179], v4 offset:35840
  s_waitcnt vmcnt(20)
  s_barrier
  s_waitcnt lgkmcnt(6)
  v_mfma_f32_16x16x32_bf16 a[180:183], a[144:147], a[40:43], a[180:183]
  s_add_u32 m0, s21, 65536
  s_add_u32 s30, s26, 276480
  v_mfma_f32_16x16x32_bf16 a[184:187], a[144:147], a[44:47], a[184:187]
  ds_read_b128 a[144:147], v4 offset:36864
  v_mfma_f32_16x16x32_bf16 a[188:191], a[148:151], a[40:43], a[188:191]
  buffer_load_dwordx4 v3, s[8:11], s30 offen lds
  v_mfma_f32_16x16x32_bf16 a[192:195], a[148:151], a[44:47], a[192:195]
  ds_read_b128 a[148:151], v4 offset:37888
  v_mfma_f32_16x16x32_bf16 a[196:199], a[152:155], a[40:43], a[196:199]
  v_mfma_f32_16x16x32_bf16 a[200:203], a[152:155], a[44:47], a[200:203]
  ds_read_b128 a[152:155], v4 offset:38912
  s_waitcnt lgkmcnt(6)
  v_mfma_f32_16x16x32_bf16 a[204:207], a[156:159], a[40:43], a[204:207]
  buffer_load_dwordx4 v3, s[8:11], s30 offen offset:1024 lds
  v_mfma_f32_16x16x32_bf16 a[208:211], a[156:159], a[44:47], a[208:211]
  ds_read_b128 a[156:159], v4 offset:39936
  v_mfma_f32_16x16x32_bf16 a[212:215], a[160:163], a[40:43], a[212:215]
  v_mfma_f32_16x16x32_bf16 a[216:219], a[160:163], a[44:47], a[216:219]
  ds_read_b128 a[160:163], v4 offset:40960
  v_mfma_f32_16x16x32_bf16 a[220:223], a[164:167], a[40:43], a[220:223]
  buffer_load_dwordx4 v3, s[8:11], s30 offen offset:2048 lds
  v_mfma_f32_16x16x32_bf16 a[224:227], a[164:167], a[44:47], a[224:227]
  ds_read_b128 a[164:167], v4 offset:41984
  s_waitcnt lgkmcnt(6)
  v_mfma_f32_16x16x32_bf16 a[228:231], a[168:171], a[40:43], a[228:231]
  v_mfma_f32_16x16x32_bf16 a[232:235], a[168:171], a[44:47], a[232:235]
  ds_read_b128 a[168:171], v4 offset:43008
  v_mfma_f32_16x16x32_bf16 a[236:239], a[172:175], a[40:43], a[236:239]
  buffer_load_dwordx4 v3, s[8:11], s30 offen offset:3072 lds
  v_mfma_f32_16x16x32_bf16 a[240:243], a[172:175], a[44:47], a[240:243]
  ds_read_b128 a[172:175], v4 offset:44032
  s_mul_i32 s31, s24, 65536
  v_mfma_f32_16x16x32_bf16 a[244:247], a[176:179], a[40:43], a[244:247]
  s_add_u32 m0, s27, s31
  s_add_u32 s31, s30, s23
  v_mfma_f32_16x16x32_bf16 a[248:251], a[176:179], a[44:47], a[248:251]
  ds_read_b128 a[176:179], v4 offset:45056
  s_waitcnt lgkmcnt(6)
  v_mfma_f32_16x16x32_bf16 a[180:183], a[144:147], a[48:51], a[180:183]
  buffer_load_dwordx4 v3, s[8:11], s31 offen lds
  v_mfma_f32_16x16x32_bf16 a[184:187], a[144:147], a[52:55], a[184:187]
  ds_read_b128 a[144:147], v4 offset:46080
  v_mfma_f32_16x16x32_bf16 a[188:191], a[148:151], a[48:51], a[188:191]
  v_mfma_f32_16x16x32_bf16 a[192:195], a[148:151], a[52:55], a[192:195]
  ds_read_b128 a[148:151], v4 offset:47104
  v_mfma_f32_16x16x32_bf16 a[196:199], a[152:155], a[48:51], a[196:199]
  v_mfma_f32_16x16x32_bf16 a[200:203], a[152:155], a[52:55], a[200:203]
  ds_read_b128 a[152:155], v4 offset:48128
  s_waitcnt lgkmcnt(6)
  v_mfma_f32_16x16x32_bf16 a[204:207], a[156:159], a[48:51], a[204:207]
  v_mfma_f32_16x16x32_bf16 a[208:211], a[156:159], a[52:55], a[208:211]
  ds_read_b128 a[156:159], v4 offset:49152
  v_mfma_f32_16x16x32_bf16 a[212:215], a[160:163], a[48:51], a[212:215]
  v_mfma_f32_16x16x32_bf16 a[216:219], a[160:163], a[52:55], a[216:219]
  ds_read_b128 a[160:163], v4 offset:50176
  v_mfma_f32_16x16x32_bf16 a[220:223], a[164:167], a[48:51], a[220:223]
  v_mfma_f32_16x16x32_bf16 a[224:227], a[164:167], a[52:55], a[224:227]
  ds_read_b128 a[164:167], v4 offset:51200
  s_waitcnt lgkmcnt(6)
  v_mfma_f32_16x16x32_bf16 a[228:231], a[168:171], a[48:51], a[228:231]
  v_mfma_f32_16x16x32_bf16 a[232:235], a[168:171], a[52:55], a[232:235]
  ds_read_b128 a[168:171], v4 offset:52224
  v_mfma_f32_16x16x32_bf16 a[236:239], a[172:175], a[48:51], a[236:239]
  v_mfma_f32_16x16x32_bf16 a[240:243], a[172:175], a[52:55], a[240:243]
  ds_read_b128 a[172:175], v4 offset:53248
  v_mfma_f32_16x16x32_bf16 a[244:247], a[176:179], a[48:51], a[244:247]
  v_mfma_f32_16x16x32_bf16 a[248:251], a[176:179], a[52:55], a[248:251]
  ds_read_b128 a[176:179], v4 offset:54272
  s_waitcnt vmcnt(10)
  s_barrier
  s_cmp_lg_u32 s20, 0
  s_cbranch_scc1 kg_sig_6
  s_lshl_b32 s90, s16, 8
  s_add_u32 s90, s90, 81920
  v_mov_b32 v250, 1
  v_mov_b32 v251, 0
  s_mov_b64 exec, 1
  buffer_atomic_add v250, v251, s[8:11], s90 offen sc1
  s_mov_b64 exec, -1
kg_sig_6:
  s_waitcnt lgkmcnt(6)
  v_mfma_f32_16x16x32_bf16 a[180:183], a[144:147], a[56:59], a[180:183]
  s_add_u32 m0, s21, 83968
  s_add_u32 s30, s26, 294912
  v_mfma_f32_16x16x32_bf16 a[184:187], a[144:147], a[60:63], a[184:187]
  ds_read_b128 a[144:147], v4 offset:55296
  v_mfma_f32_16x16x32_bf16 a[188:191], a[148:151], a[56:59], a[188:191]
  buffer_load_dwordx4 v3, s[8:11], s30 offen lds
  v_mfma_f32_16x16x32_bf16 a[192:195], a[148:151], a[60:63], a[192:195]
  ds_read_b128 a[148:151], v4 offset:56320
  v_mfma_f32_16x16x32_bf16 a[196:199], a[152:155], a[56:59], a[196:199]
  v_mfma_f32_16x16x32_bf16 a[200:203], a[152:155], a[60:63], a[200:203]
  ds_read_b128 a[152:155], v4 offset:57344
  s_waitcnt lgkmcnt(6)
  v_mfma_f32_16x16x32_bf16 a[204:207], a[156:159], a[56:59], a[204:207]
  buffer_load_dwordx4 v3, s[8:11], s30 offen offset:1024 lds
  v_mfma_f32_16x16x32_bf16 a[208:211], a[156:159], a[60:63], a[208:211]
  ds_read_b128 a[156:159], v4 offset:58368
  v_mfma_f32_16x16x32_bf16 a[212:215], a[160:163], a[56:59], a[212:215]
  v_mfma_f32_16x16x32_bf16 a[216:219], a[160:163], a[60:63], a[216:219]
  ds_read_b128 a[160:163], v4 offset:59392
  v_mfma_f32_16x16x32_bf16 a[220:223], a[164:167], a[56:59], a[220:223]
  buffer_load_dwordx4 v3, s[8:11], s30 offen offset:2048 lds
  v_mfma_f32_16x16x32_bf16 a[224:227], a[164:167], a[60:63], a[224:227]
  ds_read_b128 a[164:167], v4 offset:60416
  s_waitcnt lgkmcnt(6)
  v_mfma_f32_16x16x32_bf16 a[228:231], a[168:171], a[56:59], a[228:231]
  v_mfma_f32_16x16x32_bf16 a[232:235], a[168:171], a[60:63], a[232:235]
  ds_read_b128 a[168:171], v4 offset:61440
  v_mfma_f32_16x16x32_bf16 a[236:239], a[172:175], a[56:59], a[236:239]
  buffer_load_dwordx4 v3, s[8:11], s30 offen offset:3072 lds
  v_mfma_f32_16x16x32_bf16 a[240:243], a[172:175], a[60:63], a[240:243]
  ds_read_b128 a[172:175], v4 offset:62464
  s_mul_i32 s31, s24, 83968
  v_mfma_f32_16x16x32_bf16 a[244:247], a[176:179], a[56:59], a[244:247]
  s_add_u32 m0, s27, s31
  s_add_u32 s31, s30, s23
  v_mfma_f32_16x16x32_bf16 a[248:251], a[176:179], a[60:63], a[248:251]
  ds_read_b128 a[176:179], v4 offset:63488
  s_waitcnt lgkmcnt(6)
  v_mfma_f32_16x16x32_bf16 a[180:183], a[144:147], a[64:67], a[180:183]
  buffer_load_dwordx4 v3, s[8:11], s31 offen lds
  v_mfma_f32_16x16x32_bf16 a[184:187], a[144:147], a[68:71], a[184:187]
  ds_read_b128 a[144:147], v4 offset:64512
  v_mfma_f32_16x16x32_bf16 a[188:191], a[148:151], a[64:67], a[188:191]
  v_xor_b32 v19, 0, v17
  ds_read_b128 v[168:171], v19 offset:0
  v_mfma_f32_16x16x32_bf16 a[192:195], a[148:151], a[68:71], a[192:195]
  ds_read_b128 a[148:151], v5 offset:0
  v_xor_b32 v19, 64, v17
  v_mfma_f32_16x16x32_bf16 a[196:199], a[152:155], a[64:67], a[196:199]
  ds_read_b128 v[172:175], v19 offset:0
  v_xor_b32 v19, 128, v17
  v_mfma_f32_16x16x32_bf16 a[200:203], a[152:155], a[68:71], a[200:203]
  ds_read_b128 a[152:155], v5 offset:1024
  s_waitcnt lgkmcnt(8)
  v_mfma_f32_16x16x32_bf16 a[204:207], a[156:159], a[64:67], a[204:207]
  ds_read_b128 v[176:179], v19 offset:0
  v_xor_b32 v19, 192, v17
  v_mfma_f32_16x16x32_bf16 a[208:211], a[156:159], a[68:71], a[208:211]
  ds_read_b128 a[156:159], v5 offset:2048
  ds_read_b128 v[180:183], v19 offset:0
  v_mfma_f32_16x16x32_bf16 a[212:215], a[160:163], a[64:67], a[212:215]
  v_xor_b32 v19, 0, v17
  ds_read_b128 v[184:187], v19 offset:4096
  v_mfma_f32_16x16x32_bf16 a[216:219], a[160:163], a[68:71], a[216:219]
  ds_read_b128 a[160:163], v5 offset:3072
  v_xor_b32 v19, 64, v17
  v_mfma_f32_16x16x32_bf16 a[220:223], a[164:167], a[64:67], a[220:223]
  ds_read_b128 v[188:191], v19 offset:4096
  v_xor_b32 v19, 128, v17
  v_mfma_f32_16x16x32_bf16 a[224:227], a[164:167], a[68:71], a[224:227]
  ds_read_b128 a[164:167], v5 offset:4096
  s_waitcnt lgkmcnt(12)
  v_mfma_f32_16x16x32_bf16 a[228:231], a[168:171], a[64:67], a[228:231]
  ds_read_b128 v[192:195], v19 offset:4096
  v_xor_b32 v19, 192, v17
  v_mfma_f32_16x16x32_bf16 a[232:235], a[168:171], a[68:71], a[232:235]
  ds_read_b128 a[168:171], v5 offset:5120
  ds_read_b128 v[196:199], v19 offset:4096
  v_mfma_f32_16x16x32_bf16 a[236:239], a[172:175], a[64:67], a[236:239]
  s_waitcnt lgkmcnt(13)
  s_add_u32 s40, s39, 0
  v_mfma_f32_16x16x32_bf16 a[240:243], a[172:175], a[68:71], a[240:243]
  ds_read_b128 a[172:175], v5 offset:6144
  v_mfma_f32_16x16x32_bf16 a[244:247], a[176:179], a[64:67], a[244:247]
  buffer_store_dwordx4 v[168:171], v3, s[8:11], s40 offen sc1
  v_mfma_f32_16x16x32_bf16 a[248:251], a[176:179], a[68:71], a[248:251]
  ds_read_b128 a[176:179], v5 offset:7168
  s_waitcnt vmcnt(11)
  s_barrier
  s_waitcnt lgkmcnt(12)
  v_mfma_f32_16x16x32_bf16 a[180:183], a[144:147], a[72:75], a[180:183]
  s_add_u32 s40, s39, 2048
  v_mfma_f32_16x16x32_bf16 a[184:187], a[144:147], a[76:79], a[184:187]
  ds_read_b128 a[144:147], v5 offset:8192
  v_mfma_f32_16x16x32_bf16 a[188:191], a[148:151], a[72:75], a[188:191]
  buffer_store_dwordx4 v[172:175], v3, s[8:11], s40 offen sc1
  v_mfma_f32_16x16x32_bf16 a[192:195], a[148:151], a[76:79], a[192:195]
  ds_read_b128 a[148:151], v5 offset:9216
  s_waitcnt lgkmcnt(13)
  v_mfma_f32_16x16x32_bf16 a[196:199], a[152:155], a[72:75], a[196:199]
  s_add_u32 s40, s39, 4096
  v_mfma_f32_16x16x32_bf16 a[200:203], a[152:155], a[76:79], a[200:203]
  ds_read_b128 a[152:155], v5 offset:10240
  s_waitcnt lgkmcnt(8)
  v_mfma_f32_16x16x32_bf16 a[204:207], a[156:159], a[72:75], a[204:207]
  buffer_store_dwordx4 v[176:179], v3, s[8:11], s40 offen sc1
  v_mfma_f32_16x16x32_bf16 a[208:211], a[156:159], a[76:79], a[208:211]
  ds_read_b128 a[156:159], v5 offset:11264
  v_mfma_f32_16x16x32_bf16 a[212:215], a[160:163], a[72:75], a[212:215]
  s_add_u32 s40, s39, 6144
  v_mfma_f32_16x16x32_bf16 a[216:219], a[160:163], a[76:79], a[216:219]
  ds_read_b128 a[160:163], v5 offset:12288
  v_mfma_f32_16x16x32_bf16 a[220:223], a[164:167], a[72:75], a[220:223]
  buffer_store_dwordx4 v[180:183], v3, s[8:11], s40 offen sc1
  v_mfma_f32_16x16x32_bf16 a[224:227], a[164:167], a[76:79], a[224:227]
  ds_read_b128 a[164:167], v5 offset:13312
  s_waitcnt lgkmcnt(6)
  v_mfma_f32_16x16x32_bf16 a[228:231], a[168:171], a[72:75], a[228:231]
  s_add_u32 s40, s39, 1024
  v_mfma_f32_16x16x32_bf16 a[232:235], a[168:171], a[76:79], a[232:235]
  ds_read_b128 a[168:171], v5 offset:14336
  v_mfma_f32_16x16x32_bf16 a[236:239], a[172:175], a[72:75], a[236:239]
  buffer_store_dwordx4 v[184:187], v3, s[8:11], s40 offen sc1
  v_mfma_f32_16x16x32_bf16 a[240:243], a[172:175], a[76:79], a[240:243]
  ds_read_b128 a[172:175], v5 offset:15360
  v_mfma_f32_16x16x32_bf16 a[244:247], a[176:179], a[72:75], a[244:247]
  s_add_u32 s40, s39, 3072
  v_mfma_f32_16x16x32_bf16 a[248:251], a[176:179], a[76:79], a[248:251]
  ds_read_b128 a[176:179], v5 offset:16384
  s_waitcnt lgkmcnt(6)
  v_mfma_f32_16x16x32_bf16 a[180:183], a[144:147], a[80:83], a[180:183]
  buffer_store_dwordx4 v[188:191], v3, s[8:11], s40 offen sc1
  v_mfma_f32_16x16x32_bf16 a[184:187], a[144:147], a[84:87], a[184:187]
  ds_read_b128 a[144:147], v5 offset:17408
  v_mfma_f32_16x16x32_bf16 a[188:191], a[148:151], a[80:83], a[188:191]
  s_add_u32 s40, s39, 5120
  v_mfma_f32_16x16x32_bf16 a[192:195], a[148:151], a[84:87], a[192:195]
  ds_read_b128 a[148:151], v5 offset:18432
  v_mfma_f32_16x16x32_bf16 a[196:199], a[152:155], a[80:83], a[196:199]
  buffer_store_dwordx4 v[192:195], v3, s[8:11], s40 offen sc1
  v_mfma_f32_16x16x32_bf16 a[200:203], a[152:155], a[84:87], a[200:203]
  ds_read_b128 a[152:155], v5 offset:19456
  s_waitcnt lgkmcnt(6)
  v_mfma_f32_16x16x32_bf16 a[204:207], a[156:159], a[80:83], a[204:207]
  s_add_u32 s40, s39, 7168
  v_mfma_f32_16x16x32_bf16 a[208:211], a[156:159], a[84:87], a[208:211]
  ds_read_b128 a[156:159], v5 offset:20480
  v_mfma_f32_16x16x32_bf16 a[212:215], a[160:163], a[80:83], a[212:215]
  buffer_store_dwordx4 v[196:199], v3, s[8:11], s40 offen sc1
  v_mfma_f32_16x16x32_bf16 a[216:219], a[160:163], a[84:87], a[216:219]
  ds_read_b128 a[160:163], v5 offset:21504
  s_add_u32 m0, s21, 102400
  v_mfma_f32_16x16x32_bf16 a[220:223], a[164:167], a[80:83], a[220:223]
  s_add_u32 s30, s26, 313344
  v_mfma_f32_16x16x32_bf16 a[224:227], a[164:167], a[84:87], a[224:227]
  ds_read_b128 a[164:167], v5 offset:22528
  s_waitcnt lgkmcnt(6)
  v_mfma_f32_16x16x32_bf16 a[228:231], a[168:171], a[80:83], a[228:231]
  buffer_load_dwordx4 v3, s[8:11], s30 offen lds
  v_mfma_f32_16x16x32_bf16 a[232:235], a[168:171], a[84:87], a[232:235]
  ds_read_b128 a[168:171], v5 offset:23552
  v_mfma_f32_16x16x32_bf16 a[236:239], a[172:175], a[80:83], a[236:239]
  v_mfma_f32_16x16x32_bf16 a[240:243], a[172:175], a[84:87], a[240:243]
  ds_read_b128 a[172:175], v5 offset:24576
  v_mfma_f32_16x16x32_bf16 a[244:247], a[176:179], a[80:83], a[244:247]
  buffer_load_dwordx4 v3, s[8:11], s30 offen offset:1024 lds
  v_mfma_f32_16x16x32_bf16 a[248:251], a[176:179], a[84:87], a[248:251]
  ds_read_b128 a[176:179], v5 offset:25600
  s_waitcnt vmcnt(15)
  s_barrier
  s_waitcnt lgkmcnt(6)
  v_mfma_f32_16x16x32_bf16 a[180:183], a[144:147], a[88:91], a[180:183]
  v_mfma_f32_16x16x32_bf16 a[184:187], a[144:147], a[92:95], a[184:187]
  ds_read_b128 a[144:147], v4 offset:0
  v_mfma_f32_16x16x32_bf16 a[188:191], a[148:151], a[88:91], a[188:191]
  buffer_load_dwordx4 v3, s[8:11], s30 offen offset:2048 lds
  v_mfma_f32_16x16x32_bf16 a[192:195], a[148:151], a[92:95], a[192:195]
  ds_read_b128 a[148:151], v4 offset:1024
  v_mfma_f32_16x16x32_bf16 a[196:199], a[152:155], a[88:91], a[196:199]
  v_mfma_f32_16x16x32_bf16 a[200:203], a[152:155], a[92:95], a[200:203]
  ds_read_b128 a[152:155], v4 offset:2048
  s_waitcnt lgkmcnt(6)
  v_mfma_f32_16x16x32_bf16 a[204:207], a[156:159], a[88:91], a[204:207]
  buffer_load_dwordx4 v3, s[8:11], s30 offen offset:3072 lds
  v_mfma_f32_16x16x32_bf16 a[208:211], a[156:159], a[92:95], a[208:211]
  ds_read_b128 a[156:159], v4 offset:3072
  s_mul_i32 s31, s24, 102400
  v_mfma_f32_16x16x32_bf16 a[212:215], a[160:163], a[88:91], a[212:215]
  s_add_u32 m0, s27, s31
  s_add_u32 s31, s30, s23
  v_mfma_f32_16x16x32_bf16 a[216:219], a[160:163], a[92:95], a[216:219]
  ds_read_b128 a[160:163], v4 offset:4096
  v_mfma_f32_16x16x32_bf16 a[220:223], a[164:167], a[88:91], a[220:223]
  buffer_load_dwordx4 v3, s[8:11], s31 offen lds
  v_mfma_f32_16x16x32_bf16 a[224:227], a[164:167], a[92:95], a[224:227]
  ds_read_b128 a[164:167], v4 offset:5120
  s_waitcnt lgkmcnt(6)
  v_mfma_f32_16x16x32_bf16 a[228:231], a[168:171], a[88:91], a[228:231]
  v_mfma_f32_16x16x32_bf16 a[232:235], a[168:171], a[92:95], a[232:235]
  ds_read_b128 a[168:171], v4 offset:6144
  v_mfma_f32_16x16x32_bf16 a[236:239], a[172:175], a[88:91], a[236:239]
  v_mfma_f32_16x16x32_bf16 a[240:243], a[172:175], a[92:95], a[240:243]
  ds_read_b128 a[172:175], v4 offset:7168
  v_mfma_f32_16x16x32_bf16 a[244:247], a[176:179], a[88:91], a[244:247]
  v_mfma_f32_16x16x32_bf16 a[248:251], a[176:179], a[92:95], a[248:251]
  ds_read_b128 a[176:179], v4 offset:8192
  s_waitcnt lgkmcnt(6)
  v_mfma_f32_16x16x32_bf16 a[180:183], a[144:147], a[96:99], a[180:183]
  v_mfma_f32_16x16x32_bf16 a[184:187], a[144:147], a[100:103], a[184:187]
  ds_read_b128 a[144:147], v4 offset:9216
  v_mfma_f32_16x16x32_bf16 a[188:191], a[148:151], a[96:99], a[188:191]
  v_mfma_f32_16x16x32_bf16 a[192:195], a[148:151], a[100:103], a[192:195]
  ds_read_b128 a[148:151], v4 offset:10240
  v_mfma_f32_16x16x32_bf16 a[196:199], a[152:155], a[96:99], a[196:199]
  v_mfma_f32_16x16x32_bf16 a[200:203], a[152:155], a[100:103], a[200:203]
  ds_read_b128 a[152:155], v4 offset:11264
  s_waitcnt lgkmcnt(6)
  v_mfma_f32_16x16x32_bf16 a[204:207], a[156:159], a[96:99], a[204:207]
  v_mfma_f32_16x16x32_bf16 a[208:211], a[156:159], a[100:103], a[208:211]
  ds_read_b128 a[156:159], v4 offset:12288
  v_mfma_f32_16x16x32_bf16 a[212:215], a[160:163], a[96:99], a[212:215]
  v_mfma_f32_16x16x32_bf16 a[216:219], a[160:163], a[100:103], a[216:219]
  ds_read_b128 a[160:163], v4 offset:13312
  v_mfma_f32_16x16x32_bf16 a[220:223], a[164:167], a[96:99], a[220:223]
  v_mfma_f32_16x16x32_bf16 a[224:227], a[164:167], a[100:103], a[224:227]
  ds_read_b128 a[164:167], v4 offset:14336
  s_waitcnt lgkmcnt(6)
  v_mfma_f32_16x16x32_bf16 a[228:231], a[168:171], a[96:99], a[228:231]
  v_mfma_f32_16x16x32_bf16 a[232:235], a[168:171], a[100:103], a[232:235]
  ds_read_b128 a[168:171], v4 offset:15360
  v_mfma_f32_16x16x32_bf16 a[236:239], a[172:175], a[96:99], a[236:239]
  v_mfma_f32_16x16x32_bf16 a[240:243], a[172:175], a[100:103], a[240:243]
  ds_read_b128 a[172:175], v4 offset:16384
  v_mfma_f32_16x16x32_bf16 a[244:247], a[176:179], a[96:99], a[244:247]
  v_mfma_f32_16x16x32_bf16 a[248:251], a[176:179], a[100:103], a[248:251]
  ds_read_b128 a[176:179], v4 offset:17408
  s_waitcnt vmcnt(5)
  s_barrier
  s_cmp_lg_u32 s20, 0
  s_cbranch_scc1 kg_sig_7
  s_lshl_b32 s90, s16, 8
  s_add_u32 s90, s90, 86016
  v_mov_b32 v250, 1
  v_mov_b32 v251, 0
  s_mov_b64 exec, 1
  buffer_atomic_add v250, v251, s[8:11], s90 offen sc1
  s_mov_b64 exec, -1
kg_sig_7:
  s_waitcnt lgkmcnt(6)
  v_mfma_f32_16x16x32_bf16 a[180:183], a[144:147], a[104:107], a[180:183]
  v_mfma_f32_16x16x32_bf16 a[184:187], a[144:147], a[108:111], a[184:187]
  ds_read_b128 a[144:147], v4 offset:18432
  v_mfma_f32_16x16x32_bf16 a[188:191], a[148:151], a[104:107], a[188:191]
  v_mfma_f32_16x16x32_bf16 a[192:195], a[148:151], a[108:111], a[192:195]
  ds_read_b128 a[148:151], v4 offset:19456
  v_mfma_f32_16x16x32_bf16 a[196:199], a[152:155], a[104:107], a[196:199]
  v_mfma_f32_16x16x32_bf16 a[200:203], a[152:155], a[108:111], a[200:203]
  ds_read_b128 a[152:155], v4 offset:20480
  s_waitcnt lgkmcnt(6)
  v_mfma_f32_16x16x32_bf16 a[204:207], a[156:159], a[104:107], a[204:207]
  v_mfma_f32_16x16x32_bf16 a[208:211], a[156:159], a[108:111], a[208:211]
  ds_read_b128 a[156:159], v4 offset:21504
  v_mfma_f32_16x16x32_bf16 a[212:215], a[160:163], a[104:107], a[212:215]
  v_mfma_f32_16x16x32_bf16 a[216:219], a[160:163], a[108:111], a[216:219]
  ds_read_b128 a[160:163], v4 offset:22528
  v_mfma_f32_16x16x32_bf16 a[220:223], a[164:167], a[104:107], a[220:223]
  v_mfma_f32_16x16x32_bf16 a[224:227], a[164:167], a[108:111], a[224:227]
  ds_read_b128 a[164:167], v4 offset:23552
  s_waitcnt lgkmcnt(6)
  v_mfma_f32_16x16x32_bf16 a[228:231], a[168:171], a[104:107], a[228:231]
  v_mfma_f32_16x16x32_bf16 a[232:235], a[168:171], a[108:111], a[232:235]
  ds_read_b128 a[168:171], v4 offset:24576
  v_mfma_f32_16x16x32_bf16 a[236:239], a[172:175], a[104:107], a[236:239]
  v_mfma_f32_16x16x32_bf16 a[240:243], a[172:175], a[108:111], a[240:243]
  ds_read_b128 a[172:175], v4 offset:25600
  v_mfma_f32_16x16x32_bf16 a[244:247], a[176:179], a[104:107], a[244:247]
  v_mfma_f32_16x16x32_bf16 a[248:251], a[176:179], a[108:111], a[248:251]
  ds_read_b128 a[176:179], v4 offset:26624
  s_waitcnt lgkmcnt(6)
  v_mfma_f32_16x16x32_bf16 a[180:183], a[144:147], a[112:115], a[180:183]
  v_mfma_f32_16x16x32_bf16 a[184:187], a[144:147], a[116:119], a[184:187]
  ds_read_b128 a[144:147], v4 offset:27648
  v_mfma_f32_16x16x32_bf16 a[188:191], a[148:151], a[112:115], a[188:191]
  v_mfma_f32_16x16x32_bf16 a[192:195], a[148:151], a[116:119], a[192:195]
  ds_read_b128 a[148:151], v4 offset:28672
  v_mfma_f32_16x16x32_bf16 a[196:199], a[152:155], a[112:115], a[196:199]
  v_mfma_f32_16x16x32_bf16 a[200:203], a[152:155], a[116:119], a[200:203]
  ds_read_b128 a[152:155], v4 offset:29696
  s_waitcnt lgkmcnt(6)
  v_mfma_f32_16x16x32_bf16 a[204:207], a[156:159], a[112:115], a[204:207]
  v_mfma_f32_16x16x32_bf16 a[208:211], a[156:159], a[116:119], a[208:211]
  ds_read_b128 a[156:159], v4 offset:30720
  v_mfma_f32_16x16x32_bf16 a[212:215], a[160:163], a[112:115], a[212:215]
  v_mfma_f32_16x16x32_bf16 a[216:219], a[160:163], a[116:119], a[216:219]
  ds_read_b128 a[160:163], v4 offset:31744
  v_mfma_f32_16x16x32_bf16 a[220:223], a[164:167], a[112:115], a[220:223]
  v_mfma_f32_16x16x32_bf16 a[224:227], a[164:167], a[116:119], a[224:227]
  ds_read_b128 a[164:167], v4 offset:32768
  s_waitcnt lgkmcnt(6)
  v_mfma_f32_16x16x32_bf16 a[228:231], a[168:171], a[112:115], a[228:231]
  v_mfma_f32_16x16x32_bf16 a[232:235], a[168:171], a[116:119], a[232:235]
  ds_read_b128 a[168:171], v4 offset:33792
  v_mfma_f32_16x16x32_bf16 a[236:239], a[172:175], a[112:115], a[236:239]
  v_mfma_f32_16x16x32_bf16 a[240:243], a[172:175], a[116:119], a[240:243]
  ds_read_b128 a[172:175], v4 offset:34816
  v_mfma_f32_16x16x32_bf16 a[244:247], a[176:179], a[112:115], a[244:247]
  v_mfma_f32_16x16x32_bf16 a[248:251], a[176:179], a[116:119], a[248:251]
  ds_read_b128 a[176:179], v4 offset:35840
  s_waitcnt vmcnt(0)
  s_cmp_lg_u32 s20, 0
  s_cbranch_scc1 kg_polled_8
  v_mov_b32 v251, 0
  s_lshl_b32 s90, s16, 8
  s_add_u32 s90, s90, 81920
  s_mov_b32 s91, 0x100000
kg_poll_9:
  buffer_load_dword v250, v251, s[8:11], s90 offen sc1
  s_waitcnt vmcnt(0)
  v_readfirstlane_b32 s92, v250
  s_sub_u32 s91, s91, 1
  s_cmp_eq_u32 s91, 0
  s_cbranch_scc1 kg_ok_10
  s_cmp_ge_u32 s92, 16
  s_cbranch_scc1 kg_ok_10
  s_sleep 1
  s_branch kg_poll_9
kg_ok_10:
kg_polled_8:
  s_barrier
  v_lshl_add_u32 v60, v2, 5, v6
  v_lshlrev_b32 v60, 7, v60
  v_lshl_add_u32 v60, v7, 5, v60
  s_lshl_b32 s48, s16, 14
  s_add_u32 s48, s48, 131072
  buffer_load_dwordx4 v[20:23], v60, s[8:11], s48 offen offset:0 sc1
  buffer_load_dwordx4 v[24:27], v60, s[8:11], s48 offen offset:16 sc1
  buffer_load_dwordx4 v[28:31], v60, s[8:11], s48 offen offset:2048 sc1
  buffer_load_dwordx4 v[32:35], v60, s[8:11], s48 offen offset:2064 sc1
  s_waitcnt lgkmcnt(6)
  v_mfma_f32_16x16x32_bf16 a[180:183], a[144:147], a[120:123], a[180:183]
  v_mfma_f32_16x16x32_bf16 a[184:187], a[144:147], a[124:127], a[184:187]
  ds_read_b128 a[144:147], v4 offset:36864
  v_mfma_f32_16x16x32_bf16 a[188:191], a[148:151], a[120:123], a[188:191]
  v_mfma_f32_16x16x32_bf16 a[192:195], a[148:151], a[124:127], a[192:195]
  ds_read_b128 a[148:151], v4 offset:37888
  v_mfma_f32_16x16x32_bf16 a[196:199], a[152:155], a[120:123], a[196:199]
  v_mfma_f32_16x16x32_bf16 a[200:203], a[152:155], a[124:127], a[200:203]
  ds_read_b128 a[152:155], v4 offset:38912
  s_waitcnt lgkmcnt(6)
  v_mfma_f32_16x16x32_bf16 a[204:207], a[156:159], a[120:123], a[204:207]
  v_mfma_f32_16x16x32_bf16 a[208:211], a[156:159], a[124:127], a[208:211]
  ds_read_b128 a[156:159], v4 offset:39936
  v_mfma_f32_16x16x32_bf16 a[212:215], a[160:163], a[120:123], a[212:215]
  v_mfma_f32_16x16x32_bf16 a[216:219], a[160:163], a[124:127], a[216:219]
  ds_read_b128 a[160:163], v4 offset:40960
  v_mfma_f32_16x16x32_bf16 a[220:223], a[164:167], a[120:123], a[220:223]
  v_mfma_f32_16x16x32_bf16 a[224:227], a[164:167], a[124:127], a[224:227]
  ds_read_b128 a[164:167], v4 offset:41984
  s_waitcnt lgkmcnt(6)
  v_mfma_f32_16x16x32_bf16 a[228:231], a[168:171], a[120:123], a[228:231]
  v_mfma_f32_16x16x32_bf16 a[232:235], a[168:171], a[124:127], a[232:235]
  ds_read_b128 a[168:171], v4 offset:43008
  v_mfma_f32_16x16x32_bf16 a[236:239], a[172:175], a[120:123], a[236:239]
  v_mfma_f32_16x16x32_bf16 a[240:243], a[172:175], a[124:127], a[240:243]
  ds_read_b128 a[172:175], v4 offset:44032
  v_mfma_f32_16x16x32_bf16 a[244:247], a[176:179], a[120:123], a[244:247]
  v_mfma_f32_16x16x32_bf16 a[248:251], a[176:179], a[124:127], a[248:251]
  ds_read_b128 a[176:179], v4 offset:45056
  s_waitcnt lgkmcnt(6)
  v_mfma_f32_16x16x32_bf16 a[180:183], a[144:147], a[128:131], a[180:183]
  v_mfma_f32_16x16x32_bf16 a[184:187], a[144:147], a[132:135], a[184:187]
  ds_read_b128 a[144:147], v4 offset:46080
  v_mfma_f32_16x16x32_bf16 a[188:191], a[148:151], a[128:131], a[188:191]
  v_mfma_f32_16x16x32_bf16 a[192:195], a[148:151], a[132:135], a[192:195]
  ds_read_b128 a[148:151], v4 offset:47104
  v_mfma_f32_16x16x32_bf16 a[196:199], a[152:155], a[128:131], a[196:199]
  v_mfma_f32_16x16x32_bf16 a[200:203], a[152:155], a[132:135], a[200:203]
  ds_read_b128 a[152:155], v4 offset:48128
  s_waitcnt lgkmcnt(6)
  v_mfma_f32_16x16x32_bf16 a[204:207], a[156:159], a[128:131], a[204:207]
  v_mfma_f32_16x16x32_bf16 a[208:211], a[156:159], a[132:135], a[208:211]
  ds_read_b128 a[156:159], v4 offset:49152
  v_mfma_f32_16x16x32_bf16 a[212:215], a[160:163], a[128:131], a[212:215]
  v_mfma_f32_16x16x32_bf16 a[216:219], a[160:163], a[132:135], a[216:219]
  ds_read_b128 a[160:163], v4 offset:50176
  v_mfma_f32_16x16x32_bf16 a[220:223], a[164:167], a[128:131], a[220:223]
  v_mfma_f32_16x16x32_bf16 a[224:227], a[164:167], a[132:135], a[224:227]
  ds_read_b128 a[164:167], v4 offset:51200
  s_waitcnt lgkmcnt(6)
  v_mfma_f32_16x16x32_bf16 a[228:231], a[168:171], a[128:131], a[228:231]
  v_mfma_f32_16x16x32_bf16 a[232:235], a[168:171], a[132:135], a[232:235]
  ds_read_b128 a[168:171], v4 offset:52224
  v_mfma_f32_16x16x32_bf16 a[236:239], a[172:175], a[128:131], a[236:239]
  v_mfma_f32_16x16x32_bf16 a[240:243], a[172:175], a[132:135], a[240:243]
  ds_read_b128 a[172:175], v4 offset:53248
  v_mfma_f32_16x16x32_bf16 a[244:247], a[176:179], a[128:131], a[244:247]
  v_mfma_f32_16x16x32_bf16 a[248:251], a[176:179], a[132:135], a[248:251]
  ds_read_b128 a[176:179], v4 offset:54272
  s_waitcnt lgkmcnt(6)
  v_mfma_f32_16x16x32_bf16 a[180:183], a[144:147], a[136:139], a[180:183]
  v_mfma_f32_16x16x32_bf16 a[184:187], a[144:147], a[140:143], a[184:187]
  v_mfma_f32_16x16x32_bf16 a[188:191], a[148:151], a[136:139], a[188:191]
  v_mfma_f32_16x16x32_bf16 a[192:195], a[148:151], a[140:143], a[192:195]
  v_mfma_f32_16x16x32_bf16 a[196:199], a[152:155], a[136:139], a[196:199]
  v_mfma_f32_16x16x32_bf16 a[200:203], a[152:155], a[140:143], a[200:203]
  s_waitcnt lgkmcnt(3)
  v_mfma_f32_16x16x32_bf16 a[204:207], a[156:159], a[136:139], a[204:207]
  v_mfma_f32_16x16x32_bf16 a[208:211], a[156:159], a[140:143], a[208:211]
  v_mfma_f32_16x16x32_bf16 a[212:215], a[160:163], a[136:139], a[212:215]
  v_mfma_f32_16x16x32_bf16 a[216:219], a[160:163], a[140:143], a[216:219]
  v_mfma_f32_16x16x32_bf16 a[220:223], a[164:167], a[136:139], a[220:223]
  v_mfma_f32_16x16x32_bf16 a[224:227], a[164:167], a[140:143], a[224:227]
  s_waitcnt lgkmcnt(0)
  v_mfma_f32_16x16x32_bf16 a[228:231], a[168:171], a[136:139], a[228:231]
  v_mfma_f32_16x16x32_bf16 a[232:235], a[168:171], a[140:143], a[232:235]
  v_mfma_f32_16x16x32_bf16 a[236:239], a[172:175], a[136:139], a[236:239]
  v_mfma_f32_16x16x32_bf16 a[240:243], a[172:175], a[140:143], a[240:243]
  v_mfma_f32_16x16x32_bf16 a[244:247], a[176:179], a[136:139], a[244:247]
  v_mfma_f32_16x16x32_bf16 a[248:251], a[176:179], a[140:143], a[248:251]
  s_barrier
  s_waitcnt vmcnt(0)
  v_pk_add_f32 v[20:21], v[20:21], v[22:23]
  v_pk_add_f32 v[24:25], v[24:25], v[26:27]
  v_pk_add_f32 v[20:21], v[20:21], v[24:25]
  v_pk_add_f32 v[28:29], v[28:29], v[30:31]
  v_pk_add_f32 v[32:33], v[32:33], v[34:35]
  v_pk_add_f32 v[28:29], v[28:29], v[32:33]
  v_mul_u32_u24 v60, 304, v6
  v_lshl_add_u32 v60, v7, 3, v60
  v_mul_u32_u24 v61, 9728, v2
  v_add_u32 v61, 65536, v61
  v_add_u32 v60, v60, v61
  v_mov_b32 v64, v20
  s_nop 1
  v_permlane32_swap_b32 v20, v64
  v_add_f32 v20, v20, v64
  v_mov_b32 v64, v20
  s_nop 1
  v_permlane16_swap_b32 v20, v64
  v_add_f32 v20, v20, v64
  v_mov_b32 v64, v21
  s_nop 1
  v_permlane32_swap_b32 v21, v64
  v_add_f32 v21, v21, v64
  v_mov_b32 v64, v21
  s_nop 1
  v_permlane16_swap_b32 v21, v64
  v_add_f32 v21, v21, v64
  v_mov_b32 v64, v28
  s_nop 1
  v_permlane32_swap_b32 v28, v64
  v_add_f32 v28, v28, v64
  v_mov_b32 v64, v28
  s_nop 1
  v_permlane16_swap_b32 v28, v64
  v_add_f32 v28, v28, v64
  v_mov_b32 v64, v29
  s_nop 1
  v_permlane32_swap_b32 v29, v64
  v_add_f32 v29, v29, v64
  v_mov_b32 v64, v29
  s_nop 1
  v_permlane16_swap_b32 v29, v64
  v_add_f32 v29, v29, v64
  v_lshrrev_b32 v62, 2, v6
  v_lshl_add_u32 v62, v7, 3, v62
  v_mul_u32_u24 v62, 304, v62
  v_and_b32 v63, 3, v1
  v_lshl_add_u32 v62, v63, 3, v62
  v_add_u32 v62, v62, v61
  v_mul_f32 v20, 0x39e38e39, v20
  v_mul_f32 v21, 0x39e38e39, v21
  v_fma_f32 v21, -v20, v20, v21
  v_max_f32 v21, 0, v21
  v_add_f32 v21, 0x3727c5ac, v21
  v_rsq_f32 v168, v21
  s_nop 0
  v_mul_f32 v169, v20, v168
  v_mul_f32 v28, 0x39e38e39, v28
  v_mul_f32 v29, 0x39e38e39, v29
  v_fma_f32 v29, -v28, v28, v29
  v_max_f32 v29, 0, v29
  v_add_f32 v29, 0x3727c5ac, v29
  v_rsq_f32 v170, v29
  s_nop 0
  v_mul_f32 v171, v28, v170
  v_pk_fma_f32 v[96:97], v[96:97], v[168:169], v[168:169] op_sel:[0,0,1] op_sel_hi:[1,0,1] neg_lo:[0,0,1] neg_hi:[0,0,1]
  v_pk_fma_f32 v[98:99], v[98:99], v[168:169], v[168:169] op_sel:[0,0,1] op_sel_hi:[1,0,1] neg_lo:[0,0,1] neg_hi:[0,0,1]
  v_pk_fma_f32 v[100:101], v[100:101], v[170:171], v[170:171] op_sel:[0,0,1] op_sel_hi:[1,0,1] neg_lo:[0,0,1] neg_hi:[0,0,1]
  v_pk_fma_f32 v[102:103], v[102:103], v[170:171], v[170:171] op_sel:[0,0,1] op_sel_hi:[1,0,1] neg_lo:[0,0,1] neg_hi:[0,0,1]
  v_cvt_pk_bf16_f32 v96, v96, v97
  v_cvt_pk_bf16_f32 v97, v98, v99
  v_cvt_pk_bf16_f32 v100, v100, v101
  v_cvt_pk_bf16_f32 v101, v102, v103
  ds_write_b64 v60, v[96:97] offset:0
  ds_write_b64 v60, v[100:101] offset:4864
  v_pk_fma_f32 v[104:105], v[104:105], v[168:169], v[168:169] op_sel:[0,0,1] op_sel_hi:[1,0,1] neg_lo:[0,0,1] neg_hi:[0,0,1]
  v_pk_fma_f32 v[106:107], v[106:107], v[168:169], v[168:169] op_sel:[0,0,1] op_sel_hi:[1,0,1] neg_lo:[0,0,1] neg_hi:[0,0,1]
  v_pk_fma_f32 v[108:109], v[108:109], v[170:171], v[170:171] op_sel:[0,0,1] op_sel_hi:[1,0,1] neg_lo:[0,0,1] neg_hi:[0,0,1]
  v_pk_fma_f32 v[110:111], v[110:111], v[170:171], v[170:171] op_sel:[0,0,1] op_sel_hi:[1,0,1] neg_lo:[0,0,1] neg_hi:[0,0,1]
  v_cvt_pk_bf16_f32 v104, v104, v105
  v_cvt_pk_bf16_f32 v105, v106, v107
  v_cvt_pk_bf16_f32 v108, v108, v109
  v_cvt_pk_bf16_f32 v109, v110, v111
  ds_write_b64 v60, v[104:105] offset:32
  ds_write_b64 v60, v[108:109] offset:4896
  v_pk_fma_f32 v[112:113], v[112:113], v[168:169], v[168:169] op_sel:[0,0,1] op_sel_hi:[1,0,1] neg_lo:[0,0,1] neg_hi:[0,0,1]
  v_pk_fma_f32 v[114:115], v[114:115], v[168:169], v[168:169] op_sel:[0,0,1] op_sel_hi:[1,0,1] neg_lo:[0,0,1] neg_hi:[0,0,1]
  v_pk_fma_f32 v[116:117], v[116:117], v[170:171], v[170:171] op_sel:[0,0,1] op_sel_hi:[1,0,1] neg_lo:[0,0,1] neg_hi:[0,0,1]
  v_pk_fma_f32 v[118:119], v[118:119], v[170:171], v[170:171] op_sel:[0,0,1] op_sel_hi:[1,0,1] neg_lo:[0,0,1] neg_hi:[0,0,1]
  v_cvt_pk_bf16_f32 v112, v112, v113
  v_cvt_pk_bf16_f32 v113, v114, v115
  v_cvt_pk_bf16_f32 v116, v116, v117
  v_cvt_pk_bf16_f32 v117, v118, v119
  ds_write_b64 v60, v[112:113] offset:64
  ds_write_b64 v60, v[116:117] offset:4928
  v_pk_fma_f32 v[120:121], v[120:121], v[168:169], v[168:169] op_sel:[0,0,1] op_sel_hi:[1,0,1] neg_lo:[0,0,1] neg_hi:[0,0,1]
  v_pk_fma_f32 v[122:123], v[122:123], v[168:169], v[168:169] op_sel:[0,0,1] op_sel_hi:[1,0,1] neg_lo:[0,0,1] neg_hi:[0,0,1]
  v_pk_fma_f32 v[124:125], v[124:125], v[170:171], v[170:171] op_sel:[0,0,1] op_sel_hi:[1,0,1] neg_lo:[0,0,1] neg_hi:[0,0,1]
  v_pk_fma_f32 v[126:127], v[126:127], v[170:171], v[170:171] op_sel:[0,0,1] op_sel_hi:[1,0,1] neg_lo:[0,0,1] neg_hi:[0,0,1]
  v_cvt_pk_bf16_f32 v120, v120, v121
  v_cvt_pk_bf16_f32 v121, v122, v123
  v_cvt_pk_bf16_f32 v124, v124, v125
  v_cvt_pk_bf16_f32 v125, v126, v127
  ds_write_b64 v60, v[120:121] offset:96
  ds_write_b64 v60, v[124:125] offset:4960
  v_pk_fma_f32 v[128:129], v[128:129], v[168:169], v[168:169] op_sel:[0,0,1] op_sel_hi:[1,0,1] neg_lo:[0,0,1] neg_hi:[0,0,1]
  v_pk_fma_f32 v[130:131], v[130:131], v[168:169], v[168:169] op_sel:[0,0,1] op_sel_hi:[1,0,1] neg_lo:[0,0,1] neg_hi:[0,0,1]
  v_pk_fma_f32 v[132:133], v[132:133], v[170:171], v[170:171] op_sel:[0,0,1] op_sel_hi:[1,0,1] neg_lo:[0,0,1] neg_hi:[0,0,1]
  v_pk_fma_f32 v[134:135], v[134:135], v[170:171], v[170:171] op_sel:[0,0,1] op_sel_hi:[1,0,1] neg_lo:[0,0,1] neg_hi:[0,0,1]
  v_cvt_pk_bf16_f32 v128, v128, v129
  v_cvt_pk_bf16_f32 v129, v130, v131
  v_cvt_pk_bf16_f32 v132, v132, v133
  v_cvt_pk_bf16_f32 v133, v134, v135
  ds_write_b64 v60, v[128:129] offset:128
  ds_write_b64 v60, v[132:133] offset:4992
  v_pk_fma_f32 v[136:137], v[136:137], v[168:169], v[168:169] op_sel:[0,0,1] op_sel_hi:[1,0,1] neg_lo:[0,0,1] neg_hi:[0,0,1]
  v_pk_fma_f32 v[138:139], v[138:139], v[168:169], v[168:169] op_sel:[0,0,1] op_sel_hi:[1,0,1] neg_lo:[0,0,1] neg_hi:[0,0,1]
  v_pk_fma_f32 v[140:141], v[140:141], v[170:171], v[170:171] op_sel:[0,0,1] op_sel_hi:[1,0,1] neg_lo:[0,0,1] neg_hi:[0,0,1]
  v_pk_fma_f32 v[142:143], v[142:143], v[170:171], v[170:171] op_sel:[0,0,1] op_sel_hi:[1,0,1] neg_lo:[0,0,1] neg_hi:[0,0,1]
  v_cvt_pk_bf16_f32 v136, v136, v137
  v_cvt_pk_bf16_f32 v137, v138, v139
  v_cvt_pk_bf16_f32 v140, v140, v141
  v_cvt_pk_bf16_f32 v141, v142, v143
  ds_write_b64 v60, v[136:137] offset:160
  ds_write_b64 v60, v[140:141] offset:5024
  v_pk_fma_f32 v[144:145], v[144:145], v[168:169], v[168:169] op_sel:[0,0,1] op_sel_hi:[1,0,1] neg_lo:[0,0,1] neg_hi:[0,0,1]
  v_pk_fma_f32 v[146:147], v[146:147], v[168:169], v[168:169] op_sel:[0,0,1] op_sel_hi:[1,0,1] neg_lo:[0,0,1] neg_hi:[0,0,1]
  v_pk_fma_f32 v[148:149], v[148:149], v[170:171], v[170:171] op_sel:[0,0,1] op_sel_hi:[1,0,1] neg_lo:[0,0,1] neg_hi:[0,0,1]
  v_pk_fma_f32 v[150:151], v[150:151], v[170:171], v[170:171] op_sel:[0,0,1] op_sel_hi:[1,0,1] neg_lo:[0,0,1] neg_hi:[0,0,1]
  v_cvt_pk_bf16_f32 v144, v144, v145
  v_cvt_pk_bf16_f32 v145, v146, v147
  v_cvt_pk_bf16_f32 v148, v148, v149
  v_cvt_pk_bf16_f32 v149, v150, v151
  ds_write_b64 v60, v[144:145] offset:192
  ds_write_b64 v60, v[148:149] offset:5056
  v_pk_fma_f32 v[152:153], v[152:153], v[168:169], v[168:169] op_sel:[0,0,1] op_sel_hi:[1,0,1] neg_lo:[0,0,1] neg_hi:[0,0,1]
  v_pk_fma_f32 v[154:155], v[154:155], v[168:169], v[168:169] op_sel:[0,0,1] op_sel_hi:[1,0,1] neg_lo:[0,0,1] neg_hi:[0,0,1]
  v_pk_fma_f32 v[156:157], v[156:157], v[170:171], v[170:171] op_sel:[0,0,1] op_sel_hi:[1,0,1] neg_lo:[0,0,1] neg_hi:[0,0,1]
  v_pk_fma_f32 v[158:159], v[158:159], v[170:171], v[170:171] op_sel:[0,0,1] op_sel_hi:[1,0,1] neg_lo:[0,0,1] neg_hi:[0,0,1]
  v_cvt_pk_bf16_f32 v152, v152, v153
  v_cvt_pk_bf16_f32 v153, v154, v155
  v_cvt_pk_bf16_f32 v156, v156, v157
  v_cvt_pk_bf16_f32 v157, v158, v159
  ds_write_b64 v60, v[152:153] offset:224
  ds_write_b64 v60, v[156:157] offset:5088
  v_pk_fma_f32 v[160:161], v[160:161], v[168:169], v[168:169] op_sel:[0,0,1] op_sel_hi:[1,0,1] neg_lo:[0,0,1] neg_hi:[0,0,1]
  v_pk_fma_f32 v[162:163], v[162:163], v[168:169], v[168:169] op_sel:[0,0,1] op_sel_hi:[1,0,1] neg_lo:[0,0,1] neg_hi:[0,0,1]
  v_pk_fma_f32 v[164:165], v[164:165], v[170:171], v[170:171] op_sel:[0,0,1] op_sel_hi:[1,0,1] neg_lo:[0,0,1] neg_hi:[0,0,1]
  v_pk_fma_f32 v[166:167], v[166:167], v[170:171], v[170:171] op_sel:[0,0,1] op_sel_hi:[1,0,1] neg_lo:[0,0,1] neg_hi:[0,0,1]
  v_cvt_pk_bf16_f32 v160, v160, v161
  v_cvt_pk_bf16_f32 v161, v162, v163
  v_cvt_pk_bf16_f32 v164, v164, v165
  v_cvt_pk_bf16_f32 v165, v166, v167
  ds_write_b64 v60, v[160:161] offset:256
  ds_write_b64 v60, v[164:165] offset:5120
  s_waitcnt lgkmcnt(0)
  ds_read_b64_tr_b16 v[96:97], v62 offset:0
  ds_read_b64_tr_b16 v[98:99], v62 offset:1216
  ds_read_b64_tr_b16 v[100:101], v62 offset:32
  ds_read_b64_tr_b16 v[102:103], v62 offset:1248
  ds_read_b64_tr_b16 v[104:105], v62 offset:64
  ds_read_b64_tr_b16 v[106:107], v62 offset:1280
  ds_read_b64_tr_b16 v[108:109], v62 offset:96
  ds_read_b64_tr_b16 v[110:111], v62 offset:1312
  ds_read_b64_tr_b16 v[112:113], v62 offset:128
  ds_read_b64_tr_b16 v[114:115], v62 offset:1344
  ds_read_b64_tr_b16 v[116:117], v62 offset:160
  ds_read_b64_tr_b16 v[118:119], v62 offset:1376
  ds_read_b64_tr_b16 v[120:121], v62 offset:192
  ds_read_b64_tr_b16 v[122:123], v62 offset:1408
  ds_read_b64_tr_b16 v[124:125], v62 offset:224
  ds_read_b64_tr_b16 v[126:127], v62 offset:1440
  ds_read_b64_tr_b16 v[128:129], v62 offset:256
  ds_read_b64_tr_b16 v[130:131], v62 offset:1472
  s_lshl_b32 s50, s17, 6
  s_lshl_b32 s51, s16, 2
  s_add_u32 s50, s50, s51
  s_add_u32 s50, s50, s20
  s_mul_i32 s50, s50, 9216
  s_add_u32 s50, s50, 46137344
  s_waitcnt lgkmcnt(15)
  s_add_u32 s51, s50, 0
  buffer_store_dwordx4 v[96:99], v3, s[8:11], s51 offen sc1
  s_waitcnt lgkmcnt(14)
  s_add_u32 s51, s50, 1024
  buffer_store_dwordx4 v[100:103], v3, s[8:11], s51 offen sc1
  s_waitcnt lgkmcnt(12)
  s_add_u32 s51, s50, 2048
  buffer_store_dwordx4 v[104:107], v3, s[8:11], s51 offen sc1
  s_waitcnt lgkmcnt(10)
  s_add_u32 s51, s50, 3072
  buffer_store_dwordx4 v[108:111], v3, s[8:11], s51 offen sc1
  s_waitcnt lgkmcnt(8)
  s_add_u32 s51, s50, 4096
  buffer_store_dwordx4 v[112:115], v3, s[8:11], s51 offen sc1
  s_waitcnt lgkmcnt(6)
  s_add_u32 s51, s50, 5120
  buffer_store_dwordx4 v[116:119], v3, s[8:11], s51 offen sc1
  s_waitcnt lgkmcnt(4)
  s_add_u32 s51, s50, 6144
  buffer_store_dwordx4 v[120:123], v3, s[8:11], s51 offen sc1
  s_waitcnt lgkmcnt(2)
  s_add_u32 s51, s50, 7168
  buffer_store_dwordx4 v[124:127], v3, s[8:11], s51 offen sc1
  s_waitcnt lgkmcnt(0)
  s_add_u32 s51, s50, 8192
  buffer_store_dwordx4 v[128:131], v3, s[8:11], s51 offen sc1
  ds_read_b128 v[44:47], v18 offset:1152
  ds_read_b128 v[48:51], v18 offset:1728
  ds_read_b128 v[52:55], v18 offset:1216
  ds_read_b128 v[56:59], v18 offset:1792
  v_accvgpr_read_b32 v88, a180
  v_accvgpr_read_b32 v89, a181
  v_accvgpr_read_b32 v90, a182
  v_accvgpr_read_b32 v91, a183
  v_accvgpr_read_b32 v92, a184
  v_accvgpr_read_b32 v93, a185
  v_accvgpr_read_b32 v94, a186
  v_accvgpr_read_b32 v95, a187
  s_waitcnt lgkmcnt(2)
  v_pk_fma_f32 v[60:61], v[40:41], v[44:45], v[48:49] op_sel:[1,0,0] op_sel_hi:[1,1,1] neg_lo:[1,0,0] neg_hi:[1,0,0]
  v_pk_fma_f32 v[68:69], v[42:43], v[44:45], v[48:49] op_sel:[1,0,0] op_sel_hi:[1,1,1] neg_lo:[1,0,0] neg_hi:[1,0,0]
  v_pk_fma_f32 v[62:63], v[40:41], v[46:47], v[50:51] op_sel:[1,0,0] op_sel_hi:[1,1,1] neg_lo:[1,0,0] neg_hi:[1,0,0]
  v_pk_fma_f32 v[70:71], v[42:43], v[46:47], v[50:51] op_sel:[1,0,0] op_sel_hi:[1,1,1] neg_lo:[1,0,0] neg_hi:[1,0,0]
  v_pk_fma_f32 v[88:89], v[88:89], v[40:41], v[60:61] op_sel:[0,0,0] op_sel_hi:[1,0,1]
  v_pk_fma_f32 v[92:93], v[92:93], v[42:43], v[68:69] op_sel:[0,0,0] op_sel_hi:[1,0,1]
  v_pk_fma_f32 v[90:91], v[90:91], v[40:41], v[62:63] op_sel:[0,0,0] op_sel_hi:[1,0,1]
  v_pk_fma_f32 v[94:95], v[94:95], v[42:43], v[70:71] op_sel:[0,0,0] op_sel_hi:[1,0,1]
  v_cvt_pk_bf16_f32 v200, v88, v89
  v_cvt_pk_bf16_f32 v201, v90, v91
  v_cvt_pk_bf16_f32 v202, v92, v93
  v_cvt_pk_bf16_f32 v203, v94, v95
  ds_read_b128 v[44:47], v18 offset:1280
  ds_read_b128 v[48:51], v18 offset:1856
  v_accvgpr_read_b32 v88, a188
  v_accvgpr_read_b32 v89, a189
  v_accvgpr_read_b32 v90, a190
  v_accvgpr_read_b32 v91, a191
  v_accvgpr_read_b32 v92, a192
  v_accvgpr_read_b32 v93, a193
  v_accvgpr_read_b32 v94, a194
  v_accvgpr_read_b32 v95, a195
  s_waitcnt lgkmcnt(2)
  v_pk_fma_f32 v[60:61], v[40:41], v[52:53], v[56:57] op_sel:[1,0,0] op_sel_hi:[1,1,1] neg_lo:[1,0,0] neg_hi:[1,0,0]
  v_pk_fma_f32 v[68:69], v[42:43], v[52:53], v[56:57] op_sel:[1,0,0] op_sel_hi:[1,1,1] neg_lo:[1,0,0] neg_hi:[1,0,0]
  v_pk_fma_f32 v[62:63], v[40:41], v[54:55], v[58:59] op_sel:[1,0,0] op_sel_hi:[1,1,1] neg_lo:[1,0,0] neg_hi:[1,0,0]
  v_pk_fma_f32 v[70:71], v[42:43], v[54:55], v[58:59] op_sel:[1,0,0] op_sel_hi:[1,1,1] neg_lo:[1,0,0] neg_hi:[1,0,0]
  v_pk_fma_f32 v[88:89], v[88:89], v[40:41], v[60:61] op_sel:[0,0,0] op_sel_hi:[1,0,1]
  v_pk_fma_f32 v[92:93], v[92:93], v[42:43], v[68:69] op_sel:[0,0,0] op_sel_hi:[1,0,1]
  v_pk_fma_f32 v[90:91], v[90:91], v[40:41], v[62:63] op_sel:[0,0,0] op_sel_hi:[1,0,1]
  v_pk_fma_f32 v[94:95], v[94:95], v[42:43], v[70:71] op_sel:[0,0,0] op_sel_hi:[1,0,1]
  v_cvt_pk_bf16_f32 v204, v88, v89
  v_cvt_pk_bf16_f32 v205, v90, v91
  v_cvt_pk_bf16_f32 v206, v92, v93
  v_cvt_pk_bf16_f32 v207, v94, v95
  ds_read_b128 v[52:55], v18 offset:1344
  ds_read_b128 v[56:59], v18 offset:1920
  v_accvgpr_read_b32 v88, a196
  v_accvgpr_read_b32 v89, a197
  v_accvgpr_read_b32 v90, a198
  v_accvgpr_read_b32 v91, a199
  v_accvgpr_read_b32 v92, a200
  v_accvgpr_read_b32 v93, a201
  v_accvgpr_read_b32 v94, a202
  v_accvgpr_read_b32 v95, a203
  s_waitcnt lgkmcnt(2)
  v_pk_fma_f32 v[60:61], v[40:41], v[44:45], v[48:49] op_sel:[1,0,0] op_sel_hi:[1,1,1] neg_lo:[1,0,0] neg_hi:[1,0,0]
  v_pk_fma_f32 v[68:69], v[42:43], v[44:45], v[48:49] op_sel:[1,0,0] op_sel_hi:[1,1,1] neg_lo:[1,0,0] neg_hi:[1,0,0]
  v_pk_fma_f32 v[62:63], v[40:41], v[46:47], v[50:51] op_sel:[1,0,0] op_sel_hi:[1,1,1] neg_lo:[1,0,0] neg_hi:[1,0,0]
  v_pk_fma_f32 v[70:71], v[42:43], v[46:47], v[50:51] op_sel:[1,0,0] op_sel_hi:[1,1,1] neg_lo:[1,0,0] neg_hi:[1,0,0]
  v_pk_fma_f32 v[88:89], v[88:89], v[40:41], v[60:61] op_sel:[0,0,0] op_sel_hi:[1,0,1]
  v_pk_fma_f32 v[92:93], v[92:93], v[42:43], v[68:69] op_sel:[0,0,0] op_sel_hi:[1,0,1]
  v_pk_fma_f32 v[90:91], v[90:91], v[40:41], v[62:63] op_sel:[0,0,0] op_sel_hi:[1,0,1]
  v_pk_fma_f32 v[94:95], v[94:95], v[42:43], v[70:71] op_sel:[0,0,0] op_sel_hi:[1,0,1]
  v_cvt_pk_bf16_f32 v208, v88, v89
  v_cvt_pk_bf16_f32 v209, v90, v91
  v_cvt_pk_bf16_f32 v210, v92, v93
  v_cvt_pk_bf16_f32 v211, v94, v95
  ds_read_b128 v[44:47], v18 offset:1408
  ds_read_b128 v[48:51], v18 offset:1984
  v_accvgpr_read_b32 v88, a204
  v_accvgpr_read_b32 v89, a205
  v_accvgpr_read_b32 v90, a206
  v_accvgpr_read_b32 v91, a207
  v_accvgpr_read_b32 v92, a208
  v_accvgpr_read_b32 v93, a209
  v_accvgpr_read_b32 v94, a210
  v_accvgpr_read_b32 v95, a211
  s_waitcnt lgkmcnt(2)
  v_pk_fma_f32 v[60:61], v[40:41], v[52:53], v[56:57] op_sel:[1,0,0] op_sel_hi:[1,1,1] neg_lo:[1,0,0] neg_hi:[1,0,0]
  v_pk_fma_f32 v[68:69], v[42:43], v[52:53], v[56:57] op_sel:[1,0,0] op_sel_hi:[1,1,1] neg_lo:[1,0,0] neg_hi:[1,0,0]
  v_pk_fma_f32 v[62:63], v[40:41], v[54:55], v[58:59] op_sel:[1,0,0] op_sel_hi:[1,1,1] neg_lo:[1,0,0] neg_hi:[1,0,0]
  v_pk_fma_f32 v[70:71], v[42:43], v[54:55], v[58:59] op_sel:[1,0,0] op_sel_hi:[1,1,1] neg_lo:[1,0,0] neg_hi:[1,0,0]
  v_pk_fma_f32 v[88:89], v[88:89], v[40:41], v[60:61] op_sel:[0,0,0] op_sel_hi:[1,0,1]
  v_pk_fma_f32 v[92:93], v[92:93], v[42:43], v[68:69] op_sel:[0,0,0] op_sel_hi:[1,0,1]
  v_pk_fma_f32 v[90:91], v[90:91], v[40:41], v[62:63] op_sel:[0,0,0] op_sel_hi:[1,0,1]
  v_pk_fma_f32 v[94:95], v[94:95], v[42:43], v[70:71] op_sel:[0,0,0] op_sel_hi:[1,0,1]
  v_cvt_pk_bf16_f32 v212, v88, v89
  v_cvt_pk_bf16_f32 v213, v90, v91
  v_cvt_pk_bf16_f32 v214, v92, v93
  v_cvt_pk_bf16_f32 v215, v94, v95
  ds_read_b128 v[52:55], v18 offset:1472
  ds_read_b128 v[56:59], v18 offset:2048
  v_accvgpr_read_b32 v88, a212
  v_accvgpr_read_b32 v89, a213
  v_accvgpr_read_b32 v90, a214
  v_accvgpr_read_b32 v91, a215
  v_accvgpr_read_b32 v92, a216
  v_accvgpr_read_b32 v93, a217
  v_accvgpr_read_b32 v94, a218
  v_accvgpr_read_b32 v95, a219
  s_waitcnt lgkmcnt(2)
  v_pk_fma_f32 v[60:61], v[40:41], v[44:45], v[48:49] op_sel:[1,0,0] op_sel_hi:[1,1,1] neg_lo:[1,0,0] neg_hi:[1,0,0]
  v_pk_fma_f32 v[68:69], v[42:43], v[44:45], v[48:49] op_sel:[1,0,0] op_sel_hi:[1,1,1] neg_lo:[1,0,0] neg_hi:[1,0,0]
  v_pk_fma_f32 v[62:63], v[40:41], v[46:47], v[50:51] op_sel:[1,0,0] op_sel_hi:[1,1,1] neg_lo:[1,0,0] neg_hi:[1,0,0]
  v_pk_fma_f32 v[70:71], v[42:43], v[46:47], v[50:51] op_sel:[1,0,0] op_sel_hi:[1,1,1] neg_lo:[1,0,0] neg_hi:[1,0,0]
  v_pk_fma_f32 v[88:89], v[88:89], v[40:41], v[60:61] op_sel:[0,0,0] op_sel_hi:[1,0,1]
  v_pk_fma_f32 v[92:93], v[92:93], v[42:43], v[68:69] op_sel:[0,0,0] op_sel_hi:[1,0,1]
  v_pk_fma_f32 v[90:91], v[90:91], v[40:41], v[62:63] op_sel:[0,0,0] op_sel_hi:[1,0,1]
  v_pk_fma_f32 v[94:95], v[94:95], v[42:43], v[70:71] op_sel:[0,0,0] op_sel_hi:[1,0,1]
  v_cvt_pk_bf16_f32 v216, v88, v89
  v_cvt_pk_bf16_f32 v217, v90, v91
  v_cvt_pk_bf16_f32 v218, v92, v93
  v_cvt_pk_bf16_f32 v219, v94, v95
  ds_read_b128 v[44:47], v18 offset:1536
  ds_read_b128 v[48:51], v18 offset:2112
  v_accvgpr_read_b32 v88, a220
  v_accvgpr_read_b32 v89, a221
  v_accvgpr_read_b32 v90, a222
  v_accvgpr_read_b32 v91, a223
  v_accvgpr_read_b32 v92, a224
  v_accvgpr_read_b32 v93, a225
  v_accvgpr_read_b32 v94, a226
  v_accvgpr_read_b32 v95, a227
  s_waitcnt lgkmcnt(2)
  v_pk_fma_f32 v[60:61], v[40:41], v[52:53], v[56:57] op_sel:[1,0,0] op_sel_hi:[1,1,1] neg_lo:[1,0,0] neg_hi:[1,0,0]
  v_pk_fma_f32 v[68:69], v[42:43], v[52:53], v[56:57] op_sel:[1,0,0] op_sel_hi:[1,1,1] neg_lo:[1,0,0] neg_hi:[1,0,0]
  v_pk_fma_f32 v[62:63], v[40:41], v[54:55], v[58:59] op_sel:[1,0,0] op_sel_hi:[1,1,1] neg_lo:[1,0,0] neg_hi:[1,0,0]
  v_pk_fma_f32 v[70:71], v[42:43], v[54:55], v[58:59] op_sel:[1,0,0] op_sel_hi:[1,1,1] neg_lo:[1,0,0] neg_hi:[1,0,0]
  v_pk_fma_f32 v[88:89], v[88:89], v[40:41], v[60:61] op_sel:[0,0,0] op_sel_hi:[1,0,1]
  v_pk_fma_f32 v[92:93], v[92:93], v[42:43], v[68:69] op_sel:[0,0,0] op_sel_hi:[1,0,1]
  v_pk_fma_f32 v[90:91], v[90:91], v[40:41], v[62:63] op_sel:[0,0,0] op_sel_hi:[1,0,1]
  v_pk_fma_f32 v[94:95], v[94:95], v[42:43], v[70:71] op_sel:[0,0,0] op_sel_hi:[1,0,1]
  v_cvt_pk_bf16_f32 v220, v88, v89
  v_cvt_pk_bf16_f32 v221, v90, v91
  v_cvt_pk_bf16_f32 v222, v92, v93
  v_cvt_pk_bf16_f32 v223, v94, v95
  ds_read_b128 v[52:55], v18 offset:1600
  ds_read_b128 v[56:59], v18 offset:2176
  v_accvgpr_read_b32 v88, a228
  v_accvgpr_read_b32 v89, a229
  v_accvgpr_read_b32 v90, a230
  v_accvgpr_read_b32 v91, a231
  v_accvgpr_read_b32 v92, a232
  v_accvgpr_read_b32 v93, a233
  v_accvgpr_read_b32 v94, a234
  v_accvgpr_read_b32 v95, a235
  s_waitcnt lgkmcnt(2)
  v_pk_fma_f32 v[60:61], v[40:41], v[44:45], v[48:49] op_sel:[1,0,0] op_sel_hi:[1,1,1] neg_lo:[1,0,0] neg_hi:[1,0,0]
  v_pk_fma_f32 v[68:69], v[42:43], v[44:45], v[48:49] op_sel:[1,0,0] op_sel_hi:[1,1,1] neg_lo:[1,0,0] neg_hi:[1,0,0]
  v_pk_fma_f32 v[62:63], v[40:41], v[46:47], v[50:51] op_sel:[1,0,0] op_sel_hi:[1,1,1] neg_lo:[1,0,0] neg_hi:[1,0,0]
  v_pk_fma_f32 v[70:71], v[42:43], v[46:47], v[50:51] op_sel:[1,0,0] op_sel_hi:[1,1,1] neg_lo:[1,0,0] neg_hi:[1,0,0]
  v_pk_fma_f32 v[88:89], v[88:89], v[40:41], v[60:61] op_sel:[0,0,0] op_sel_hi:[1,0,1]
  v_pk_fma_f32 v[92:93], v[92:93], v[42:43], v[68:69] op_sel:[0,0,0] op_sel_hi:[1,0,1]
  v_pk_fma_f32 v[90:91], v[90:91], v[40:41], v[62:63] op_sel:[0,0,0] op_sel_hi:[1,0,1]
  v_pk_fma_f32 v[94:95], v[94:95], v[42:43], v[70:71] op_sel:[0,0,0] op_sel_hi:[1,0,1]
  v_cvt_pk_bf16_f32 v224, v88, v89
  v_cvt_pk_bf16_f32 v225, v90, v91
  v_cvt_pk_bf16_f32 v226, v92, v93
  v_cvt_pk_bf16_f32 v227, v94, v95
  ds_read_b128 v[44:47], v18 offset:1664
  ds_read_b128 v[48:51], v18 offset:2240
  v_accvgpr_read_b32 v88, a236
  v_accvgpr_read_b32 v89, a237
  v_accvgpr_read_b32 v90, a238
  v_accvgpr_read_b32 v91, a239
  v_accvgpr_read_b32 v92, a240
  v_accvgpr_read_b32 v93, a241
  v_accvgpr_read_b32 v94, a242
  v_accvgpr_read_b32 v95, a243
  s_waitcnt lgkmcnt(2)
  v_pk_fma_f32 v[60:61], v[40:41], v[52:53], v[56:57] op_sel:[1,0,0] op_sel_hi:[1,1,1] neg_lo:[1,0,0] neg_hi:[1,0,0]
  v_pk_fma_f32 v[68:69], v[42:43], v[52:53], v[56:57] op_sel:[1,0,0] op_sel_hi:[1,1,1] neg_lo:[1,0,0] neg_hi:[1,0,0]
  v_pk_fma_f32 v[62:63], v[40:41], v[54:55], v[58:59] op_sel:[1,0,0] op_sel_hi:[1,1,1] neg_lo:[1,0,0] neg_hi:[1,0,0]
  v_pk_fma_f32 v[70:71], v[42:43], v[54:55], v[58:59] op_sel:[1,0,0] op_sel_hi:[1,1,1] neg_lo:[1,0,0] neg_hi:[1,0,0]
  v_pk_fma_f32 v[88:89], v[88:89], v[40:41], v[60:61] op_sel:[0,0,0] op_sel_hi:[1,0,1]
  v_pk_fma_f32 v[92:93], v[92:93], v[42:43], v[68:69] op_sel:[0,0,0] op_sel_hi:[1,0,1]
  v_pk_fma_f32 v[90:91], v[90:91], v[40:41], v[62:63] op_sel:[0,0,0] op_sel_hi:[1,0,1]
  v_pk_fma_f32 v[94:95], v[94:95], v[42:43], v[70:71] op_sel:[0,0,0] op_sel_hi:[1,0,1]
  v_cvt_pk_bf16_f32 v228, v88, v89
  v_cvt_pk_bf16_f32 v229, v90, v91
  v_cvt_pk_bf16_f32 v230, v92, v93
  v_cvt_pk_bf16_f32 v231, v94, v95
  v_accvgpr_read_b32 v88, a244
  v_accvgpr_read_b32 v89, a245
  v_accvgpr_read_b32 v90, a246
  v_accvgpr_read_b32 v91, a247
  v_accvgpr_read_b32 v92, a248
  v_accvgpr_read_b32 v93, a249
  v_accvgpr_read_b32 v94, a250
  v_accvgpr_read_b32 v95, a251
  s_waitcnt lgkmcnt(0)
  v_pk_fma_f32 v[60:61], v[40:41], v[44:45], v[48:49] op_sel:[1,0,0] op_sel_hi:[1,1,1] neg_lo:[1,0,0] neg_hi:[1,0,0]
  v_pk_fma_f32 v[68:69], v[42:43], v[44:45], v[48:49] op_sel:[1,0,0] op_sel_hi:[1,1,1] neg_lo:[1,0,0] neg_hi:[1,0,0]
  v_pk_fma_f32 v[62:63], v[40:41], v[46:47], v[50:51] op_sel:[1,0,0] op_sel_hi:[1,1,1] neg_lo:[1,0,0] neg_hi:[1,0,0]
  v_pk_fma_f32 v[70:71], v[42:43], v[46:47], v[50:51] op_sel:[1,0,0] op_sel_hi:[1,1,1] neg_lo:[1,0,0] neg_hi:[1,0,0]
  v_pk_fma_f32 v[88:89], v[88:89], v[40:41], v[60:61] op_sel:[0,0,0] op_sel_hi:[1,0,1]
  v_pk_fma_f32 v[92:93], v[92:93], v[42:43], v[68:69] op_sel:[0,0,0] op_sel_hi:[1,0,1]
  v_pk_fma_f32 v[90:91], v[90:91], v[40:41], v[62:63] op_sel:[0,0,0] op_sel_hi:[1,0,1]
  v_pk_fma_f32 v[94:95], v[94:95], v[42:43], v[70:71] op_sel:[0,0,0] op_sel_hi:[1,0,1]
  v_cvt_pk_bf16_f32 v232, v88, v89
  v_cvt_pk_bf16_f32 v233, v90, v91
  v_cvt_pk_bf16_f32 v234, v92, v93
  v_cvt_pk_bf16_f32 v235, v94, v95
  s_load_dwordx2 s[4:5], s[0:1], 96
  s_mul_i32 s34, s17, 589824
  s_add_u32 s34, s34, 46137344
  s_mul_i32 s31, s20, 9216
  s_add_u32 s24, s34, s31
  s_lshl_b32 s25, s16, 2
  s_add_u32 s25, s25, s20
  s_lshl_b32 s25, s25, 17
  s_add_u32 s25, s25, 27262976
  v_lshlrev_b32 v8, 1, v6
  s_waitcnt vmcnt(0) lgkmcnt(0)
  s_barrier
  s_cmp_lg_u32 s20, 0
  s_cbranch_scc1 kg_sig_11
  s_lshl_b32 s90, s17, 8
  s_add_u32 s90, s90, 90112
  v_mov_b32 v250, 1
  v_mov_b32 v251, 0
  s_mov_b64 exec, 1
  buffer_atomic_add v250, v251, s[8:11], s90 offen sc1
  s_mov_b64 exec, -1
kg_sig_11:
  s_and_b32 s5, s5, 0xffff
  s_mov_b32 s6, 4096
  s_mov_b32 s7, 0x20000
  s_lshl_b32 s43, s16, 8
  s_lshl_b32 s44, s20, 6
  s_add_u32 s43, s43, s44
  buffer_load_ushort v156, v8, s[4:7], s43 offen
  buffer_load_ushort v157, v8, s[4:7], s43 offen offset:32
  s_cmp_lg_u32 s20, 0
  s_cbranch_scc1 kg_polled_12
  v_mov_b32 v251, 0
  s_lshl_b32 s90, s16, 8
  s_add_u32 s90, s90, 86016
  s_mov_b32 s91, 0x100000
kg_poll_13:
  buffer_load_dword v250, v251, s[8:11], s90 offen sc1
  s_waitcnt vmcnt(0)
  v_readfirstlane_b32 s92, v250
  s_sub_u32 s91, s91, 1
  s_cmp_eq_u32 s91, 0
  s_cbranch_scc1 kg_ok_14
  s_cmp_ge_u32 s92, 16
  s_cbranch_scc1 kg_ok_14
  s_sleep 1
  s_branch kg_poll_13
kg_ok_14:
kg_polled_12:
  s_barrier
  s_add_u32 s27, s25, 0
  buffer_load_dwordx4 a[0:3], v3, s[8:11], s27 offen sc1
  buffer_load_dwordx4 a[4:7], v3, s[8:11], s27 offen offset:1024 sc1
  buffer_load_dwordx4 a[8:11], v3, s[8:11], s27 offen offset:2048 sc1
  buffer_load_dwordx4 a[12:15], v3, s[8:11], s27 offen offset:3072 sc1
  s_add_u32 s27, s25, 4096
  buffer_load_dwordx4 a[16:19], v3, s[8:11], s27 offen sc1
  buffer_load_dwordx4 a[20:23], v3, s[8:11], s27 offen offset:1024 sc1
  buffer_load_dwordx4 a[24:27], v3, s[8:11], s27 offen offset:2048 sc1
  buffer_load_dwordx4 a[28:31], v3, s[8:11], s27 offen offset:3072 sc1
  s_add_u32 s27, s25, 8192
  buffer_load_dwordx4 a[32:35], v3, s[8:11], s27 offen sc1
  buffer_load_dwordx4 a[36:39], v3, s[8:11], s27 offen offset:1024 sc1
  buffer_load_dwordx4 a[40:43], v3, s[8:11], s27 offen offset:2048 sc1
  buffer_load_dwordx4 a[44:47], v3, s[8:11], s27 offen offset:3072 sc1
  s_add_u32 s27, s25, 12288
  buffer_load_dwordx4 a[48:51], v3, s[8:11], s27 offen sc1
  buffer_load_dwordx4 a[52:55], v3, s[8:11], s27 offen offset:1024 sc1
  buffer_load_dwordx4 a[56:59], v3, s[8:11], s27 offen offset:2048 sc1
  buffer_load_dwordx4 a[60:63], v3, s[8:11], s27 offen offset:3072 sc1
  s_cmp_lg_u32 s20, 0
  s_cbranch_scc1 kg_polled_15
  v_mov_b32 v251, 0
  s_lshl_b32 s90, s17, 8
  s_add_u32 s90, s90, 90112
  s_mov_b32 s91, 0x100000
kg_poll_16:
  buffer_load_dword v250, v251, s[8:11], s90 offen sc1
  s_waitcnt vmcnt(0)
  v_readfirstlane_b32 s92, v250
  s_sub_u32 s91, s91, 1
  s_cmp_eq_u32 s91, 0
  s_cbranch_scc1 kg_ok_17
  s_cmp_ge_u32 s92, 16
  s_cbranch_scc1 kg_ok_17
  s_sleep 1
  s_branch kg_poll_16
kg_ok_17:
kg_polled_15:
  s_barrier
  s_add_u32 m0, s31, 0
  s_add_u32 s26, s24, 0
  buffer_load_dwordx4 v3, s[8:11], s26 offen sc1 lds
  buffer_load_dwordx4 v3, s[8:11], s26 offen offset:1024 sc1 lds
  buffer_load_dwordx4 v3, s[8:11], s26 offen offset:2048 sc1 lds
  buffer_load_dwordx4 v3, s[8:11], s26 offen offset:3072 sc1 lds
  s_add_u32 m0, s31, 4096
  s_add_u32 s26, s24, 4096
  buffer_load_dwordx4 v3, s[8:11], s26 offen sc1 lds
  buffer_load_dwordx4 v3, s[8:11], s26 offen offset:1024 sc1 lds
  buffer_load_dwordx4 v3, s[8:11], s26 offen offset:2048 sc1 lds
  buffer_load_dwordx4 v3, s[8:11], s26 offen offset:3072 sc1 lds
  s_add_u32 m0, s31, 8192
  s_add_u32 s26, s24, 8192
  buffer_load_dwordx4 v3, s[8:11], s26 offen sc1 lds
  s_add_u32 m0, s31, 36864
  s_add_u32 s26, s24, 36864
  buffer_load_dwordx4 v3, s[8:11], s26 offen sc1 lds
  buffer_load_dwordx4 v3, s[8:11], s26 offen offset:1024 sc1 lds
  buffer_load_dwordx4 v3, s[8:11], s26 offen offset:2048 sc1 lds
  buffer_load_dwordx4 v3, s[8:11], s26 offen offset:3072 sc1 lds
  s_add_u32 m0, s31, 40960
  s_add_u32 s26, s24, 40960
  buffer_load_dwordx4 v3, s[8:11], s26 offen sc1 lds
  buffer_load_dwordx4 v3, s[8:11], s26 offen offset:1024 sc1 lds
  buffer_load_dwordx4 v3, s[8:11], s26 offen offset:2048 sc1 lds
  buffer_load_dwordx4 v3, s[8:11], s26 offen offset:3072 sc1 lds
  s_add_u32 m0, s31, 45056
  s_add_u32 s26, s24, 45056
  buffer_load_dwordx4 v3, s[8:11], s26 offen sc1 lds
  s_waitcnt vmcnt(9)
  s_barrier
  ds_read_b128 v[12:15], v3 offset:0
  ds_read_b128 v[16:19], v3 offset:1024
  ds_read_b128 v[20:23], v3 offset:2048
  ds_read_b128 v[24:27], v3 offset:3072
  ds_read_b128 v[28:31], v3 offset:4096
  ds_read_b128 v[32:35], v3 offset:5120
  ds_read_b128 v[36:39], v3 offset:6144
  ds_read_b128 v[40:43], v3 offset:7168
  ds_read_b128 v[44:47], v3 offset:8192
  s_mov_b32 s53, 0xbdd2d3e8
  v_mov_b32 v178, 0xc0135761
  s_waitcnt lgkmcnt(6)
  v_mfma_f32_16x16x32_bf16 v[48:51], v[12:15], a[0:3], 0
  s_add_u32 m0, s31, 73728
  s_add_u32 s26, s24, 73728
  v_mfma_f32_16x16x32_bf16 v[52:55], v[12:15], a[4:7], 0
  ds_read_b128 v[12:15], v3 offset:9216
  v_mfma_f32_16x16x32_bf16 v[56:59], v[16:19], a[0:3], 0
  buffer_load_dwordx4 v3, s[8:11], s26 offen sc1 lds
  v_mfma_f32_16x16x32_bf16 v[60:63], v[16:19], a[4:7], 0
  ds_read_b128 v[16:19], v3 offset:10240
  s_add_u32 s27, s25, 16384
  v_mfma_f32_16x16x32_bf16 v[64:67], v[20:23], a[0:3], 0
  v_mfma_f32_16x16x32_bf16 v[68:71], v[20:23], a[4:7], 0
  ds_read_b128 v[20:23], v3 offset:11264
  s_waitcnt lgkmcnt(6)
  v_mfma_f32_16x16x32_bf16 v[72:75], v[24:27], a[0:3], 0
  buffer_load_dwordx4 a[64:67], v3, s[8:11], s27 offen sc1
  v_mfma_f32_16x16x32_bf16 v[76:79], v[24:27], a[4:7], 0
  ds_read_b128 v[24:27], v3 offset:12288
  v_mfma_f32_16x16x32_bf16 v[80:83], v[28:31], a[0:3], 0
  v_mfma_f32_16x16x32_bf16 v[84:87], v[28:31], a[4:7], 0
  ds_read_b128 v[28:31], v3 offset:13312
  v_mfma_f32_16x16x32_bf16 v[88:91], v[32:35], a[0:3], 0
  buffer_load_dwordx4 v3, s[8:11], s26 offen offset:1024 sc1 lds
  v_mfma_f32_16x16x32_bf16 v[92:95], v[32:35], a[4:7], 0
  ds_read_b128 v[32:35], v3 offset:14336
  s_waitcnt lgkmcnt(6)
  v_mfma_f32_16x16x32_bf16 v[96:99], v[36:39], a[0:3], 0
  v_mfma_f32_16x16x32_bf16 v[100:103], v[36:39], a[4:7], 0
  ds_read_b128 v[36:39], v3 offset:15360
  v_mfma_f32_16x16x32_bf16 v[104:107], v[40:43], a[0:3], 0
  buffer_load_dwordx4 a[68:71], v3, s[8:11], s27 offen offset:1024 sc1
  v_mfma_f32_16x16x32_bf16 v[108:111], v[40:43], a[4:7], 0
  ds_read_b128 v[40:43], v3 offset:16384
  v_mfma_f32_16x16x32_bf16 v[112:115], v[44:47], a[0:3], 0
  v_mfma_f32_16x16x32_bf16 v[116:119], v[44:47], a[4:7], 0
  ds_read_b128 v[44:47], v3 offset:17408
  s_waitcnt lgkmcnt(6)
  v_mfma_f32_16x16x32_bf16 v[48:51], v[12:15], a[8:11], v[48:51]
  buffer_load_dwordx4 v3, s[8:11], s26 offen offset:2048 sc1 lds
  v_mfma_f32_16x16x32_bf16 v[52:55], v[12:15], a[12:15], v[52:55]
  ds_read_b128 v[12:15], v3 offset:18432
  v_mfma_f32_16x16x32_bf16 v[56:59], v[16:19], a[8:11], v[56:59]
  v_mfma_f32_16x16x32_bf16 v[60:63], v[16:19], a[12:15], v[60:63]
  ds_read_b128 v[16:19], v3 offset:19456
  v_mfma_f32_16x16x32_bf16 v[64:67], v[20:23], a[8:11], v[64:67]
  buffer_load_dwordx4 a[72:75], v3, s[8:11], s27 offen offset:2048 sc1
  v_mfma_f32_16x16x32_bf16 v[68:71], v[20:23], a[12:15], v[68:71]
  ds_read_b128 v[20:23], v3 offset:20480
  s_waitcnt lgkmcnt(6)
  v_mfma_f32_16x16x32_bf16 v[72:75], v[24:27], a[8:11], v[72:75]
  v_mfma_f32_16x16x32_bf16 v[76:79], v[24:27], a[12:15], v[76:79]
  ds_read_b128 v[24:27], v3 offset:21504
  v_mfma_f32_16x16x32_bf16 v[80:83], v[28:31], a[8:11], v[80:83]
  buffer_load_dwordx4 v3, s[8:11], s26 offen offset:3072 sc1 lds
  v_mfma_f32_16x16x32_bf16 v[84:87], v[28:31], a[12:15], v[84:87]
  ds_read_b128 v[28:31], v3 offset:22528
  v_mfma_f32_16x16x32_bf16 v[88:91], v[32:35], a[8:11], v[88:91]
  v_mfma_f32_16x16x32_bf16 v[92:95], v[32:35], a[12:15], v[92:95]
  ds_read_b128 v[32:35], v3 offset:23552
  s_waitcnt lgkmcnt(6)
  v_mfma_f32_16x16x32_bf16 v[96:99], v[36:39], a[8:11], v[96:99]
  buffer_load_dwordx4 a[76:79], v3, s[8:11], s27 offen offset:3072 sc1
  v_mfma_f32_16x16x32_bf16 v[100:103], v[36:39], a[12:15], v[100:103]
  ds_read_b128 v[36:39], v3 offset:24576
  s_add_u32 m0, s31, 77824
  v_mfma_f32_16x16x32_bf16 v[104:107], v[40:43], a[8:11], v[104:107]
  s_add_u32 s26, s24, 77824
  v_mfma_f32_16x16x32_bf16 v[108:111], v[40:43], a[12:15], v[108:111]
  ds_read_b128 v[40:43], v3 offset:25600
  v_mfma_f32_16x16x32_bf16 v[112:115], v[44:47], a[8:11], v[112:115]
  buffer_load_dwordx4 v3, s[8:11], s26 offen sc1 lds
  v_mfma_f32_16x16x32_bf16 v[116:119], v[44:47], a[12:15], v[116:119]
  ds_read_b128 v[44:47], v3 offset:26624
  s_waitcnt lgkmcnt(6)
  v_mfma_f32_16x16x32_bf16 v[48:51], v[12:15], a[16:19], v[48:51]
  s_add_u32 s27, s25, 20480
  v_lshlrev_b32 v158, 16, v200
  v_mfma_f32_16x16x32_bf16 v[52:55], v[12:15], a[20:23], v[52:55]
  ds_read_b128 v[12:15], v3 offset:27648
  v_and_b32 v159, 0xffff0000, v200
  v_mfma_f32_16x16x32_bf16 v[56:59], v[16:19], a[16:19], v[56:59]
  buffer_load_dwordx4 a[80:83], v3, s[8:11], s27 offen sc1
  v_mfma_f32_16x16x32_bf16 v[60:63], v[16:19], a[20:23], v[60:63]
  ds_read_b128 v[16:19], v3 offset:28672
  v_lshlrev_b32 v160, 16, v201
  v_mfma_f32_16x16x32_bf16 v[64:67], v[20:23], a[16:19], v[64:67]
  v_and_b32 v161, 0xffff0000, v201
  v_mul_f32 v162, v158, v158
  v_mfma_f32_16x16x32_bf16 v[68:71], v[20:23], a[20:23], v[68:71]
  ds_read_b128 v[20:23], v3 offset:29696
  s_waitcnt lgkmcnt(6)
  v_mfma_f32_16x16x32_bf16 v[72:75], v[24:27], a[16:19], v[72:75]
  buffer_load_dwordx4 v3, s[8:11], s26 offen offset:1024 sc1 lds
  v_mfma_f32_16x16x32_bf16 v[76:79], v[24:27], a[20:23], v[76:79]
  ds_read_b128 v[24:27], v3 offset:30720
  v_mul_f32 v163, v159, v159
  v_mfma_f32_16x16x32_bf16 v[80:83], v[28:31], a[16:19], v[80:83]
  v_mul_f32 v164, v160, v160
  v_mul_f32 v165, v161, v161
  v_mfma_f32_16x16x32_bf16 v[84:87], v[28:31], a[20:23], v[84:87]
  ds_read_b128 v[28:31], v3 offset:31744
  v_fma_f32 v162, v162, s53, v178
  v_mfma_f32_16x16x32_bf16 v[88:91], v[32:35], a[16:19], v[88:91]
  buffer_load_dwordx4 a[84:87], v3, s[8:11], s27 offen offset:1024 sc1
  v_mfma_f32_16x16x32_bf16 v[92:95], v[32:35], a[20:23], v[92:95]
  ds_read_b128 v[32:35], v3 offset:32768
  s_waitcnt lgkmcnt(6)
  v_mfma_f32_16x16x32_bf16 v[96:99], v[36:39], a[16:19], v[96:99]
  v_fma_f32 v163, v163, s53, v178
  v_fma_f32 v164, v164, s53, v178
  v_mfma_f32_16x16x32_bf16 v[100:103], v[36:39], a[20:23], v[100:103]
  ds_read_b128 v[36:39], v3 offset:33792
  v_fma_f32 v165, v165, s53, v178
  v_mfma_f32_16x16x32_bf16 v[104:107], v[40:43], a[16:19], v[104:107]
  buffer_load_dwordx4 v3, s[8:11], s26 offen offset:2048 sc1 lds
  v_mfma_f32_16x16x32_bf16 v[108:111], v[40:43], a[20:23], v[108:111]
  ds_read_b128 v[40:43], v3 offset:34816
  v_mul_f32 v162, v162, v158
  v_mfma_f32_16x16x32_bf16 v[112:115], v[44:47], a[16:19], v[112:115]
  v_mul_f32 v163, v163, v159
  v_mul_f32 v164, v164, v160
  v_mfma_f32_16x16x32_bf16 v[116:119], v[44:47], a[20:23], v[116:119]
  ds_read_b128 v[44:47], v3 offset:35840
  s_waitcnt vmcnt(13)
  s_barrier
  s_waitcnt lgkmcnt(6)
  v_mfma_f32_16x16x32_bf16 v[48:51], v[12:15], a[24:27], v[48:51]
  buffer_load_dwordx4 a[88:91], v3, s[8:11], s27 offen offset:2048 sc1
  v_mfma_f32_16x16x32_bf16 v[52:55], v[12:15], a[28:31], v[52:55]
  ds_read_b128 v[12:15], v3 offset:36864
  v_mul_f32 v165, v165, v161
  v_mfma_f32_16x16x32_bf16 v[56:59], v[16:19], a[24:27], v[56:59]
  v_exp_f32 v162, v162
  v_mfma_f32_16x16x32_bf16 v[60:63], v[16:19], a[28:31], v[60:63]
  ds_read_b128 v[16:19], v3 offset:37888
  v_mfma_f32_16x16x32_bf16 v[64:67], v[20:23], a[24:27], v[64:67]
  buffer_load_dwordx4 v3, s[8:11], s26 offen offset:3072 sc1 lds
  v_mfma_f32_16x16x32_bf16 v[68:71], v[20:23], a[28:31], v[68:71]
  ds_read_b128 v[20:23], v3 offset:38912
  s_waitcnt lgkmcnt(6)
  v_mfma_f32_16x16x32_bf16 v[72:75], v[24:27], a[24:27], v[72:75]
  v_exp_f32 v163, v163
  v_mfma_f32_16x16x32_bf16 v[76:79], v[24:27], a[28:31], v[76:79]
  ds_read_b128 v[24:27], v3 offset:39936
  v_mfma_f32_16x16x32_bf16 v[80:83], v[28:31], a[24:27], v[80:83]
  buffer_load_dwordx4 a[92:95], v3, s[8:11], s27 offen offset:3072 sc1
  v_mfma_f32_16x16x32_bf16 v[84:87], v[28:31], a[28:31], v[84:87]
  ds_read_b128 v[28:31], v3 offset:40960
  s_add_u32 m0, s31, 81920
  v_mfma_f32_16x16x32_bf16 v[88:91], v[32:35], a[24:27], v[88:91]
  s_add_u32 s26, s24, 81920
  v_mfma_f32_16x16x32_bf16 v[92:95], v[32:35], a[28:31], v[92:95]
  ds_read_b128 v[32:35], v3 offset:41984
  s_waitcnt lgkmcnt(6)
  v_mfma_f32_16x16x32_bf16 v[96:99], v[36:39], a[24:27], v[96:99]
  buffer_load_dwordx4 v3, s[8:11], s26 offen sc1 lds
  v_mfma_f32_16x16x32_bf16 v[100:103], v[36:39], a[28:31], v[100:103]
  ds_read_b128 v[36:39], v3 offset:43008
  s_add_u32 m0, s31, 110592
  v_mfma_f32_16x16x32_bf16 v[104:107], v[40:43], a[24:27], v[104:107]
  s_add_u32 s26, s24, 110592
  v_mfma_f32_16x16x32_bf16 v[108:111], v[40:43], a[28:31], v[108:111]
  ds_read_b128 v[40:43], v3 offset:44032
  v_mfma_f32_16x16x32_bf16 v[112:115], v[44:47], a[24:27], v[112:115]
  buffer_load_dwordx4 v3, s[8:11], s26 offen sc1 lds
  v_mfma_f32_16x16x32_bf16 v[116:119], v[44:47], a[28:31], v[116:119]
  ds_read_b128 v[44:47], v3 offset:45056
  s_waitcnt lgkmcnt(6)
  v_mfma_f32_16x16x32_bf16 v[48:51], v[12:15], a[32:35], v[48:51]
  s_add_u32 s27, s25, 24576
  v_mfma_f32_16x16x32_bf16 v[52:55], v[12:15], a[36:39], v[52:55]
  ds_read_b128 v[12:15], v3 offset:46080
  v_mfma_f32_16x16x32_bf16 v[56:59], v[16:19], a[32:35], v[56:59]
  buffer_load_dwordx4 a[96:99], v3, s[8:11], s27 offen sc1
  v_mfma_f32_16x16x32_bf16 v[60:63], v[16:19], a[36:39], v[60:63]
  ds_read_b128 v[16:19], v3 offset:47104
  v_mfma_f32_16x16x32_bf16 v[64:67], v[20:23], a[32:35], v[64:67]
  v_exp_f32 v164, v164
  v_mfma_f32_16x16x32_bf16 v[68:71], v[20:23], a[36:39], v[68:71]
  ds_read_b128 v[20:23], v3 offset:48128
  s_waitcnt lgkmcnt(6)
  v_mfma_f32_16x16x32_bf16 v[72:75], v[24:27], a[32:35], v[72:75]
  buffer_load_dwordx4 v3, s[8:11], s26 offen offset:1024 sc1 lds
  v_mfma_f32_16x16x32_bf16 v[76:79], v[24:27], a[36:39], v[76:79]
  ds_read_b128 v[24:27], v3 offset:49152
  v_mfma_f32_16x16x32_bf16 v[80:83], v[28:31], a[32:35], v[80:83]
  v_exp_f32 v165, v165
  v_mfma_f32_16x16x32_bf16 v[84:87], v[28:31], a[36:39], v[84:87]
  ds_read_b128 v[28:31], v3 offset:50176
  v_add_f32 v162, 1.0, v162
  v_mfma_f32_16x16x32_bf16 v[88:91], v[32:35], a[32:35], v[88:91]
  buffer_load_dwordx4 a[100:103], v3, s[8:11], s27 offen offset:1024 sc1
  v_mfma_f32_16x16x32_bf16 v[92:95], v[32:35], a[36:39], v[92:95]
  ds_read_b128 v[32:35], v3 offset:51200
  s_waitcnt lgkmcnt(6)
  v_mfma_f32_16x16x32_bf16 v[96:99], v[36:39], a[32:35], v[96:99]
  v_add_f32 v163, 1.0, v163
  v_add_f32 v164, 1.0, v164
  v_mfma_f32_16x16x32_bf16 v[100:103], v[36:39], a[36:39], v[100:103]
  ds_read_b128 v[36:39], v3 offset:52224
  v_add_f32 v165, 1.0, v165
  v_mfma_f32_16x16x32_bf16 v[104:107], v[40:43], a[32:35], v[104:107]
  buffer_load_dwordx4 v3, s[8:11], s26 offen offset:2048 sc1 lds
  v_mfma_f32_16x16x32_bf16 v[108:111], v[40:43], a[36:39], v[108:111]
  ds_read_b128 v[40:43], v3 offset:53248
  v_mfma_f32_16x16x32_bf16 v[112:115], v[44:47], a[32:35], v[112:115]
  v_rcp_f32 v162, v162
  v_mfma_f32_16x16x32_bf16 v[116:119], v[44:47], a[36:39], v[116:119]
  ds_read_b128 v[44:47], v3 offset:54272
  s_waitcnt lgkmcnt(6)
  v_mfma_f32_16x16x32_bf16 v[48:51], v[12:15], a[40:43], v[48:51]
  buffer_load_dwordx4 a[104:107], v3, s[8:11], s27 offen offset:2048 sc1
  v_mfma_f32_16x16x32_bf16 v[52:55], v[12:15], a[44:47], v[52:55]
  ds_read_b128 v[12:15], v3 offset:55296
  v_mfma_f32_16x16x32_bf16 v[56:59], v[16:19], a[40:43], v[56:59]
  v_rcp_f32 v163, v163
  v_mfma_f32_16x16x32_bf16 v[60:63], v[16:19], a[44:47], v[60:63]
  ds_read_b128 v[16:19], v3 offset:56320
  v_mfma_f32_16x16x32_bf16 v[64:67], v[20:23], a[40:43], v[64:67]
  buffer_load_dwordx4 v3, s[8:11], s26 offen offset:3072 sc1 lds
  v_mfma_f32_16x16x32_bf16 v[68:71], v[20:23], a[44:47], v[68:71]
  ds_read_b128 v[20:23], v3 offset:57344
  s_waitcnt lgkmcnt(6)
  v_mfma_f32_16x16x32_bf16 v[72:75], v[24:27], a[40:43], v[72:75]
  v_rcp_f32 v164, v164
  v_mfma_f32_16x16x32_bf16 v[76:79], v[24:27], a[44:47], v[76:79]
  ds_read_b128 v[24:27], v3 offset:58368
  v_mfma_f32_16x16x32_bf16 v[80:83], v[28:31], a[40:43], v[80:83]
  buffer_load_dwordx4 a[108:111], v3, s[8:11], s27 offen offset:3072 sc1
  v_mfma_f32_16x16x32_bf16 v[84:87], v[28:31], a[44:47], v[84:87]
  ds_read_b128 v[28:31], v3 offset:59392
  s_add_u32 m0, s31, 114688
  v_mfma_f32_16x16x32_bf16 v[88:91], v[32:35], a[40:43], v[88:91]
  s_add_u32 s26, s24, 114688
  v_mfma_f32_16x16x32_bf16 v[92:95], v[32:35], a[44:47], v[92:95]
  ds_read_b128 v[32:35], v3 offset:60416
  s_waitcnt lgkmcnt(6)
  v_mfma_f32_16x16x32_bf16 v[96:99], v[36:39], a[40:43], v[96:99]
  buffer_load_dwordx4 v3, s[8:11], s26 offen sc1 lds
  v_mfma_f32_16x16x32_bf16 v[100:103], v[36:39], a[44:47], v[100:103]
  ds_read_b128 v[36:39], v3 offset:61440
  s_add_u32 s27, s25, 28672
  v_mfma_f32_16x16x32_bf16 v[104:107], v[40:43], a[40:43], v[104:107]
  v_rcp_f32 v165, v165
  v_mfma_f32_16x16x32_bf16 v[108:111], v[40:43], a[44:47], v[108:111]
  ds_read_b128 v[40:43], v3 offset:62464
  v_mul_f32 v158, v158, v162
  v_mfma_f32_16x16x32_bf16 v[112:115], v[44:47], a[40:43], v[112:115]
  buffer_load_dwordx4 a[112:115], v3, s[8:11], s27 offen sc1
  v_mfma_f32_16x16x32_bf16 v[116:119], v[44:47], a[44:47], v[116:119]
  ds_read_b128 v[44:47], v3 offset:63488
  s_waitcnt lgkmcnt(6)
  v_mfma_f32_16x16x32_bf16 v[48:51], v[12:15], a[48:51], v[48:51]
  v_mul_f32 v159, v159, v163
  v_mul_f32 v160, v160, v164
  v_mfma_f32_16x16x32_bf16 v[52:55], v[12:15], a[52:55], v[52:55]
  ds_read_b128 v[12:15], v3 offset:64512
  v_mul_f32 v161, v161, v165
  v_mfma_f32_16x16x32_bf16 v[56:59], v[16:19], a[48:51], v[56:59]
  buffer_load_dwordx4 v3, s[8:11], s26 offen offset:1024 sc1 lds
  v_mfma_f32_16x16x32_bf16 v[60:63], v[16:19], a[52:55], v[60:63]
  ds_read_b128 v[16:19], v4 offset:0
  v_cvt_pk_bf16_f32 v200, v158, v159
  v_mfma_f32_16x16x32_bf16 v[64:67], v[20:23], a[48:51], v[64:67]
  v_cvt_pk_bf16_f32 v201, v160, v161
  v_lshlrev_b32 v166, 16, v202
  v_mfma_f32_16x16x32_bf16 v[68:71], v[20:23], a[52:55], v[68:71]
  ds_read_b128 v[20:23], v4 offset:1024
  s_waitcnt lgkmcnt(6)
  v_mfma_f32_16x16x32_bf16 v[72:75], v[24:27], a[48:51], v[72:75]
  buffer_load_dwordx4 a[116:119], v3, s[8:11], s27 offen offset:1024 sc1
  v_mfma_f32_16x16x32_bf16 v[76:79], v[24:27], a[52:55], v[76:79]
  ds_read_b128 v[24:27], v4 offset:2048
  v_and_b32 v167, 0xffff0000, v202
  v_mfma_f32_16x16x32_bf16 v[80:83], v[28:31], a[48:51], v[80:83]
  v_lshlrev_b32 v168, 16, v203
  v_and_b32 v169, 0xffff0000, v203
  v_mfma_f32_16x16x32_bf16 v[84:87], v[28:31], a[52:55], v[84:87]
  ds_read_b128 v[28:31], v4 offset:3072
  v_mul_f32 v170, v166, v166
  v_mfma_f32_16x16x32_bf16 v[88:91], v[32:35], a[48:51], v[88:91]
  buffer_load_dwordx4 v3, s[8:11], s26 offen offset:2048 sc1 lds
  v_mfma_f32_16x16x32_bf16 v[92:95], v[32:35], a[52:55], v[92:95]
  ds_read_b128 v[32:35], v4 offset:4096
  s_waitcnt lgkmcnt(6)
  v_mfma_f32_16x16x32_bf16 v[96:99], v[36:39], a[48:51], v[96:99]
  v_mul_f32 v171, v167, v167
  v_mul_f32 v172, v168, v168
  v_mfma_f32_16x16x32_bf16 v[100:103], v[36:39], a[52:55], v[100:103]
  ds_read_b128 v[36:39], v4 offset:5120
  v_mul_f32 v173, v169, v169
  v_mfma_f32_16x16x32_bf16 v[104:107], v[40:43], a[48:51], v[104:107]
  buffer_load_dwordx4 a[120:123], v3, s[8:11], s27 offen offset:2048 sc1
  v_mfma_f32_16x16x32_bf16 v[108:111], v[40:43], a[52:55], v[108:111]
  ds_read_b128 v[40:43], v4 offset:6144
  v_fma_f32 v170, v170, s53, v178
  v_mfma_f32_16x16x32_bf16 v[112:115], v[44:47], a[48:51], v[112:115]
  v_fma_f32 v171, v171, s53, v178
  v_fma_f32 v172, v172, s53, v178
  v_mfma_f32_16x16x32_bf16 v[116:119], v[44:47], a[52:55], v[116:119]
  ds_read_b128 v[44:47], v4 offset:7168
  s_waitcnt vmcnt(14)
  s_barrier
  s_waitcnt lgkmcnt(6)
  v_mfma_f32_16x16x32_bf16 v[48:51], v[12:15], a[56:59], v[48:51]
  buffer_load_dwordx4 v3, s[8:11], s26 offen offset:3072 sc1 lds
  v_mfma_f32_16x16x32_bf16 v[52:55], v[12:15], a[60:63], v[52:55]
  ds_read_b128 v[12:15], v4 offset:8192
  v_fma_f32 v173, v173, s53, v178
  v_mfma_f32_16x16x32_bf16 v[56:59], v[16:19], a[56:59], v[56:59]
  v_mul_f32 v170, v170, v166
  v_mul_f32 v171, v171, v167
  v_mfma_f32_16x16x32_bf16 v[60:63], v[16:19], a[60:63], v[60:63]
  ds_read_b128 v[16:19], v4 offset:9216
  v_mul_f32 v172, v172, v168
  v_mfma_f32_16x16x32_bf16 v[64:67], v[20:23], a[56:59], v[64:67]
  buffer_load_dwordx4 a[124:127], v3, s[8:11], s27 offen offset:3072 sc1
  v_mfma_f32_16x16x32_bf16 v[68:71], v[20:23], a[60:63], v[68:71]
  ds_read_b128 v[20:23], v4 offset:10240
  s_waitcnt lgkmcnt(6)
  v_mfma_f32_16x16x32_bf16 v[72:75], v[24:27], a[56:59], v[72:75]
  s_add_u32 m0, s31, 118784
  s_add_u32 s26, s24, 118784
  v_mfma_f32_16x16x32_bf16 v[76:79], v[24:27], a[60:63], v[76:79]
  ds_read_b128 v[24:27], v4 offset:11264
  v_mul_f32 v173, v173, v169
  v_mfma_f32_16x16x32_bf16 v[80:83], v[28:31], a[56:59], v[80:83]
  buffer_load_dwordx4 v3, s[8:11], s26 offen sc1 lds
  v_mfma_f32_16x16x32_bf16 v[84:87], v[28:31], a[60:63], v[84:87]
  ds_read_b128 v[28:31], v4 offset:12288
  s_add_u32 m0, s31, 0
  v_mfma_f32_16x16x32_bf16 v[88:91], v[32:35], a[56:59], v[88:91]
  s_add_u32 s26, s24, 147456
  v_mfma_f32_16x16x32_bf16 v[92:95], v[32:35], a[60:63], v[92:95]
  ds_read_b128 v[32:35], v4 offset:13312
  s_waitcnt lgkmcnt(6)
  v_mfma_f32_16x16x32_bf16 v[96:99], v[36:39], a[56:59], v[96:99]
  buffer_load_dwordx4 v3, s[8:11], s26 offen sc1 lds
  v_mfma_f32_16x16x32_bf16 v[100:103], v[36:39], a[60:63], v[100:103]
  ds_read_b128 v[36:39], v4 offset:14336
  s_add_u32 s27, s25, 32768
  v_mfma_f32_16x16x32_bf16 v[104:107], v[40:43], a[56:59], v[104:107]
  v_exp_f32 v170, v170
  v_mfma_f32_16x16x32_bf16 v[108:111], v[40:43], a[60:63], v[108:111]
  ds_read_b128 v[40:43], v4 offset:15360
  v_mfma_f32_16x16x32_bf16 v[112:115], v[44:47], a[56:59], v[112:115]
  buffer_load_dwordx4 a[0:3], v3, s[8:11], s27 offen sc1
  v_mfma_f32_16x16x32_bf16 v[116:119], v[44:47], a[60:63], v[116:119]
  ds_read_b128 v[44:47], v4 offset:16384
  s_waitcnt lgkmcnt(6)
  v_mfma_f32_16x16x32_bf16 v[48:51], v[12:15], a[64:67], v[48:51]
  v_exp_f32 v171, v171
  v_mfma_f32_16x16x32_bf16 v[52:55], v[12:15], a[68:71], v[52:55]
  ds_read_b128 v[12:15], v4 offset:17408
  v_mfma_f32_16x16x32_bf16 v[56:59], v[16:19], a[64:67], v[56:59]
  buffer_load_dwordx4 v3, s[8:11], s26 offen offset:1024 sc1 lds
  v_mfma_f32_16x16x32_bf16 v[60:63], v[16:19], a[68:71], v[60:63]
  ds_read_b128 v[16:19], v4 offset:18432
  v_mfma_f32_16x16x32_bf16 v[64:67], v[20:23], a[64:67], v[64:67]
  v_exp_f32 v172, v172
  v_mfma_f32_16x16x32_bf16 v[68:71], v[20:23], a[68:71], v[68:71]
  ds_read_b128 v[20:23], v4 offset:19456
  s_waitcnt lgkmcnt(6)
  v_mfma_f32_16x16x32_bf16 v[72:75], v[24:27], a[64:67], v[72:75]
  buffer_load_dwordx4 a[4:7], v3, s[8:11], s27 offen offset:1024 sc1
  v_mfma_f32_16x16x32_bf16 v[76:79], v[24:27], a[68:71], v[76:79]
  ds_read_b128 v[24:27], v4 offset:20480
  v_mfma_f32_16x16x32_bf16 v[80:83], v[28:31], a[64:67], v[80:83]
  v_exp_f32 v173, v173
  v_mfma_f32_16x16x32_bf16 v[84:87], v[28:31], a[68:71], v[84:87]
  ds_read_b128 v[28:31], v4 offset:21504
  v_add_f32 v170, 1.0, v170
  v_mfma_f32_16x16x32_bf16 v[88:91], v[32:35], a[64:67], v[88:91]
  buffer_load_dwordx4 v3, s[8:11], s26 offen offset:2048 sc1 lds
  v_mfma_f32_16x16x32_bf16 v[92:95], v[32:35], a[68:71], v[92:95]
  ds_read_b128 v[32:35], v4 offset:22528
  s_waitcnt lgkmcnt(6)
  v_mfma_f32_16x16x32_bf16 v[96:99], v[36:39], a[64:67], v[96:99]
  v_add_f32 v171, 1.0, v171
  v_add_f32 v172, 1.0, v172
  v_mfma_f32_16x16x32_bf16 v[100:103], v[36:39], a[68:71], v[100:103]
  ds_read_b128 v[36:39], v4 offset:23552
  v_add_f32 v173, 1.0, v173
  v_mfma_f32_16x16x32_bf16 v[104:107], v[40:43], a[64:67], v[104:107]
  buffer_load_dwordx4 a[8:11], v3, s[8:11], s27 offen offset:2048 sc1
  v_mfma_f32_16x16x32_bf16 v[108:111], v[40:43], a[68:71], v[108:111]
  ds_read_b128 v[40:43], v4 offset:24576
  v_mfma_f32_16x16x32_bf16 v[112:115], v[44:47], a[64:67], v[112:115]
  v_rcp_f32 v170, v170
  v_mfma_f32_16x16x32_bf16 v[116:119], v[44:47], a[68:71], v[116:119]
  ds_read_b128 v[44:47], v4 offset:25600
  s_waitcnt lgkmcnt(6)
  v_mfma_f32_16x16x32_bf16 v[48:51], v[12:15], a[72:75], v[48:51]
  buffer_load_dwordx4 v3, s[8:11], s26 offen offset:3072 sc1 lds
  v_mfma_f32_16x16x32_bf16 v[52:55], v[12:15], a[76:79], v[52:55]
  ds_read_b128 v[12:15], v4 offset:26624
  v_mfma_f32_16x16x32_bf16 v[56:59], v[16:19], a[72:75], v[56:59]
  v_rcp_f32 v171, v171
  v_mfma_f32_16x16x32_bf16 v[60:63], v[16:19], a[76:79], v[60:63]
  ds_read_b128 v[16:19], v4 offset:27648
  v_mfma_f32_16x16x32_bf16 v[64:67], v[20:23], a[72:75], v[64:67]
  buffer_load_dwordx4 a[12:15], v3, s[8:11], s27 offen offset:3072 sc1
  v_mfma_f32_16x16x32_bf16 v[68:71], v[20:23], a[76:79], v[68:71]
  ds_read_b128 v[20:23], v4 offset:28672
  s_waitcnt lgkmcnt(6)
  v_mfma_f32_16x16x32_bf16 v[72:75], v[24:27], a[72:75], v[72:75]
  s_add_u32 m0, s31, 4096
  s_add_u32 s26, s24, 151552
  v_mfma_f32_16x16x32_bf16 v[76:79], v[24:27], a[76:79], v[76:79]
  ds_read_b128 v[24:27], v4 offset:29696
  v_mfma_f32_16x16x32_bf16 v[80:83], v[28:31], a[72:75], v[80:83]
  buffer_load_dwordx4 v3, s[8:11], s26 offen sc1 lds
  v_mfma_f32_16x16x32_bf16 v[84:87], v[28:31], a[76:79], v[84:87]
  ds_read_b128 v[28:31], v4 offset:30720
  s_add_u32 s27, s25, 36864
  v_mfma_f32_16x16x32_bf16 v[88:91], v[32:35], a[72:75], v[88:91]
  v_rcp_f32 v172, v172
  v_mfma_f32_16x16x32_bf16 v[92:95], v[32:35], a[76:79], v[92:95]
  ds_read_b128 v[32:35], v4 offset:31744
  s_waitcnt lgkmcnt(6)
  v_mfma_f32_16x16x32_bf16 v[96:99], v[36:39], a[72:75], v[96:99]
  buffer_load_dwordx4 a[16:19], v3, s[8:11], s27 offen sc1
  v_mfma_f32_16x16x32_bf16 v[100:103], v[36:39], a[76:79], v[100:103]
  ds_read_b128 v[36:39], v4 offset:32768
  v_mfma_f32_16x16x32_bf16 v[104:107], v[40:43], a[72:75], v[104:107]
  v_rcp_f32 v173, v173
  v_mfma_f32_16x16x32_bf16 v[108:111], v[40:43], a[76:79], v[108:111]
  ds_read_b128 v[40:43], v4 offset:33792
  v_mul_f32 v166, v166, v170
  v_mfma_f32_16x16x32_bf16 v[112:115], v[44:47], a[72:75], v[112:115]
  buffer_load_dwordx4 v3, s[8:11], s26 offen offset:1024 sc1 lds
  v_mfma_f32_16x16x32_bf16 v[116:119], v[44:47], a[76:79], v[116:119]
  ds_read_b128 v[44:47], v4 offset:34816
  s_waitcnt lgkmcnt(6)
  v_mfma_f32_16x16x32_bf16 v[48:51], v[12:15], a[80:83], v[48:51]
  v_mul_f32 v167, v167, v171
  v_mul_f32 v168, v168, v172
  v_mfma_f32_16x16x32_bf16 v[52:55], v[12:15], a[84:87], v[52:55]
  ds_read_b128 v[12:15], v4 offset:35840
  v_mul_f32 v169, v169, v173
  v_mfma_f32_16x16x32_bf16 v[56:59], v[16:19], a[80:83], v[56:59]
  buffer_load_dwordx4 a[20:23], v3, s[8:11], s27 offen offset:1024 sc1
  v_mfma_f32_16x16x32_bf16 v[60:63], v[16:19], a[84:87], v[60:63]
  ds_read_b128 v[16:19], v4 offset:36864
  v_cvt_pk_bf16_f32 v202, v166, v167
  v_mfma_f32_16x16x32_bf16 v[64:67], v[20:23], a[80:83], v[64:67]
  v_cvt_pk_bf16_f32 v203, v168, v169
  v_lshlrev_b32 v158, 16, v204
  v_mfma_f32_16x16x32_bf16 v[68:71], v[20:23], a[84:87], v[68:71]
  ds_read_b128 v[20:23], v4 offset:37888
  s_waitcnt lgkmcnt(6)
  v_mfma_f32_16x16x32_bf16 v[72:75], v[24:27], a[80:83], v[72:75]
  buffer_load_dwordx4 v3, s[8:11], s26 offen offset:2048 sc1 lds
  v_mfma_f32_16x16x32_bf16 v[76:79], v[24:27], a[84:87], v[76:79]
  ds_read_b128 v[24:27], v4 offset:38912
  v_and_b32 v159, 0xffff0000, v204
  v_mfma_f32_16x16x32_bf16 v[80:83], v[28:31], a[80:83], v[80:83]
  v_lshlrev_b32 v160, 16, v205
  v_and_b32 v161, 0xffff0000, v205
  v_mfma_f32_16x16x32_bf16 v[84:87], v[28:31], a[84:87], v[84:87]
  ds_read_b128 v[28:31], v4 offset:39936
  v_mul_f32 v162, v158, v158
  v_mfma_f32_16x16x32_bf16 v[88:91], v[32:35], a[80:83], v[88:91]
  buffer_load_dwordx4 a[24:27], v3, s[8:11], s27 offen offset:2048 sc1
  v_mfma_f32_16x16x32_bf16 v[92:95], v[32:35], a[84:87], v[92:95]
  ds_read_b128 v[32:35], v4 offset:40960
  s_waitcnt lgkmcnt(6)
  v_mfma_f32_16x16x32_bf16 v[96:99], v[36:39], a[80:83], v[96:99]
  v_mul_f32 v163, v159, v159
  v_mul_f32 v164, v160, v160
  v_mfma_f32_16x16x32_bf16 v[100:103], v[36:39], a[84:87], v[100:103]
  ds_read_b128 v[36:39], v4 offset:41984
  v_mul_f32 v165, v161, v161
  v_mfma_f32_16x16x32_bf16 v[104:107], v[40:43], a[80:83], v[104:107]
  buffer_load_dwordx4 v3, s[8:11], s26 offen offset:3072 sc1 lds
  v_mfma_f32_16x16x32_bf16 v[108:111], v[40:43], a[84:87], v[108:111]
  ds_read_b128 v[40:43], v4 offset:43008
  v_fma_f32 v162, v162, s53, v178
  v_mfma_f32_16x16x32_bf16 v[112:115], v[44:47], a[80:83], v[112:115]
  v_fma_f32 v163, v163, s53, v178
  v_fma_f32 v164, v164, s53, v178
  v_mfma_f32_16x16x32_bf16 v[116:119], v[44:47], a[84:87], v[116:119]
  ds_read_b128 v[44:47], v4 offset:44032
  s_waitcnt vmcnt(15)
  s_barrier
  s_waitcnt lgkmcnt(6)
  v_mfma_f32_16x16x32_bf16 v[48:51], v[12:15], a[88:91], v[48:51]
  buffer_load_dwordx4 a[28:31], v3, s[8:11], s27 offen offset:3072 sc1
  v_mfma_f32_16x16x32_bf16 v[52:55], v[12:15], a[92:95], v[52:55]
  ds_read_b128 v[12:15], v4 offset:45056
  s_add_u32 m0, s31, 8192
  v_mfma_f32_16x16x32_bf16 v[56:59], v[16:19], a[88:91], v[56:59]
  s_add_u32 s26, s24, 155648
  v_fma_f32 v165, v165, s53, v178
  v_mfma_f32_16x16x32_bf16 v[60:63], v[16:19], a[92:95], v[60:63]
  ds_read_b128 v[16:19], v4 offset:46080
  v_mul_f32 v162, v162, v158
  v_mfma_f32_16x16x32_bf16 v[64:67], v[20:23], a[88:91], v[64:67]
  buffer_load_dwordx4 v3, s[8:11], s26 offen sc1 lds
  v_mfma_f32_16x16x32_bf16 v[68:71], v[20:23], a[92:95], v[68:71]
  ds_read_b128 v[20:23], v4 offset:47104
  s_waitcnt lgkmcnt(6)
  v_mfma_f32_16x16x32_bf16 v[72:75], v[24:27], a[88:91], v[72:75]
  s_add_u32 m0, s31, 36864
  s_add_u32 s26, s24, 184320
  v_mfma_f32_16x16x32_bf16 v[76:79], v[24:27], a[92:95], v[76:79]
  ds_read_b128 v[24:27], v4 offset:48128
  v_mul_f32 v163, v163, v159
  v_mfma_f32_16x16x32_bf16 v[80:83], v[28:31], a[88:91], v[80:83]
  buffer_load_dwordx4 v3, s[8:11], s26 offen sc1 lds
  v_mfma_f32_16x16x32_bf16 v[84:87], v[28:31], a[92:95], v[84:87]
  ds_read_b128 v[28:31], v4 offset:49152
  s_add_u32 s27, s25, 40960
  v_mfma_f32_16x16x32_bf16 v[88:91], v[32:35], a[88:91], v[88:91]
  v_mul_f32 v164, v164, v160
  v_mul_f32 v165, v165, v161
  v_mfma_f32_16x16x32_bf16 v[92:95], v[32:35], a[92:95], v[92:95]
  ds_read_b128 v[32:35], v4 offset:50176
  s_waitcnt lgkmcnt(6)
  v_mfma_f32_16x16x32_bf16 v[96:99], v[36:39], a[88:91], v[96:99]
  buffer_load_dwordx4 a[32:35], v3, s[8:11], s27 offen sc1
  v_mfma_f32_16x16x32_bf16 v[100:103], v[36:39], a[92:95], v[100:103]
  ds_read_b128 v[36:39], v4 offset:51200
  v_mfma_f32_16x16x32_bf16 v[104:107], v[40:43], a[88:91], v[104:107]
  v_exp_f32 v162, v162
  v_mfma_f32_16x16x32_bf16 v[108:111], v[40:43], a[92:95], v[108:111]
  ds_read_b128 v[40:43], v4 offset:52224
  v_mfma_f32_16x16x32_bf16 v[112:115], v[44:47], a[88:91], v[112:115]
  buffer_load_dwordx4 v3, s[8:11], s26 offen offset:1024 sc1 lds
  v_mfma_f32_16x16x32_bf16 v[116:119], v[44:47], a[92:95], v[116:119]
  ds_read_b128 v[44:47], v4 offset:53248
  s_waitcnt lgkmcnt(6)
  v_mfma_f32_16x16x32_bf16 v[48:51], v[12:15], a[96:99], v[48:51]
  v_exp_f32 v163, v163
  v_mfma_f32_16x16x32_bf16 v[52:55], v[12:15], a[100:103], v[52:55]
  ds_read_b128 v[12:15], v4 offset:54272
  v_mfma_f32_16x16x32_bf16 v[56:59], v[16:19], a[96:99], v[56:59]
  buffer_load_dwordx4 a[36:39], v3, s[8:11], s27 offen offset:1024 sc1
  v_mfma_f32_16x16x32_bf16 v[60:63], v[16:19], a[100:103], v[60:63]
  ds_read_b128 v[16:19], v4 offset:55296
  v_mfma_f32_16x16x32_bf16 v[64:67], v[20:23], a[96:99], v[64:67]
  v_exp_f32 v164, v164
  v_mfma_f32_16x16x32_bf16 v[68:71], v[20:23], a[100:103], v[68:71]
  ds_read_b128 v[20:23], v4 offset:56320
  s_waitcnt lgkmcnt(6)
  v_mfma_f32_16x16x32_bf16 v[72:75], v[24:27], a[96:99], v[72:75]
  buffer_load_dwordx4 v3, s[8:11], s26 offen offset:2048 sc1 lds
  v_mfma_f32_16x16x32_bf16 v[76:79], v[24:27], a[100:103], v[76:79]
  ds_read_b128 v[24:27], v4 offset:57344
  v_mfma_f32_16x16x32_bf16 v[80:83], v[28:31], a[96:99], v[80:83]
  v_exp_f32 v165, v165
  v_mfma_f32_16x16x32_bf16 v[84:87], v[28:31], a[100:103], v[84:87]
  ds_read_b128 v[28:31], v4 offset:58368
  v_add_f32 v162, 1.0, v162
  v_mfma_f32_16x16x32_bf16 v[88:91], v[32:35], a[96:99], v[88:91]
  buffer_load_dwordx4 a[40:43], v3, s[8:11], s27 offen offset:2048 sc1
  v_mfma_f32_16x16x32_bf16 v[92:95], v[32:35], a[100:103], v[92:95]
  ds_read_b128 v[32:35], v4 offset:59392
  s_waitcnt lgkmcnt(6)
  v_mfma_f32_16x16x32_bf16 v[96:99], v[36:39], a[96:99], v[96:99]
  v_add_f32 v163, 1.0, v163
  v_add_f32 v164, 1.0, v164
  v_mfma_f32_16x16x32_bf16 v[100:103], v[36:39], a[100:103], v[100:103]
  ds_read_b128 v[36:39], v4 offset:60416
  v_add_f32 v165, 1.0, v165
  v_mfma_f32_16x16x32_bf16 v[104:107], v[40:43], a[96:99], v[104:107]
  buffer_load_dwordx4 v3, s[8:11], s26 offen offset:3072 sc1 lds
  v_mfma_f32_16x16x32_bf16 v[108:111], v[40:43], a[100:103], v[108:111]
  ds_read_b128 v[40:43], v4 offset:61440
  v_mfma_f32_16x16x32_bf16 v[112:115], v[44:47], a[96:99], v[112:115]
  v_rcp_f32 v162, v162
  v_mfma_f32_16x16x32_bf16 v[116:119], v[44:47], a[100:103], v[116:119]
  ds_read_b128 v[44:47], v4 offset:62464
  s_waitcnt lgkmcnt(6)
  v_mfma_f32_16x16x32_bf16 v[48:51], v[12:15], a[104:107], v[48:51]
  buffer_load_dwordx4 a[44:47], v3, s[8:11], s27 offen offset:3072 sc1
  v_mfma_f32_16x16x32_bf16 v[52:55], v[12:15], a[108:111], v[52:55]
  ds_read_b128 v[12:15], v4 offset:63488
  s_add_u32 m0, s31, 40960
  v_mfma_f32_16x16x32_bf16 v[56:59], v[16:19], a[104:107], v[56:59]
  s_add_u32 s26, s24, 188416
  v_mfma_f32_16x16x32_bf16 v[60:63], v[16:19], a[108:111], v[60:63]
  ds_read_b128 v[16:19], v4 offset:64512
  v_mfma_f32_16x16x32_bf16 v[64:67], v[20:23], a[104:107], v[64:67]
  buffer_load_dwordx4 v3, s[8:11], s26 offen sc1 lds
  v_mfma_f32_16x16x32_bf16 v[68:71], v[20:23], a[108:111], v[68:71]
  ds_read_b128 v[20:23], v5 offset:0
  s_waitcnt lgkmcnt(6)
  v_mfma_f32_16x16x32_bf16 v[72:75], v[24:27], a[104:107], v[72:75]
  s_add_u32 s27, s25, 45056
  v_mfma_f32_16x16x32_bf16 v[76:79], v[24:27], a[108:111], v[76:79]
  ds_read_b128 v[24:27], v5 offset:1024
  v_mfma_f32_16x16x32_bf16 v[80:83], v[28:31], a[104:107], v[80:83]
  buffer_load_dwordx4 a[48:51], v3, s[8:11], s27 offen sc1
  v_mfma_f32_16x16x32_bf16 v[84:87], v[28:31], a[108:111], v[84:87]
  ds_read_b128 v[28:31], v5 offset:2048
  v_mfma_f32_16x16x32_bf16 v[88:91], v[32:35], a[104:107], v[88:91]
  v_rcp_f32 v163, v163
  v_mfma_f32_16x16x32_bf16 v[92:95], v[32:35], a[108:111], v[92:95]
  ds_read_b128 v[32:35], v5 offset:3072
  s_waitcnt lgkmcnt(6)
  v_mfma_f32_16x16x32_bf16 v[96:99], v[36:39], a[104:107], v[96:99]
  buffer_load_dwordx4 v3, s[8:11], s26 offen offset:1024 sc1 lds
  v_mfma_f32_16x16x32_bf16 v[100:103], v[36:39], a[108:111], v[100:103]
  ds_read_b128 v[36:39], v5 offset:4096
  v_mfma_f32_16x16x32_bf16 v[104:107], v[40:43], a[104:107], v[104:107]
  v_rcp_f32 v164, v164
  v_mfma_f32_16x16x32_bf16 v[108:111], v[40:43], a[108:111], v[108:111]
  ds_read_b128 v[40:43], v5 offset:5120
  v_mfma_f32_16x16x32_bf16 v[112:115], v[44:47], a[104:107], v[112:115]
  buffer_load_dwordx4 a[52:55], v3, s[8:11], s27 offen offset:1024 sc1
  v_mfma_f32_16x16x32_bf16 v[116:119], v[44:47], a[108:111], v[116:119]
  ds_read_b128 v[44:47], v5 offset:6144
  s_waitcnt lgkmcnt(6)
  v_mfma_f32_16x16x32_bf16 v[48:51], v[12:15], a[112:115], v[48:51]
  v_rcp_f32 v165, v165
  v_mfma_f32_16x16x32_bf16 v[52:55], v[12:15], a[116:119], v[52:55]
  ds_read_b128 v[12:15], v5 offset:7168
  v_mul_f32 v158, v158, v162
  v_mfma_f32_16x16x32_bf16 v[56:59], v[16:19], a[112:115], v[56:59]
  buffer_load_dwordx4 v3, s[8:11], s26 offen offset:2048 sc1 lds
  v_mfma_f32_16x16x32_bf16 v[60:63], v[16:19], a[116:119], v[60:63]
  ds_read_b128 v[16:19], v5 offset:8192
  v_mul_f32 v159, v159, v163
  v_mfma_f32_16x16x32_bf16 v[64:67], v[20:23], a[112:115], v[64:67]
  v_mul_f32 v160, v160, v164
  v_mul_f32 v161, v161, v165
  v_mfma_f32_16x16x32_bf16 v[68:71], v[20:23], a[116:119], v[68:71]
  ds_read_b128 v[20:23], v5 offset:9216
  s_waitcnt lgkmcnt(6)
  v_mfma_f32_16x16x32_bf16 v[72:75], v[24:27], a[112:115], v[72:75]
  buffer_load_dwordx4 a[56:59], v3, s[8:11], s27 offen offset:2048 sc1
  v_mfma_f32_16x16x32_bf16 v[76:79], v[24:27], a[116:119], v[76:79]
  ds_read_b128 v[24:27], v5 offset:10240
  v_cvt_pk_bf16_f32 v204, v158, v159
  v_mfma_f32_16x16x32_bf16 v[80:83], v[28:31], a[112:115], v[80:83]
  v_cvt_pk_bf16_f32 v205, v160, v161
  v_lshlrev_b32 v166, 16, v206
  v_mfma_f32_16x16x32_bf16 v[84:87], v[28:31], a[116:119], v[84:87]
  ds_read_b128 v[28:31], v5 offset:11264
  v_and_b32 v167, 0xffff0000, v206
  v_mfma_f32_16x16x32_bf16 v[88:91], v[32:35], a[112:115], v[88:91]
  buffer_load_dwordx4 v3, s[8:11], s26 offen offset:3072 sc1 lds
  v_mfma_f32_16x16x32_bf16 v[92:95], v[32:35], a[116:119], v[92:95]
  ds_read_b128 v[32:35], v5 offset:12288
  s_waitcnt lgkmcnt(6)
  v_mfma_f32_16x16x32_bf16 v[96:99], v[36:39], a[112:115], v[96:99]
  v_lshlrev_b32 v168, 16, v207
  v_and_b32 v169, 0xffff0000, v207
  v_mfma_f32_16x16x32_bf16 v[100:103], v[36:39], a[116:119], v[100:103]
  ds_read_b128 v[36:39], v5 offset:13312
  v_mul_f32 v170, v166, v166
  v_mfma_f32_16x16x32_bf16 v[104:107], v[40:43], a[112:115], v[104:107]
  buffer_load_dwordx4 a[60:63], v3, s[8:11], s27 offen offset:3072 sc1
  v_mfma_f32_16x16x32_bf16 v[108:111], v[40:43], a[116:119], v[108:111]
  ds_read_b128 v[40:43], v5 offset:14336
  s_add_u32 m0, s31, 45056
  v_mfma_f32_16x16x32_bf16 v[112:115], v[44:47], a[112:115], v[112:115]
  s_add_u32 s26, s24, 192512
  v_mul_f32 v171, v167, v167
  v_mfma_f32_16x16x32_bf16 v[116:119], v[44:47], a[116:119], v[116:119]
  ds_read_b128 v[44:47], v5 offset:15360
  s_waitcnt vmcnt(16)
  s_barrier
  s_waitcnt lgkmcnt(6)
  v_mfma_f32_16x16x32_bf16 v[48:51], v[12:15], a[120:123], v[48:51]
  buffer_load_dwordx4 v3, s[8:11], s26 offen sc1 lds
  v_mfma_f32_16x16x32_bf16 v[52:55], v[12:15], a[124:127], v[52:55]
  ds_read_b128 v[12:15], v3 offset:0
  s_add_u32 m0, s31, 73728
  v_mfma_f32_16x16x32_bf16 v[56:59], v[16:19], a[120:123], v[56:59]
  s_add_u32 s26, s24, 221184
  v_mul_f32 v172, v168, v168
  v_mfma_f32_16x16x32_bf16 v[60:63], v[16:19], a[124:127], v[60:63]
  ds_read_b128 v[16:19], v3 offset:1024
  v_mul_f32 v173, v169, v169
  v_mfma_f32_16x16x32_bf16 v[64:67], v[20:23], a[120:123], v[64:67]
  buffer_load_dwordx4 v3, s[8:11], s26 offen sc1 lds
  v_mfma_f32_16x16x32_bf16 v[68:71], v[20:23], a[124:127], v[68:71]
  ds_read_b128 v[20:23], v3 offset:2048
  s_waitcnt lgkmcnt(6)
  v_mfma_f32_16x16x32_bf16 v[72:75], v[24:27], a[120:123], v[72:75]
  s_add_u32 s27, s25, 49152
  v_fma_f32 v170, v170, s53, v178
  v_mfma_f32_16x16x32_bf16 v[76:79], v[24:27], a[124:127], v[76:79]
  ds_read_b128 v[24:27], v3 offset:3072
  v_fma_f32 v171, v171, s53, v178
  v_mfma_f32_16x16x32_bf16 v[80:83], v[28:31], a[120:123], v[80:83]
  buffer_load_dwordx4 a[64:67], v3, s[8:11], s27 offen sc1
  v_mfma_f32_16x16x32_bf16 v[84:87], v[28:31], a[124:127], v[84:87]
  ds_read_b128 v[28:31], v3 offset:4096
  v_fma_f32 v172, v172, s53, v178
  v_mfma_f32_16x16x32_bf16 v[88:91], v[32:35], a[120:123], v[88:91]
  v_fma_f32 v173, v173, s53, v178
  v_mul_f32 v170, v170, v166
  v_mfma_f32_16x16x32_bf16 v[92:95], v[32:35], a[124:127], v[92:95]
  ds_read_b128 v[32:35], v3 offset:5120
  s_waitcnt lgkmcnt(6)
  v_mfma_f32_16x16x32_bf16 v[96:99], v[36:39], a[120:123], v[96:99]
  buffer_load_dwordx4 v3, s[8:11], s26 offen offset:1024 sc1 lds
  v_mfma_f32_16x16x32_bf16 v[100:103], v[36:39], a[124:127], v[100:103]
  ds_read_b128 v[36:39], v3 offset:6144
  v_mul_f32 v171, v171, v167
  v_mfma_f32_16x16x32_bf16 v[104:107], v[40:43], a[120:123], v[104:107]
  v_mul_f32 v172, v172, v168
  v_mul_f32 v173, v173, v169
  v_mfma_f32_16x16x32_bf16 v[108:111], v[40:43], a[124:127], v[108:111]
  ds_read_b128 v[40:43], v3 offset:7168
  v_mfma_f32_16x16x32_bf16 v[112:115], v[44:47], a[120:123], v[112:115]
  buffer_load_dwordx4 a[68:71], v3, s[8:11], s27 offen offset:1024 sc1
  v_mfma_f32_16x16x32_bf16 v[116:119], v[44:47], a[124:127], v[116:119]
  ds_read_b128 v[44:47], v3 offset:8192
  s_waitcnt lgkmcnt(6)
  v_mfma_f32_16x16x32_bf16 v[48:51], v[12:15], a[0:3], v[48:51]
  v_exp_f32 v170, v170
  v_mfma_f32_16x16x32_bf16 v[52:55], v[12:15], a[4:7], v[52:55]
  ds_read_b128 v[12:15], v3 offset:9216
  v_mfma_f32_16x16x32_bf16 v[56:59], v[16:19], a[0:3], v[56:59]
  buffer_load_dwordx4 v3, s[8:11], s26 offen offset:2048 sc1 lds
  v_mfma_f32_16x16x32_bf16 v[60:63], v[16:19], a[4:7], v[60:63]
  ds_read_b128 v[16:19], v3 offset:10240
  v_mfma_f32_16x16x32_bf16 v[64:67], v[20:23], a[0:3], v[64:67]
  v_exp_f32 v171, v171
  v_mfma_f32_16x16x32_bf16 v[68:71], v[20:23], a[4:7], v[68:71]
  ds_read_b128 v[20:23], v3 offset:11264
  s_waitcnt lgkmcnt(6)
  v_mfma_f32_16x16x32_bf16 v[72:75], v[24:27], a[0:3], v[72:75]
  buffer_load_dwordx4 a[72:75], v3, s[8:11], s27 offen offset:2048 sc1
  v_mfma_f32_16x16x32_bf16 v[76:79], v[24:27], a[4:7], v[76:79]
  ds_read_b128 v[24:27], v3 offset:12288
  v_mfma_f32_16x16x32_bf16 v[80:83], v[28:31], a[0:3], v[80:83]
  v_exp_f32 v172, v172
  v_mfma_f32_16x16x32_bf16 v[84:87], v[28:31], a[4:7], v[84:87]
  ds_read_b128 v[28:31], v3 offset:13312
  v_mfma_f32_16x16x32_bf16 v[88:91], v[32:35], a[0:3], v[88:91]
  buffer_load_dwordx4 v3, s[8:11], s26 offen offset:3072 sc1 lds
  v_mfma_f32_16x16x32_bf16 v[92:95], v[32:35], a[4:7], v[92:95]
  ds_read_b128 v[32:35], v3 offset:14336
  s_waitcnt lgkmcnt(6)
  v_mfma_f32_16x16x32_bf16 v[96:99], v[36:39], a[0:3], v[96:99]
  v_exp_f32 v173, v173
  v_mfma_f32_16x16x32_bf16 v[100:103], v[36:39], a[4:7], v[100:103]
  ds_read_b128 v[36:39], v3 offset:15360
  v_add_f32 v170, 1.0, v170
  v_mfma_f32_16x16x32_bf16 v[104:107], v[40:43], a[0:3], v[104:107]
  buffer_load_dwordx4 a[76:79], v3, s[8:11], s27 offen offset:3072 sc1
  v_mfma_f32_16x16x32_bf16 v[108:111], v[40:43], a[4:7], v[108:111]
  ds_read_b128 v[40:43], v3 offset:16384
  s_add_u32 m0, s31, 77824
  v_mfma_f32_16x16x32_bf16 v[112:115], v[44:47], a[0:3], v[112:115]
  s_add_u32 s26, s24, 225280
  v_add_f32 v171, 1.0, v171
  v_mfma_f32_16x16x32_bf16 v[116:119], v[44:47], a[4:7], v[116:119]
  ds_read_b128 v[44:47], v3 offset:17408
  s_waitcnt lgkmcnt(6)
  v_mfma_f32_16x16x32_bf16 v[48:51], v[12:15], a[8:11], v[48:51]
  buffer_load_dwordx4 v3, s[8:11], s26 offen sc1 lds
  v_mfma_f32_16x16x32_bf16 v[52:55], v[12:15], a[12:15], v[52:55]
  ds_read_b128 v[12:15], v3 offset:18432
  s_add_u32 s27, s25, 53248
  v_mfma_f32_16x16x32_bf16 v[56:59], v[16:19], a[8:11], v[56:59]
  v_add_f32 v172, 1.0, v172
  v_add_f32 v173, 1.0, v173
  v_mfma_f32_16x16x32_bf16 v[60:63], v[16:19], a[12:15], v[60:63]
  ds_read_b128 v[16:19], v3 offset:19456
  v_mfma_f32_16x16x32_bf16 v[64:67], v[20:23], a[8:11], v[64:67]
  buffer_load_dwordx4 a[80:83], v3, s[8:11], s27 offen sc1
  v_mfma_f32_16x16x32_bf16 v[68:71], v[20:23], a[12:15], v[68:71]
  ds_read_b128 v[20:23], v3 offset:20480
  s_waitcnt lgkmcnt(6)
  v_mfma_f32_16x16x32_bf16 v[72:75], v[24:27], a[8:11], v[72:75]
  v_rcp_f32 v170, v170
  v_mfma_f32_16x16x32_bf16 v[76:79], v[24:27], a[12:15], v[76:79]
  ds_read_b128 v[24:27], v3 offset:21504
  v_mfma_f32_16x16x32_bf16 v[80:83], v[28:31], a[8:11], v[80:83]
  buffer_load_dwordx4 v3, s[8:11], s26 offen offset:1024 sc1 lds
  v_mfma_f32_16x16x32_bf16 v[84:87], v[28:31], a[12:15], v[84:87]
  ds_read_b128 v[28:31], v3 offset:22528
  v_mfma_f32_16x16x32_bf16 v[88:91], v[32:35], a[8:11], v[88:91]
  v_rcp_f32 v171, v171
  v_mfma_f32_16x16x32_bf16 v[92:95], v[32:35], a[12:15], v[92:95]
  ds_read_b128 v[32:35], v3 offset:23552
  s_waitcnt lgkmcnt(6)
  v_mfma_f32_16x16x32_bf16 v[96:99], v[36:39], a[8:11], v[96:99]
  buffer_load_dwordx4 a[84:87], v3, s[8:11], s27 offen offset:1024 sc1
  v_mfma_f32_16x16x32_bf16 v[100:103], v[36:39], a[12:15], v[100:103]
  ds_read_b128 v[36:39], v3 offset:24576
  v_mfma_f32_16x16x32_bf16 v[104:107], v[40:43], a[8:11], v[104:107]
  v_rcp_f32 v172, v172
  v_mfma_f32_16x16x32_bf16 v[108:111], v[40:43], a[12:15], v[108:111]
  ds_read_b128 v[40:43], v3 offset:25600
  v_mfma_f32_16x16x32_bf16 v[112:115], v[44:47], a[8:11], v[112:115]
  buffer_load_dwordx4 v3, s[8:11], s26 offen offset:2048 sc1 lds
  v_mfma_f32_16x16x32_bf16 v[116:119], v[44:47], a[12:15], v[116:119]
  ds_read_b128 v[44:47], v3 offset:26624
  s_waitcnt lgkmcnt(6)
  v_mfma_f32_16x16x32_bf16 v[48:51], v[12:15], a[16:19], v[48:51]
  v_rcp_f32 v173, v173
  v_mfma_f32_16x16x32_bf16 v[52:55], v[12:15], a[20:23], v[52:55]
  ds_read_b128 v[12:15], v3 offset:27648
  v_mul_f32 v166, v166, v170
  v_mfma_f32_16x16x32_bf16 v[56:59], v[16:19], a[16:19], v[56:59]
  buffer_load_dwordx4 a[88:91], v3, s[8:11], s27 offen offset:2048 sc1
  v_mfma_f32_16x16x32_bf16 v[60:63], v[16:19], a[20:23], v[60:63]
  ds_read_b128 v[16:19], v3 offset:28672
  v_mul_f32 v167, v167, v171
  v_mfma_f32_16x16x32_bf16 v[64:67], v[20:23], a[16:19], v[64:67]
  v_mul_f32 v168, v168, v172
  v_mul_f32 v169, v169, v173
  v_mfma_f32_16x16x32_bf16 v[68:71], v[20:23], a[20:23], v[68:71]
  ds_read_b128 v[20:23], v3 offset:29696
  s_waitcnt lgkmcnt(6)
  v_mfma_f32_16x16x32_bf16 v[72:75], v[24:27], a[16:19], v[72:75]
  buffer_load_dwordx4 v3, s[8:11], s26 offen offset:3072 sc1 lds
  v_mfma_f32_16x16x32_bf16 v[76:79], v[24:27], a[20:23], v[76:79]
  ds_read_b128 v[24:27], v3 offset:30720
  v_cvt_pk_bf16_f32 v206, v166, v167
  v_mfma_f32_16x16x32_bf16 v[80:83], v[28:31], a[16:19], v[80:83]
  v_cvt_pk_bf16_f32 v207, v168, v169
  v_lshlrev_b32 v158, 16, v208
  v_mfma_f32_16x16x32_bf16 v[84:87], v[28:31], a[20:23], v[84:87]
  ds_read_b128 v[28:31], v3 offset:31744
  v_and_b32 v159, 0xffff0000, v208
  v_mfma_f32_16x16x32_bf16 v[88:91], v[32:35], a[16:19], v[88:91]
  buffer_load_dwordx4 a[92:95], v3, s[8:11], s27 offen offset:3072 sc1
  v_mfma_f32_16x16x32_bf16 v[92:95], v[32:35], a[20:23], v[92:95]
  ds_read_b128 v[32:35], v3 offset:32768
  s_waitcnt lgkmcnt(6)
  v_mfma_f32_16x16x32_bf16 v[96:99], v[36:39], a[16:19], v[96:99]
  s_add_u32 m0, s31, 81920
  s_add_u32 s26, s24, 229376
  v_mfma_f32_16x16x32_bf16 v[100:103], v[36:39], a[20:23], v[100:103]
  ds_read_b128 v[36:39], v3 offset:33792
  v_lshlrev_b32 v160, 16, v209
  v_mfma_f32_16x16x32_bf16 v[104:107], v[40:43], a[16:19], v[104:107]
  buffer_load_dwordx4 v3, s[8:11], s26 offen sc1 lds
  v_mfma_f32_16x16x32_bf16 v[108:111], v[40:43], a[20:23], v[108:111]
  ds_read_b128 v[40:43], v3 offset:34816
  v_and_b32 v161, 0xffff0000, v209
  v_mfma_f32_16x16x32_bf16 v[112:115], v[44:47], a[16:19], v[112:115]
  v_mul_f32 v162, v158, v158
  v_mul_f32 v163, v159, v159
  v_mfma_f32_16x16x32_bf16 v[116:119], v[44:47], a[20:23], v[116:119]
  ds_read_b128 v[44:47], v3 offset:35840
  s_waitcnt vmcnt(17)
  s_barrier
  s_waitcnt lgkmcnt(6)
  v_mfma_f32_16x16x32_bf16 v[48:51], v[12:15], a[24:27], v[48:51]
  s_add_u32 m0, s31, 110592
  s_add_u32 s26, s24, 258048
  v_mfma_f32_16x16x32_bf16 v[52:55], v[12:15], a[28:31], v[52:55]
  ds_read_b128 v[12:15], v3 offset:36864
  v_mul_f32 v164, v160, v160
  v_mfma_f32_16x16x32_bf16 v[56:59], v[16:19], a[24:27], v[56:59]
  buffer_load_dwordx4 v3, s[8:11], s26 offen sc1 lds
  v_mfma_f32_16x16x32_bf16 v[60:63], v[16:19], a[28:31], v[60:63]
  ds_read_b128 v[16:19], v3 offset:37888
  s_add_u32 s27, s25, 57344
  v_mfma_f32_16x16x32_bf16 v[64:67], v[20:23], a[24:27], v[64:67]
  v_mul_f32 v165, v161, v161
  v_fma_f32 v162, v162, s53, v178
  v_mfma_f32_16x16x32_bf16 v[68:71], v[20:23], a[28:31], v[68:71]
  ds_read_b128 v[20:23], v3 offset:38912
  s_waitcnt lgkmcnt(6)
  v_mfma_f32_16x16x32_bf16 v[72:75], v[24:27], a[24:27], v[72:75]
  buffer_load_dwordx4 a[96:99], v3, s[8:11], s27 offen sc1
  v_mfma_f32_16x16x32_bf16 v[76:79], v[24:27], a[28:31], v[76:79]
  ds_read_b128 v[24:27], v3 offset:39936
  v_fma_f32 v163, v163, s53, v178
  v_mfma_f32_16x16x32_bf16 v[80:83], v[28:31], a[24:27], v[80:83]
  v_fma_f32 v164, v164, s53, v178
  v_fma_f32 v165, v165, s53, v178
  v_mfma_f32_16x16x32_bf16 v[84:87], v[28:31], a[28:31], v[84:87]
  ds_read_b128 v[28:31], v3 offset:40960
  v_mul_f32 v162, v162, v158
  v_mfma_f32_16x16x32_bf16 v[88:91], v[32:35], a[24:27], v[88:91]
  buffer_load_dwordx4 v3, s[8:11], s26 offen offset:1024 sc1 lds
  v_mfma_f32_16x16x32_bf16 v[92:95], v[32:35], a[28:31], v[92:95]
  ds_read_b128 v[32:35], v3 offset:41984
  s_waitcnt lgkmcnt(6)
  v_mfma_f32_16x16x32_bf16 v[96:99], v[36:39], a[24:27], v[96:99]
  v_mul_f32 v163, v163, v159
  v_mul_f32 v164, v164, v160
  v_mfma_f32_16x16x32_bf16 v[100:103], v[36:39], a[28:31], v[100:103]
  ds_read_b128 v[36:39], v3 offset:43008
  v_mul_f32 v165, v165, v161
  v_mfma_f32_16x16x32_bf16 v[104:107], v[40:43], a[24:27], v[104:107]
  buffer_load_dwordx4 a[100:103], v3, s[8:11], s27 offen offset:1024 sc1
  v_mfma_f32_16x16x32_bf16 v[108:111], v[40:43], a[28:31], v[108:111]
  ds_read_b128 v[40:43], v3 offset:44032
  v_mfma_f32_16x16x32_bf16 v[112:115], v[44:47], a[24:27], v[112:115]
  v_exp_f32 v162, v162
  v_mfma_f32_16x16x32_bf16 v[116:119], v[44:47], a[28:31], v[116:119]
  ds_read_b128 v[44:47], v3 offset:45056
  s_waitcnt lgkmcnt(6)
  v_mfma_f32_16x16x32_bf16 v[48:51], v[12:15], a[32:35], v[48:51]
  buffer_load_dwordx4 v3, s[8:11], s26 offen offset:2048 sc1 lds
  v_mfma_f32_16x16x32_bf16 v[52:55], v[12:15], a[36:39], v[52:55]
  ds_read_b128 v[12:15], v3 offset:46080
  v_mfma_f32_16x16x32_bf16 v[56:59], v[16:19], a[32:35], v[56:59]
  v_exp_f32 v163, v163
  v_mfma_f32_16x16x32_bf16 v[60:63], v[16:19], a[36:39], v[60:63]
  ds_read_b128 v[16:19], v3 offset:47104
  v_mfma_f32_16x16x32_bf16 v[64:67], v[20:23], a[32:35], v[64:67]
  buffer_load_dwordx4 a[104:107], v3, s[8:11], s27 offen offset:2048 sc1
  v_mfma_f32_16x16x32_bf16 v[68:71], v[20:23], a[36:39], v[68:71]
  ds_read_b128 v[20:23], v3 offset:48128
  s_waitcnt lgkmcnt(6)
  v_mfma_f32_16x16x32_bf16 v[72:75], v[24:27], a[32:35], v[72:75]
  v_exp_f32 v164, v164
  v_mfma_f32_16x16x32_bf16 v[76:79], v[24:27], a[36:39], v[76:79]
  ds_read_b128 v[24:27], v3 offset:49152
  v_mfma_f32_16x16x32_bf16 v[80:83], v[28:31], a[32:35], v[80:83]
  buffer_load_dwordx4 v3, s[8:11], s26 offen offset:3072 sc1 lds
  v_mfma_f32_16x16x32_bf16 v[84:87], v[28:31], a[36:39], v[84:87]
  ds_read_b128 v[28:31], v3 offset:50176
  v_mfma_f32_16x16x32_bf16 v[88:91], v[32:35], a[32:35], v[88:91]
  v_exp_f32 v165, v165
  v_mfma_f32_16x16x32_bf16 v[92:95], v[32:35], a[36:39], v[92:95]
  ds_read_b128 v[32:35], v3 offset:51200
  s_waitcnt lgkmcnt(6)
  v_mfma_f32_16x16x32_bf16 v[96:99], v[36:39], a[32:35], v[96:99]
  buffer_load_dwordx4 a[108:111], v3, s[8:11], s27 offen offset:3072 sc1
  v_mfma_f32_16x16x32_bf16 v[100:103], v[36:39], a[36:39], v[100:103]
  ds_read_b128 v[36:39], v3 offset:52224
  s_add_u32 m0, s31, 114688
  v_mfma_f32_16x16x32_bf16 v[104:107], v[40:43], a[32:35], v[104:107]
  s_add_u32 s26, s24, 262144
  v_add_f32 v162, 1.0, v162
  v_mfma_f32_16x16x32_bf16 v[108:111], v[40:43], a[36:39], v[108:111]
  ds_read_b128 v[40:43], v3 offset:53248
  v_add_f32 v163, 1.0, v163
  v_mfma_f32_16x16x32_bf16 v[112:115], v[44:47], a[32:35], v[112:115]
  buffer_load_dwordx4 v3, s[8:11], s26 offen sc1 lds
  v_mfma_f32_16x16x32_bf16 v[116:119], v[44:47], a[36:39], v[116:119]
  ds_read_b128 v[44:47], v3 offset:54272
  s_waitcnt lgkmcnt(6)
  v_mfma_f32_16x16x32_bf16 v[48:51], v[12:15], a[40:43], v[48:51]
  s_add_u32 s27, s25, 61440
  v_add_f32 v164, 1.0, v164
  v_mfma_f32_16x16x32_bf16 v[52:55], v[12:15], a[44:47], v[52:55]
  ds_read_b128 v[12:15], v3 offset:55296
  v_add_f32 v165, 1.0, v165
  v_mfma_f32_16x16x32_bf16 v[56:59], v[16:19], a[40:43], v[56:59]
  buffer_load_dwordx4 a[112:115], v3, s[8:11], s27 offen sc1
  v_mfma_f32_16x16x32_bf16 v[60:63], v[16:19], a[44:47], v[60:63]
  ds_read_b128 v[16:19], v3 offset:56320
  v_mfma_f32_16x16x32_bf16 v[64:67], v[20:23], a[40:43], v[64:67]
  v_rcp_f32 v162, v162
  v_mfma_f32_16x16x32_bf16 v[68:71], v[20:23], a[44:47], v[68:71]
  ds_read_b128 v[20:23], v3 offset:57344
  s_waitcnt lgkmcnt(6)
  v_mfma_f32_16x16x32_bf16 v[72:75], v[24:27], a[40:43], v[72:75]
  buffer_load_dwordx4 v3, s[8:11], s26 offen offset:1024 sc1 lds
  v_mfma_f32_16x16x32_bf16 v[76:79], v[24:27], a[44:47], v[76:79]
  ds_read_b128 v[24:27], v3 offset:58368
  v_mfma_f32_16x16x32_bf16 v[80:83], v[28:31], a[40:43], v[80:83]
  v_rcp_f32 v163, v163
  v_mfma_f32_16x16x32_bf16 v[84:87], v[28:31], a[44:47], v[84:87]
  ds_read_b128 v[28:31], v3 offset:59392
  v_mfma_f32_16x16x32_bf16 v[88:91], v[32:35], a[40:43], v[88:91]
  buffer_load_dwordx4 a[116:119], v3, s[8:11], s27 offen offset:1024 sc1
  v_mfma_f32_16x16x32_bf16 v[92:95], v[32:35], a[44:47], v[92:95]
  ds_read_b128 v[32:35], v3 offset:60416
  s_waitcnt lgkmcnt(6)
  v_mfma_f32_16x16x32_bf16 v[96:99], v[36:39], a[40:43], v[96:99]
  v_rcp_f32 v164, v164
  v_mfma_f32_16x16x32_bf16 v[100:103], v[36:39], a[44:47], v[100:103]
  ds_read_b128 v[36:39], v3 offset:61440
  v_mfma_f32_16x16x32_bf16 v[104:107], v[40:43], a[40:43], v[104:107]
  buffer_load_dwordx4 v3, s[8:11], s26 offen offset:2048 sc1 lds
  v_mfma_f32_16x16x32_bf16 v[108:111], v[40:43], a[44:47], v[108:111]
  ds_read_b128 v[40:43], v3 offset:62464
  v_mfma_f32_16x16x32_bf16 v[112:115], v[44:47], a[40:43], v[112:115]
  v_rcp_f32 v165, v165
  v_mfma_f32_16x16x32_bf16 v[116:119], v[44:47], a[44:47], v[116:119]
  ds_read_b128 v[44:47], v3 offset:63488
  s_waitcnt lgkmcnt(6)
  v_mfma_f32_16x16x32_bf16 v[48:51], v[12:15], a[48:51], v[48:51]
  buffer_load_dwordx4 a[120:123], v3, s[8:11], s27 offen offset:2048 sc1
  v_mfma_f32_16x16x32_bf16 v[52:55], v[12:15], a[52:55], v[52:55]
  ds_read_b128 v[12:15], v3 offset:64512
  v_mul_f32 v158, v158, v162
  v_mfma_f32_16x16x32_bf16 v[56:59], v[16:19], a[48:51], v[56:59]
  v_mul_f32 v159, v159, v163
  v_mul_f32 v160, v160, v164
  v_mfma_f32_16x16x32_bf16 v[60:63], v[16:19], a[52:55], v[60:63]
  ds_read_b128 v[16:19], v4 offset:0
  v_mul_f32 v161, v161, v165
  v_mfma_f32_16x16x32_bf16 v[64:67], v[20:23], a[48:51], v[64:67]
  buffer_load_dwordx4 v3, s[8:11], s26 offen offset:3072 sc1 lds
  v_mfma_f32_16x16x32_bf16 v[68:71], v[20:23], a[52:55], v[68:71]
  ds_read_b128 v[20:23], v4 offset:1024
  s_waitcnt lgkmcnt(6)
  v_mfma_f32_16x16x32_bf16 v[72:75], v[24:27], a[48:51], v[72:75]
  v_cvt_pk_bf16_f32 v208, v158, v159
  v_cvt_pk_bf16_f32 v209, v160, v161
  v_mfma_f32_16x16x32_bf16 v[76:79], v[24:27], a[52:55], v[76:79]
  ds_read_b128 v[24:27], v4 offset:2048
  v_lshlrev_b32 v166, 16, v210
  v_mfma_f32_16x16x32_bf16 v[80:83], v[28:31], a[48:51], v[80:83]
  buffer_load_dwordx4 a[124:127], v3, s[8:11], s27 offen offset:3072 sc1
  v_mfma_f32_16x16x32_bf16 v[84:87], v[28:31], a[52:55], v[84:87]
  ds_read_b128 v[28:31], v4 offset:3072
  s_add_u32 m0, s31, 118784
  v_mfma_f32_16x16x32_bf16 v[88:91], v[32:35], a[48:51], v[88:91]
  s_add_u32 s26, s24, 266240
  v_and_b32 v167, 0xffff0000, v210
  v_mfma_f32_16x16x32_bf16 v[92:95], v[32:35], a[52:55], v[92:95]
  ds_read_b128 v[32:35], v4 offset:4096
  s_waitcnt lgkmcnt(6)
  v_mfma_f32_16x16x32_bf16 v[96:99], v[36:39], a[48:51], v[96:99]
  buffer_load_dwordx4 v3, s[8:11], s26 offen sc1 lds
  v_mfma_f32_16x16x32_bf16 v[100:103], v[36:39], a[52:55], v[100:103]
  ds_read_b128 v[36:39], v4 offset:5120
  v_lshlrev_b32 v168, 16, v211
  v_mfma_f32_16x16x32_bf16 v[104:107], v[40:43], a[48:51], v[104:107]
  v_and_b32 v169, 0xffff0000, v211
  v_mul_f32 v170, v166, v166
  v_mfma_f32_16x16x32_bf16 v[108:111], v[40:43], a[52:55], v[108:111]
  ds_read_b128 v[40:43], v4 offset:6144
  v_mul_f32 v171, v167, v167
  v_mfma_f32_16x16x32_bf16 v[112:115], v[44:47], a[48:51], v[112:115]
  v_mul_f32 v172, v168, v168
  v_mul_f32 v173, v169, v169
  v_mfma_f32_16x16x32_bf16 v[116:119], v[44:47], a[52:55], v[116:119]
  ds_read_b128 v[44:47], v4 offset:7168
  s_waitcnt vmcnt(17)
  s_barrier
  s_waitcnt lgkmcnt(6)
  v_mfma_f32_16x16x32_bf16 v[48:51], v[12:15], a[56:59], v[48:51]
  s_add_u32 m0, s31, 0
  s_add_u32 s26, s24, 294912
  v_mfma_f32_16x16x32_bf16 v[52:55], v[12:15], a[60:63], v[52:55]
  ds_read_b128 v[12:15], v4 offset:8192
  v_fma_f32 v170, v170, s53, v178
  v_mfma_f32_16x16x32_bf16 v[56:59], v[16:19], a[56:59], v[56:59]
  buffer_load_dwordx4 v3, s[8:11], s26 offen sc1 lds
  v_mfma_f32_16x16x32_bf16 v[60:63], v[16:19], a[60:63], v[60:63]
  ds_read_b128 v[16:19], v4 offset:9216
  s_add_u32 s27, s25, 65536
  v_mfma_f32_16x16x32_bf16 v[64:67], v[20:23], a[56:59], v[64:67]
  v_fma_f32 v171, v171, s53, v178
  v_fma_f32 v172, v172, s53, v178
  v_mfma_f32_16x16x32_bf16 v[68:71], v[20:23], a[60:63], v[68:71]
  ds_read_b128 v[20:23], v4 offset:10240
  s_waitcnt lgkmcnt(6)
  v_mfma_f32_16x16x32_bf16 v[72:75], v[24:27], a[56:59], v[72:75]
  buffer_load_dwordx4 a[0:3], v3, s[8:11], s27 offen sc1
  v_mfma_f32_16x16x32_bf16 v[76:79], v[24:27], a[60:63], v[76:79]
  ds_read_b128 v[24:27], v4 offset:11264
  v_fma_f32 v173, v173, s53, v178
  v_mfma_f32_16x16x32_bf16 v[80:83], v[28:31], a[56:59], v[80:83]
  v_mul_f32 v170, v170, v166
  v_mul_f32 v171, v171, v167
  v_mfma_f32_16x16x32_bf16 v[84:87], v[28:31], a[60:63], v[84:87]
  ds_read_b128 v[28:31], v4 offset:12288
  v_mul_f32 v172, v172, v168
  v_mfma_f32_16x16x32_bf16 v[88:91], v[32:35], a[56:59], v[88:91]
  buffer_load_dwordx4 v3, s[8:11], s26 offen offset:1024 sc1 lds
  v_mfma_f32_16x16x32_bf16 v[92:95], v[32:35], a[60:63], v[92:95]
  ds_read_b128 v[32:35], v4 offset:13312
  s_waitcnt lgkmcnt(6)
  v_mfma_f32_16x16x32_bf16 v[96:99], v[36:39], a[56:59], v[96:99]
  v_mul_f32 v173, v173, v169
  v_mfma_f32_16x16x32_bf16 v[100:103], v[36:39], a[60:63], v[100:103]
  ds_read_b128 v[36:39], v4 offset:14336
  v_mfma_f32_16x16x32_bf16 v[104:107], v[40:43], a[56:59], v[104:107]
  buffer_load_dwordx4 a[4:7], v3, s[8:11], s27 offen offset:1024 sc1
  v_mfma_f32_16x16x32_bf16 v[108:111], v[40:43], a[60:63], v[108:111]
  ds_read_b128 v[40:43], v4 offset:15360
  v_mfma_f32_16x16x32_bf16 v[112:115], v[44:47], a[56:59], v[112:115]
  v_exp_f32 v170, v170
  v_mfma_f32_16x16x32_bf16 v[116:119], v[44:47], a[60:63], v[116:119]
  ds_read_b128 v[44:47], v4 offset:16384
  s_waitcnt lgkmcnt(6)
  v_mfma_f32_16x16x32_bf16 v[48:51], v[12:15], a[64:67], v[48:51]
  buffer_load_dwordx4 v3, s[8:11], s26 offen offset:2048 sc1 lds
  v_mfma_f32_16x16x32_bf16 v[52:55], v[12:15], a[68:71], v[52:55]
  ds_read_b128 v[12:15], v4 offset:17408
  v_mfma_f32_16x16x32_bf16 v[56:59], v[16:19], a[64:67], v[56:59]
  v_exp_f32 v171, v171
  v_mfma_f32_16x16x32_bf16 v[60:63], v[16:19], a[68:71], v[60:63]
  ds_read_b128 v[16:19], v4 offset:18432
  v_mfma_f32_16x16x32_bf16 v[64:67], v[20:23], a[64:67], v[64:67]
  buffer_load_dwordx4 a[8:11], v3, s[8:11], s27 offen offset:2048 sc1
  v_mfma_f32_16x16x32_bf16 v[68:71], v[20:23], a[68:71], v[68:71]
  ds_read_b128 v[20:23], v4 offset:19456
  s_waitcnt lgkmcnt(6)
  v_mfma_f32_16x16x32_bf16 v[72:75], v[24:27], a[64:67], v[72:75]
  v_exp_f32 v172, v172
  v_mfma_f32_16x16x32_bf16 v[76:79], v[24:27], a[68:71], v[76:79]
  ds_read_b128 v[24:27], v4 offset:20480
  v_mfma_f32_16x16x32_bf16 v[80:83], v[28:31], a[64:67], v[80:83]
  buffer_load_dwordx4 v3, s[8:11], s26 offen offset:3072 sc1 lds
  v_mfma_f32_16x16x32_bf16 v[84:87], v[28:31], a[68:71], v[84:87]
  ds_read_b128 v[28:31], v4 offset:21504
  v_mfma_f32_16x16x32_bf16 v[88:91], v[32:35], a[64:67], v[88:91]
  v_exp_f32 v173, v173
  v_mfma_f32_16x16x32_bf16 v[92:95], v[32:35], a[68:71], v[92:95]
  ds_read_b128 v[32:35], v4 offset:22528
  s_waitcnt lgkmcnt(6)
  v_mfma_f32_16x16x32_bf16 v[96:99], v[36:39], a[64:67], v[96:99]
  buffer_load_dwordx4 a[12:15], v3, s[8:11], s27 offen offset:3072 sc1
  v_mfma_f32_16x16x32_bf16 v[100:103], v[36:39], a[68:71], v[100:103]
  ds_read_b128 v[36:39], v4 offset:23552
  s_add_u32 m0, s31, 4096
  v_mfma_f32_16x16x32_bf16 v[104:107], v[40:43], a[64:67], v[104:107]
  s_add_u32 s26, s24, 299008
  v_add_f32 v170, 1.0, v170
  v_mfma_f32_16x16x32_bf16 v[108:111], v[40:43], a[68:71], v[108:111]
  ds_read_b128 v[40:43], v4 offset:24576
  v_add_f32 v171, 1.0, v171
  v_mfma_f32_16x16x32_bf16 v[112:115], v[44:47], a[64:67], v[112:115]
  buffer_load_dwordx4 v3, s[8:11], s26 offen sc1 lds
  v_mfma_f32_16x16x32_bf16 v[116:119], v[44:47], a[68:71], v[116:119]
  ds_read_b128 v[44:47], v4 offset:25600
  s_waitcnt lgkmcnt(6)
  v_mfma_f32_16x16x32_bf16 v[48:51], v[12:15], a[72:75], v[48:51]
  s_add_u32 s27, s25, 69632
  v_add_f32 v172, 1.0, v172
  v_mfma_f32_16x16x32_bf16 v[52:55], v[12:15], a[76:79], v[52:55]
  ds_read_b128 v[12:15], v4 offset:26624
  v_add_f32 v173, 1.0, v173
  v_mfma_f32_16x16x32_bf16 v[56:59], v[16:19], a[72:75], v[56:59]
  buffer_load_dwordx4 a[16:19], v3, s[8:11], s27 offen sc1
  v_mfma_f32_16x16x32_bf16 v[60:63], v[16:19], a[76:79], v[60:63]
  ds_read_b128 v[16:19], v4 offset:27648
  v_mfma_f32_16x16x32_bf16 v[64:67], v[20:23], a[72:75], v[64:67]
  v_rcp_f32 v170, v170
  v_mfma_f32_16x16x32_bf16 v[68:71], v[20:23], a[76:79], v[68:71]
  ds_read_b128 v[20:23], v4 offset:28672
  s_waitcnt lgkmcnt(6)
  v_mfma_f32_16x16x32_bf16 v[72:75], v[24:27], a[72:75], v[72:75]
  buffer_load_dwordx4 v3, s[8:11], s26 offen offset:1024 sc1 lds
  v_mfma_f32_16x16x32_bf16 v[76:79], v[24:27], a[76:79], v[76:79]
  ds_read_b128 v[24:27], v4 offset:29696
  v_mfma_f32_16x16x32_bf16 v[80:83], v[28:31], a[72:75], v[80:83]
  v_rcp_f32 v171, v171
  v_mfma_f32_16x16x32_bf16 v[84:87], v[28:31], a[76:79], v[84:87]
  ds_read_b128 v[28:31], v4 offset:30720
  v_mfma_f32_16x16x32_bf16 v[88:91], v[32:35], a[72:75], v[88:91]
  buffer_load_dwordx4 a[20:23], v3, s[8:11], s27 offen offset:1024 sc1
  v_mfma_f32_16x16x32_bf16 v[92:95], v[32:35], a[76:79], v[92:95]
  ds_read_b128 v[32:35], v4 offset:31744
  s_waitcnt lgkmcnt(6)
  v_mfma_f32_16x16x32_bf16 v[96:99], v[36:39], a[72:75], v[96:99]
  v_rcp_f32 v172, v172
  v_mfma_f32_16x16x32_bf16 v[100:103], v[36:39], a[76:79], v[100:103]
  ds_read_b128 v[36:39], v4 offset:32768
  v_mfma_f32_16x16x32_bf16 v[104:107], v[40:43], a[72:75], v[104:107]
  buffer_load_dwordx4 v3, s[8:11], s26 offen offset:2048 sc1 lds
  v_mfma_f32_16x16x32_bf16 v[108:111], v[40:43], a[76:79], v[108:111]
  ds_read_b128 v[40:43], v4 offset:33792
  v_mfma_f32_16x16x32_bf16 v[112:115], v[44:47], a[72:75], v[112:115]
  v_rcp_f32 v173, v173
  v_mfma_f32_16x16x32_bf16 v[116:119], v[44:47], a[76:79], v[116:119]
  ds_read_b128 v[44:47], v4 offset:34816
  s_waitcnt lgkmcnt(6)
  v_mfma_f32_16x16x32_bf16 v[48:51], v[12:15], a[80:83], v[48:51]
  buffer_load_dwordx4 a[24:27], v3, s[8:11], s27 offen offset:2048 sc1
  v_mfma_f32_16x16x32_bf16 v[52:55], v[12:15], a[84:87], v[52:55]
  ds_read_b128 v[12:15], v4 offset:35840
  v_mul_f32 v166, v166, v170
  v_mfma_f32_16x16x32_bf16 v[56:59], v[16:19], a[80:83], v[56:59]
  v_mul_f32 v167, v167, v171
  v_mul_f32 v168, v168, v172
  v_mfma_f32_16x16x32_bf16 v[60:63], v[16:19], a[84:87], v[60:63]
  ds_read_b128 v[16:19], v4 offset:36864
  v_mul_f32 v169, v169, v173
  v_mfma_f32_16x16x32_bf16 v[64:67], v[20:23], a[80:83], v[64:67]
  buffer_load_dwordx4 v3, s[8:11], s26 offen offset:3072 sc1 lds
  v_mfma_f32_16x16x32_bf16 v[68:71], v[20:23], a[84:87], v[68:71]
  ds_read_b128 v[20:23], v4 offset:37888
  s_waitcnt lgkmcnt(6)
  v_mfma_f32_16x16x32_bf16 v[72:75], v[24:27], a[80:83], v[72:75]
  v_cvt_pk_bf16_f32 v210, v166, v167
  v_cvt_pk_bf16_f32 v211, v168, v169
  v_mfma_f32_16x16x32_bf16 v[76:79], v[24:27], a[84:87], v[76:79]
  ds_read_b128 v[24:27], v4 offset:38912
  v_lshlrev_b32 v158, 16, v212
  v_mfma_f32_16x16x32_bf16 v[80:83], v[28:31], a[80:83], v[80:83]
  buffer_load_dwordx4 a[28:31], v3, s[8:11], s27 offen offset:3072 sc1
  v_mfma_f32_16x16x32_bf16 v[84:87], v[28:31], a[84:87], v[84:87]
  ds_read_b128 v[28:31], v4 offset:39936
  s_add_u32 m0, s31, 8192
  v_mfma_f32_16x16x32_bf16 v[88:91], v[32:35], a[80:83], v[88:91]
  s_add_u32 s26, s24, 303104
  v_and_b32 v159, 0xffff0000, v212
  v_mfma_f32_16x16x32_bf16 v[92:95], v[32:35], a[84:87], v[92:95]
  ds_read_b128 v[32:35], v4 offset:40960
  s_waitcnt lgkmcnt(6)
  v_mfma_f32_16x16x32_bf16 v[96:99], v[36:39], a[80:83], v[96:99]
  buffer_load_dwordx4 v3, s[8:11], s26 offen sc1 lds
  v_mfma_f32_16x16x32_bf16 v[100:103], v[36:39], a[84:87], v[100:103]
  ds_read_b128 v[36:39], v4 offset:41984
  v_lshlrev_b32 v160, 16, v213
  v_mfma_f32_16x16x32_bf16 v[104:107], v[40:43], a[80:83], v[104:107]
  v_and_b32 v161, 0xffff0000, v213
  v_mul_f32 v162, v158, v158
  v_mfma_f32_16x16x32_bf16 v[108:111], v[40:43], a[84:87], v[108:111]
  ds_read_b128 v[40:43], v4 offset:43008
  v_mul_f32 v163, v159, v159
  v_mfma_f32_16x16x32_bf16 v[112:115], v[44:47], a[80:83], v[112:115]
  v_mul_f32 v164, v160, v160
  v_mul_f32 v165, v161, v161
  v_mfma_f32_16x16x32_bf16 v[116:119], v[44:47], a[84:87], v[116:119]
  ds_read_b128 v[44:47], v4 offset:44032
  s_waitcnt vmcnt(17)
  s_barrier
  s_waitcnt lgkmcnt(6)
  v_mfma_f32_16x16x32_bf16 v[48:51], v[12:15], a[88:91], v[48:51]
  s_add_u32 m0, s31, 36864
  s_add_u32 s26, s24, 331776
  v_mfma_f32_16x16x32_bf16 v[52:55], v[12:15], a[92:95], v[52:55]
  ds_read_b128 v[12:15], v4 offset:45056
  v_fma_f32 v162, v162, s53, v178
  v_mfma_f32_16x16x32_bf16 v[56:59], v[16:19], a[88:91], v[56:59]
  buffer_load_dwordx4 v3, s[8:11], s26 offen sc1 lds
  v_mfma_f32_16x16x32_bf16 v[60:63], v[16:19], a[92:95], v[60:63]
  ds_read_b128 v[16:19], v4 offset:46080
  s_add_u32 s27, s25, 73728
  v_mfma_f32_16x16x32_bf16 v[64:67], v[20:23], a[88:91], v[64:67]
  v_fma_f32 v163, v163, s53, v178
  v_fma_f32 v164, v164, s53, v178
  v_mfma_f32_16x16x32_bf16 v[68:71], v[20:23], a[92:95], v[68:71]
  ds_read_b128 v[20:23], v4 offset:47104
  s_waitcnt lgkmcnt(6)
  v_mfma_f32_16x16x32_bf16 v[72:75], v[24:27], a[88:91], v[72:75]
  buffer_load_dwordx4 a[32:35], v3, s[8:11], s27 offen sc1
  v_mfma_f32_16x16x32_bf16 v[76:79], v[24:27], a[92:95], v[76:79]
  ds_read_b128 v[24:27], v4 offset:48128
  v_fma_f32 v165, v165, s53, v178
  v_mfma_f32_16x16x32_bf16 v[80:83], v[28:31], a[88:91], v[80:83]
  v_mul_f32 v162, v162, v158
  v_mul_f32 v163, v163, v159
  v_mfma_f32_16x16x32_bf16 v[84:87], v[28:31], a[92:95], v[84:87]
  ds_read_b128 v[28:31], v4 offset:49152
  v_mul_f32 v164, v164, v160
  v_mfma_f32_16x16x32_bf16 v[88:91], v[32:35], a[88:91], v[88:91]
  buffer_load_dwordx4 v3, s[8:11], s26 offen offset:1024 sc1 lds
  v_mfma_f32_16x16x32_bf16 v[92:95], v[32:35], a[92:95], v[92:95]
  ds_read_b128 v[32:35], v4 offset:50176
  s_waitcnt lgkmcnt(6)
  v_mfma_f32_16x16x32_bf16 v[96:99], v[36:39], a[88:91], v[96:99]
  v_mul_f32 v165, v165, v161
  v_mfma_f32_16x16x32_bf16 v[100:103], v[36:39], a[92:95], v[100:103]
  ds_read_b128 v[36:39], v4 offset:51200
  v_mfma_f32_16x16x32_bf16 v[104:107], v[40:43], a[88:91], v[104:107]
  buffer_load_dwordx4 a[36:39], v3, s[8:11], s27 offen offset:1024 sc1
  v_mfma_f32_16x16x32_bf16 v[108:111], v[40:43], a[92:95], v[108:111]
  ds_read_b128 v[40:43], v4 offset:52224
  v_mfma_f32_16x16x32_bf16 v[112:115], v[44:47], a[88:91], v[112:115]
  v_exp_f32 v162, v162
  v_mfma_f32_16x16x32_bf16 v[116:119], v[44:47], a[92:95], v[116:119]
  ds_read_b128 v[44:47], v4 offset:53248
  s_waitcnt lgkmcnt(6)
  v_mfma_f32_16x16x32_bf16 v[48:51], v[12:15], a[96:99], v[48:51]
  buffer_load_dwordx4 v3, s[8:11], s26 offen offset:2048 sc1 lds
  v_mfma_f32_16x16x32_bf16 v[52:55], v[12:15], a[100:103], v[52:55]
  ds_read_b128 v[12:15], v4 offset:54272
  v_mfma_f32_16x16x32_bf16 v[56:59], v[16:19], a[96:99], v[56:59]
  v_exp_f32 v163, v163
  v_mfma_f32_16x16x32_bf16 v[60:63], v[16:19], a[100:103], v[60:63]
  ds_read_b128 v[16:19], v4 offset:55296
  v_mfma_f32_16x16x32_bf16 v[64:67], v[20:23], a[96:99], v[64:67]
  buffer_load_dwordx4 a[40:43], v3, s[8:11], s27 offen offset:2048 sc1
  v_mfma_f32_16x16x32_bf16 v[68:71], v[20:23], a[100:103], v[68:71]
  ds_read_b128 v[20:23], v4 offset:56320
  s_waitcnt lgkmcnt(6)
  v_mfma_f32_16x16x32_bf16 v[72:75], v[24:27], a[96:99], v[72:75]
  v_exp_f32 v164, v164
  v_mfma_f32_16x16x32_bf16 v[76:79], v[24:27], a[100:103], v[76:79]
  ds_read_b128 v[24:27], v4 offset:57344
  v_mfma_f32_16x16x32_bf16 v[80:83], v[28:31], a[96:99], v[80:83]
  buffer_load_dwordx4 v3, s[8:11], s26 offen offset:3072 sc1 lds
  v_mfma_f32_16x16x32_bf16 v[84:87], v[28:31], a[100:103], v[84:87]
  ds_read_b128 v[28:31], v4 offset:58368
  v_mfma_f32_16x16x32_bf16 v[88:91], v[32:35], a[96:99], v[88:91]
  v_exp_f32 v165, v165
  v_mfma_f32_16x16x32_bf16 v[92:95], v[32:35], a[100:103], v[92:95]
  ds_read_b128 v[32:35], v4 offset:59392
  s_waitcnt lgkmcnt(6)
  v_mfma_f32_16x16x32_bf16 v[96:99], v[36:39], a[96:99], v[96:99]
  buffer_load_dwordx4 a[44:47], v3, s[8:11], s27 offen offset:3072 sc1
  v_mfma_f32_16x16x32_bf16 v[100:103], v[36:39], a[100:103], v[100:103]
  ds_read_b128 v[36:39], v4 offset:60416
  s_add_u32 m0, s31, 40960
  v_mfma_f32_16x16x32_bf16 v[104:107], v[40:43], a[96:99], v[104:107]
  s_add_u32 s26, s24, 335872
  v_add_f32 v162, 1.0, v162
  v_mfma_f32_16x16x32_bf16 v[108:111], v[40:43], a[100:103], v[108:111]
  ds_read_b128 v[40:43], v4 offset:61440
  v_add_f32 v163, 1.0, v163
  v_mfma_f32_16x16x32_bf16 v[112:115], v[44:47], a[96:99], v[112:115]
  buffer_load_dwordx4 v3, s[8:11], s26 offen sc1 lds
  v_mfma_f32_16x16x32_bf16 v[116:119], v[44:47], a[100:103], v[116:119]
  ds_read_b128 v[44:47], v4 offset:62464
  s_waitcnt lgkmcnt(6)
  v_mfma_f32_16x16x32_bf16 v[48:51], v[12:15], a[104:107], v[48:51]
  s_add_u32 s27, s25, 77824
  v_add_f32 v164, 1.0, v164
  v_mfma_f32_16x16x32_bf16 v[52:55], v[12:15], a[108:111], v[52:55]
  ds_read_b128 v[12:15], v4 offset:63488
  v_add_f32 v165, 1.0, v165
  v_mfma_f32_16x16x32_bf16 v[56:59], v[16:19], a[104:107], v[56:59]
  buffer_load_dwordx4 a[48:51], v3, s[8:11], s27 offen sc1
  v_mfma_f32_16x16x32_bf16 v[60:63], v[16:19], a[108:111], v[60:63]
  ds_read_b128 v[16:19], v4 offset:64512
  v_mfma_f32_16x16x32_bf16 v[64:67], v[20:23], a[104:107], v[64:67]
  v_rcp_f32 v162, v162
  v_mfma_f32_16x16x32_bf16 v[68:71], v[20:23], a[108:111], v[68:71]
  ds_read_b128 v[20:23], v5 offset:0
  s_waitcnt lgkmcnt(6)
  v_mfma_f32_16x16x32_bf16 v[72:75], v[24:27], a[104:107], v[72:75]
  buffer_load_dwordx4 v3, s[8:11], s26 offen offset:1024 sc1 lds
  v_mfma_f32_16x16x32_bf16 v[76:79], v[24:27], a[108:111], v[76:79]
  ds_read_b128 v[24:27], v5 offset:1024
  v_mfma_f32_16x16x32_bf16 v[80:83], v[28:31], a[104:107], v[80:83]
  v_rcp_f32 v163, v163
  v_mfma_f32_16x16x32_bf16 v[84:87], v[28:31], a[108:111], v[84:87]
  ds_read_b128 v[28:31], v5 offset:2048
  v_mfma_f32_16x16x32_bf16 v[88:91], v[32:35], a[104:107], v[88:91]
  buffer_load_dwordx4 a[52:55], v3, s[8:11], s27 offen offset:1024 sc1
  v_mfma_f32_16x16x32_bf16 v[92:95], v[32:35], a[108:111], v[92:95]
  ds_read_b128 v[32:35], v5 offset:3072
  s_waitcnt lgkmcnt(6)
  v_mfma_f32_16x16x32_bf16 v[96:99], v[36:39], a[104:107], v[96:99]
  v_rcp_f32 v164, v164
  v_mfma_f32_16x16x32_bf16 v[100:103], v[36:39], a[108:111], v[100:103]
  ds_read_b128 v[36:39], v5 offset:4096
  v_mfma_f32_16x16x32_bf16 v[104:107], v[40:43], a[104:107], v[104:107]
  buffer_load_dwordx4 v3, s[8:11], s26 offen offset:2048 sc1 lds
  v_mfma_f32_16x16x32_bf16 v[108:111], v[40:43], a[108:111], v[108:111]
  ds_read_b128 v[40:43], v5 offset:5120
  v_mfma_f32_16x16x32_bf16 v[112:115], v[44:47], a[104:107], v[112:115]
  v_rcp_f32 v165, v165
  v_mfma_f32_16x16x32_bf16 v[116:119], v[44:47], a[108:111], v[116:119]
  ds_read_b128 v[44:47], v5 offset:6144
  s_waitcnt lgkmcnt(6)
  v_mfma_f32_16x16x32_bf16 v[48:51], v[12:15], a[112:115], v[48:51]
  buffer_load_dwordx4 a[56:59], v3, s[8:11], s27 offen offset:2048 sc1
  v_mfma_f32_16x16x32_bf16 v[52:55], v[12:15], a[116:119], v[52:55]
  ds_read_b128 v[12:15], v5 offset:7168
  v_mul_f32 v158, v158, v162
  v_mfma_f32_16x16x32_bf16 v[56:59], v[16:19], a[112:115], v[56:59]
  v_mul_f32 v159, v159, v163
  v_mul_f32 v160, v160, v164
  v_mfma_f32_16x16x32_bf16 v[60:63], v[16:19], a[116:119], v[60:63]
  ds_read_b128 v[16:19], v5 offset:8192
  v_mul_f32 v161, v161, v165
  v_mfma_f32_16x16x32_bf16 v[64:67], v[20:23], a[112:115], v[64:67]
  buffer_load_dwordx4 v3, s[8:11], s26 offen offset:3072 sc1 lds
  v_mfma_f32_16x16x32_bf16 v[68:71], v[20:23], a[116:119], v[68:71]
  ds_read_b128 v[20:23], v5 offset:9216
  s_waitcnt lgkmcnt(6)
  v_mfma_f32_16x16x32_bf16 v[72:75], v[24:27], a[112:115], v[72:75]
  v_cvt_pk_bf16_f32 v212, v158, v159
  v_cvt_pk_bf16_f32 v213, v160, v161
  v_mfma_f32_16x16x32_bf16 v[76:79], v[24:27], a[116:119], v[76:79]
  ds_read_b128 v[24:27], v5 offset:10240
  v_lshlrev_b32 v166, 16, v214
  v_mfma_f32_16x16x32_bf16 v[80:83], v[28:31], a[112:115], v[80:83]
  buffer_load_dwordx4 a[60:63], v3, s[8:11], s27 offen offset:3072 sc1
  v_mfma_f32_16x16x32_bf16 v[84:87], v[28:31], a[116:119], v[84:87]
  ds_read_b128 v[28:31], v5 offset:11264
  s_add_u32 m0, s31, 45056
  v_mfma_f32_16x16x32_bf16 v[88:91], v[32:35], a[112:115], v[88:91]
  s_add_u32 s26, s24, 339968
  v_and_b32 v167, 0xffff0000, v214
  v_mfma_f32_16x16x32_bf16 v[92:95], v[32:35], a[116:119], v[92:95]
  ds_read_b128 v[32:35], v5 offset:12288
  s_waitcnt lgkmcnt(6)
  v_mfma_f32_16x16x32_bf16 v[96:99], v[36:39], a[112:115], v[96:99]
  buffer_load_dwordx4 v3, s[8:11], s26 offen sc1 lds
  v_mfma_f32_16x16x32_bf16 v[100:103], v[36:39], a[116:119], v[100:103]
  ds_read_b128 v[36:39], v5 offset:13312
  v_lshlrev_b32 v168, 16, v215
  v_mfma_f32_16x16x32_bf16 v[104:107], v[40:43], a[112:115], v[104:107]
  v_and_b32 v169, 0xffff0000, v215
  v_mul_f32 v170, v166, v166
  v_mfma_f32_16x16x32_bf16 v[108:111], v[40:43], a[116:119], v[108:111]
  ds_read_b128 v[40:43], v5 offset:14336
  v_mul_f32 v171, v167, v167
  v_mfma_f32_16x16x32_bf16 v[112:115], v[44:47], a[112:115], v[112:115]
  v_mul_f32 v172, v168, v168
  v_mul_f32 v173, v169, v169
  v_mfma_f32_16x16x32_bf16 v[116:119], v[44:47], a[116:119], v[116:119]
  ds_read_b128 v[44:47], v5 offset:15360
  s_waitcnt vmcnt(17)
  s_barrier
  s_waitcnt lgkmcnt(6)
  v_mfma_f32_16x16x32_bf16 v[48:51], v[12:15], a[120:123], v[48:51]
  s_add_u32 m0, s31, 73728
  s_add_u32 s26, s24, 368640
  v_mfma_f32_16x16x32_bf16 v[52:55], v[12:15], a[124:127], v[52:55]
  ds_read_b128 v[12:15], v3 offset:0
  v_fma_f32 v170, v170, s53, v178
  v_mfma_f32_16x16x32_bf16 v[56:59], v[16:19], a[120:123], v[56:59]
  buffer_load_dwordx4 v3, s[8:11], s26 offen sc1 lds
  v_mfma_f32_16x16x32_bf16 v[60:63], v[16:19], a[124:127], v[60:63]
  ds_read_b128 v[16:19], v3 offset:1024
  s_add_u32 s27, s25, 81920
  v_mfma_f32_16x16x32_bf16 v[64:67], v[20:23], a[120:123], v[64:67]
  v_fma_f32 v171, v171, s53, v178
  v_fma_f32 v172, v172, s53, v178
  v_mfma_f32_16x16x32_bf16 v[68:71], v[20:23], a[124:127], v[68:71]
  ds_read_b128 v[20:23], v3 offset:2048
  s_waitcnt lgkmcnt(6)
  v_mfma_f32_16x16x32_bf16 v[72:75], v[24:27], a[120:123], v[72:75]
  buffer_load_dwordx4 a[64:67], v3, s[8:11], s27 offen sc1
  v_mfma_f32_16x16x32_bf16 v[76:79], v[24:27], a[124:127], v[76:79]
  ds_read_b128 v[24:27], v3 offset:3072
  v_fma_f32 v173, v173, s53, v178
  v_mfma_f32_16x16x32_bf16 v[80:83], v[28:31], a[120:123], v[80:83]
  v_mul_f32 v170, v170, v166
  v_mul_f32 v171, v171, v167
  v_mfma_f32_16x16x32_bf16 v[84:87], v[28:31], a[124:127], v[84:87]
  ds_read_b128 v[28:31], v3 offset:4096
  v_mul_f32 v172, v172, v168
  v_mfma_f32_16x16x32_bf16 v[88:91], v[32:35], a[120:123], v[88:91]
  buffer_load_dwordx4 v3, s[8:11], s26 offen offset:1024 sc1 lds
  v_mfma_f32_16x16x32_bf16 v[92:95], v[32:35], a[124:127], v[92:95]
  ds_read_b128 v[32:35], v3 offset:5120
  s_waitcnt lgkmcnt(6)
  v_mfma_f32_16x16x32_bf16 v[96:99], v[36:39], a[120:123], v[96:99]
  v_mul_f32 v173, v173, v169
  v_mfma_f32_16x16x32_bf16 v[100:103], v[36:39], a[124:127], v[100:103]
  ds_read_b128 v[36:39], v3 offset:6144
  v_mfma_f32_16x16x32_bf16 v[104:107], v[40:43], a[120:123], v[104:107]
  buffer_load_dwordx4 a[68:71], v3, s[8:11], s27 offen offset:1024 sc1
  v_mfma_f32_16x16x32_bf16 v[108:111], v[40:43], a[124:127], v[108:111]
  ds_read_b128 v[40:43], v3 offset:7168
  v_mfma_f32_16x16x32_bf16 v[112:115], v[44:47], a[120:123], v[112:115]
  v_exp_f32 v170, v170
  v_mfma_f32_16x16x32_bf16 v[116:119], v[44:47], a[124:127], v[116:119]
  ds_read_b128 v[44:47], v3 offset:8192
  s_waitcnt lgkmcnt(6)
  v_mfma_f32_16x16x32_bf16 v[48:51], v[12:15], a[0:3], v[48:51]
  buffer_load_dwordx4 v3, s[8:11], s26 offen offset:2048 sc1 lds
  v_mfma_f32_16x16x32_bf16 v[52:55], v[12:15], a[4:7], v[52:55]
  ds_read_b128 v[12:15], v3 offset:9216
  v_mfma_f32_16x16x32_bf16 v[56:59], v[16:19], a[0:3], v[56:59]
  v_exp_f32 v171, v171
  v_mfma_f32_16x16x32_bf16 v[60:63], v[16:19], a[4:7], v[60:63]
  ds_read_b128 v[16:19], v3 offset:10240
  v_mfma_f32_16x16x32_bf16 v[64:67], v[20:23], a[0:3], v[64:67]
  buffer_load_dwordx4 a[72:75], v3, s[8:11], s27 offen offset:2048 sc1
  v_mfma_f32_16x16x32_bf16 v[68:71], v[20:23], a[4:7], v[68:71]
  ds_read_b128 v[20:23], v3 offset:11264
  s_waitcnt lgkmcnt(6)
  v_mfma_f32_16x16x32_bf16 v[72:75], v[24:27], a[0:3], v[72:75]
  v_exp_f32 v172, v172
  v_mfma_f32_16x16x32_bf16 v[76:79], v[24:27], a[4:7], v[76:79]
  ds_read_b128 v[24:27], v3 offset:12288
  v_mfma_f32_16x16x32_bf16 v[80:83], v[28:31], a[0:3], v[80:83]
  buffer_load_dwordx4 v3, s[8:11], s26 offen offset:3072 sc1 lds
  v_mfma_f32_16x16x32_bf16 v[84:87], v[28:31], a[4:7], v[84:87]
  ds_read_b128 v[28:31], v3 offset:13312
  v_mfma_f32_16x16x32_bf16 v[88:91], v[32:35], a[0:3], v[88:91]
  v_exp_f32 v173, v173
  v_mfma_f32_16x16x32_bf16 v[92:95], v[32:35], a[4:7], v[92:95]
  ds_read_b128 v[32:35], v3 offset:14336
  s_waitcnt lgkmcnt(6)
  v_mfma_f32_16x16x32_bf16 v[96:99], v[36:39], a[0:3], v[96:99]
  buffer_load_dwordx4 a[76:79], v3, s[8:11], s27 offen offset:3072 sc1
  v_mfma_f32_16x16x32_bf16 v[100:103], v[36:39], a[4:7], v[100:103]
  ds_read_b128 v[36:39], v3 offset:15360
  s_add_u32 m0, s31, 77824
  v_mfma_f32_16x16x32_bf16 v[104:107], v[40:43], a[0:3], v[104:107]
  s_add_u32 s26, s24, 372736
  v_add_f32 v170, 1.0, v170
  v_mfma_f32_16x16x32_bf16 v[108:111], v[40:43], a[4:7], v[108:111]
  ds_read_b128 v[40:43], v3 offset:16384
  v_add_f32 v171, 1.0, v171
  v_mfma_f32_16x16x32_bf16 v[112:115], v[44:47], a[0:3], v[112:115]
  buffer_load_dwordx4 v3, s[8:11], s26 offen sc1 lds
  v_mfma_f32_16x16x32_bf16 v[116:119], v[44:47], a[4:7], v[116:119]
  ds_read_b128 v[44:47], v3 offset:17408
  s_waitcnt lgkmcnt(6)
  v_mfma_f32_16x16x32_bf16 v[48:51], v[12:15], a[8:11], v[48:51]
  s_add_u32 s27, s25, 86016
  v_add_f32 v172, 1.0, v172
  v_mfma_f32_16x16x32_bf16 v[52:55], v[12:15], a[12:15], v[52:55]
  ds_read_b128 v[12:15], v3 offset:18432
  v_add_f32 v173, 1.0, v173
  v_mfma_f32_16x16x32_bf16 v[56:59], v[16:19], a[8:11], v[56:59]
  buffer_load_dwordx4 a[80:83], v3, s[8:11], s27 offen sc1
  v_mfma_f32_16x16x32_bf16 v[60:63], v[16:19], a[12:15], v[60:63]
  ds_read_b128 v[16:19], v3 offset:19456
  v_mfma_f32_16x16x32_bf16 v[64:67], v[20:23], a[8:11], v[64:67]
  v_rcp_f32 v170, v170
  v_mfma_f32_16x16x32_bf16 v[68:71], v[20:23], a[12:15], v[68:71]
  ds_read_b128 v[20:23], v3 offset:20480
  s_waitcnt lgkmcnt(6)
  v_mfma_f32_16x16x32_bf16 v[72:75], v[24:27], a[8:11], v[72:75]
  buffer_load_dwordx4 v3, s[8:11], s26 offen offset:1024 sc1 lds
  v_mfma_f32_16x16x32_bf16 v[76:79], v[24:27], a[12:15], v[76:79]
  ds_read_b128 v[24:27], v3 offset:21504
  v_mfma_f32_16x16x32_bf16 v[80:83], v[28:31], a[8:11], v[80:83]
  v_rcp_f32 v171, v171
  v_mfma_f32_16x16x32_bf16 v[84:87], v[28:31], a[12:15], v[84:87]
  ds_read_b128 v[28:31], v3 offset:22528
  v_mfma_f32_16x16x32_bf16 v[88:91], v[32:35], a[8:11], v[88:91]
  buffer_load_dwordx4 a[84:87], v3, s[8:11], s27 offen offset:1024 sc1
  v_mfma_f32_16x16x32_bf16 v[92:95], v[32:35], a[12:15], v[92:95]
  ds_read_b128 v[32:35], v3 offset:23552
  s_waitcnt lgkmcnt(6)
  v_mfma_f32_16x16x32_bf16 v[96:99], v[36:39], a[8:11], v[96:99]
  v_rcp_f32 v172, v172
  v_mfma_f32_16x16x32_bf16 v[100:103], v[36:39], a[12:15], v[100:103]
  ds_read_b128 v[36:39], v3 offset:24576
  v_mfma_f32_16x16x32_bf16 v[104:107], v[40:43], a[8:11], v[104:107]
  buffer_load_dwordx4 v3, s[8:11], s26 offen offset:2048 sc1 lds
  v_mfma_f32_16x16x32_bf16 v[108:111], v[40:43], a[12:15], v[108:111]
  ds_read_b128 v[40:43], v3 offset:25600
  v_mfma_f32_16x16x32_bf16 v[112:115], v[44:47], a[8:11], v[112:115]
  v_rcp_f32 v173, v173
  v_mfma_f32_16x16x32_bf16 v[116:119], v[44:47], a[12:15], v[116:119]
  ds_read_b128 v[44:47], v3 offset:26624
  s_waitcnt lgkmcnt(6)
  v_mfma_f32_16x16x32_bf16 v[48:51], v[12:15], a[16:19], v[48:51]
  buffer_load_dwordx4 a[88:91], v3, s[8:11], s27 offen offset:2048 sc1
  v_mfma_f32_16x16x32_bf16 v[52:55], v[12:15], a[20:23], v[52:55]
  ds_read_b128 v[12:15], v3 offset:27648
  v_mul_f32 v166, v166, v170
  v_mfma_f32_16x16x32_bf16 v[56:59], v[16:19], a[16:19], v[56:59]
  v_mul_f32 v167, v167, v171
  v_mul_f32 v168, v168, v172
  v_mfma_f32_16x16x32_bf16 v[60:63], v[16:19], a[20:23], v[60:63]
  ds_read_b128 v[16:19], v3 offset:28672
  v_mul_f32 v169, v169, v173
  v_mfma_f32_16x16x32_bf16 v[64:67], v[20:23], a[16:19], v[64:67]
  buffer_load_dwordx4 v3, s[8:11], s26 offen offset:3072 sc1 lds
  v_mfma_f32_16x16x32_bf16 v[68:71], v[20:23], a[20:23], v[68:71]
  ds_read_b128 v[20:23], v3 offset:29696
  s_waitcnt lgkmcnt(6)
  v_mfma_f32_16x16x32_bf16 v[72:75], v[24:27], a[16:19], v[72:75]
  v_cvt_pk_bf16_f32 v214, v166, v167
  v_cvt_pk_bf16_f32 v215, v168, v169
  v_mfma_f32_16x16x32_bf16 v[76:79], v[24:27], a[20:23], v[76:79]
  ds_read_b128 v[24:27], v3 offset:30720
  v_lshlrev_b32 v158, 16, v216
  v_mfma_f32_16x16x32_bf16 v[80:83], v[28:31], a[16:19], v[80:83]
  buffer_load_dwordx4 a[92:95], v3, s[8:11], s27 offen offset:3072 sc1
  v_mfma_f32_16x16x32_bf16 v[84:87], v[28:31], a[20:23], v[84:87]
  ds_read_b128 v[28:31], v3 offset:31744
  s_add_u32 m0, s31, 81920
  v_mfma_f32_16x16x32_bf16 v[88:91], v[32:35], a[16:19], v[88:91]
  s_add_u32 s26, s24, 376832
  v_and_b32 v159, 0xffff0000, v216
  v_mfma_f32_16x16x32_bf16 v[92:95], v[32:35], a[20:23], v[92:95]
  ds_read_b128 v[32:35], v3 offset:32768
  s_waitcnt lgkmcnt(6)
  v_mfma_f32_16x16x32_bf16 v[96:99], v[36:39], a[16:19], v[96:99]
  buffer_load_dwordx4 v3, s[8:11], s26 offen sc1 lds
  v_mfma_f32_16x16x32_bf16 v[100:103], v[36:39], a[20:23], v[100:103]
  ds_read_b128 v[36:39], v3 offset:33792
  v_lshlrev_b32 v160, 16, v217
  v_mfma_f32_16x16x32_bf16 v[104:107], v[40:43], a[16:19], v[104:107]
  v_and_b32 v161, 0xffff0000, v217
  v_mul_f32 v162, v158, v158
  v_mfma_f32_16x16x32_bf16 v[108:111], v[40:43], a[20:23], v[108:111]
  ds_read_b128 v[40:43], v3 offset:34816
  v_mul_f32 v163, v159, v159
  v_mfma_f32_16x16x32_bf16 v[112:115], v[44:47], a[16:19], v[112:115]
  v_mul_f32 v164, v160, v160
  v_mul_f32 v165, v161, v161
  v_mfma_f32_16x16x32_bf16 v[116:119], v[44:47], a[20:23], v[116:119]
  ds_read_b128 v[44:47], v3 offset:35840
  s_waitcnt vmcnt(17)
  s_barrier
  s_waitcnt lgkmcnt(6)
  v_mfma_f32_16x16x32_bf16 v[48:51], v[12:15], a[24:27], v[48:51]
  s_add_u32 m0, s31, 110592
  s_add_u32 s26, s24, 405504
  v_mfma_f32_16x16x32_bf16 v[52:55], v[12:15], a[28:31], v[52:55]
  ds_read_b128 v[12:15], v3 offset:36864
  v_fma_f32 v162, v162, s53, v178
  v_mfma_f32_16x16x32_bf16 v[56:59], v[16:19], a[24:27], v[56:59]
  buffer_load_dwordx4 v3, s[8:11], s26 offen sc1 lds
  v_mfma_f32_16x16x32_bf16 v[60:63], v[16:19], a[28:31], v[60:63]
  ds_read_b128 v[16:19], v3 offset:37888
  s_add_u32 s27, s25, 90112
  v_mfma_f32_16x16x32_bf16 v[64:67], v[20:23], a[24:27], v[64:67]
  v_fma_f32 v163, v163, s53, v178
  v_fma_f32 v164, v164, s53, v178
  v_mfma_f32_16x16x32_bf16 v[68:71], v[20:23], a[28:31], v[68:71]
  ds_read_b128 v[20:23], v3 offset:38912
  s_waitcnt lgkmcnt(6)
  v_mfma_f32_16x16x32_bf16 v[72:75], v[24:27], a[24:27], v[72:75]
  buffer_load_dwordx4 a[96:99], v3, s[8:11], s27 offen sc1
  v_mfma_f32_16x16x32_bf16 v[76:79], v[24:27], a[28:31], v[76:79]
  ds_read_b128 v[24:27], v3 offset:39936
  v_fma_f32 v165, v165, s53, v178
  v_mfma_f32_16x16x32_bf16 v[80:83], v[28:31], a[24:27], v[80:83]
  v_mul_f32 v162, v162, v158
  v_mul_f32 v163, v163, v159
  v_mfma_f32_16x16x32_bf16 v[84:87], v[28:31], a[28:31], v[84:87]
  ds_read_b128 v[28:31], v3 offset:40960
  v_mul_f32 v164, v164, v160
  v_mfma_f32_16x16x32_bf16 v[88:91], v[32:35], a[24:27], v[88:91]
  buffer_load_dwordx4 v3, s[8:11], s26 offen offset:1024 sc1 lds
  v_mfma_f32_16x16x32_bf16 v[92:95], v[32:35], a[28:31], v[92:95]
  ds_read_b128 v[32:35], v3 offset:41984
  s_waitcnt lgkmcnt(6)
  v_mfma_f32_16x16x32_bf16 v[96:99], v[36:39], a[24:27], v[96:99]
  v_mul_f32 v165, v165, v161
  v_mfma_f32_16x16x32_bf16 v[100:103], v[36:39], a[28:31], v[100:103]
  ds_read_b128 v[36:39], v3 offset:43008
  v_mfma_f32_16x16x32_bf16 v[104:107], v[40:43], a[24:27], v[104:107]
  buffer_load_dwordx4 a[100:103], v3, s[8:11], s27 offen offset:1024 sc1
  v_mfma_f32_16x16x32_bf16 v[108:111], v[40:43], a[28:31], v[108:111]
  ds_read_b128 v[40:43], v3 offset:44032
  v_mfma_f32_16x16x32_bf16 v[112:115], v[44:47], a[24:27], v[112:115]
  v_exp_f32 v162, v162
  v_mfma_f32_16x16x32_bf16 v[116:119], v[44:47], a[28:31], v[116:119]
  ds_read_b128 v[44:47], v3 offset:45056
  s_waitcnt lgkmcnt(6)
  v_mfma_f32_16x16x32_bf16 v[48:51], v[12:15], a[32:35], v[48:51]
  buffer_load_dwordx4 v3, s[8:11], s26 offen offset:2048 sc1 lds
  v_mfma_f32_16x16x32_bf16 v[52:55], v[12:15], a[36:39], v[52:55]
  ds_read_b128 v[12:15], v3 offset:46080
  v_mfma_f32_16x16x32_bf16 v[56:59], v[16:19], a[32:35], v[56:59]
  v_exp_f32 v163, v163
  v_mfma_f32_16x16x32_bf16 v[60:63], v[16:19], a[36:39], v[60:63]
  ds_read_b128 v[16:19], v3 offset:47104
  v_mfma_f32_16x16x32_bf16 v[64:67], v[20:23], a[32:35], v[64:67]
  buffer_load_dwordx4 a[104:107], v3, s[8:11], s27 offen offset:2048 sc1
  v_mfma_f32_16x16x32_bf16 v[68:71], v[20:23], a[36:39], v[68:71]
  ds_read_b128 v[20:23], v3 offset:48128
  s_waitcnt lgkmcnt(6)
  v_mfma_f32_16x16x32_bf16 v[72:75], v[24:27], a[32:35], v[72:75]
  v_exp_f32 v164, v164
  v_mfma_f32_16x16x32_bf16 v[76:79], v[24:27], a[36:39], v[76:79]
  ds_read_b128 v[24:27], v3 offset:49152
  v_mfma_f32_16x16x32_bf16 v[80:83], v[28:31], a[32:35], v[80:83]
  buffer_load_dwordx4 v3, s[8:11], s26 offen offset:3072 sc1 lds
  v_mfma_f32_16x16x32_bf16 v[84:87], v[28:31], a[36:39], v[84:87]
  ds_read_b128 v[28:31], v3 offset:50176
  v_mfma_f32_16x16x32_bf16 v[88:91], v[32:35], a[32:35], v[88:91]
  v_exp_f32 v165, v165
  v_mfma_f32_16x16x32_bf16 v[92:95], v[32:35], a[36:39], v[92:95]
  ds_read_b128 v[32:35], v3 offset:51200
  s_waitcnt lgkmcnt(6)
  v_mfma_f32_16x16x32_bf16 v[96:99], v[36:39], a[32:35], v[96:99]
  buffer_load_dwordx4 a[108:111], v3, s[8:11], s27 offen offset:3072 sc1
  v_mfma_f32_16x16x32_bf16 v[100:103], v[36:39], a[36:39], v[100:103]
  ds_read_b128 v[36:39], v3 offset:52224
  s_add_u32 m0, s31, 114688
  v_mfma_f32_16x16x32_bf16 v[104:107], v[40:43], a[32:35], v[104:107]
  s_add_u32 s26, s24, 409600
  v_add_f32 v162, 1.0, v162
  v_mfma_f32_16x16x32_bf16 v[108:111], v[40:43], a[36:39], v[108:111]
  ds_read_b128 v[40:43], v3 offset:53248
  v_add_f32 v163, 1.0, v163
  v_mfma_f32_16x16x32_bf16 v[112:115], v[44:47], a[32:35], v[112:115]
  buffer_load_dwordx4 v3, s[8:11], s26 offen sc1 lds
  v_mfma_f32_16x16x32_bf16 v[116:119], v[44:47], a[36:39], v[116:119]
  ds_read_b128 v[44:47], v3 offset:54272
  s_waitcnt lgkmcnt(6)
  v_mfma_f32_16x16x32_bf16 v[48:51], v[12:15], a[40:43], v[48:51]
  s_add_u32 s27, s25, 94208
  v_add_f32 v164, 1.0, v164
  v_mfma_f32_16x16x32_bf16 v[52:55], v[12:15], a[44:47], v[52:55]
  ds_read_b128 v[12:15], v3 offset:55296
  v_add_f32 v165, 1.0, v165
  v_mfma_f32_16x16x32_bf16 v[56:59], v[16:19], a[40:43], v[56:59]
  buffer_load_dwordx4 a[112:115], v3, s[8:11], s27 offen sc1
  v_mfma_f32_16x16x32_bf16 v[60:63], v[16:19], a[44:47], v[60:63]
  ds_read_b128 v[16:19], v3 offset:56320
  v_mfma_f32_16x16x32_bf16 v[64:67], v[20:23], a[40:43], v[64:67]
  v_rcp_f32 v162, v162
  v_mfma_f32_16x16x32_bf16 v[68:71], v[20:23], a[44:47], v[68:71]
  ds_read_b128 v[20:23], v3 offset:57344
  s_waitcnt lgkmcnt(6)
  v_mfma_f32_16x16x32_bf16 v[72:75], v[24:27], a[40:43], v[72:75]
  buffer_load_dwordx4 v3, s[8:11], s26 offen offset:1024 sc1 lds
  v_mfma_f32_16x16x32_bf16 v[76:79], v[24:27], a[44:47], v[76:79]
  ds_read_b128 v[24:27], v3 offset:58368
  v_mfma_f32_16x16x32_bf16 v[80:83], v[28:31], a[40:43], v[80:83]
  v_rcp_f32 v163, v163
  v_mfma_f32_16x16x32_bf16 v[84:87], v[28:31], a[44:47], v[84:87]
  ds_read_b128 v[28:31], v3 offset:59392
  v_mfma_f32_16x16x32_bf16 v[88:91], v[32:35], a[40:43], v[88:91]
  buffer_load_dwordx4 a[116:119], v3, s[8:11], s27 offen offset:1024 sc1
  v_mfma_f32_16x16x32_bf16 v[92:95], v[32:35], a[44:47], v[92:95]
  ds_read_b128 v[32:35], v3 offset:60416
  s_waitcnt lgkmcnt(6)
  v_mfma_f32_16x16x32_bf16 v[96:99], v[36:39], a[40:43], v[96:99]
  v_rcp_f32 v164, v164
  v_mfma_f32_16x16x32_bf16 v[100:103], v[36:39], a[44:47], v[100:103]
  ds_read_b128 v[36:39], v3 offset:61440
  v_mfma_f32_16x16x32_bf16 v[104:107], v[40:43], a[40:43], v[104:107]
  buffer_load_dwordx4 v3, s[8:11], s26 offen offset:2048 sc1 lds
  v_mfma_f32_16x16x32_bf16 v[108:111], v[40:43], a[44:47], v[108:111]
  ds_read_b128 v[40:43], v3 offset:62464
  v_mfma_f32_16x16x32_bf16 v[112:115], v[44:47], a[40:43], v[112:115]
  v_rcp_f32 v165, v165
  v_mfma_f32_16x16x32_bf16 v[116:119], v[44:47], a[44:47], v[116:119]
  ds_read_b128 v[44:47], v3 offset:63488
  s_waitcnt lgkmcnt(6)
  v_mfma_f32_16x16x32_bf16 v[48:51], v[12:15], a[48:51], v[48:51]
  buffer_load_dwordx4 a[120:123], v3, s[8:11], s27 offen offset:2048 sc1
  v_mfma_f32_16x16x32_bf16 v[52:55], v[12:15], a[52:55], v[52:55]
  ds_read_b128 v[12:15], v3 offset:64512
  v_mul_f32 v158, v158, v162
  v_mfma_f32_16x16x32_bf16 v[56:59], v[16:19], a[48:51], v[56:59]
  v_mul_f32 v159, v159, v163
  v_mul_f32 v160, v160, v164
  v_mfma_f32_16x16x32_bf16 v[60:63], v[16:19], a[52:55], v[60:63]
  ds_read_b128 v[16:19], v4 offset:0
  v_mul_f32 v161, v161, v165
  v_mfma_f32_16x16x32_bf16 v[64:67], v[20:23], a[48:51], v[64:67]
  buffer_load_dwordx4 v3, s[8:11], s26 offen offset:3072 sc1 lds
  v_mfma_f32_16x16x32_bf16 v[68:71], v[20:23], a[52:55], v[68:71]
  ds_read_b128 v[20:23], v4 offset:1024
  s_waitcnt lgkmcnt(6)
  v_mfma_f32_16x16x32_bf16 v[72:75], v[24:27], a[48:51], v[72:75]
  v_cvt_pk_bf16_f32 v216, v158, v159
  v_cvt_pk_bf16_f32 v217, v160, v161
  v_mfma_f32_16x16x32_bf16 v[76:79], v[24:27], a[52:55], v[76:79]
  ds_read_b128 v[24:27], v4 offset:2048
  v_lshlrev_b32 v166, 16, v218
  v_mfma_f32_16x16x32_bf16 v[80:83], v[28:31], a[48:51], v[80:83]
  buffer_load_dwordx4 a[124:127], v3, s[8:11], s27 offen offset:3072 sc1
  v_mfma_f32_16x16x32_bf16 v[84:87], v[28:31], a[52:55], v[84:87]
  ds_read_b128 v[28:31], v4 offset:3072
  s_add_u32 m0, s31, 118784
  v_mfma_f32_16x16x32_bf16 v[88:91], v[32:35], a[48:51], v[88:91]
  s_add_u32 s26, s24, 413696
  v_and_b32 v167, 0xffff0000, v218
  v_mfma_f32_16x16x32_bf16 v[92:95], v[32:35], a[52:55], v[92:95]
  ds_read_b128 v[32:35], v4 offset:4096
  s_waitcnt lgkmcnt(6)
  v_mfma_f32_16x16x32_bf16 v[96:99], v[36:39], a[48:51], v[96:99]
  buffer_load_dwordx4 v3, s[8:11], s26 offen sc1 lds
  v_mfma_f32_16x16x32_bf16 v[100:103], v[36:39], a[52:55], v[100:103]
  ds_read_b128 v[36:39], v4 offset:5120
  v_lshlrev_b32 v168, 16, v219
  v_mfma_f32_16x16x32_bf16 v[104:107], v[40:43], a[48:51], v[104:107]
  v_and_b32 v169, 0xffff0000, v219
  v_mul_f32 v170, v166, v166
  v_mfma_f32_16x16x32_bf16 v[108:111], v[40:43], a[52:55], v[108:111]
  ds_read_b128 v[40:43], v4 offset:6144
  v_mul_f32 v171, v167, v167
  v_mfma_f32_16x16x32_bf16 v[112:115], v[44:47], a[48:51], v[112:115]
  v_mul_f32 v172, v168, v168
  v_mul_f32 v173, v169, v169
  v_mfma_f32_16x16x32_bf16 v[116:119], v[44:47], a[52:55], v[116:119]
  ds_read_b128 v[44:47], v4 offset:7168
  s_waitcnt vmcnt(17)
  s_barrier
  s_waitcnt lgkmcnt(6)
  v_mfma_f32_16x16x32_bf16 v[48:51], v[12:15], a[56:59], v[48:51]
  s_add_u32 m0, s31, 0
  s_add_u32 s26, s24, 442368
  v_mfma_f32_16x16x32_bf16 v[52:55], v[12:15], a[60:63], v[52:55]
  ds_read_b128 v[12:15], v4 offset:8192
  v_fma_f32 v170, v170, s53, v178
  v_mfma_f32_16x16x32_bf16 v[56:59], v[16:19], a[56:59], v[56:59]
  buffer_load_dwordx4 v3, s[8:11], s26 offen sc1 lds
  v_mfma_f32_16x16x32_bf16 v[60:63], v[16:19], a[60:63], v[60:63]
  ds_read_b128 v[16:19], v4 offset:9216
  s_add_u32 s27, s25, 98304
  v_mfma_f32_16x16x32_bf16 v[64:67], v[20:23], a[56:59], v[64:67]
  v_fma_f32 v171, v171, s53, v178
  v_fma_f32 v172, v172, s53, v178
  v_mfma_f32_16x16x32_bf16 v[68:71], v[20:23], a[60:63], v[68:71]
  ds_read_b128 v[20:23], v4 offset:10240
  s_waitcnt lgkmcnt(6)
  v_mfma_f32_16x16x32_bf16 v[72:75], v[24:27], a[56:59], v[72:75]
  buffer_load_dwordx4 a[0:3], v3, s[8:11], s27 offen sc1
  v_mfma_f32_16x16x32_bf16 v[76:79], v[24:27], a[60:63], v[76:79]
  ds_read_b128 v[24:27], v4 offset:11264
  v_fma_f32 v173, v173, s53, v178
  v_mfma_f32_16x16x32_bf16 v[80:83], v[28:31], a[56:59], v[80:83]
  v_mul_f32 v170, v170, v166
  v_mul_f32 v171, v171, v167
  v_mfma_f32_16x16x32_bf16 v[84:87], v[28:31], a[60:63], v[84:87]
  ds_read_b128 v[28:31], v4 offset:12288
  v_mul_f32 v172, v172, v168
  v_mfma_f32_16x16x32_bf16 v[88:91], v[32:35], a[56:59], v[88:91]
  buffer_load_dwordx4 v3, s[8:11], s26 offen offset:1024 sc1 lds
  v_mfma_f32_16x16x32_bf16 v[92:95], v[32:35], a[60:63], v[92:95]
  ds_read_b128 v[32:35], v4 offset:13312
  s_waitcnt lgkmcnt(6)
  v_mfma_f32_16x16x32_bf16 v[96:99], v[36:39], a[56:59], v[96:99]
  v_mul_f32 v173, v173, v169
  v_mfma_f32_16x16x32_bf16 v[100:103], v[36:39], a[60:63], v[100:103]
  ds_read_b128 v[36:39], v4 offset:14336
  v_mfma_f32_16x16x32_bf16 v[104:107], v[40:43], a[56:59], v[104:107]
  buffer_load_dwordx4 a[4:7], v3, s[8:11], s27 offen offset:1024 sc1
  v_mfma_f32_16x16x32_bf16 v[108:111], v[40:43], a[60:63], v[108:111]
  ds_read_b128 v[40:43], v4 offset:15360
  v_mfma_f32_16x16x32_bf16 v[112:115], v[44:47], a[56:59], v[112:115]
  v_exp_f32 v170, v170
  v_mfma_f32_16x16x32_bf16 v[116:119], v[44:47], a[60:63], v[116:119]
  ds_read_b128 v[44:47], v4 offset:16384
  s_waitcnt lgkmcnt(6)
  v_mfma_f32_16x16x32_bf16 v[48:51], v[12:15], a[64:67], v[48:51]
  buffer_load_dwordx4 v3, s[8:11], s26 offen offset:2048 sc1 lds
  v_mfma_f32_16x16x32_bf16 v[52:55], v[12:15], a[68:71], v[52:55]
  ds_read_b128 v[12:15], v4 offset:17408
  v_mfma_f32_16x16x32_bf16 v[56:59], v[16:19], a[64:67], v[56:59]
  v_exp_f32 v171, v171
  v_mfma_f32_16x16x32_bf16 v[60:63], v[16:19], a[68:71], v[60:63]
  ds_read_b128 v[16:19], v4 offset:18432
  v_mfma_f32_16x16x32_bf16 v[64:67], v[20:23], a[64:67], v[64:67]
  buffer_load_dwordx4 a[8:11], v3, s[8:11], s27 offen offset:2048 sc1
  v_mfma_f32_16x16x32_bf16 v[68:71], v[20:23], a[68:71], v[68:71]
  ds_read_b128 v[20:23], v4 offset:19456
  s_waitcnt lgkmcnt(6)
  v_mfma_f32_16x16x32_bf16 v[72:75], v[24:27], a[64:67], v[72:75]
  v_exp_f32 v172, v172
  v_mfma_f32_16x16x32_bf16 v[76:79], v[24:27], a[68:71], v[76:79]
  ds_read_b128 v[24:27], v4 offset:20480
  v_mfma_f32_16x16x32_bf16 v[80:83], v[28:31], a[64:67], v[80:83]
  buffer_load_dwordx4 v3, s[8:11], s26 offen offset:3072 sc1 lds
  v_mfma_f32_16x16x32_bf16 v[84:87], v[28:31], a[68:71], v[84:87]
  ds_read_b128 v[28:31], v4 offset:21504
  v_mfma_f32_16x16x32_bf16 v[88:91], v[32:35], a[64:67], v[88:91]
  v_exp_f32 v173, v173
  v_mfma_f32_16x16x32_bf16 v[92:95], v[32:35], a[68:71], v[92:95]
  ds_read_b128 v[32:35], v4 offset:22528
  s_waitcnt lgkmcnt(6)
  v_mfma_f32_16x16x32_bf16 v[96:99], v[36:39], a[64:67], v[96:99]
  buffer_load_dwordx4 a[12:15], v3, s[8:11], s27 offen offset:3072 sc1
  v_mfma_f32_16x16x32_bf16 v[100:103], v[36:39], a[68:71], v[100:103]
  ds_read_b128 v[36:39], v4 offset:23552
  s_add_u32 m0, s31, 4096
  v_mfma_f32_16x16x32_bf16 v[104:107], v[40:43], a[64:67], v[104:107]
  s_add_u32 s26, s24, 446464
  v_add_f32 v170, 1.0, v170
  v_mfma_f32_16x16x32_bf16 v[108:111], v[40:43], a[68:71], v[108:111]
  ds_read_b128 v[40:43], v4 offset:24576
  v_add_f32 v171, 1.0, v171
  v_mfma_f32_16x16x32_bf16 v[112:115], v[44:47], a[64:67], v[112:115]
  buffer_load_dwordx4 v3, s[8:11], s26 offen sc1 lds
  v_mfma_f32_16x16x32_bf16 v[116:119], v[44:47], a[68:71], v[116:119]
  ds_read_b128 v[44:47], v4 offset:25600
  s_waitcnt lgkmcnt(6)
  v_mfma_f32_16x16x32_bf16 v[48:51], v[12:15], a[72:75], v[48:51]
  s_add_u32 s27, s25, 102400
  v_add_f32 v172, 1.0, v172
  v_mfma_f32_16x16x32_bf16 v[52:55], v[12:15], a[76:79], v[52:55]
  ds_read_b128 v[12:15], v4 offset:26624
  v_add_f32 v173, 1.0, v173
  v_mfma_f32_16x16x32_bf16 v[56:59], v[16:19], a[72:75], v[56:59]
  buffer_load_dwordx4 a[16:19], v3, s[8:11], s27 offen sc1
  v_mfma_f32_16x16x32_bf16 v[60:63], v[16:19], a[76:79], v[60:63]
  ds_read_b128 v[16:19], v4 offset:27648
  v_mfma_f32_16x16x32_bf16 v[64:67], v[20:23], a[72:75], v[64:67]
  v_rcp_f32 v170, v170
  v_mfma_f32_16x16x32_bf16 v[68:71], v[20:23], a[76:79], v[68:71]
  ds_read_b128 v[20:23], v4 offset:28672
  s_waitcnt lgkmcnt(6)
  v_mfma_f32_16x16x32_bf16 v[72:75], v[24:27], a[72:75], v[72:75]
  buffer_load_dwordx4 v3, s[8:11], s26 offen offset:1024 sc1 lds
  v_mfma_f32_16x16x32_bf16 v[76:79], v[24:27], a[76:79], v[76:79]
  ds_read_b128 v[24:27], v4 offset:29696
  v_mfma_f32_16x16x32_bf16 v[80:83], v[28:31], a[72:75], v[80:83]
  v_rcp_f32 v171, v171
  v_mfma_f32_16x16x32_bf16 v[84:87], v[28:31], a[76:79], v[84:87]
  ds_read_b128 v[28:31], v4 offset:30720
  v_mfma_f32_16x16x32_bf16 v[88:91], v[32:35], a[72:75], v[88:91]
  buffer_load_dwordx4 a[20:23], v3, s[8:11], s27 offen offset:1024 sc1
  v_mfma_f32_16x16x32_bf16 v[92:95], v[32:35], a[76:79], v[92:95]
  ds_read_b128 v[32:35], v4 offset:31744
  s_waitcnt lgkmcnt(6)
  v_mfma_f32_16x16x32_bf16 v[96:99], v[36:39], a[72:75], v[96:99]
  v_rcp_f32 v172, v172
  v_mfma_f32_16x16x32_bf16 v[100:103], v[36:39], a[76:79], v[100:103]
  ds_read_b128 v[36:39], v4 offset:32768
  v_mfma_f32_16x16x32_bf16 v[104:107], v[40:43], a[72:75], v[104:107]
  buffer_load_dwordx4 v3, s[8:11], s26 offen offset:2048 sc1 lds
  v_mfma_f32_16x16x32_bf16 v[108:111], v[40:43], a[76:79], v[108:111]
  ds_read_b128 v[40:43], v4 offset:33792
  v_mfma_f32_16x16x32_bf16 v[112:115], v[44:47], a[72:75], v[112:115]
  v_rcp_f32 v173, v173
  v_mfma_f32_16x16x32_bf16 v[116:119], v[44:47], a[76:79], v[116:119]
  ds_read_b128 v[44:47], v4 offset:34816
  s_waitcnt lgkmcnt(6)
  v_mfma_f32_16x16x32_bf16 v[48:51], v[12:15], a[80:83], v[48:51]
  buffer_load_dwordx4 a[24:27], v3, s[8:11], s27 offen offset:2048 sc1
  v_mfma_f32_16x16x32_bf16 v[52:55], v[12:15], a[84:87], v[52:55]
  ds_read_b128 v[12:15], v4 offset:35840
  v_mul_f32 v166, v166, v170
  v_mfma_f32_16x16x32_bf16 v[56:59], v[16:19], a[80:83], v[56:59]
  v_mul_f32 v167, v167, v171
  v_mul_f32 v168, v168, v172
  v_mfma_f32_16x16x32_bf16 v[60:63], v[16:19], a[84:87], v[60:63]
  ds_read_b128 v[16:19], v4 offset:36864
  v_mul_f32 v169, v169, v173
  v_mfma_f32_16x16x32_bf16 v[64:67], v[20:23], a[80:83], v[64:67]
  buffer_load_dwordx4 v3, s[8:11], s26 offen offset:3072 sc1 lds
  v_mfma_f32_16x16x32_bf16 v[68:71], v[20:23], a[84:87], v[68:71]
  ds_read_b128 v[20:23], v4 offset:37888
  s_waitcnt lgkmcnt(6)
  v_mfma_f32_16x16x32_bf16 v[72:75], v[24:27], a[80:83], v[72:75]
  v_cvt_pk_bf16_f32 v218, v166, v167
  v_cvt_pk_bf16_f32 v219, v168, v169
  v_mfma_f32_16x16x32_bf16 v[76:79], v[24:27], a[84:87], v[76:79]
  ds_read_b128 v[24:27], v4 offset:38912
  v_lshlrev_b32 v158, 16, v220
  v_mfma_f32_16x16x32_bf16 v[80:83], v[28:31], a[80:83], v[80:83]
  buffer_load_dwordx4 a[28:31], v3, s[8:11], s27 offen offset:3072 sc1
  v_mfma_f32_16x16x32_bf16 v[84:87], v[28:31], a[84:87], v[84:87]
  ds_read_b128 v[28:31], v4 offset:39936
  s_add_u32 m0, s31, 8192
  v_mfma_f32_16x16x32_bf16 v[88:91], v[32:35], a[80:83], v[88:91]
  s_add_u32 s26, s24, 450560
  v_and_b32 v159, 0xffff0000, v220
  v_mfma_f32_16x16x32_bf16 v[92:95], v[32:35], a[84:87], v[92:95]
  ds_read_b128 v[32:35], v4 offset:40960
  s_waitcnt lgkmcnt(6)
  v_mfma_f32_16x16x32_bf16 v[96:99], v[36:39], a[80:83], v[96:99]
  buffer_load_dwordx4 v3, s[8:11], s26 offen sc1 lds
  v_mfma_f32_16x16x32_bf16 v[100:103], v[36:39], a[84:87], v[100:103]
  ds_read_b128 v[36:39], v4 offset:41984
  v_lshlrev_b32 v160, 16, v221
  v_mfma_f32_16x16x32_bf16 v[104:107], v[40:43], a[80:83], v[104:107]
  v_and_b32 v161, 0xffff0000, v221
  v_mul_f32 v162, v158, v158
  v_mfma_f32_16x16x32_bf16 v[108:111], v[40:43], a[84:87], v[108:111]
  ds_read_b128 v[40:43], v4 offset:43008
  v_mul_f32 v163, v159, v159
  v_mfma_f32_16x16x32_bf16 v[112:115], v[44:47], a[80:83], v[112:115]
  v_mul_f32 v164, v160, v160
  v_mul_f32 v165, v161, v161
  v_mfma_f32_16x16x32_bf16 v[116:119], v[44:47], a[84:87], v[116:119]
  ds_read_b128 v[44:47], v4 offset:44032
  s_waitcnt vmcnt(17)
  s_barrier
  s_waitcnt lgkmcnt(6)
  v_mfma_f32_16x16x32_bf16 v[48:51], v[12:15], a[88:91], v[48:51]
  s_add_u32 m0, s31, 36864
  s_add_u32 s26, s24, 479232
  v_mfma_f32_16x16x32_bf16 v[52:55], v[12:15], a[92:95], v[52:55]
  ds_read_b128 v[12:15], v4 offset:45056
  v_fma_f32 v162, v162, s53, v178
  v_mfma_f32_16x16x32_bf16 v[56:59], v[16:19], a[88:91], v[56:59]
  buffer_load_dwordx4 v3, s[8:11], s26 offen sc1 lds
  v_mfma_f32_16x16x32_bf16 v[60:63], v[16:19], a[92:95], v[60:63]
  ds_read_b128 v[16:19], v4 offset:46080
  s_add_u32 s27, s25, 106496
  v_mfma_f32_16x16x32_bf16 v[64:67], v[20:23], a[88:91], v[64:67]
  v_fma_f32 v163, v163, s53, v178
  v_fma_f32 v164, v164, s53, v178
  v_mfma_f32_16x16x32_bf16 v[68:71], v[20:23], a[92:95], v[68:71]
  ds_read_b128 v[20:23], v4 offset:47104
  s_waitcnt lgkmcnt(6)
  v_mfma_f32_16x16x32_bf16 v[72:75], v[24:27], a[88:91], v[72:75]
  buffer_load_dwordx4 a[32:35], v3, s[8:11], s27 offen sc1
  v_mfma_f32_16x16x32_bf16 v[76:79], v[24:27], a[92:95], v[76:79]
  ds_read_b128 v[24:27], v4 offset:48128
  v_fma_f32 v165, v165, s53, v178
  v_mfma_f32_16x16x32_bf16 v[80:83], v[28:31], a[88:91], v[80:83]
  v_mul_f32 v162, v162, v158
  v_mul_f32 v163, v163, v159
  v_mfma_f32_16x16x32_bf16 v[84:87], v[28:31], a[92:95], v[84:87]
  ds_read_b128 v[28:31], v4 offset:49152
  v_mul_f32 v164, v164, v160
  v_mfma_f32_16x16x32_bf16 v[88:91], v[32:35], a[88:91], v[88:91]
  buffer_load_dwordx4 v3, s[8:11], s26 offen offset:1024 sc1 lds
  v_mfma_f32_16x16x32_bf16 v[92:95], v[32:35], a[92:95], v[92:95]
  ds_read_b128 v[32:35], v4 offset:50176
  s_waitcnt lgkmcnt(6)
  v_mfma_f32_16x16x32_bf16 v[96:99], v[36:39], a[88:91], v[96:99]
  v_mul_f32 v165, v165, v161
  v_mfma_f32_16x16x32_bf16 v[100:103], v[36:39], a[92:95], v[100:103]
  ds_read_b128 v[36:39], v4 offset:51200
  v_mfma_f32_16x16x32_bf16 v[104:107], v[40:43], a[88:91], v[104:107]
  buffer_load_dwordx4 a[36:39], v3, s[8:11], s27 offen offset:1024 sc1
  v_mfma_f32_16x16x32_bf16 v[108:111], v[40:43], a[92:95], v[108:111]
  ds_read_b128 v[40:43], v4 offset:52224
  v_mfma_f32_16x16x32_bf16 v[112:115], v[44:47], a[88:91], v[112:115]
  v_exp_f32 v162, v162
  v_mfma_f32_16x16x32_bf16 v[116:119], v[44:47], a[92:95], v[116:119]
  ds_read_b128 v[44:47], v4 offset:53248
  s_waitcnt lgkmcnt(6)
  v_mfma_f32_16x16x32_bf16 v[48:51], v[12:15], a[96:99], v[48:51]
  buffer_load_dwordx4 v3, s[8:11], s26 offen offset:2048 sc1 lds
  v_mfma_f32_16x16x32_bf16 v[52:55], v[12:15], a[100:103], v[52:55]
  ds_read_b128 v[12:15], v4 offset:54272
  v_mfma_f32_16x16x32_bf16 v[56:59], v[16:19], a[96:99], v[56:59]
  v_exp_f32 v163, v163
  v_mfma_f32_16x16x32_bf16 v[60:63], v[16:19], a[100:103], v[60:63]
  ds_read_b128 v[16:19], v4 offset:55296
  v_mfma_f32_16x16x32_bf16 v[64:67], v[20:23], a[96:99], v[64:67]
  buffer_load_dwordx4 a[40:43], v3, s[8:11], s27 offen offset:2048 sc1
  v_mfma_f32_16x16x32_bf16 v[68:71], v[20:23], a[100:103], v[68:71]
  ds_read_b128 v[20:23], v4 offset:56320
  s_waitcnt lgkmcnt(6)
  v_mfma_f32_16x16x32_bf16 v[72:75], v[24:27], a[96:99], v[72:75]
  v_exp_f32 v164, v164
  v_mfma_f32_16x16x32_bf16 v[76:79], v[24:27], a[100:103], v[76:79]
  ds_read_b128 v[24:27], v4 offset:57344
  v_mfma_f32_16x16x32_bf16 v[80:83], v[28:31], a[96:99], v[80:83]
  buffer_load_dwordx4 v3, s[8:11], s26 offen offset:3072 sc1 lds
  v_mfma_f32_16x16x32_bf16 v[84:87], v[28:31], a[100:103], v[84:87]
  ds_read_b128 v[28:31], v4 offset:58368
  v_mfma_f32_16x16x32_bf16 v[88:91], v[32:35], a[96:99], v[88:91]
  v_exp_f32 v165, v165
  v_mfma_f32_16x16x32_bf16 v[92:95], v[32:35], a[100:103], v[92:95]
  ds_read_b128 v[32:35], v4 offset:59392
  s_waitcnt lgkmcnt(6)
  v_mfma_f32_16x16x32_bf16 v[96:99], v[36:39], a[96:99], v[96:99]
  buffer_load_dwordx4 a[44:47], v3, s[8:11], s27 offen offset:3072 sc1
  v_mfma_f32_16x16x32_bf16 v[100:103], v[36:39], a[100:103], v[100:103]
  ds_read_b128 v[36:39], v4 offset:60416
  s_add_u32 m0, s31, 40960
  v_mfma_f32_16x16x32_bf16 v[104:107], v[40:43], a[96:99], v[104:107]
  s_add_u32 s26, s24, 483328
  v_add_f32 v162, 1.0, v162
  v_mfma_f32_16x16x32_bf16 v[108:111], v[40:43], a[100:103], v[108:111]
  ds_read_b128 v[40:43], v4 offset:61440
  v_add_f32 v163, 1.0, v163
  v_mfma_f32_16x16x32_bf16 v[112:115], v[44:47], a[96:99], v[112:115]
  buffer_load_dwordx4 v3, s[8:11], s26 offen sc1 lds
  v_mfma_f32_16x16x32_bf16 v[116:119], v[44:47], a[100:103], v[116:119]
  ds_read_b128 v[44:47], v4 offset:62464
  s_waitcnt lgkmcnt(6)
  v_mfma_f32_16x16x32_bf16 v[48:51], v[12:15], a[104:107], v[48:51]
  s_add_u32 s27, s25, 110592
  v_add_f32 v164, 1.0, v164
  v_mfma_f32_16x16x32_bf16 v[52:55], v[12:15], a[108:111], v[52:55]
  ds_read_b128 v[12:15], v4 offset:63488
  v_add_f32 v165, 1.0, v165
  v_mfma_f32_16x16x32_bf16 v[56:59], v[16:19], a[104:107], v[56:59]
  buffer_load_dwordx4 a[48:51], v3, s[8:11], s27 offen sc1
  v_mfma_f32_16x16x32_bf16 v[60:63], v[16:19], a[108:111], v[60:63]
  ds_read_b128 v[16:19], v4 offset:64512
  v_mfma_f32_16x16x32_bf16 v[64:67], v[20:23], a[104:107], v[64:67]
  v_rcp_f32 v162, v162
  v_mfma_f32_16x16x32_bf16 v[68:71], v[20:23], a[108:111], v[68:71]
  ds_read_b128 v[20:23], v5 offset:0
  s_waitcnt lgkmcnt(6)
  v_mfma_f32_16x16x32_bf16 v[72:75], v[24:27], a[104:107], v[72:75]
  buffer_load_dwordx4 v3, s[8:11], s26 offen offset:1024 sc1 lds
  v_mfma_f32_16x16x32_bf16 v[76:79], v[24:27], a[108:111], v[76:79]
  ds_read_b128 v[24:27], v5 offset:1024
  v_mfma_f32_16x16x32_bf16 v[80:83], v[28:31], a[104:107], v[80:83]
  v_rcp_f32 v163, v163
  v_mfma_f32_16x16x32_bf16 v[84:87], v[28:31], a[108:111], v[84:87]
  ds_read_b128 v[28:31], v5 offset:2048
  v_mfma_f32_16x16x32_bf16 v[88:91], v[32:35], a[104:107], v[88:91]
  buffer_load_dwordx4 a[52:55], v3, s[8:11], s27 offen offset:1024 sc1
  v_mfma_f32_16x16x32_bf16 v[92:95], v[32:35], a[108:111], v[92:95]
  ds_read_b128 v[32:35], v5 offset:3072
  s_waitcnt lgkmcnt(6)
  v_mfma_f32_16x16x32_bf16 v[96:99], v[36:39], a[104:107], v[96:99]
  v_rcp_f32 v164, v164
  v_mfma_f32_16x16x32_bf16 v[100:103], v[36:39], a[108:111], v[100:103]
  ds_read_b128 v[36:39], v5 offset:4096
  v_mfma_f32_16x16x32_bf16 v[104:107], v[40:43], a[104:107], v[104:107]
  buffer_load_dwordx4 v3, s[8:11], s26 offen offset:2048 sc1 lds
  v_mfma_f32_16x16x32_bf16 v[108:111], v[40:43], a[108:111], v[108:111]
  ds_read_b128 v[40:43], v5 offset:5120
  v_mfma_f32_16x16x32_bf16 v[112:115], v[44:47], a[104:107], v[112:115]
  v_rcp_f32 v165, v165
  v_mfma_f32_16x16x32_bf16 v[116:119], v[44:47], a[108:111], v[116:119]
  ds_read_b128 v[44:47], v5 offset:6144
  s_waitcnt lgkmcnt(6)
  v_mfma_f32_16x16x32_bf16 v[48:51], v[12:15], a[112:115], v[48:51]
  buffer_load_dwordx4 a[56:59], v3, s[8:11], s27 offen offset:2048 sc1
  v_mfma_f32_16x16x32_bf16 v[52:55], v[12:15], a[116:119], v[52:55]
  ds_read_b128 v[12:15], v5 offset:7168
  v_mul_f32 v158, v158, v162
  v_mfma_f32_16x16x32_bf16 v[56:59], v[16:19], a[112:115], v[56:59]
  v_mul_f32 v159, v159, v163
  v_mul_f32 v160, v160, v164
  v_mfma_f32_16x16x32_bf16 v[60:63], v[16:19], a[116:119], v[60:63]
  ds_read_b128 v[16:19], v5 offset:8192
  v_mul_f32 v161, v161, v165
  v_mfma_f32_16x16x32_bf16 v[64:67], v[20:23], a[112:115], v[64:67]
  buffer_load_dwordx4 v3, s[8:11], s26 offen offset:3072 sc1 lds
  v_mfma_f32_16x16x32_bf16 v[68:71], v[20:23], a[116:119], v[68:71]
  ds_read_b128 v[20:23], v5 offset:9216
  s_waitcnt lgkmcnt(6)
  v_mfma_f32_16x16x32_bf16 v[72:75], v[24:27], a[112:115], v[72:75]
  v_cvt_pk_bf16_f32 v220, v158, v159
  v_cvt_pk_bf16_f32 v221, v160, v161
  v_mfma_f32_16x16x32_bf16 v[76:79], v[24:27], a[116:119], v[76:79]
  ds_read_b128 v[24:27], v5 offset:10240
  v_lshlrev_b32 v166, 16, v222
  v_mfma_f32_16x16x32_bf16 v[80:83], v[28:31], a[112:115], v[80:83]
  buffer_load_dwordx4 a[60:63], v3, s[8:11], s27 offen offset:3072 sc1
  v_mfma_f32_16x16x32_bf16 v[84:87], v[28:31], a[116:119], v[84:87]
  ds_read_b128 v[28:31], v5 offset:11264
  s_add_u32 m0, s31, 45056
  v_mfma_f32_16x16x32_bf16 v[88:91], v[32:35], a[112:115], v[88:91]
  s_add_u32 s26, s24, 487424
  v_and_b32 v167, 0xffff0000, v222
  v_mfma_f32_16x16x32_bf16 v[92:95], v[32:35], a[116:119], v[92:95]
  ds_read_b128 v[32:35], v5 offset:12288
  s_waitcnt lgkmcnt(6)
  v_mfma_f32_16x16x32_bf16 v[96:99], v[36:39], a[112:115], v[96:99]
  buffer_load_dwordx4 v3, s[8:11], s26 offen sc1 lds
  v_mfma_f32_16x16x32_bf16 v[100:103], v[36:39], a[116:119], v[100:103]
  ds_read_b128 v[36:39], v5 offset:13312
  v_lshlrev_b32 v168, 16, v223
  v_mfma_f32_16x16x32_bf16 v[104:107], v[40:43], a[112:115], v[104:107]
  v_and_b32 v169, 0xffff0000, v223
  v_mul_f32 v170, v166, v166
  v_mfma_f32_16x16x32_bf16 v[108:111], v[40:43], a[116:119], v[108:111]
  ds_read_b128 v[40:43], v5 offset:14336
  v_mul_f32 v171, v167, v167
  v_mfma_f32_16x16x32_bf16 v[112:115], v[44:47], a[112:115], v[112:115]
  v_mul_f32 v172, v168, v168
  v_mul_f32 v173, v169, v169
  v_mfma_f32_16x16x32_bf16 v[116:119], v[44:47], a[116:119], v[116:119]
  ds_read_b128 v[44:47], v5 offset:15360
  s_waitcnt vmcnt(17)
  s_barrier
  s_waitcnt lgkmcnt(6)
  v_mfma_f32_16x16x32_bf16 v[48:51], v[12:15], a[120:123], v[48:51]
  s_add_u32 m0, s31, 73728
  s_add_u32 s26, s24, 516096
  v_mfma_f32_16x16x32_bf16 v[52:55], v[12:15], a[124:127], v[52:55]
  ds_read_b128 v[12:15], v3 offset:0
  v_fma_f32 v170, v170, s53, v178
  v_mfma_f32_16x16x32_bf16 v[56:59], v[16:19], a[120:123], v[56:59]
  buffer_load_dwordx4 v3, s[8:11], s26 offen sc1 lds
  v_mfma_f32_16x16x32_bf16 v[60:63], v[16:19], a[124:127], v[60:63]
  ds_read_b128 v[16:19], v3 offset:1024
  s_add_u32 s27, s25, 114688
  v_mfma_f32_16x16x32_bf16 v[64:67], v[20:23], a[120:123], v[64:67]
  v_fma_f32 v171, v171, s53, v178
  v_fma_f32 v172, v172, s53, v178
  v_mfma_f32_16x16x32_bf16 v[68:71], v[20:23], a[124:127], v[68:71]
  ds_read_b128 v[20:23], v3 offset:2048
  s_waitcnt lgkmcnt(6)
  v_mfma_f32_16x16x32_bf16 v[72:75], v[24:27], a[120:123], v[72:75]
  buffer_load_dwordx4 a[64:67], v3, s[8:11], s27 offen sc1
  v_mfma_f32_16x16x32_bf16 v[76:79], v[24:27], a[124:127], v[76:79]
  ds_read_b128 v[24:27], v3 offset:3072
  v_fma_f32 v173, v173, s53, v178
  v_mfma_f32_16x16x32_bf16 v[80:83], v[28:31], a[120:123], v[80:83]
  v_mul_f32 v170, v170, v166
  v_mul_f32 v171, v171, v167
  v_mfma_f32_16x16x32_bf16 v[84:87], v[28:31], a[124:127], v[84:87]
  ds_read_b128 v[28:31], v3 offset:4096
  v_mul_f32 v172, v172, v168
  v_mfma_f32_16x16x32_bf16 v[88:91], v[32:35], a[120:123], v[88:91]
  buffer_load_dwordx4 v3, s[8:11], s26 offen offset:1024 sc1 lds
  v_mfma_f32_16x16x32_bf16 v[92:95], v[32:35], a[124:127], v[92:95]
  ds_read_b128 v[32:35], v3 offset:5120
  s_waitcnt lgkmcnt(6)
  v_mfma_f32_16x16x32_bf16 v[96:99], v[36:39], a[120:123], v[96:99]
  v_mul_f32 v173, v173, v169
  v_mfma_f32_16x16x32_bf16 v[100:103], v[36:39], a[124:127], v[100:103]
  ds_read_b128 v[36:39], v3 offset:6144
  v_mfma_f32_16x16x32_bf16 v[104:107], v[40:43], a[120:123], v[104:107]
  buffer_load_dwordx4 a[68:71], v3, s[8:11], s27 offen offset:1024 sc1
  v_mfma_f32_16x16x32_bf16 v[108:111], v[40:43], a[124:127], v[108:111]
  ds_read_b128 v[40:43], v3 offset:7168
  v_mfma_f32_16x16x32_bf16 v[112:115], v[44:47], a[120:123], v[112:115]
  v_exp_f32 v170, v170
  v_mfma_f32_16x16x32_bf16 v[116:119], v[44:47], a[124:127], v[116:119]
  ds_read_b128 v[44:47], v3 offset:8192
  s_waitcnt lgkmcnt(6)
  v_mfma_f32_16x16x32_bf16 v[48:51], v[12:15], a[0:3], v[48:51]
  buffer_load_dwordx4 v3, s[8:11], s26 offen offset:2048 sc1 lds
  v_mfma_f32_16x16x32_bf16 v[52:55], v[12:15], a[4:7], v[52:55]
  ds_read_b128 v[12:15], v3 offset:9216
  v_mfma_f32_16x16x32_bf16 v[56:59], v[16:19], a[0:3], v[56:59]
  v_exp_f32 v171, v171
  v_mfma_f32_16x16x32_bf16 v[60:63], v[16:19], a[4:7], v[60:63]
  ds_read_b128 v[16:19], v3 offset:10240
  v_mfma_f32_16x16x32_bf16 v[64:67], v[20:23], a[0:3], v[64:67]
  buffer_load_dwordx4 a[72:75], v3, s[8:11], s27 offen offset:2048 sc1
  v_mfma_f32_16x16x32_bf16 v[68:71], v[20:23], a[4:7], v[68:71]
  ds_read_b128 v[20:23], v3 offset:11264
  s_waitcnt lgkmcnt(6)
  v_mfma_f32_16x16x32_bf16 v[72:75], v[24:27], a[0:3], v[72:75]
  v_exp_f32 v172, v172
  v_mfma_f32_16x16x32_bf16 v[76:79], v[24:27], a[4:7], v[76:79]
  ds_read_b128 v[24:27], v3 offset:12288
  v_mfma_f32_16x16x32_bf16 v[80:83], v[28:31], a[0:3], v[80:83]
  buffer_load_dwordx4 v3, s[8:11], s26 offen offset:3072 sc1 lds
  v_mfma_f32_16x16x32_bf16 v[84:87], v[28:31], a[4:7], v[84:87]
  ds_read_b128 v[28:31], v3 offset:13312
  v_mfma_f32_16x16x32_bf16 v[88:91], v[32:35], a[0:3], v[88:91]
  v_exp_f32 v173, v173
  v_mfma_f32_16x16x32_bf16 v[92:95], v[32:35], a[4:7], v[92:95]
  ds_read_b128 v[32:35], v3 offset:14336
  s_waitcnt lgkmcnt(6)
  v_mfma_f32_16x16x32_bf16 v[96:99], v[36:39], a[0:3], v[96:99]
  buffer_load_dwordx4 a[76:79], v3, s[8:11], s27 offen offset:3072 sc1
  v_mfma_f32_16x16x32_bf16 v[100:103], v[36:39], a[4:7], v[100:103]
  ds_read_b128 v[36:39], v3 offset:15360
  s_add_u32 m0, s31, 77824
  v_mfma_f32_16x16x32_bf16 v[104:107], v[40:43], a[0:3], v[104:107]
  s_add_u32 s26, s24, 520192
  v_add_f32 v170, 1.0, v170
  v_mfma_f32_16x16x32_bf16 v[108:111], v[40:43], a[4:7], v[108:111]
  ds_read_b128 v[40:43], v3 offset:16384
  v_add_f32 v171, 1.0, v171
  v_mfma_f32_16x16x32_bf16 v[112:115], v[44:47], a[0:3], v[112:115]
  buffer_load_dwordx4 v3, s[8:11], s26 offen sc1 lds
  v_mfma_f32_16x16x32_bf16 v[116:119], v[44:47], a[4:7], v[116:119]
  ds_read_b128 v[44:47], v3 offset:17408
  s_waitcnt lgkmcnt(6)
  v_mfma_f32_16x16x32_bf16 v[48:51], v[12:15], a[8:11], v[48:51]
  s_add_u32 s27, s25, 118784
  v_add_f32 v172, 1.0, v172
  v_mfma_f32_16x16x32_bf16 v[52:55], v[12:15], a[12:15], v[52:55]
  ds_read_b128 v[12:15], v3 offset:18432
  v_add_f32 v173, 1.0, v173
  v_mfma_f32_16x16x32_bf16 v[56:59], v[16:19], a[8:11], v[56:59]
  buffer_load_dwordx4 a[80:83], v3, s[8:11], s27 offen sc1
  v_mfma_f32_16x16x32_bf16 v[60:63], v[16:19], a[12:15], v[60:63]
  ds_read_b128 v[16:19], v3 offset:19456
  v_mfma_f32_16x16x32_bf16 v[64:67], v[20:23], a[8:11], v[64:67]
  v_rcp_f32 v170, v170
  v_mfma_f32_16x16x32_bf16 v[68:71], v[20:23], a[12:15], v[68:71]
  ds_read_b128 v[20:23], v3 offset:20480
  s_waitcnt lgkmcnt(6)
  v_mfma_f32_16x16x32_bf16 v[72:75], v[24:27], a[8:11], v[72:75]
  buffer_load_dwordx4 v3, s[8:11], s26 offen offset:1024 sc1 lds
  v_mfma_f32_16x16x32_bf16 v[76:79], v[24:27], a[12:15], v[76:79]
  ds_read_b128 v[24:27], v3 offset:21504
  v_mfma_f32_16x16x32_bf16 v[80:83], v[28:31], a[8:11], v[80:83]
  v_rcp_f32 v171, v171
  v_mfma_f32_16x16x32_bf16 v[84:87], v[28:31], a[12:15], v[84:87]
  ds_read_b128 v[28:31], v3 offset:22528
  v_mfma_f32_16x16x32_bf16 v[88:91], v[32:35], a[8:11], v[88:91]
  buffer_load_dwordx4 a[84:87], v3, s[8:11], s27 offen offset:1024 sc1
  v_mfma_f32_16x16x32_bf16 v[92:95], v[32:35], a[12:15], v[92:95]
  ds_read_b128 v[32:35], v3 offset:23552
  s_waitcnt lgkmcnt(6)
  v_mfma_f32_16x16x32_bf16 v[96:99], v[36:39], a[8:11], v[96:99]
  v_rcp_f32 v172, v172
  v_mfma_f32_16x16x32_bf16 v[100:103], v[36:39], a[12:15], v[100:103]
  ds_read_b128 v[36:39], v3 offset:24576
  v_mfma_f32_16x16x32_bf16 v[104:107], v[40:43], a[8:11], v[104:107]
  buffer_load_dwordx4 v3, s[8:11], s26 offen offset:2048 sc1 lds
  v_mfma_f32_16x16x32_bf16 v[108:111], v[40:43], a[12:15], v[108:111]
  ds_read_b128 v[40:43], v3 offset:25600
  v_mfma_f32_16x16x32_bf16 v[112:115], v[44:47], a[8:11], v[112:115]
  v_rcp_f32 v173, v173
  v_mfma_f32_16x16x32_bf16 v[116:119], v[44:47], a[12:15], v[116:119]
  ds_read_b128 v[44:47], v3 offset:26624
  s_waitcnt lgkmcnt(6)
  v_mfma_f32_16x16x32_bf16 v[48:51], v[12:15], a[16:19], v[48:51]
  buffer_load_dwordx4 a[88:91], v3, s[8:11], s27 offen offset:2048 sc1
  v_mfma_f32_16x16x32_bf16 v[52:55], v[12:15], a[20:23], v[52:55]
  ds_read_b128 v[12:15], v3 offset:27648
  v_mul_f32 v166, v166, v170
  v_mfma_f32_16x16x32_bf16 v[56:59], v[16:19], a[16:19], v[56:59]
  v_mul_f32 v167, v167, v171
  v_mul_f32 v168, v168, v172
  v_mfma_f32_16x16x32_bf16 v[60:63], v[16:19], a[20:23], v[60:63]
  ds_read_b128 v[16:19], v3 offset:28672
  v_mul_f32 v169, v169, v173
  v_mfma_f32_16x16x32_bf16 v[64:67], v[20:23], a[16:19], v[64:67]
  buffer_load_dwordx4 v3, s[8:11], s26 offen offset:3072 sc1 lds
  v_mfma_f32_16x16x32_bf16 v[68:71], v[20:23], a[20:23], v[68:71]
  ds_read_b128 v[20:23], v3 offset:29696
  s_waitcnt lgkmcnt(6)
  v_mfma_f32_16x16x32_bf16 v[72:75], v[24:27], a[16:19], v[72:75]
  v_cvt_pk_bf16_f32 v222, v166, v167
  v_cvt_pk_bf16_f32 v223, v168, v169
  v_mfma_f32_16x16x32_bf16 v[76:79], v[24:27], a[20:23], v[76:79]
  ds_read_b128 v[24:27], v3 offset:30720
  v_lshlrev_b32 v158, 16, v224
  v_mfma_f32_16x16x32_bf16 v[80:83], v[28:31], a[16:19], v[80:83]
  buffer_load_dwordx4 a[92:95], v3, s[8:11], s27 offen offset:3072 sc1
  v_mfma_f32_16x16x32_bf16 v[84:87], v[28:31], a[20:23], v[84:87]
  ds_read_b128 v[28:31], v3 offset:31744
  s_add_u32 m0, s31, 81920
  v_mfma_f32_16x16x32_bf16 v[88:91], v[32:35], a[16:19], v[88:91]
  s_add_u32 s26, s24, 524288
  v_and_b32 v159, 0xffff0000, v224
  v_mfma_f32_16x16x32_bf16 v[92:95], v[32:35], a[20:23], v[92:95]
  ds_read_b128 v[32:35], v3 offset:32768
  s_waitcnt lgkmcnt(6)
  v_mfma_f32_16x16x32_bf16 v[96:99], v[36:39], a[16:19], v[96:99]
  buffer_load_dwordx4 v3, s[8:11], s26 offen sc1 lds
  v_mfma_f32_16x16x32_bf16 v[100:103], v[36:39], a[20:23], v[100:103]
  ds_read_b128 v[36:39], v3 offset:33792
  v_lshlrev_b32 v160, 16, v225
  v_mfma_f32_16x16x32_bf16 v[104:107], v[40:43], a[16:19], v[104:107]
  v_and_b32 v161, 0xffff0000, v225
  v_mul_f32 v162, v158, v158
  v_mfma_f32_16x16x32_bf16 v[108:111], v[40:43], a[20:23], v[108:111]
  ds_read_b128 v[40:43], v3 offset:34816
  v_mul_f32 v163, v159, v159
  v_mfma_f32_16x16x32_bf16 v[112:115], v[44:47], a[16:19], v[112:115]
  v_mul_f32 v164, v160, v160
  v_mul_f32 v165, v161, v161
  v_mfma_f32_16x16x32_bf16 v[116:119], v[44:47], a[20:23], v[116:119]
  ds_read_b128 v[44:47], v3 offset:35840
  s_waitcnt vmcnt(17)
  s_barrier
  s_waitcnt lgkmcnt(6)
  v_mfma_f32_16x16x32_bf16 v[48:51], v[12:15], a[24:27], v[48:51]
  s_add_u32 m0, s31, 110592
  s_add_u32 s26, s24, 552960
  v_mfma_f32_16x16x32_bf16 v[52:55], v[12:15], a[28:31], v[52:55]
  ds_read_b128 v[12:15], v3 offset:36864
  v_fma_f32 v162, v162, s53, v178
  v_mfma_f32_16x16x32_bf16 v[56:59], v[16:19], a[24:27], v[56:59]
  buffer_load_dwordx4 v3, s[8:11], s26 offen sc1 lds
  v_mfma_f32_16x16x32_bf16 v[60:63], v[16:19], a[28:31], v[60:63]
  ds_read_b128 v[16:19], v3 offset:37888
  s_add_u32 s27, s25, 122880
  v_mfma_f32_16x16x32_bf16 v[64:67], v[20:23], a[24:27], v[64:67]
  v_fma_f32 v163, v163, s53, v178
  v_fma_f32 v164, v164, s53, v178
  v_mfma_f32_16x16x32_bf16 v[68:71], v[20:23], a[28:31], v[68:71]
  ds_read_b128 v[20:23], v3 offset:38912
  s_waitcnt lgkmcnt(6)
  v_mfma_f32_16x16x32_bf16 v[72:75], v[24:27], a[24:27], v[72:75]
  buffer_load_dwordx4 a[96:99], v3, s[8:11], s27 offen sc1
  v_mfma_f32_16x16x32_bf16 v[76:79], v[24:27], a[28:31], v[76:79]
  ds_read_b128 v[24:27], v3 offset:39936
  v_fma_f32 v165, v165, s53, v178
  v_mfma_f32_16x16x32_bf16 v[80:83], v[28:31], a[24:27], v[80:83]
  v_mul_f32 v162, v162, v158
  v_mul_f32 v163, v163, v159
  v_mfma_f32_16x16x32_bf16 v[84:87], v[28:31], a[28:31], v[84:87]
  ds_read_b128 v[28:31], v3 offset:40960
  v_mul_f32 v164, v164, v160
  v_mfma_f32_16x16x32_bf16 v[88:91], v[32:35], a[24:27], v[88:91]
  buffer_load_dwordx4 v3, s[8:11], s26 offen offset:1024 sc1 lds
  v_mfma_f32_16x16x32_bf16 v[92:95], v[32:35], a[28:31], v[92:95]
  ds_read_b128 v[32:35], v3 offset:41984
  s_waitcnt lgkmcnt(6)
  v_mfma_f32_16x16x32_bf16 v[96:99], v[36:39], a[24:27], v[96:99]
  v_mul_f32 v165, v165, v161
  v_mfma_f32_16x16x32_bf16 v[100:103], v[36:39], a[28:31], v[100:103]
  ds_read_b128 v[36:39], v3 offset:43008
  v_mfma_f32_16x16x32_bf16 v[104:107], v[40:43], a[24:27], v[104:107]
  buffer_load_dwordx4 a[100:103], v3, s[8:11], s27 offen offset:1024 sc1
  v_mfma_f32_16x16x32_bf16 v[108:111], v[40:43], a[28:31], v[108:111]
  ds_read_b128 v[40:43], v3 offset:44032
  v_mfma_f32_16x16x32_bf16 v[112:115], v[44:47], a[24:27], v[112:115]
  v_exp_f32 v162, v162
  v_mfma_f32_16x16x32_bf16 v[116:119], v[44:47], a[28:31], v[116:119]
  ds_read_b128 v[44:47], v3 offset:45056
  s_waitcnt lgkmcnt(6)
  v_mfma_f32_16x16x32_bf16 v[48:51], v[12:15], a[32:35], v[48:51]
  buffer_load_dwordx4 v3, s[8:11], s26 offen offset:2048 sc1 lds
  v_mfma_f32_16x16x32_bf16 v[52:55], v[12:15], a[36:39], v[52:55]
  ds_read_b128 v[12:15], v3 offset:46080
  v_mfma_f32_16x16x32_bf16 v[56:59], v[16:19], a[32:35], v[56:59]
  v_exp_f32 v163, v163
  v_mfma_f32_16x16x32_bf16 v[60:63], v[16:19], a[36:39], v[60:63]
  ds_read_b128 v[16:19], v3 offset:47104
  v_mfma_f32_16x16x32_bf16 v[64:67], v[20:23], a[32:35], v[64:67]
  buffer_load_dwordx4 a[104:107], v3, s[8:11], s27 offen offset:2048 sc1
  v_mfma_f32_16x16x32_bf16 v[68:71], v[20:23], a[36:39], v[68:71]
  ds_read_b128 v[20:23], v3 offset:48128
  s_waitcnt lgkmcnt(6)
  v_mfma_f32_16x16x32_bf16 v[72:75], v[24:27], a[32:35], v[72:75]
  v_exp_f32 v164, v164
  v_mfma_f32_16x16x32_bf16 v[76:79], v[24:27], a[36:39], v[76:79]
  ds_read_b128 v[24:27], v3 offset:49152
  v_mfma_f32_16x16x32_bf16 v[80:83], v[28:31], a[32:35], v[80:83]
  buffer_load_dwordx4 v3, s[8:11], s26 offen offset:3072 sc1 lds
  v_mfma_f32_16x16x32_bf16 v[84:87], v[28:31], a[36:39], v[84:87]
  ds_read_b128 v[28:31], v3 offset:50176
  v_mfma_f32_16x16x32_bf16 v[88:91], v[32:35], a[32:35], v[88:91]
  v_exp_f32 v165, v165
  v_mfma_f32_16x16x32_bf16 v[92:95], v[32:35], a[36:39], v[92:95]
  ds_read_b128 v[32:35], v3 offset:51200
  s_waitcnt lgkmcnt(6)
  v_mfma_f32_16x16x32_bf16 v[96:99], v[36:39], a[32:35], v[96:99]
  buffer_load_dwordx4 a[108:111], v3, s[8:11], s27 offen offset:3072 sc1
  v_mfma_f32_16x16x32_bf16 v[100:103], v[36:39], a[36:39], v[100:103]
  ds_read_b128 v[36:39], v3 offset:52224
  s_add_u32 m0, s31, 114688
  v_mfma_f32_16x16x32_bf16 v[104:107], v[40:43], a[32:35], v[104:107]
  s_add_u32 s26, s24, 557056
  v_add_f32 v162, 1.0, v162
  v_mfma_f32_16x16x32_bf16 v[108:111], v[40:43], a[36:39], v[108:111]
  ds_read_b128 v[40:43], v3 offset:53248
  v_add_f32 v163, 1.0, v163
  v_mfma_f32_16x16x32_bf16 v[112:115], v[44:47], a[32:35], v[112:115]
  buffer_load_dwordx4 v3, s[8:11], s26 offen sc1 lds
  v_mfma_f32_16x16x32_bf16 v[116:119], v[44:47], a[36:39], v[116:119]
  ds_read_b128 v[44:47], v3 offset:54272
  s_waitcnt lgkmcnt(6)
  v_mfma_f32_16x16x32_bf16 v[48:51], v[12:15], a[40:43], v[48:51]
  s_add_u32 s27, s25, 126976
  v_add_f32 v164, 1.0, v164
  v_mfma_f32_16x16x32_bf16 v[52:55], v[12:15], a[44:47], v[52:55]
  ds_read_b128 v[12:15], v3 offset:55296
  v_add_f32 v165, 1.0, v165
  v_mfma_f32_16x16x32_bf16 v[56:59], v[16:19], a[40:43], v[56:59]
  buffer_load_dwordx4 a[112:115], v3, s[8:11], s27 offen sc1
  v_mfma_f32_16x16x32_bf16 v[60:63], v[16:19], a[44:47], v[60:63]
  ds_read_b128 v[16:19], v3 offset:56320
  v_mfma_f32_16x16x32_bf16 v[64:67], v[20:23], a[40:43], v[64:67]
  v_rcp_f32 v162, v162
  v_mfma_f32_16x16x32_bf16 v[68:71], v[20:23], a[44:47], v[68:71]
  ds_read_b128 v[20:23], v3 offset:57344
  s_waitcnt lgkmcnt(6)
  v_mfma_f32_16x16x32_bf16 v[72:75], v[24:27], a[40:43], v[72:75]
  buffer_load_dwordx4 v3, s[8:11], s26 offen offset:1024 sc1 lds
  v_mfma_f32_16x16x32_bf16 v[76:79], v[24:27], a[44:47], v[76:79]
  ds_read_b128 v[24:27], v3 offset:58368
  v_mfma_f32_16x16x32_bf16 v[80:83], v[28:31], a[40:43], v[80:83]
  v_rcp_f32 v163, v163
  v_mfma_f32_16x16x32_bf16 v[84:87], v[28:31], a[44:47], v[84:87]
  ds_read_b128 v[28:31], v3 offset:59392
  v_mfma_f32_16x16x32_bf16 v[88:91], v[32:35], a[40:43], v[88:91]
  buffer_load_dwordx4 a[116:119], v3, s[8:11], s27 offen offset:1024 sc1
  v_mfma_f32_16x16x32_bf16 v[92:95], v[32:35], a[44:47], v[92:95]
  ds_read_b128 v[32:35], v3 offset:60416
  s_waitcnt lgkmcnt(6)
  v_mfma_f32_16x16x32_bf16 v[96:99], v[36:39], a[40:43], v[96:99]
  v_rcp_f32 v164, v164
  v_mfma_f32_16x16x32_bf16 v[100:103], v[36:39], a[44:47], v[100:103]
  ds_read_b128 v[36:39], v3 offset:61440
  v_mfma_f32_16x16x32_bf16 v[104:107], v[40:43], a[40:43], v[104:107]
  buffer_load_dwordx4 v3, s[8:11], s26 offen offset:2048 sc1 lds
  v_mfma_f32_16x16x32_bf16 v[108:111], v[40:43], a[44:47], v[108:111]
  ds_read_b128 v[40:43], v3 offset:62464
  v_mfma_f32_16x16x32_bf16 v[112:115], v[44:47], a[40:43], v[112:115]
  v_rcp_f32 v165, v165
  v_mfma_f32_16x16x32_bf16 v[116:119], v[44:47], a[44:47], v[116:119]
  ds_read_b128 v[44:47], v3 offset:63488
  s_waitcnt lgkmcnt(6)
  v_mfma_f32_16x16x32_bf16 v[48:51], v[12:15], a[48:51], v[48:51]
  buffer_load_dwordx4 a[120:123], v3, s[8:11], s27 offen offset:2048 sc1
  v_mfma_f32_16x16x32_bf16 v[52:55], v[12:15], a[52:55], v[52:55]
  ds_read_b128 v[12:15], v3 offset:64512
  v_mul_f32 v158, v158, v162
  v_mfma_f32_16x16x32_bf16 v[56:59], v[16:19], a[48:51], v[56:59]
  v_mul_f32 v159, v159, v163
  v_mul_f32 v160, v160, v164
  v_mfma_f32_16x16x32_bf16 v[60:63], v[16:19], a[52:55], v[60:63]
  ds_read_b128 v[16:19], v4 offset:0
  v_mul_f32 v161, v161, v165
  v_mfma_f32_16x16x32_bf16 v[64:67], v[20:23], a[48:51], v[64:67]
  buffer_load_dwordx4 v3, s[8:11], s26 offen offset:3072 sc1 lds
  v_mfma_f32_16x16x32_bf16 v[68:71], v[20:23], a[52:55], v[68:71]
  ds_read_b128 v[20:23], v4 offset:1024
  s_waitcnt lgkmcnt(6)
  v_mfma_f32_16x16x32_bf16 v[72:75], v[24:27], a[48:51], v[72:75]
  v_cvt_pk_bf16_f32 v224, v158, v159
  v_cvt_pk_bf16_f32 v225, v160, v161
  v_mfma_f32_16x16x32_bf16 v[76:79], v[24:27], a[52:55], v[76:79]
  ds_read_b128 v[24:27], v4 offset:2048
  v_lshlrev_b32 v166, 16, v226
  v_mfma_f32_16x16x32_bf16 v[80:83], v[28:31], a[48:51], v[80:83]
  buffer_load_dwordx4 a[124:127], v3, s[8:11], s27 offen offset:3072 sc1
  v_mfma_f32_16x16x32_bf16 v[84:87], v[28:31], a[52:55], v[84:87]
  ds_read_b128 v[28:31], v4 offset:3072
  s_add_u32 m0, s31, 118784
  v_mfma_f32_16x16x32_bf16 v[88:91], v[32:35], a[48:51], v[88:91]
  s_add_u32 s26, s24, 561152
  v_and_b32 v167, 0xffff0000, v226
  v_mfma_f32_16x16x32_bf16 v[92:95], v[32:35], a[52:55], v[92:95]
  ds_read_b128 v[32:35], v4 offset:4096
  s_waitcnt lgkmcnt(6)
  v_mfma_f32_16x16x32_bf16 v[96:99], v[36:39], a[48:51], v[96:99]
  buffer_load_dwordx4 v3, s[8:11], s26 offen sc1 lds
  v_mfma_f32_16x16x32_bf16 v[100:103], v[36:39], a[52:55], v[100:103]
  ds_read_b128 v[36:39], v4 offset:5120
  v_lshlrev_b32 v168, 16, v227
  v_mfma_f32_16x16x32_bf16 v[104:107], v[40:43], a[48:51], v[104:107]
  v_and_b32 v169, 0xffff0000, v227
  v_mul_f32 v170, v166, v166
  v_mfma_f32_16x16x32_bf16 v[108:111], v[40:43], a[52:55], v[108:111]
  ds_read_b128 v[40:43], v4 offset:6144
  v_mul_f32 v171, v167, v167
  v_mfma_f32_16x16x32_bf16 v[112:115], v[44:47], a[48:51], v[112:115]
  v_mul_f32 v172, v168, v168
  v_mul_f32 v173, v169, v169
  v_mfma_f32_16x16x32_bf16 v[116:119], v[44:47], a[52:55], v[116:119]
  ds_read_b128 v[44:47], v4 offset:7168
  s_waitcnt vmcnt(17)
  s_barrier
  s_waitcnt lgkmcnt(6)
  v_mfma_f32_16x16x32_bf16 v[48:51], v[12:15], a[56:59], v[48:51]
  v_fma_f32 v170, v170, s53, v178
  v_fma_f32 v171, v171, s53, v178
  v_mfma_f32_16x16x32_bf16 v[52:55], v[12:15], a[60:63], v[52:55]
  ds_read_b128 v[12:15], v4 offset:8192
  v_fma_f32 v172, v172, s53, v178
  v_mfma_f32_16x16x32_bf16 v[56:59], v[16:19], a[56:59], v[56:59]
  v_fma_f32 v173, v173, s53, v178
  v_mul_f32 v170, v170, v166
  v_mfma_f32_16x16x32_bf16 v[60:63], v[16:19], a[60:63], v[60:63]
  ds_read_b128 v[16:19], v4 offset:9216
  v_mul_f32 v171, v171, v167
  v_mfma_f32_16x16x32_bf16 v[64:67], v[20:23], a[56:59], v[64:67]
  v_mul_f32 v172, v172, v168
  v_mul_f32 v173, v173, v169
  v_mfma_f32_16x16x32_bf16 v[68:71], v[20:23], a[60:63], v[68:71]
  ds_read_b128 v[20:23], v4 offset:10240
  s_waitcnt lgkmcnt(6)
  v_mfma_f32_16x16x32_bf16 v[72:75], v[24:27], a[56:59], v[72:75]
  v_exp_f32 v170, v170
  v_mfma_f32_16x16x32_bf16 v[76:79], v[24:27], a[60:63], v[76:79]
  ds_read_b128 v[24:27], v4 offset:11264
  v_mfma_f32_16x16x32_bf16 v[80:83], v[28:31], a[56:59], v[80:83]
  v_exp_f32 v171, v171
  v_mfma_f32_16x16x32_bf16 v[84:87], v[28:31], a[60:63], v[84:87]
  ds_read_b128 v[28:31], v4 offset:12288
  v_mfma_f32_16x16x32_bf16 v[88:91], v[32:35], a[56:59], v[88:91]
  v_exp_f32 v172, v172
  v_mfma_f32_16x16x32_bf16 v[92:95], v[32:35], a[60:63], v[92:95]
  ds_read_b128 v[32:35], v4 offset:13312
  s_waitcnt lgkmcnt(6)
  v_mfma_f32_16x16x32_bf16 v[96:99], v[36:39], a[56:59], v[96:99]
  v_exp_f32 v173, v173
  v_mfma_f32_16x16x32_bf16 v[100:103], v[36:39], a[60:63], v[100:103]
  ds_read_b128 v[36:39], v4 offset:14336
  v_add_f32 v170, 1.0, v170
  v_mfma_f32_16x16x32_bf16 v[104:107], v[40:43], a[56:59], v[104:107]
  v_add_f32 v171, 1.0, v171
  v_add_f32 v172, 1.0, v172
  v_mfma_f32_16x16x32_bf16 v[108:111], v[40:43], a[60:63], v[108:111]
  ds_read_b128 v[40:43], v4 offset:15360
  v_add_f32 v173, 1.0, v173
  v_mfma_f32_16x16x32_bf16 v[112:115], v[44:47], a[56:59], v[112:115]
  v_rcp_f32 v170, v170
  v_mfma_f32_16x16x32_bf16 v[116:119], v[44:47], a[60:63], v[116:119]
  ds_read_b128 v[44:47], v4 offset:16384
  s_waitcnt lgkmcnt(6)
  v_mfma_f32_16x16x32_bf16 v[48:51], v[12:15], a[64:67], v[48:51]
  v_rcp_f32 v171, v171
  v_mfma_f32_16x16x32_bf16 v[52:55], v[12:15], a[68:71], v[52:55]
  ds_read_b128 v[12:15], v4 offset:17408
  v_mfma_f32_16x16x32_bf16 v[56:59], v[16:19], a[64:67], v[56:59]
  v_rcp_f32 v172, v172
  v_mfma_f32_16x16x32_bf16 v[60:63], v[16:19], a[68:71], v[60:63]
  ds_read_b128 v[16:19], v4 offset:18432
  v_mfma_f32_16x16x32_bf16 v[64:67], v[20:23], a[64:67], v[64:67]
  v_rcp_f32 v173, v173
  v_mfma_f32_16x16x32_bf16 v[68:71], v[20:23], a[68:71], v[68:71]
  ds_read_b128 v[20:23], v4 offset:19456
  s_waitcnt lgkmcnt(6)
  v_mfma_f32_16x16x32_bf16 v[72:75], v[24:27], a[64:67], v[72:75]
  v_mul_f32 v166, v166, v170
  v_mul_f32 v167, v167, v171
  v_mfma_f32_16x16x32_bf16 v[76:79], v[24:27], a[68:71], v[76:79]
  ds_read_b128 v[24:27], v4 offset:20480
  v_mul_f32 v168, v168, v172
  v_mfma_f32_16x16x32_bf16 v[80:83], v[28:31], a[64:67], v[80:83]
  v_mul_f32 v169, v169, v173
  v_cvt_pk_bf16_f32 v226, v166, v167
  v_mfma_f32_16x16x32_bf16 v[84:87], v[28:31], a[68:71], v[84:87]
  ds_read_b128 v[28:31], v4 offset:21504
  v_cvt_pk_bf16_f32 v227, v168, v169
  v_mfma_f32_16x16x32_bf16 v[88:91], v[32:35], a[64:67], v[88:91]
  v_lshlrev_b32 v158, 16, v228
  v_and_b32 v159, 0xffff0000, v228
  v_mfma_f32_16x16x32_bf16 v[92:95], v[32:35], a[68:71], v[92:95]
  ds_read_b128 v[32:35], v4 offset:22528
  s_waitcnt lgkmcnt(6)
  v_mfma_f32_16x16x32_bf16 v[96:99], v[36:39], a[64:67], v[96:99]
  v_lshlrev_b32 v160, 16, v229
  v_and_b32 v161, 0xffff0000, v229
  v_mfma_f32_16x16x32_bf16 v[100:103], v[36:39], a[68:71], v[100:103]
  ds_read_b128 v[36:39], v4 offset:23552
  v_mul_f32 v162, v158, v158
  v_mfma_f32_16x16x32_bf16 v[104:107], v[40:43], a[64:67], v[104:107]
  v_mul_f32 v163, v159, v159
  v_mul_f32 v164, v160, v160
  v_mfma_f32_16x16x32_bf16 v[108:111], v[40:43], a[68:71], v[108:111]
  ds_read_b128 v[40:43], v4 offset:24576
  v_mul_f32 v165, v161, v161
  v_mfma_f32_16x16x32_bf16 v[112:115], v[44:47], a[64:67], v[112:115]
  v_fma_f32 v162, v162, s53, v178
  v_fma_f32 v163, v163, s53, v178
  v_mfma_f32_16x16x32_bf16 v[116:119], v[44:47], a[68:71], v[116:119]
  ds_read_b128 v[44:47], v4 offset:25600
  s_waitcnt lgkmcnt(6)
  v_mfma_f32_16x16x32_bf16 v[48:51], v[12:15], a[72:75], v[48:51]
  v_fma_f32 v164, v164, s53, v178
  v_fma_f32 v165, v165, s53, v178
  v_mfma_f32_16x16x32_bf16 v[52:55], v[12:15], a[76:79], v[52:55]
  ds_read_b128 v[12:15], v4 offset:26624
  v_mul_f32 v162, v162, v158
  v_mfma_f32_16x16x32_bf16 v[56:59], v[16:19], a[72:75], v[56:59]
  v_mul_f32 v163, v163, v159
  v_mul_f32 v164, v164, v160
  v_mfma_f32_16x16x32_bf16 v[60:63], v[16:19], a[76:79], v[60:63]
  ds_read_b128 v[16:19], v4 offset:27648
  v_mul_f32 v165, v165, v161
  v_mfma_f32_16x16x32_bf16 v[64:67], v[20:23], a[72:75], v[64:67]
  v_exp_f32 v162, v162
  v_mfma_f32_16x16x32_bf16 v[68:71], v[20:23], a[76:79], v[68:71]
  ds_read_b128 v[20:23], v4 offset:28672
  s_waitcnt lgkmcnt(6)
  v_mfma_f32_16x16x32_bf16 v[72:75], v[24:27], a[72:75], v[72:75]
  v_exp_f32 v163, v163
  v_mfma_f32_16x16x32_bf16 v[76:79], v[24:27], a[76:79], v[76:79]
  ds_read_b128 v[24:27], v4 offset:29696
  v_mfma_f32_16x16x32_bf16 v[80:83], v[28:31], a[72:75], v[80:83]
  v_exp_f32 v164, v164
  v_mfma_f32_16x16x32_bf16 v[84:87], v[28:31], a[76:79], v[84:87]
  ds_read_b128 v[28:31], v4 offset:30720
  v_mfma_f32_16x16x32_bf16 v[88:91], v[32:35], a[72:75], v[88:91]
  v_exp_f32 v165, v165
  v_mfma_f32_16x16x32_bf16 v[92:95], v[32:35], a[76:79], v[92:95]
  ds_read_b128 v[32:35], v4 offset:31744
  s_waitcnt lgkmcnt(6)
  v_mfma_f32_16x16x32_bf16 v[96:99], v[36:39], a[72:75], v[96:99]
  v_add_f32 v162, 1.0, v162
  v_add_f32 v163, 1.0, v163
  v_mfma_f32_16x16x32_bf16 v[100:103], v[36:39], a[76:79], v[100:103]
  ds_read_b128 v[36:39], v4 offset:32768
  v_add_f32 v164, 1.0, v164
  v_mfma_f32_16x16x32_bf16 v[104:107], v[40:43], a[72:75], v[104:107]
  v_add_f32 v165, 1.0, v165
  v_mfma_f32_16x16x32_bf16 v[108:111], v[40:43], a[76:79], v[108:111]
  ds_read_b128 v[40:43], v4 offset:33792
  v_mfma_f32_16x16x32_bf16 v[112:115], v[44:47], a[72:75], v[112:115]
  v_rcp_f32 v162, v162
  v_mfma_f32_16x16x32_bf16 v[116:119], v[44:47], a[76:79], v[116:119]
  ds_read_b128 v[44:47], v4 offset:34816
  s_waitcnt lgkmcnt(6)
  v_mfma_f32_16x16x32_bf16 v[48:51], v[12:15], a[80:83], v[48:51]
  v_rcp_f32 v163, v163
  v_mfma_f32_16x16x32_bf16 v[52:55], v[12:15], a[84:87], v[52:55]
  ds_read_b128 v[12:15], v4 offset:35840
  v_mfma_f32_16x16x32_bf16 v[56:59], v[16:19], a[80:83], v[56:59]
  v_rcp_f32 v164, v164
  v_mfma_f32_16x16x32_bf16 v[60:63], v[16:19], a[84:87], v[60:63]
  ds_read_b128 v[16:19], v4 offset:36864
  v_mfma_f32_16x16x32_bf16 v[64:67], v[20:23], a[80:83], v[64:67]
  v_rcp_f32 v165, v165
  v_mfma_f32_16x16x32_bf16 v[68:71], v[20:23], a[84:87], v[68:71]
  ds_read_b128 v[20:23], v4 offset:37888
  s_waitcnt lgkmcnt(6)
  v_mfma_f32_16x16x32_bf16 v[72:75], v[24:27], a[80:83], v[72:75]
  v_mul_f32 v158, v158, v162
  v_mul_f32 v159, v159, v163
  v_mfma_f32_16x16x32_bf16 v[76:79], v[24:27], a[84:87], v[76:79]
  ds_read_b128 v[24:27], v4 offset:38912
  v_mul_f32 v160, v160, v164
  v_mfma_f32_16x16x32_bf16 v[80:83], v[28:31], a[80:83], v[80:83]
  v_mul_f32 v161, v161, v165
  v_cvt_pk_bf16_f32 v228, v158, v159
  v_mfma_f32_16x16x32_bf16 v[84:87], v[28:31], a[84:87], v[84:87]
  ds_read_b128 v[28:31], v4 offset:39936
  v_cvt_pk_bf16_f32 v229, v160, v161
  v_mfma_f32_16x16x32_bf16 v[88:91], v[32:35], a[80:83], v[88:91]
  v_lshlrev_b32 v166, 16, v230
  v_and_b32 v167, 0xffff0000, v230
  v_mfma_f32_16x16x32_bf16 v[92:95], v[32:35], a[84:87], v[92:95]
  ds_read_b128 v[32:35], v4 offset:40960
  s_waitcnt lgkmcnt(6)
  v_mfma_f32_16x16x32_bf16 v[96:99], v[36:39], a[80:83], v[96:99]
  v_lshlrev_b32 v168, 16, v231
  v_and_b32 v169, 0xffff0000, v231
  v_mfma_f32_16x16x32_bf16 v[100:103], v[36:39], a[84:87], v[100:103]
  ds_read_b128 v[36:39], v4 offset:41984
  v_mul_f32 v170, v166, v166
  v_mfma_f32_16x16x32_bf16 v[104:107], v[40:43], a[80:83], v[104:107]
  v_mul_f32 v171, v167, v167
  v_mul_f32 v172, v168, v168
  v_mfma_f32_16x16x32_bf16 v[108:111], v[40:43], a[84:87], v[108:111]
  ds_read_b128 v[40:43], v4 offset:43008
  v_mul_f32 v173, v169, v169
  v_mfma_f32_16x16x32_bf16 v[112:115], v[44:47], a[80:83], v[112:115]
  v_fma_f32 v170, v170, s53, v178
  v_fma_f32 v171, v171, s53, v178
  v_mfma_f32_16x16x32_bf16 v[116:119], v[44:47], a[84:87], v[116:119]
  ds_read_b128 v[44:47], v4 offset:44032
  s_waitcnt vmcnt(0)
  s_barrier
  s_waitcnt lgkmcnt(6)
  v_mfma_f32_16x16x32_bf16 v[48:51], v[12:15], a[88:91], v[48:51]
  v_fma_f32 v172, v172, s53, v178
  v_fma_f32 v173, v173, s53, v178
  v_mfma_f32_16x16x32_bf16 v[52:55], v[12:15], a[92:95], v[52:55]
  ds_read_b128 v[12:15], v4 offset:45056
  v_mul_f32 v170, v170, v166
  v_mfma_f32_16x16x32_bf16 v[56:59], v[16:19], a[88:91], v[56:59]
  v_mul_f32 v171, v171, v167
  v_mul_f32 v172, v172, v168
  v_mfma_f32_16x16x32_bf16 v[60:63], v[16:19], a[92:95], v[60:63]
  ds_read_b128 v[16:19], v4 offset:46080
  v_mul_f32 v173, v173, v169
  v_mfma_f32_16x16x32_bf16 v[64:67], v[20:23], a[88:91], v[64:67]
  v_exp_f32 v170, v170
  v_mfma_f32_16x16x32_bf16 v[68:71], v[20:23], a[92:95], v[68:71]
  ds_read_b128 v[20:23], v4 offset:47104
  s_waitcnt lgkmcnt(6)
  v_mfma_f32_16x16x32_bf16 v[72:75], v[24:27], a[88:91], v[72:75]
  v_exp_f32 v171, v171
  v_mfma_f32_16x16x32_bf16 v[76:79], v[24:27], a[92:95], v[76:79]
  ds_read_b128 v[24:27], v4 offset:48128
  v_mfma_f32_16x16x32_bf16 v[80:83], v[28:31], a[88:91], v[80:83]
  v_exp_f32 v172, v172
  v_mfma_f32_16x16x32_bf16 v[84:87], v[28:31], a[92:95], v[84:87]
  ds_read_b128 v[28:31], v4 offset:49152
  v_mfma_f32_16x16x32_bf16 v[88:91], v[32:35], a[88:91], v[88:91]
  v_exp_f32 v173, v173
  v_mfma_f32_16x16x32_bf16 v[92:95], v[32:35], a[92:95], v[92:95]
  ds_read_b128 v[32:35], v4 offset:50176
  s_waitcnt lgkmcnt(6)
  v_mfma_f32_16x16x32_bf16 v[96:99], v[36:39], a[88:91], v[96:99]
  v_add_f32 v170, 1.0, v170
  v_add_f32 v171, 1.0, v171
  v_mfma_f32_16x16x32_bf16 v[100:103], v[36:39], a[92:95], v[100:103]
  ds_read_b128 v[36:39], v4 offset:51200
  v_add_f32 v172, 1.0, v172
  v_mfma_f32_16x16x32_bf16 v[104:107], v[40:43], a[88:91], v[104:107]
  v_add_f32 v173, 1.0, v173
  v_mfma_f32_16x16x32_bf16 v[108:111], v[40:43], a[92:95], v[108:111]
  ds_read_b128 v[40:43], v4 offset:52224
  v_mfma_f32_16x16x32_bf16 v[112:115], v[44:47], a[88:91], v[112:115]
  v_rcp_f32 v170, v170
  v_mfma_f32_16x16x32_bf16 v[116:119], v[44:47], a[92:95], v[116:119]
  ds_read_b128 v[44:47], v4 offset:53248
  s_waitcnt lgkmcnt(6)
  v_mfma_f32_16x16x32_bf16 v[48:51], v[12:15], a[96:99], v[48:51]
  v_rcp_f32 v171, v171
  v_mfma_f32_16x16x32_bf16 v[52:55], v[12:15], a[100:103], v[52:55]
  ds_read_b128 v[12:15], v4 offset:54272
  v_mfma_f32_16x16x32_bf16 v[56:59], v[16:19], a[96:99], v[56:59]
  v_rcp_f32 v172, v172
  v_mfma_f32_16x16x32_bf16 v[60:63], v[16:19], a[100:103], v[60:63]
  ds_read_b128 v[16:19], v4 offset:55296
  v_mfma_f32_16x16x32_bf16 v[64:67], v[20:23], a[96:99], v[64:67]
  v_rcp_f32 v173, v173
  v_mfma_f32_16x16x32_bf16 v[68:71], v[20:23], a[100:103], v[68:71]
  ds_read_b128 v[20:23], v4 offset:56320
  s_waitcnt lgkmcnt(6)
  v_mfma_f32_16x16x32_bf16 v[72:75], v[24:27], a[96:99], v[72:75]
  v_mul_f32 v166, v166, v170
  v_mul_f32 v167, v167, v171
  v_mfma_f32_16x16x32_bf16 v[76:79], v[24:27], a[100:103], v[76:79]
  ds_read_b128 v[24:27], v4 offset:57344
  v_mul_f32 v168, v168, v172
  v_mfma_f32_16x16x32_bf16 v[80:83], v[28:31], a[96:99], v[80:83]
  v_mul_f32 v169, v169, v173
  v_cvt_pk_bf16_f32 v230, v166, v167
  v_mfma_f32_16x16x32_bf16 v[84:87], v[28:31], a[100:103], v[84:87]
  ds_read_b128 v[28:31], v4 offset:58368
  v_cvt_pk_bf16_f32 v231, v168, v169
  v_mfma_f32_16x16x32_bf16 v[88:91], v[32:35], a[96:99], v[88:91]
  v_lshlrev_b32 v158, 16, v232
  v_and_b32 v159, 0xffff0000, v232
  v_mfma_f32_16x16x32_bf16 v[92:95], v[32:35], a[100:103], v[92:95]
  ds_read_b128 v[32:35], v4 offset:59392
  s_waitcnt lgkmcnt(6)
  v_mfma_f32_16x16x32_bf16 v[96:99], v[36:39], a[96:99], v[96:99]
  v_lshlrev_b32 v160, 16, v233
  v_and_b32 v161, 0xffff0000, v233
  v_mfma_f32_16x16x32_bf16 v[100:103], v[36:39], a[100:103], v[100:103]
  ds_read_b128 v[36:39], v4 offset:60416
  v_mul_f32 v162, v158, v158
  v_mfma_f32_16x16x32_bf16 v[104:107], v[40:43], a[96:99], v[104:107]
  v_mul_f32 v163, v159, v159
  v_mul_f32 v164, v160, v160
  v_mfma_f32_16x16x32_bf16 v[108:111], v[40:43], a[100:103], v[108:111]
  ds_read_b128 v[40:43], v4 offset:61440
  v_mul_f32 v165, v161, v161
  v_mfma_f32_16x16x32_bf16 v[112:115], v[44:47], a[96:99], v[112:115]
  v_fma_f32 v162, v162, s53, v178
  v_fma_f32 v163, v163, s53, v178
  v_mfma_f32_16x16x32_bf16 v[116:119], v[44:47], a[100:103], v[116:119]
  ds_read_b128 v[44:47], v4 offset:62464
  s_waitcnt lgkmcnt(6)
  v_mfma_f32_16x16x32_bf16 v[48:51], v[12:15], a[104:107], v[48:51]
  v_fma_f32 v164, v164, s53, v178
  v_fma_f32 v165, v165, s53, v178
  v_mfma_f32_16x16x32_bf16 v[52:55], v[12:15], a[108:111], v[52:55]
  ds_read_b128 v[12:15], v4 offset:63488
  v_mul_f32 v162, v162, v158
  v_mfma_f32_16x16x32_bf16 v[56:59], v[16:19], a[104:107], v[56:59]
  v_mul_f32 v163, v163, v159
  v_mul_f32 v164, v164, v160
  v_mfma_f32_16x16x32_bf16 v[60:63], v[16:19], a[108:111], v[60:63]
  ds_read_b128 v[16:19], v4 offset:64512
  v_mul_f32 v165, v165, v161
  v_mfma_f32_16x16x32_bf16 v[64:67], v[20:23], a[104:107], v[64:67]
  v_exp_f32 v162, v162
  v_mfma_f32_16x16x32_bf16 v[68:71], v[20:23], a[108:111], v[68:71]
  ds_read_b128 v[20:23], v5 offset:0
  s_waitcnt lgkmcnt(6)
  v_mfma_f32_16x16x32_bf16 v[72:75], v[24:27], a[104:107], v[72:75]
  v_exp_f32 v163, v163
  v_mfma_f32_16x16x32_bf16 v[76:79], v[24:27], a[108:111], v[76:79]
  ds_read_b128 v[24:27], v5 offset:1024
  v_mfma_f32_16x16x32_bf16 v[80:83], v[28:31], a[104:107], v[80:83]
  v_exp_f32 v164, v164
  v_mfma_f32_16x16x32_bf16 v[84:87], v[28:31], a[108:111], v[84:87]
  ds_read_b128 v[28:31], v5 offset:2048
  v_mfma_f32_16x16x32_bf16 v[88:91], v[32:35], a[104:107], v[88:91]
  v_exp_f32 v165, v165
  v_mfma_f32_16x16x32_bf16 v[92:95], v[32:35], a[108:111], v[92:95]
  ds_read_b128 v[32:35], v5 offset:3072
  s_waitcnt lgkmcnt(6)
  v_mfma_f32_16x16x32_bf16 v[96:99], v[36:39], a[104:107], v[96:99]
  v_add_f32 v162, 1.0, v162
  v_add_f32 v163, 1.0, v163
  v_mfma_f32_16x16x32_bf16 v[100:103], v[36:39], a[108:111], v[100:103]
  ds_read_b128 v[36:39], v5 offset:4096
  v_add_f32 v164, 1.0, v164
  v_mfma_f32_16x16x32_bf16 v[104:107], v[40:43], a[104:107], v[104:107]
  v_add_f32 v165, 1.0, v165
  v_mfma_f32_16x16x32_bf16 v[108:111], v[40:43], a[108:111], v[108:111]
  ds_read_b128 v[40:43], v5 offset:5120
  v_mfma_f32_16x16x32_bf16 v[112:115], v[44:47], a[104:107], v[112:115]
  v_rcp_f32 v162, v162
  v_mfma_f32_16x16x32_bf16 v[116:119], v[44:47], a[108:111], v[116:119]
  ds_read_b128 v[44:47], v5 offset:6144
  s_waitcnt lgkmcnt(6)
  v_mfma_f32_16x16x32_bf16 v[48:51], v[12:15], a[112:115], v[48:51]
  v_rcp_f32 v163, v163
  v_mfma_f32_16x16x32_bf16 v[52:55], v[12:15], a[116:119], v[52:55]
  ds_read_b128 v[12:15], v5 offset:7168
  v_mfma_f32_16x16x32_bf16 v[56:59], v[16:19], a[112:115], v[56:59]
  v_rcp_f32 v164, v164
  v_mfma_f32_16x16x32_bf16 v[60:63], v[16:19], a[116:119], v[60:63]
  ds_read_b128 v[16:19], v5 offset:8192
  v_mfma_f32_16x16x32_bf16 v[64:67], v[20:23], a[112:115], v[64:67]
  v_rcp_f32 v165, v165
  v_mfma_f32_16x16x32_bf16 v[68:71], v[20:23], a[116:119], v[68:71]
  ds_read_b128 v[20:23], v5 offset:9216
  s_waitcnt lgkmcnt(6)
  v_mfma_f32_16x16x32_bf16 v[72:75], v[24:27], a[112:115], v[72:75]
  v_mul_f32 v158, v158, v162
  v_mul_f32 v159, v159, v163
  v_mfma_f32_16x16x32_bf16 v[76:79], v[24:27], a[116:119], v[76:79]
  ds_read_b128 v[24:27], v5 offset:10240
  v_mul_f32 v160, v160, v164
  v_mfma_f32_16x16x32_bf16 v[80:83], v[28:31], a[112:115], v[80:83]
  v_mul_f32 v161, v161, v165
  v_cvt_pk_bf16_f32 v232, v158, v159
  v_mfma_f32_16x16x32_bf16 v[84:87], v[28:31], a[116:119], v[84:87]
  ds_read_b128 v[28:31], v5 offset:11264
  v_cvt_pk_bf16_f32 v233, v160, v161
  v_mfma_f32_16x16x32_bf16 v[88:91], v[32:35], a[112:115], v[88:91]
  v_lshlrev_b32 v166, 16, v234
  v_and_b32 v167, 0xffff0000, v234
  v_mfma_f32_16x16x32_bf16 v[92:95], v[32:35], a[116:119], v[92:95]
  ds_read_b128 v[32:35], v5 offset:12288
  s_waitcnt lgkmcnt(6)
  v_mfma_f32_16x16x32_bf16 v[96:99], v[36:39], a[112:115], v[96:99]
  v_lshlrev_b32 v168, 16, v235
  v_and_b32 v169, 0xffff0000, v235
  v_mfma_f32_16x16x32_bf16 v[100:103], v[36:39], a[116:119], v[100:103]
  ds_read_b128 v[36:39], v5 offset:13312
  v_mul_f32 v170, v166, v166
  v_mfma_f32_16x16x32_bf16 v[104:107], v[40:43], a[112:115], v[104:107]
  v_mul_f32 v171, v167, v167
  v_mul_f32 v172, v168, v168
  v_mfma_f32_16x16x32_bf16 v[108:111], v[40:43], a[116:119], v[108:111]
  ds_read_b128 v[40:43], v5 offset:14336
  v_mul_f32 v173, v169, v169
  v_mfma_f32_16x16x32_bf16 v[112:115], v[44:47], a[112:115], v[112:115]
  v_fma_f32 v170, v170, s53, v178
  v_fma_f32 v171, v171, s53, v178
  v_mfma_f32_16x16x32_bf16 v[116:119], v[44:47], a[116:119], v[116:119]
  ds_read_b128 v[44:47], v5 offset:15360
  s_waitcnt lgkmcnt(6)
  v_mfma_f32_16x16x32_bf16 v[48:51], v[12:15], a[120:123], v[48:51]
  v_fma_f32 v172, v172, s53, v178
  v_fma_f32 v173, v173, s53, v178
  v_mfma_f32_16x16x32_bf16 v[52:55], v[12:15], a[124:127], v[52:55]
  v_mul_f32 v170, v170, v166
  v_mfma_f32_16x16x32_bf16 v[56:59], v[16:19], a[120:123], v[56:59]
  v_mul_f32 v171, v171, v167
  v_mul_f32 v172, v172, v168
  v_mfma_f32_16x16x32_bf16 v[60:63], v[16:19], a[124:127], v[60:63]
  v_mul_f32 v173, v173, v169
  v_mfma_f32_16x16x32_bf16 v[64:67], v[20:23], a[120:123], v[64:67]
  v_exp_f32 v170, v170
  v_mfma_f32_16x16x32_bf16 v[68:71], v[20:23], a[124:127], v[68:71]
  s_waitcnt lgkmcnt(3)
  v_mfma_f32_16x16x32_bf16 v[72:75], v[24:27], a[120:123], v[72:75]
  v_exp_f32 v171, v171
  v_mfma_f32_16x16x32_bf16 v[76:79], v[24:27], a[124:127], v[76:79]
  v_mfma_f32_16x16x32_bf16 v[80:83], v[28:31], a[120:123], v[80:83]
  v_exp_f32 v172, v172
  v_mfma_f32_16x16x32_bf16 v[84:87], v[28:31], a[124:127], v[84:87]
  v_mfma_f32_16x16x32_bf16 v[88:91], v[32:35], a[120:123], v[88:91]
  v_exp_f32 v173, v173
  v_mfma_f32_16x16x32_bf16 v[92:95], v[32:35], a[124:127], v[92:95]
  s_waitcnt lgkmcnt(0)
  v_mfma_f32_16x16x32_bf16 v[96:99], v[36:39], a[120:123], v[96:99]
  v_add_f32 v170, 1.0, v170
  v_add_f32 v171, 1.0, v171
  v_mfma_f32_16x16x32_bf16 v[100:103], v[36:39], a[124:127], v[100:103]
  v_add_f32 v172, 1.0, v172
  v_mfma_f32_16x16x32_bf16 v[104:107], v[40:43], a[120:123], v[104:107]
  v_add_f32 v173, 1.0, v173
  v_mfma_f32_16x16x32_bf16 v[108:111], v[40:43], a[124:127], v[108:111]
  v_mfma_f32_16x16x32_bf16 v[112:115], v[44:47], a[120:123], v[112:115]
  v_rcp_f32 v170, v170
  v_mfma_f32_16x16x32_bf16 v[116:119], v[44:47], a[124:127], v[116:119]
  v_rcp_f32 v171, v171
  v_rcp_f32 v172, v172
  v_rcp_f32 v173, v173
  v_mul_f32 v166, v166, v170
  v_mul_f32 v167, v167, v171
  v_mul_f32 v168, v168, v172
  v_mul_f32 v169, v169, v173
  v_cvt_pk_bf16_f32 v234, v166, v167
  v_cvt_pk_bf16_f32 v235, v168, v169
  v_lshlrev_b32 v156, 16, v156
  v_lshlrev_b32 v157, 16, v157
  s_lshl_b32 s40, s16, 1
  s_lshr_b32 s41, s20, 1
  s_add_u32 s40, s40, s41
  s_mul_i32 s40, s40, 294912
  s_and_b32 s41, s20, 1
  s_lshl_b32 s41, s41, 11
  s_add_u32 s40, s40, s41
  s_add_u32 s40, s40, 56623104
  s_mul_i32 s41, s17, 9
  s_lshr_b32 s42, s41, 1
  s_lshl_b32 s42, s42, 12
  s_add_u32 s40, s40, s42
  v_lshlrev_b32 v9, 3, v1
  s_bitcmp1_b32 s17, 0
  s_cbranch_scc1 kg_odd_18
  v_lshlrev_b32 v158, 16, v200
  v_and_b32 v159, 0xffff0000, v200
  v_lshlrev_b32 v160, 16, v201
  v_and_b32 v161, 0xffff0000, v201
  v_lshlrev_b32 v162, 16, v202
  v_and_b32 v163, 0xffff0000, v202
  v_lshlrev_b32 v164, 16, v203
  v_and_b32 v165, 0xffff0000, v203
  v_pk_add_f32 v[48:49], v[48:49], v[156:157] op_sel:[0,0] op_sel_hi:[1,0]
  v_pk_add_f32 v[50:51], v[50:51], v[156:157] op_sel:[0,0] op_sel_hi:[1,0]
  v_pk_add_f32 v[52:53], v[52:53], v[156:157] op_sel:[0,1] op_sel_hi:[1,1]
  v_pk_add_f32 v[54:55], v[54:55], v[156:157] op_sel:[0,1] op_sel_hi:[1,1]
  v_pk_mul_f32 v[48:49], v[48:49], v[158:159]
  v_pk_mul_f32 v[50:51], v[50:51], v[160:161]
  v_pk_mul_f32 v[52:53], v[52:53], v[162:163]
  v_pk_mul_f32 v[54:55], v[54:55], v[164:165]
  v_cvt_pk_bf16_f32 v12, v48, v49
  v_cvt_pk_bf16_f32 v13, v50, v51
  v_cvt_pk_bf16_f32 v30, v52, v53
  v_cvt_pk_bf16_f32 v31, v54, v55
  v_lshlrev_b32 v158, 16, v204
  v_and_b32 v159, 0xffff0000, v204
  v_lshlrev_b32 v160, 16, v205
  v_and_b32 v161, 0xffff0000, v205
  v_lshlrev_b32 v162, 16, v206
  v_and_b32 v163, 0xffff0000, v206
  v_lshlrev_b32 v164, 16, v207
  v_and_b32 v165, 0xffff0000, v207
  v_pk_add_f32 v[56:57], v[56:57], v[156:157] op_sel:[0,0] op_sel_hi:[1,0]
  v_pk_add_f32 v[58:59], v[58:59], v[156:157] op_sel:[0,0] op_sel_hi:[1,0]
  v_pk_add_f32 v[60:61], v[60:61], v[156:157] op_sel:[0,1] op_sel_hi:[1,1]
  v_pk_add_f32 v[62:63], v[62:63], v[156:157] op_sel:[0,1] op_sel_hi:[1,1]
  v_pk_mul_f32 v[56:57], v[56:57], v[158:159]
  v_pk_mul_f32 v[58:59], v[58:59], v[160:161]
  v_pk_mul_f32 v[60:61], v[60:61], v[162:163]
  v_pk_mul_f32 v[62:63], v[62:63], v[164:165]
  v_cvt_pk_bf16_f32 v14, v56, v57
  v_cvt_pk_bf16_f32 v15, v58, v59
  v_cvt_pk_bf16_f32 v32, v60, v61
  v_cvt_pk_bf16_f32 v33, v62, v63
  s_add_u32 s43, s40, 0
  buffer_store_dwordx4 v[12:15], v3, s[8:11], s43 offen sc1
  s_add_u32 s43, s40, 1024
  buffer_store_dwordx4 v[30:33], v3, s[8:11], s43 offen sc1
  v_lshlrev_b32 v158, 16, v208
  v_and_b32 v159, 0xffff0000, v208
  v_lshlrev_b32 v160, 16, v209
  v_and_b32 v161, 0xffff0000, v209
  v_lshlrev_b32 v162, 16, v210
  v_and_b32 v163, 0xffff0000, v210
  v_lshlrev_b32 v164, 16, v211
  v_and_b32 v165, 0xffff0000, v211
  v_pk_add_f32 v[64:65], v[64:65], v[156:157] op_sel:[0,0] op_sel_hi:[1,0]
  v_pk_add_f32 v[66:67], v[66:67], v[156:157] op_sel:[0,0] op_sel_hi:[1,0]
  v_pk_add_f32 v[68:69], v[68:69], v[156:157] op_sel:[0,1] op_sel_hi:[1,1]
  v_pk_add_f32 v[70:71], v[70:71], v[156:157] op_sel:[0,1] op_sel_hi:[1,1]
  v_pk_mul_f32 v[64:65], v[64:65], v[158:159]
  v_pk_mul_f32 v[66:67], v[66:67], v[160:161]
  v_pk_mul_f32 v[68:69], v[68:69], v[162:163]
  v_pk_mul_f32 v[70:71], v[70:71], v[164:165]
  v_cvt_pk_bf16_f32 v16, v64, v65
  v_cvt_pk_bf16_f32 v17, v66, v67
  v_cvt_pk_bf16_f32 v34, v68, v69
  v_cvt_pk_bf16_f32 v35, v70, v71
  v_lshlrev_b32 v158, 16, v212
  v_and_b32 v159, 0xffff0000, v212
  v_lshlrev_b32 v160, 16, v213
  v_and_b32 v161, 0xffff0000, v213
  v_lshlrev_b32 v162, 16, v214
  v_and_b32 v163, 0xffff0000, v214
  v_lshlrev_b32 v164, 16, v215
  v_and_b32 v165, 0xffff0000, v215
  v_pk_add_f32 v[72:73], v[72:73], v[156:157] op_sel:[0,0] op_sel_hi:[1,0]
  v_pk_add_f32 v[74:75], v[74:75], v[156:157] op_sel:[0,0] op_sel_hi:[1,0]
  v_pk_add_f32 v[76:77], v[76:77], v[156:157] op_sel:[0,1] op_sel_hi:[1,1]
  v_pk_add_f32 v[78:79], v[78:79], v[156:157] op_sel:[0,1] op_sel_hi:[1,1]
  v_pk_mul_f32 v[72:73], v[72:73], v[158:159]
  v_pk_mul_f32 v[74:75], v[74:75], v[160:161]
  v_pk_mul_f32 v[76:77], v[76:77], v[162:163]
  v_pk_mul_f32 v[78:79], v[78:79], v[164:165]
  v_cvt_pk_bf16_f32 v18, v72, v73
  v_cvt_pk_bf16_f32 v19, v74, v75
  v_cvt_pk_bf16_f32 v36, v76, v77
  v_cvt_pk_bf16_f32 v37, v78, v79
  s_add_u32 s43, s40, 4096
  buffer_store_dwordx4 v[16:19], v3, s[8:11], s43 offen sc1
  s_add_u32 s43, s40, 5120
  buffer_store_dwordx4 v[34:37], v3, s[8:11], s43 offen sc1
  v_lshlrev_b32 v158, 16, v216
  v_and_b32 v159, 0xffff0000, v216
  v_lshlrev_b32 v160, 16, v217
  v_and_b32 v161, 0xffff0000, v217
  v_lshlrev_b32 v162, 16, v218
  v_and_b32 v163, 0xffff0000, v218
  v_lshlrev_b32 v164, 16, v219
  v_and_b32 v165, 0xffff0000, v219
  v_pk_add_f32 v[80:81], v[80:81], v[156:157] op_sel:[0,0] op_sel_hi:[1,0]
  v_pk_add_f32 v[82:83], v[82:83], v[156:157] op_sel:[0,0] op_sel_hi:[1,0]
  v_pk_add_f32 v[84:85], v[84:85], v[156:157] op_sel:[0,1] op_sel_hi:[1,1]
  v_pk_add_f32 v[86:87], v[86:87], v[156:157] op_sel:[0,1] op_sel_hi:[1,1]
  v_pk_mul_f32 v[80:81], v[80:81], v[158:159]
  v_pk_mul_f32 v[82:83], v[82:83], v[160:161]
  v_pk_mul_f32 v[84:85], v[84:85], v[162:163]
  v_pk_mul_f32 v[86:87], v[86:87], v[164:165]
  v_cvt_pk_bf16_f32 v20, v80, v81
  v_cvt_pk_bf16_f32 v21, v82, v83
  v_cvt_pk_bf16_f32 v38, v84, v85
  v_cvt_pk_bf16_f32 v39, v86, v87
  v_lshlrev_b32 v158, 16, v220
  v_and_b32 v159, 0xffff0000, v220
  v_lshlrev_b32 v160, 16, v221
  v_and_b32 v161, 0xffff0000, v221
  v_lshlrev_b32 v162, 16, v222
  v_and_b32 v163, 0xffff0000, v222
  v_lshlrev_b32 v164, 16, v223
  v_and_b32 v165, 0xffff0000, v223
  v_pk_add_f32 v[88:89], v[88:89], v[156:157] op_sel:[0,0] op_sel_hi:[1,0]
  v_pk_add_f32 v[90:91], v[90:91], v[156:157] op_sel:[0,0] op_sel_hi:[1,0]
  v_pk_add_f32 v[92:93], v[92:93], v[156:157] op_sel:[0,1] op_sel_hi:[1,1]
  v_pk_add_f32 v[94:95], v[94:95], v[156:157] op_sel:[0,1] op_sel_hi:[1,1]
  v_pk_mul_f32 v[88:89], v[88:89], v[158:159]
  v_pk_mul_f32 v[90:91], v[90:91], v[160:161]
  v_pk_mul_f32 v[92:93], v[92:93], v[162:163]
  v_pk_mul_f32 v[94:95], v[94:95], v[164:165]
  v_cvt_pk_bf16_f32 v22, v88, v89
  v_cvt_pk_bf16_f32 v23, v90, v91
  v_cvt_pk_bf16_f32 v40, v92, v93
  v_cvt_pk_bf16_f32 v41, v94, v95
  s_add_u32 s43, s40, 8192
  buffer_store_dwordx4 v[20:23], v3, s[8:11], s43 offen sc1
  s_add_u32 s43, s40, 9216
  buffer_store_dwordx4 v[38:41], v3, s[8:11], s43 offen sc1
  v_lshlrev_b32 v158, 16, v224
  v_and_b32 v159, 0xffff0000, v224
  v_lshlrev_b32 v160, 16, v225
  v_and_b32 v161, 0xffff0000, v225
  v_lshlrev_b32 v162, 16, v226
  v_and_b32 v163, 0xffff0000, v226
  v_lshlrev_b32 v164, 16, v227
  v_and_b32 v165, 0xffff0000, v227
  v_pk_add_f32 v[96:97], v[96:97], v[156:157] op_sel:[0,0] op_sel_hi:[1,0]
  v_pk_add_f32 v[98:99], v[98:99], v[156:157] op_sel:[0,0] op_sel_hi:[1,0]
  v_pk_add_f32 v[100:101], v[100:101], v[156:157] op_sel:[0,1] op_sel_hi:[1,1]
  v_pk_add_f32 v[102:103], v[102:103], v[156:157] op_sel:[0,1] op_sel_hi:[1,1]
  v_pk_mul_f32 v[96:97], v[96:97], v[158:159]
  v_pk_mul_f32 v[98:99], v[98:99], v[160:161]
  v_pk_mul_f32 v[100:101], v[100:101], v[162:163]
  v_pk_mul_f32 v[102:103], v[102:103], v[164:165]
  v_cvt_pk_bf16_f32 v24, v96, v97
  v_cvt_pk_bf16_f32 v25, v98, v99
  v_cvt_pk_bf16_f32 v42, v100, v101
  v_cvt_pk_bf16_f32 v43, v102, v103
  v_lshlrev_b32 v158, 16, v228
  v_and_b32 v159, 0xffff0000, v228
  v_lshlrev_b32 v160, 16, v229
  v_and_b32 v161, 0xffff0000, v229
  v_lshlrev_b32 v162, 16, v230
  v_and_b32 v163, 0xffff0000, v230
  v_lshlrev_b32 v164, 16, v231
  v_and_b32 v165, 0xffff0000, v231
  v_pk_add_f32 v[104:105], v[104:105], v[156:157] op_sel:[0,0] op_sel_hi:[1,0]
  v_pk_add_f32 v[106:107], v[106:107], v[156:157] op_sel:[0,0] op_sel_hi:[1,0]
  v_pk_add_f32 v[108:109], v[108:109], v[156:157] op_sel:[0,1] op_sel_hi:[1,1]
  v_pk_add_f32 v[110:111], v[110:111], v[156:157] op_sel:[0,1] op_sel_hi:[1,1]
  v_pk_mul_f32 v[104:105], v[104:105], v[158:159]
  v_pk_mul_f32 v[106:107], v[106:107], v[160:161]
  v_pk_mul_f32 v[108:109], v[108:109], v[162:163]
  v_pk_mul_f32 v[110:111], v[110:111], v[164:165]
  v_cvt_pk_bf16_f32 v26, v104, v105
  v_cvt_pk_bf16_f32 v27, v106, v107
  v_cvt_pk_bf16_f32 v44, v108, v109
  v_cvt_pk_bf16_f32 v45, v110, v111
  s_add_u32 s43, s40, 12288
  buffer_store_dwordx4 v[24:27], v3, s[8:11], s43 offen sc1
  s_add_u32 s43, s40, 13312
  buffer_store_dwordx4 v[42:45], v3, s[8:11], s43 offen sc1
  v_lshlrev_b32 v158, 16, v232
  v_and_b32 v159, 0xffff0000, v232
  v_lshlrev_b32 v160, 16, v233
  v_and_b32 v161, 0xffff0000, v233
  v_lshlrev_b32 v162, 16, v234
  v_and_b32 v163, 0xffff0000, v234
  v_lshlrev_b32 v164, 16, v235
  v_and_b32 v165, 0xffff0000, v235
  v_pk_add_f32 v[112:113], v[112:113], v[156:157] op_sel:[0,0] op_sel_hi:[1,0]
  v_pk_add_f32 v[114:115], v[114:115], v[156:157] op_sel:[0,0] op_sel_hi:[1,0]
  v_pk_add_f32 v[116:117], v[116:117], v[156:157] op_sel:[0,1] op_sel_hi:[1,1]
  v_pk_add_f32 v[118:119], v[118:119], v[156:157] op_sel:[0,1] op_sel_hi:[1,1]
  v_pk_mul_f32 v[112:113], v[112:113], v[158:159]
  v_pk_mul_f32 v[114:115], v[114:115], v[160:161]
  v_pk_mul_f32 v[116:117], v[116:117], v[162:163]
  v_pk_mul_f32 v[118:119], v[118:119], v[164:165]
  v_cvt_pk_bf16_f32 v28, v112, v113
  v_cvt_pk_bf16_f32 v29, v114, v115
  v_cvt_pk_bf16_f32 v46, v116, v117
  v_cvt_pk_bf16_f32 v47, v118, v119
  s_add_u32 s43, s40, 16384
  buffer_store_dwordx2 v[28:29], v9, s[8:11], s43 offen sc1
  s_add_u32 s43, s40, 17408
  buffer_store_dwordx2 v[46:47], v9, s[8:11], s43 offen sc1
  s_branch kg_join_19
kg_odd_18:
  v_lshlrev_b32 v158, 16, v200
  v_and_b32 v159, 0xffff0000, v200
  v_lshlrev_b32 v160, 16, v201
  v_and_b32 v161, 0xffff0000, v201
  v_lshlrev_b32 v162, 16, v202
  v_and_b32 v163, 0xffff0000, v202
  v_lshlrev_b32 v164, 16, v203
  v_and_b32 v165, 0xffff0000, v203
  v_pk_add_f32 v[48:49], v[48:49], v[156:157] op_sel:[0,0] op_sel_hi:[1,0]
  v_pk_add_f32 v[50:51], v[50:51], v[156:157] op_sel:[0,0] op_sel_hi:[1,0]
  v_pk_add_f32 v[52:53], v[52:53], v[156:157] op_sel:[0,1] op_sel_hi:[1,1]
  v_pk_add_f32 v[54:55], v[54:55], v[156:157] op_sel:[0,1] op_sel_hi:[1,1]
  v_pk_mul_f32 v[48:49], v[48:49], v[158:159]
  v_pk_mul_f32 v[50:51], v[50:51], v[160:161]
  v_pk_mul_f32 v[52:53], v[52:53], v[162:163]
  v_pk_mul_f32 v[54:55], v[54:55], v[164:165]
  v_cvt_pk_bf16_f32 v12, v48, v49
  v_cvt_pk_bf16_f32 v13, v50, v51
  v_cvt_pk_bf16_f32 v30, v52, v53
  v_cvt_pk_bf16_f32 v31, v54, v55
  s_add_u32 s43, s40, 512
  buffer_store_dwordx2 v[12:13], v9, s[8:11], s43 offen sc1
  s_add_u32 s43, s40, 1536
  buffer_store_dwordx2 v[30:31], v9, s[8:11], s43 offen sc1
  v_lshlrev_b32 v158, 16, v204
  v_and_b32 v159, 0xffff0000, v204
  v_lshlrev_b32 v160, 16, v205
  v_and_b32 v161, 0xffff0000, v205
  v_lshlrev_b32 v162, 16, v206
  v_and_b32 v163, 0xffff0000, v206
  v_lshlrev_b32 v164, 16, v207
  v_and_b32 v165, 0xffff0000, v207
  v_pk_add_f32 v[56:57], v[56:57], v[156:157] op_sel:[0,0] op_sel_hi:[1,0]
  v_pk_add_f32 v[58:59], v[58:59], v[156:157] op_sel:[0,0] op_sel_hi:[1,0]
  v_pk_add_f32 v[60:61], v[60:61], v[156:157] op_sel:[0,1] op_sel_hi:[1,1]
  v_pk_add_f32 v[62:63], v[62:63], v[156:157] op_sel:[0,1] op_sel_hi:[1,1]
  v_pk_mul_f32 v[56:57], v[56:57], v[158:159]
  v_pk_mul_f32 v[58:59], v[58:59], v[160:161]
  v_pk_mul_f32 v[60:61], v[60:61], v[162:163]
  v_pk_mul_f32 v[62:63], v[62:63], v[164:165]
  v_cvt_pk_bf16_f32 v14, v56, v57
  v_cvt_pk_bf16_f32 v15, v58, v59
  v_cvt_pk_bf16_f32 v32, v60, v61
  v_cvt_pk_bf16_f32 v33, v62, v63
  v_lshlrev_b32 v158, 16, v208
  v_and_b32 v159, 0xffff0000, v208
  v_lshlrev_b32 v160, 16, v209
  v_and_b32 v161, 0xffff0000, v209
  v_lshlrev_b32 v162, 16, v210
  v_and_b32 v163, 0xffff0000, v210
  v_lshlrev_b32 v164, 16, v211
  v_and_b32 v165, 0xffff0000, v211
  v_pk_add_f32 v[64:65], v[64:65], v[156:157] op_sel:[0,0] op_sel_hi:[1,0]
  v_pk_add_f32 v[66:67], v[66:67], v[156:157] op_sel:[0,0] op_sel_hi:[1,0]
  v_pk_add_f32 v[68:69], v[68:69], v[156:157] op_sel:[0,1] op_sel_hi:[1,1]
  v_pk_add_f32 v[70:71], v[70:71], v[156:157] op_sel:[0,1] op_sel_hi:[1,1]
  v_pk_mul_f32 v[64:65], v[64:65], v[158:159]
  v_pk_mul_f32 v[66:67], v[66:67], v[160:161]
  v_pk_mul_f32 v[68:69], v[68:69], v[162:163]
  v_pk_mul_f32 v[70:71], v[70:71], v[164:165]
  v_cvt_pk_bf16_f32 v16, v64, v65
  v_cvt_pk_bf16_f32 v17, v66, v67
  v_cvt_pk_bf16_f32 v34, v68, v69
  v_cvt_pk_bf16_f32 v35, v70, v71
  s_add_u32 s43, s40, 4096
  buffer_store_dwordx4 v[14:17], v3, s[8:11], s43 offen sc1
  s_add_u32 s43, s40, 5120
  buffer_store_dwordx4 v[32:35], v3, s[8:11], s43 offen sc1
  v_lshlrev_b32 v158, 16, v212
  v_and_b32 v159, 0xffff0000, v212
  v_lshlrev_b32 v160, 16, v213
  v_and_b32 v161, 0xffff0000, v213
  v_lshlrev_b32 v162, 16, v214
  v_and_b32 v163, 0xffff0000, v214
  v_lshlrev_b32 v164, 16, v215
  v_and_b32 v165, 0xffff0000, v215
  v_pk_add_f32 v[72:73], v[72:73], v[156:157] op_sel:[0,0] op_sel_hi:[1,0]
  v_pk_add_f32 v[74:75], v[74:75], v[156:157] op_sel:[0,0] op_sel_hi:[1,0]
  v_pk_add_f32 v[76:77], v[76:77], v[156:157] op_sel:[0,1] op_sel_hi:[1,1]
  v_pk_add_f32 v[78:79], v[78:79], v[156:157] op_sel:[0,1] op_sel_hi:[1,1]
  v_pk_mul_f32 v[72:73], v[72:73], v[158:159]
  v_pk_mul_f32 v[74:75], v[74:75], v[160:161]
  v_pk_mul_f32 v[76:77], v[76:77], v[162:163]
  v_pk_mul_f32 v[78:79], v[78:79], v[164:165]
  v_cvt_pk_bf16_f32 v18, v72, v73
  v_cvt_pk_bf16_f32 v19, v74, v75
  v_cvt_pk_bf16_f32 v36, v76, v77
  v_cvt_pk_bf16_f32 v37, v78, v79
  v_lshlrev_b32 v158, 16, v216
  v_and_b32 v159, 0xffff0000, v216
  v_lshlrev_b32 v160, 16, v217
  v_and_b32 v161, 0xffff0000, v217
  v_lshlrev_b32 v162, 16, v218
  v_and_b32 v163, 0xffff0000, v218
  v_lshlrev_b32 v164, 16, v219
  v_and_b32 v165, 0xffff0000, v219
  v_pk_add_f32 v[80:81], v[80:81], v[156:157] op_sel:[0,0] op_sel_hi:[1,0]
  v_pk_add_f32 v[82:83], v[82:83], v[156:157] op_sel:[0,0] op_sel_hi:[1,0]
  v_pk_add_f32 v[84:85], v[84:85], v[156:157] op_sel:[0,1] op_sel_hi:[1,1]
  v_pk_add_f32 v[86:87], v[86:87], v[156:157] op_sel:[0,1] op_sel_hi:[1,1]
  v_pk_mul_f32 v[80:81], v[80:81], v[158:159]
  v_pk_mul_f32 v[82:83], v[82:83], v[160:161]
  v_pk_mul_f32 v[84:85], v[84:85], v[162:163]
  v_pk_mul_f32 v[86:87], v[86:87], v[164:165]
  v_cvt_pk_bf16_f32 v20, v80, v81
  v_cvt_pk_bf16_f32 v21, v82, v83
  v_cvt_pk_bf16_f32 v38, v84, v85
  v_cvt_pk_bf16_f32 v39, v86, v87
  s_add_u32 s43, s40, 8192
  buffer_store_dwordx4 v[18:21], v3, s[8:11], s43 offen sc1
  s_add_u32 s43, s40, 9216
  buffer_store_dwordx4 v[36:39], v3, s[8:11], s43 offen sc1
  v_lshlrev_b32 v158, 16, v220
  v_and_b32 v159, 0xffff0000, v220
  v_lshlrev_b32 v160, 16, v221
  v_and_b32 v161, 0xffff0000, v221
  v_lshlrev_b32 v162, 16, v222
  v_and_b32 v163, 0xffff0000, v222
  v_lshlrev_b32 v164, 16, v223
  v_and_b32 v165, 0xffff0000, v223
  v_pk_add_f32 v[88:89], v[88:89], v[156:157] op_sel:[0,0] op_sel_hi:[1,0]
  v_pk_add_f32 v[90:91], v[90:91], v[156:157] op_sel:[0,0] op_sel_hi:[1,0]
  v_pk_add_f32 v[92:93], v[92:93], v[156:157] op_sel:[0,1] op_sel_hi:[1,1]
  v_pk_add_f32 v[94:95], v[94:95], v[156:157] op_sel:[0,1] op_sel_hi:[1,1]
  v_pk_mul_f32 v[88:89], v[88:89], v[158:159]
  v_pk_mul_f32 v[90:91], v[90:91], v[160:161]
  v_pk_mul_f32 v[92:93], v[92:93], v[162:163]
  v_pk_mul_f32 v[94:95], v[94:95], v[164:165]
  v_cvt_pk_bf16_f32 v22, v88, v89
  v_cvt_pk_bf16_f32 v23, v90, v91
  v_cvt_pk_bf16_f32 v40, v92, v93
  v_cvt_pk_bf16_f32 v41, v94, v95
  v_lshlrev_b32 v158, 16, v224
  v_and_b32 v159, 0xffff0000, v224
  v_lshlrev_b32 v160, 16, v225
  v_and_b32 v161, 0xffff0000, v225
  v_lshlrev_b32 v162, 16, v226
  v_and_b32 v163, 0xffff0000, v226
  v_lshlrev_b32 v164, 16, v227
  v_and_b32 v165, 0xffff0000, v227
  v_pk_add_f32 v[96:97], v[96:97], v[156:157] op_sel:[0,0] op_sel_hi:[1,0]
  v_pk_add_f32 v[98:99], v[98:99], v[156:157] op_sel:[0,0] op_sel_hi:[1,0]
  v_pk_add_f32 v[100:101], v[100:101], v[156:157] op_sel:[0,1] op_sel_hi:[1,1]
  v_pk_add_f32 v[102:103], v[102:103], v[156:157] op_sel:[0,1] op_sel_hi:[1,1]
  v_pk_mul_f32 v[96:97], v[96:97], v[158:159]
  v_pk_mul_f32 v[98:99], v[98:99], v[160:161]
  v_pk_mul_f32 v[100:101], v[100:101], v[162:163]
  v_pk_mul_f32 v[102:103], v[102:103], v[164:165]
  v_cvt_pk_bf16_f32 v24, v96, v97
  v_cvt_pk_bf16_f32 v25, v98, v99
  v_cvt_pk_bf16_f32 v42, v100, v101
  v_cvt_pk_bf16_f32 v43, v102, v103
  s_add_u32 s43, s40, 12288
  buffer_store_dwordx4 v[22:25], v3, s[8:11], s43 offen sc1
  s_add_u32 s43, s40, 13312
  buffer_store_dwordx4 v[40:43], v3, s[8:11], s43 offen sc1
  v_lshlrev_b32 v158, 16, v228
  v_and_b32 v159, 0xffff0000, v228
  v_lshlrev_b32 v160, 16, v229
  v_and_b32 v161, 0xffff0000, v229
  v_lshlrev_b32 v162, 16, v230
  v_and_b32 v163, 0xffff0000, v230
  v_lshlrev_b32 v164, 16, v231
  v_and_b32 v165, 0xffff0000, v231
  v_pk_add_f32 v[104:105], v[104:105], v[156:157] op_sel:[0,0] op_sel_hi:[1,0]
  v_pk_add_f32 v[106:107], v[106:107], v[156:157] op_sel:[0,0] op_sel_hi:[1,0]
  v_pk_add_f32 v[108:109], v[108:109], v[156:157] op_sel:[0,1] op_sel_hi:[1,1]
  v_pk_add_f32 v[110:111], v[110:111], v[156:157] op_sel:[0,1] op_sel_hi:[1,1]
  v_pk_mul_f32 v[104:105], v[104:105], v[158:159]
  v_pk_mul_f32 v[106:107], v[106:107], v[160:161]
  v_pk_mul_f32 v[108:109], v[108:109], v[162:163]
  v_pk_mul_f32 v[110:111], v[110:111], v[164:165]
  v_cvt_pk_bf16_f32 v26, v104, v105
  v_cvt_pk_bf16_f32 v27, v106, v107
  v_cvt_pk_bf16_f32 v44, v108, v109
  v_cvt_pk_bf16_f32 v45, v110, v111
  v_lshlrev_b32 v158, 16, v232
  v_and_b32 v159, 0xffff0000, v232
  v_lshlrev_b32 v160, 16, v233
  v_and_b32 v161, 0xffff0000, v233
  v_lshlrev_b32 v162, 16, v234
  v_and_b32 v163, 0xffff0000, v234
  v_lshlrev_b32 v164, 16, v235
  v_and_b32 v165, 0xffff0000, v235
  v_pk_add_f32 v[112:113], v[112:113], v[156:157] op_sel:[0,0] op_sel_hi:[1,0]
  v_pk_add_f32 v[114:115], v[114:115], v[156:157] op_sel:[0,0] op_sel_hi:[1,0]
  v_pk_add_f32 v[116:117], v[116:117], v[156:157] op_sel:[0,1] op_sel_hi:[1,1]
  v_pk_add_f32 v[118:119], v[118:119], v[156:157] op_sel:[0,1] op_sel_hi:[1,1]
  v_pk_mul_f32 v[112:113], v[112:113], v[158:159]
  v_pk_mul_f32 v[114:115], v[114:115], v[160:161]
  v_pk_mul_f32 v[116:117], v[116:117], v[162:163]
  v_pk_mul_f32 v[118:119], v[118:119], v[164:165]
  v_cvt_pk_bf16_f32 v28, v112, v113
  v_cvt_pk_bf16_f32 v29, v114, v115
  v_cvt_pk_bf16_f32 v46, v116, v117
  v_cvt_pk_bf16_f32 v47, v118, v119
  s_add_u32 s43, s40, 16384
  buffer_store_dwordx4 v[26:29], v3, s[8:11], s43 offen sc1
  s_add_u32 s43, s40, 17408
  buffer_store_dwordx4 v[44:47], v3, s[8:11], s43 offen sc1
kg_join_19:
  s_lshl_b32 s56, s16, 1
  s_lshr_b32 s57, s17, 3
  s_add_u32 s56, s56, s57
  s_and_b32 s57, s17, 7
  s_load_dwordx2 s[4:5], s[0:1], 128
  s_cmp_ge_u32 s57, 4
  s_cbranch_scc1 kg_n4_20
  s_mul_i32 s21, s57, 80
  s_mul_i32 s22, s57, 5120
  s_mul_i32 s23, s20, 663552
  s_add_u32 s22, s22, s23
  s_add_u32 s22, s22, 23068672
  s_mul_i32 s24, s56, 294912
  s_mul_i32 s23, s20, 73728
  s_add_u32 s24, s24, s23
  s_add_u32 s24, s24, 56623104
  v_lshlrev_b32 v11, 3, v1
  s_add_u32 s26, s22, 0
  buffer_load_dwordx4 v[48:51], v3, s[8:11], s26 offen
  buffer_load_dwordx4 v[52:55], v3, s[8:11], s26 offen offset:1024
  buffer_load_dwordx4 v[56:59], v3, s[8:11], s26 offen offset:2048
  buffer_load_dwordx4 v[60:63], v3, s[8:11], s26 offen offset:3072
  s_add_u32 s26, s26, 4096
  buffer_load_dwordx4 v[64:67], v3, s[8:11], s26 offen
  s_add_u32 s26, s22, 36864
  buffer_load_dwordx4 v[84:87], v3, s[8:11], s26 offen
  buffer_load_dwordx4 v[88:91], v3, s[8:11], s26 offen offset:1024
  buffer_load_dwordx4 v[92:95], v3, s[8:11], s26 offen offset:2048
  buffer_load_dwordx4 v[96:99], v3, s[8:11], s26 offen offset:3072
  s_add_u32 s26, s26, 4096
  buffer_load_dwordx4 v[100:103], v3, s[8:11], s26 offen
  s_add_u32 s26, s22, 73728
  buffer_load_dwordx4 v[120:123], v3, s[8:11], s26 offen
  buffer_load_dwordx4 v[124:127], v3, s[8:11], s26 offen offset:1024
  buffer_load_dwordx4 v[128:131], v3, s[8:11], s26 offen offset:2048
  buffer_load_dwordx4 v[132:135], v3, s[8:11], s26 offen offset:3072
  s_add_u32 s26, s26, 4096
  buffer_load_dwordx4 v[136:139], v3, s[8:11], s26 offen
  s_add_u32 s26, s22, 110592
  buffer_load_dwordx4 v[156:159], v3, s[8:11], s26 offen
  buffer_load_dwordx4 v[160:163], v3, s[8:11], s26 offen offset:1024
  buffer_load_dwordx4 v[164:167], v3, s[8:11], s26 offen offset:2048
  buffer_load_dwordx4 v[168:171], v3, s[8:11], s26 offen offset:3072
  s_add_u32 s26, s26, 4096
  buffer_load_dwordx4 v[172:175], v3, s[8:11], s26 offen
  s_lshr_b32 s27, s56, 1
  s_mul_i32 s27, s27, 147456
  s_lshl_b32 s28, s21, 8
  s_add_u32 s27, s27, s28
  s_mul_i32 s28, s20, 5120
  s_add_u32 s27, s27, s28
  s_add_u32 s27, s27, 7340032
  s_add_u32 m0, s28, 81920
  s_nop 0
  buffer_load_dwordx4 v3, s[8:11], s27 offen lds
  buffer_load_dwordx4 v3, s[8:11], s27 offen offset:1024 lds
  buffer_load_dwordx4 v3, s[8:11], s27 offen offset:2048 lds
  buffer_load_dwordx4 v3, s[8:11], s27 offen offset:3072 lds
  s_add_u32 m0, s28, 86016
  s_add_u32 s27, s27, 4096
  buffer_load_dwordx4 v3, s[8:11], s27 offen lds
  v_lshlrev_b32 v8, 4, v7
  s_lshl_b32 s29, s21, 2
  s_add_u32 s29, s29, 11520
  buffer_load_dwordx4 v[228:231], v8, s[8:11], s29 offen
  buffer_load_dwordx4 v[232:235], v8, s[8:11], s29 offen offset:64
  buffer_load_dwordx4 v[236:239], v8, s[8:11], s29 offen offset:128
  buffer_load_dwordx4 v[240:243], v8, s[8:11], s29 offen offset:192
  buffer_load_dwordx4 v[244:247], v8, s[8:11], s29 offen offset:256
  s_waitcnt vmcnt(30)
  s_barrier
  s_cmp_lg_u32 s20, 0
  s_cbranch_scc1 kg_sig_21
  s_lshl_b32 s90, s16, 8
  s_add_u32 s90, s90, 94208
  v_mov_b32 v250, 1
  v_mov_b32 v251, 0
  s_mov_b64 exec, 1
  buffer_atomic_add v250, v251, s[8:11], s90 offen sc1
  s_mov_b64 exec, -1
kg_sig_21:
  s_cmp_lg_u32 s20, 0
  s_cbranch_scc1 kg_polled_22
  v_mov_b32 v251, 0
  s_lshl_b32 s90, s16, 8
  s_add_u32 s90, s90, 94208
  s_mov_b32 s91, 0x100000
kg_poll_23:
  buffer_load_dword v250, v251, s[8:11], s90 offen sc1
  s_waitcnt vmcnt(0)
  v_readfirstlane_b32 s92, v250
  s_sub_u32 s91, s91, 1
  s_cmp_eq_u32 s91, 0
  s_cbranch_scc1 kg_ok_24
  s_cmp_ge_u32 s92, 16
  s_cbranch_scc1 kg_ok_24
  s_sleep 1
  s_branch kg_poll_23
kg_ok_24:
kg_polled_22:
  s_barrier
  s_add_u32 s25, s24, 0
  buffer_load_dwordx4 v[68:71], v3, s[8:11], s25 offen sc1
  buffer_load_dwordx4 v[72:75], v3, s[8:11], s25 offen offset:1024 sc1
  buffer_load_dwordx4 v[76:79], v3, s[8:11], s25 offen offset:2048 sc1
  buffer_load_dwordx4 v[80:83], v3, s[8:11], s25 offen offset:3072 sc1
  s_add_u32 s25, s24, 4096
  buffer_load_dwordx4 v[104:107], v3, s[8:11], s25 offen sc1
  buffer_load_dwordx4 v[108:111], v3, s[8:11], s25 offen offset:1024 sc1
  buffer_load_dwordx4 v[112:115], v3, s[8:11], s25 offen offset:2048 sc1
  buffer_load_dwordx4 v[116:119], v3, s[8:11], s25 offen offset:3072 sc1
  s_waitcnt vmcnt(4)
  v_mfma_f32_16x16x32_bf16 a[0:3], v[48:51], v[68:71], 0
  s_add_u32 s25, s24, 8192
  buffer_load_dwordx4 v[140:143], v3, s[8:11], s25 offen sc1
  v_mfma_f32_16x16x32_bf16 a[4:7], v[48:51], v[72:75], 0
  buffer_load_dwordx4 v[144:147], v3, s[8:11], s25 offen offset:1024 sc1
  v_mfma_f32_16x16x32_bf16 a[8:11], v[48:51], v[76:79], 0
  buffer_load_dwordx4 v[148:151], v3, s[8:11], s25 offen offset:2048 sc1
  v_mfma_f32_16x16x32_bf16 a[12:15], v[48:51], v[80:83], 0
  buffer_load_dwordx4 v[152:155], v3, s[8:11], s25 offen offset:3072 sc1
  v_mfma_f32_16x16x32_bf16 a[16:19], v[52:55], v[68:71], 0
  s_add_u32 s25, s24, 12288
  buffer_load_dwordx4 v[176:179], v3, s[8:11], s25 offen sc1
  v_mfma_f32_16x16x32_bf16 a[20:23], v[52:55], v[72:75], 0
  buffer_load_dwordx4 v[180:183], v3, s[8:11], s25 offen offset:1024 sc1
  v_mfma_f32_16x16x32_bf16 a[24:27], v[52:55], v[76:79], 0
  buffer_load_dwordx4 v[184:187], v3, s[8:11], s25 offen offset:2048 sc1
  v_mfma_f32_16x16x32_bf16 a[28:31], v[52:55], v[80:83], 0
  buffer_load_dwordx4 v[188:191], v3, s[8:11], s25 offen offset:3072 sc1
  v_mfma_f32_16x16x32_bf16 a[32:35], v[56:59], v[68:71], 0
  s_add_u32 s25, s24, 16384
  buffer_load_dwordx2 v[212:213], v11, s[8:11], s25 offen sc1
  v_mfma_f32_16x16x32_bf16 a[36:39], v[56:59], v[72:75], 0
  buffer_load_dwordx2 v[214:215], v11, s[8:11], s25 offen offset:512 sc1
  v_mfma_f32_16x16x32_bf16 a[40:43], v[56:59], v[76:79], 0
  buffer_load_dwordx2 v[216:217], v11, s[8:11], s25 offen offset:1024 sc1
  v_mfma_f32_16x16x32_bf16 a[44:47], v[56:59], v[80:83], 0
  buffer_load_dwordx2 v[218:219], v11, s[8:11], s25 offen offset:1536 sc1
  v_mfma_f32_16x16x32_bf16 a[48:51], v[60:63], v[68:71], 0
  v_mfma_f32_16x16x32_bf16 a[52:55], v[60:63], v[72:75], 0
  buffer_load_dwordx2 v[220:221], v11, s[8:11], s25 offen offset:2048 sc1
  v_mfma_f32_16x16x32_bf16 a[56:59], v[60:63], v[76:79], 0
  v_mfma_f32_16x16x32_bf16 a[60:63], v[60:63], v[80:83], 0
  buffer_load_dwordx2 v[222:223], v11, s[8:11], s25 offen offset:2560 sc1
  v_mfma_f32_16x16x32_bf16 a[64:67], v[64:67], v[68:71], 0
  v_mfma_f32_16x16x32_bf16 a[68:71], v[64:67], v[72:75], 0
  buffer_load_dwordx2 v[224:225], v11, s[8:11], s25 offen offset:3072 sc1
  v_mfma_f32_16x16x32_bf16 a[72:75], v[64:67], v[76:79], 0
  v_mfma_f32_16x16x32_bf16 a[76:79], v[64:67], v[80:83], 0
  buffer_load_dwordx2 v[226:227], v11, s[8:11], s25 offen offset:3584 sc1
  s_add_u32 s26, s22, 147456
  buffer_load_dwordx4 v[192:195], v3, s[8:11], s26 offen
  buffer_load_dwordx4 v[196:199], v3, s[8:11], s26 offen offset:1024
  buffer_load_dwordx4 v[200:203], v3, s[8:11], s26 offen offset:2048
  buffer_load_dwordx4 v[204:207], v3, s[8:11], s26 offen offset:3072
  s_add_u32 s26, s26, 4096
  buffer_load_dwordx4 v[208:211], v3, s[8:11], s26 offen
  s_waitcnt vmcnt(21)
  v_mfma_f32_16x16x32_bf16 a[0:3], v[84:87], v[104:107], a[0:3]
  v_mfma_f32_16x16x32_bf16 a[4:7], v[84:87], v[108:111], a[4:7]
  s_add_u32 s25, s24, 20480
  buffer_load_dwordx4 v[68:71], v3, s[8:11], s25 offen sc1
  v_mfma_f32_16x16x32_bf16 a[8:11], v[84:87], v[112:115], a[8:11]
  v_mfma_f32_16x16x32_bf16 a[12:15], v[84:87], v[116:119], a[12:15]
  buffer_load_dwordx4 v[72:75], v3, s[8:11], s25 offen offset:1024 sc1
  v_mfma_f32_16x16x32_bf16 a[16:19], v[88:91], v[104:107], a[16:19]
  v_mfma_f32_16x16x32_bf16 a[20:23], v[88:91], v[108:111], a[20:23]
  buffer_load_dwordx4 v[76:79], v3, s[8:11], s25 offen offset:2048 sc1
  v_mfma_f32_16x16x32_bf16 a[24:27], v[88:91], v[112:115], a[24:27]
  v_mfma_f32_16x16x32_bf16 a[28:31], v[88:91], v[116:119], a[28:31]
  buffer_load_dwordx4 v[80:83], v3, s[8:11], s25 offen offset:3072 sc1
  v_mfma_f32_16x16x32_bf16 a[32:35], v[92:95], v[104:107], a[32:35]
  v_mfma_f32_16x16x32_bf16 a[36:39], v[92:95], v[108:111], a[36:39]
  s_add_u32 s26, s22, 184320
  buffer_load_dwordx4 v[48:51], v3, s[8:11], s26 offen
  v_mfma_f32_16x16x32_bf16 a[40:43], v[92:95], v[112:115], a[40:43]
  v_mfma_f32_16x16x32_bf16 a[44:47], v[92:95], v[116:119], a[44:47]
  buffer_load_dwordx4 v[52:55], v3, s[8:11], s26 offen offset:1024
  v_mfma_f32_16x16x32_bf16 a[48:51], v[96:99], v[104:107], a[48:51]
  v_mfma_f32_16x16x32_bf16 a[52:55], v[96:99], v[108:111], a[52:55]
  buffer_load_dwordx4 v[56:59], v3, s[8:11], s26 offen offset:2048
  v_mfma_f32_16x16x32_bf16 a[56:59], v[96:99], v[112:115], a[56:59]
  v_mfma_f32_16x16x32_bf16 a[60:63], v[96:99], v[116:119], a[60:63]
  buffer_load_dwordx4 v[60:63], v3, s[8:11], s26 offen offset:3072
  v_mfma_f32_16x16x32_bf16 a[64:67], v[100:103], v[104:107], a[64:67]
  v_mfma_f32_16x16x32_bf16 a[68:71], v[100:103], v[108:111], a[68:71]
  s_add_u32 s26, s26, 4096
  buffer_load_dwordx4 v[64:67], v3, s[8:11], s26 offen
  v_mfma_f32_16x16x32_bf16 a[72:75], v[100:103], v[112:115], a[72:75]
  v_mfma_f32_16x16x32_bf16 a[76:79], v[100:103], v[116:119], a[76:79]
  s_waitcnt vmcnt(26)
  v_mfma_f32_16x16x32_bf16 a[0:3], v[120:123], v[140:143], a[0:3]
  v_mfma_f32_16x16x32_bf16 a[4:7], v[120:123], v[144:147], a[4:7]
  s_add_u32 s25, s24, 24576
  buffer_load_dwordx4 v[104:107], v3, s[8:11], s25 offen sc1
  v_mfma_f32_16x16x32_bf16 a[8:11], v[120:123], v[148:151], a[8:11]
  v_mfma_f32_16x16x32_bf16 a[12:15], v[120:123], v[152:155], a[12:15]
  buffer_load_dwordx4 v[108:111], v3, s[8:11], s25 offen offset:1024 sc1
  v_mfma_f32_16x16x32_bf16 a[16:19], v[124:127], v[140:143], a[16:19]
  v_mfma_f32_16x16x32_bf16 a[20:23], v[124:127], v[144:147], a[20:23]
  buffer_load_dwordx4 v[112:115], v3, s[8:11], s25 offen offset:2048 sc1
  v_mfma_f32_16x16x32_bf16 a[24:27], v[124:127], v[148:151], a[24:27]
  v_mfma_f32_16x16x32_bf16 a[28:31], v[124:127], v[152:155], a[28:31]
  buffer_load_dwordx4 v[116:119], v3, s[8:11], s25 offen offset:3072 sc1
  v_mfma_f32_16x16x32_bf16 a[32:35], v[128:131], v[140:143], a[32:35]
  v_mfma_f32_16x16x32_bf16 a[36:39], v[128:131], v[144:147], a[36:39]
  s_add_u32 s26, s22, 221184
  buffer_load_dwordx4 v[84:87], v3, s[8:11], s26 offen
  v_mfma_f32_16x16x32_bf16 a[40:43], v[128:131], v[148:151], a[40:43]
  v_mfma_f32_16x16x32_bf16 a[44:47], v[128:131], v[152:155], a[44:47]
  buffer_load_dwordx4 v[88:91], v3, s[8:11], s26 offen offset:1024
  v_mfma_f32_16x16x32_bf16 a[48:51], v[132:135], v[140:143], a[48:51]
  v_mfma_f32_16x16x32_bf16 a[52:55], v[132:135], v[144:147], a[52:55]
  buffer_load_dwordx4 v[92:95], v3, s[8:11], s26 offen offset:2048
  v_mfma_f32_16x16x32_bf16 a[56:59], v[132:135], v[148:151], a[56:59]
  v_mfma_f32_16x16x32_bf16 a[60:63], v[132:135], v[152:155], a[60:63]
  buffer_load_dwordx4 v[96:99], v3, s[8:11], s26 offen offset:3072
  v_mfma_f32_16x16x32_bf16 a[64:67], v[136:139], v[140:143], a[64:67]
  v_mfma_f32_16x16x32_bf16 a[68:71], v[136:139], v[144:147], a[68:71]
  s_add_u32 s26, s26, 4096
  buffer_load_dwordx4 v[100:103], v3, s[8:11], s26 offen
  v_mfma_f32_16x16x32_bf16 a[72:75], v[136:139], v[148:151], a[72:75]
  v_mfma_f32_16x16x32_bf16 a[76:79], v[136:139], v[152:155], a[76:79]
  s_waitcnt vmcnt(31)
  v_mfma_f32_16x16x32_bf16 a[0:3], v[156:159], v[176:179], a[0:3]
  v_mfma_f32_16x16x32_bf16 a[4:7], v[156:159], v[180:183], a[4:7]
  s_add_u32 s25, s24, 28672
  buffer_load_dwordx4 v[140:143], v3, s[8:11], s25 offen sc1
  v_mfma_f32_16x16x32_bf16 a[8:11], v[156:159], v[184:187], a[8:11]
  v_mfma_f32_16x16x32_bf16 a[12:15], v[156:159], v[188:191], a[12:15]
  buffer_load_dwordx4 v[144:147], v3, s[8:11], s25 offen offset:1024 sc1
  v_mfma_f32_16x16x32_bf16 a[16:19], v[160:163], v[176:179], a[16:19]
  v_mfma_f32_16x16x32_bf16 a[20:23], v[160:163], v[180:183], a[20:23]
  buffer_load_dwordx4 v[148:151], v3, s[8:11], s25 offen offset:2048 sc1
  v_mfma_f32_16x16x32_bf16 a[24:27], v[160:163], v[184:187], a[24:27]
  v_mfma_f32_16x16x32_bf16 a[28:31], v[160:163], v[188:191], a[28:31]
  buffer_load_dwordx4 v[152:155], v3, s[8:11], s25 offen offset:3072 sc1
  v_mfma_f32_16x16x32_bf16 a[32:35], v[164:167], v[176:179], a[32:35]
  v_mfma_f32_16x16x32_bf16 a[36:39], v[164:167], v[180:183], a[36:39]
  s_add_u32 s26, s22, 258048
  buffer_load_dwordx4 v[120:123], v3, s[8:11], s26 offen
  v_mfma_f32_16x16x32_bf16 a[40:43], v[164:167], v[184:187], a[40:43]
  v_mfma_f32_16x16x32_bf16 a[44:47], v[164:167], v[188:191], a[44:47]
  buffer_load_dwordx4 v[124:127], v3, s[8:11], s26 offen offset:1024
  v_mfma_f32_16x16x32_bf16 a[48:51], v[168:171], v[176:179], a[48:51]
  v_mfma_f32_16x16x32_bf16 a[52:55], v[168:171], v[180:183], a[52:55]
  buffer_load_dwordx4 v[128:131], v3, s[8:11], s26 offen offset:2048
  v_mfma_f32_16x16x32_bf16 a[56:59], v[168:171], v[184:187], a[56:59]
  v_mfma_f32_16x16x32_bf16 a[60:63], v[168:171], v[188:191], a[60:63]
  buffer_load_dwordx4 v[132:135], v3, s[8:11], s26 offen offset:3072
  v_mfma_f32_16x16x32_bf16 a[64:67], v[172:175], v[176:179], a[64:67]
  v_mfma_f32_16x16x32_bf16 a[68:71], v[172:175], v[180:183], a[68:71]
  s_add_u32 s26, s26, 4096
  buffer_load_dwordx4 v[136:139], v3, s[8:11], s26 offen
  v_mfma_f32_16x16x32_bf16 a[72:75], v[172:175], v[184:187], a[72:75]
  v_mfma_f32_16x16x32_bf16 a[76:79], v[172:175], v[188:191], a[76:79]
  s_waitcnt vmcnt(27)
  v_mfma_f32_16x16x32_bf16 a[0:3], v[192:195], v[212:215], a[0:3]
  v_mfma_f32_16x16x32_bf16 a[4:7], v[192:195], v[216:219], a[4:7]
  s_add_u32 s25, s24, 32768
  buffer_load_dwordx4 v[176:179], v3, s[8:11], s25 offen sc1
  v_mfma_f32_16x16x32_bf16 a[8:11], v[192:195], v[220:223], a[8:11]
  v_mfma_f32_16x16x32_bf16 a[12:15], v[192:195], v[224:227], a[12:15]
  buffer_load_dwordx4 v[180:183], v3, s[8:11], s25 offen offset:1024 sc1
  v_mfma_f32_16x16x32_bf16 a[16:19], v[196:199], v[212:215], a[16:19]
  v_mfma_f32_16x16x32_bf16 a[20:23], v[196:199], v[216:219], a[20:23]
  buffer_load_dwordx4 v[184:187], v3, s[8:11], s25 offen offset:2048 sc1
  v_mfma_f32_16x16x32_bf16 a[24:27], v[196:199], v[220:223], a[24:27]
  v_mfma_f32_16x16x32_bf16 a[28:31], v[196:199], v[224:227], a[28:31]
  buffer_load_dwordx4 v[188:191], v3, s[8:11], s25 offen offset:3072 sc1
  v_mfma_f32_16x16x32_bf16 a[32:35], v[200:203], v[212:215], a[32:35]
  v_mfma_f32_16x16x32_bf16 a[36:39], v[200:203], v[216:219], a[36:39]
  s_add_u32 s26, s22, 294912
  buffer_load_dwordx4 v[156:159], v3, s[8:11], s26 offen
  v_mfma_f32_16x16x32_bf16 a[40:43], v[200:203], v[220:223], a[40:43]
  v_mfma_f32_16x16x32_bf16 a[44:47], v[200:203], v[224:227], a[44:47]
  buffer_load_dwordx4 v[160:163], v3, s[8:11], s26 offen offset:1024
  v_mfma_f32_16x16x32_bf16 a[48:51], v[204:207], v[212:215], a[48:51]
  v_mfma_f32_16x16x32_bf16 a[52:55], v[204:207], v[216:219], a[52:55]
  buffer_load_dwordx4 v[164:167], v3, s[8:11], s26 offen offset:2048
  v_mfma_f32_16x16x32_bf16 a[56:59], v[204:207], v[220:223], a[56:59]
  v_mfma_f32_16x16x32_bf16 a[60:63], v[204:207], v[224:227], a[60:63]
  buffer_load_dwordx4 v[168:171], v3, s[8:11], s26 offen offset:3072
  v_mfma_f32_16x16x32_bf16 a[64:67], v[208:211], v[212:215], a[64:67]
  v_mfma_f32_16x16x32_bf16 a[68:71], v[208:211], v[216:219], a[68:71]
  s_add_u32 s26, s26, 4096
  buffer_load_dwordx4 v[172:175], v3, s[8:11], s26 offen
  v_mfma_f32_16x16x32_bf16 a[72:75], v[208:211], v[220:223], a[72:75]
  v_mfma_f32_16x16x32_bf16 a[76:79], v[208:211], v[224:227], a[76:79]
  s_waitcnt vmcnt(27)
  v_mfma_f32_16x16x32_bf16 a[0:3], v[48:51], v[68:71], a[0:3]
  v_mfma_f32_16x16x32_bf16 a[4:7], v[48:51], v[72:75], a[4:7]
  s_add_u32 s25, s24, 36864
  buffer_load_dwordx4 v[212:215], v3, s[8:11], s25 offen sc1
  v_mfma_f32_16x16x32_bf16 a[8:11], v[48:51], v[76:79], a[8:11]
  v_mfma_f32_16x16x32_bf16 a[12:15], v[48:51], v[80:83], a[12:15]
  buffer_load_dwordx4 v[216:219], v3, s[8:11], s25 offen offset:1024 sc1
  v_mfma_f32_16x16x32_bf16 a[16:19], v[52:55], v[68:71], a[16:19]
  v_mfma_f32_16x16x32_bf16 a[20:23], v[52:55], v[72:75], a[20:23]
  buffer_load_dwordx4 v[220:223], v3, s[8:11], s25 offen offset:2048 sc1
  v_mfma_f32_16x16x32_bf16 a[24:27], v[52:55], v[76:79], a[24:27]
  v_mfma_f32_16x16x32_bf16 a[28:31], v[52:55], v[80:83], a[28:31]
  buffer_load_dwordx4 v[224:227], v3, s[8:11], s25 offen offset:3072 sc1
  v_mfma_f32_16x16x32_bf16 a[32:35], v[56:59], v[68:71], a[32:35]
  v_mfma_f32_16x16x32_bf16 a[36:39], v[56:59], v[72:75], a[36:39]
  s_add_u32 s26, s22, 331776
  buffer_load_dwordx4 v[192:195], v3, s[8:11], s26 offen
  v_mfma_f32_16x16x32_bf16 a[40:43], v[56:59], v[76:79], a[40:43]
  v_mfma_f32_16x16x32_bf16 a[44:47], v[56:59], v[80:83], a[44:47]
  buffer_load_dwordx4 v[196:199], v3, s[8:11], s26 offen offset:1024
  v_mfma_f32_16x16x32_bf16 a[48:51], v[60:63], v[68:71], a[48:51]
  v_mfma_f32_16x16x32_bf16 a[52:55], v[60:63], v[72:75], a[52:55]
  buffer_load_dwordx4 v[200:203], v3, s[8:11], s26 offen offset:2048
  v_mfma_f32_16x16x32_bf16 a[56:59], v[60:63], v[76:79], a[56:59]
  v_mfma_f32_16x16x32_bf16 a[60:63], v[60:63], v[80:83], a[60:63]
  buffer_load_dwordx4 v[204:207], v3, s[8:11], s26 offen offset:3072
  v_mfma_f32_16x16x32_bf16 a[64:67], v[64:67], v[68:71], a[64:67]
  v_mfma_f32_16x16x32_bf16 a[68:71], v[64:67], v[72:75], a[68:71]
  s_add_u32 s26, s26, 4096
  buffer_load_dwordx4 v[208:211], v3, s[8:11], s26 offen
  v_mfma_f32_16x16x32_bf16 a[72:75], v[64:67], v[76:79], a[72:75]
  v_mfma_f32_16x16x32_bf16 a[76:79], v[64:67], v[80:83], a[76:79]
  s_waitcnt vmcnt(27)
  v_mfma_f32_16x16x32_bf16 a[0:3], v[84:87], v[104:107], a[0:3]
  v_mfma_f32_16x16x32_bf16 a[4:7], v[84:87], v[108:111], a[4:7]
  s_add_u32 s25, s24, 40960
  buffer_load_dwordx4 v[68:71], v3, s[8:11], s25 offen sc1
  v_mfma_f32_16x16x32_bf16 a[8:11], v[84:87], v[112:115], a[8:11]
  v_mfma_f32_16x16x32_bf16 a[12:15], v[84:87], v[116:119], a[12:15]
  buffer_load_dwordx4 v[72:75], v3, s[8:11], s25 offen offset:1024 sc1
  v_mfma_f32_16x16x32_bf16 a[16:19], v[88:91], v[104:107], a[16:19]
  v_mfma_f32_16x16x32_bf16 a[20:23], v[88:91], v[108:111], a[20:23]
  buffer_load_dwordx4 v[76:79], v3, s[8:11], s25 offen offset:2048 sc1
  v_mfma_f32_16x16x32_bf16 a[24:27], v[88:91], v[112:115], a[24:27]
  v_mfma_f32_16x16x32_bf16 a[28:31], v[88:91], v[116:119], a[28:31]
  buffer_load_dwordx4 v[80:83], v3, s[8:11], s25 offen offset:3072 sc1
  v_mfma_f32_16x16x32_bf16 a[32:35], v[92:95], v[104:107], a[32:35]
  v_mfma_f32_16x16x32_bf16 a[36:39], v[92:95], v[108:111], a[36:39]
  s_add_u32 s26, s22, 368640
  buffer_load_dwordx4 v[48:51], v3, s[8:11], s26 offen
  v_mfma_f32_16x16x32_bf16 a[40:43], v[92:95], v[112:115], a[40:43]
  v_mfma_f32_16x16x32_bf16 a[44:47], v[92:95], v[116:119], a[44:47]
  buffer_load_dwordx4 v[52:55], v3, s[8:11], s26 offen offset:1024
  v_mfma_f32_16x16x32_bf16 a[48:51], v[96:99], v[104:107], a[48:51]
  v_mfma_f32_16x16x32_bf16 a[52:55], v[96:99], v[108:111], a[52:55]
  buffer_load_dwordx4 v[56:59], v3, s[8:11], s26 offen offset:2048
  v_mfma_f32_16x16x32_bf16 a[56:59], v[96:99], v[112:115], a[56:59]
  v_mfma_f32_16x16x32_bf16 a[60:63], v[96:99], v[116:119], a[60:63]
  buffer_load_dwordx4 v[60:63], v3, s[8:11], s26 offen offset:3072
  v_mfma_f32_16x16x32_bf16 a[64:67], v[100:103], v[104:107], a[64:67]
  v_mfma_f32_16x16x32_bf16 a[68:71], v[100:103], v[108:111], a[68:71]
  s_add_u32 s26, s26, 4096
  buffer_load_dwordx4 v[64:67], v3, s[8:11], s26 offen
  v_mfma_f32_16x16x32_bf16 a[72:75], v[100:103], v[112:115], a[72:75]
  v_mfma_f32_16x16x32_bf16 a[76:79], v[100:103], v[116:119], a[76:79]
  s_waitcnt vmcnt(27)
  v_mfma_f32_16x16x32_bf16 a[0:3], v[120:123], v[140:143], a[0:3]
  v_mfma_f32_16x16x32_bf16 a[4:7], v[120:123], v[144:147], a[4:7]
  s_add_u32 s25, s24, 45056
  buffer_load_dwordx4 v[104:107], v3, s[8:11], s25 offen sc1
  v_mfma_f32_16x16x32_bf16 a[8:11], v[120:123], v[148:151], a[8:11]
  v_mfma_f32_16x16x32_bf16 a[12:15], v[120:123], v[152:155], a[12:15]
  buffer_load_dwordx4 v[108:111], v3, s[8:11], s25 offen offset:1024 sc1
  v_mfma_f32_16x16x32_bf16 a[16:19], v[124:127], v[140:143], a[16:19]
  v_mfma_f32_16x16x32_bf16 a[20:23], v[124:127], v[144:147], a[20:23]
  buffer_load_dwordx4 v[112:115], v3, s[8:11], s25 offen offset:2048 sc1
  v_mfma_f32_16x16x32_bf16 a[24:27], v[124:127], v[148:151], a[24:27]
  v_mfma_f32_16x16x32_bf16 a[28:31], v[124:127], v[152:155], a[28:31]
  buffer_load_dwordx4 v[116:119], v3, s[8:11], s25 offen offset:3072 sc1
  v_mfma_f32_16x16x32_bf16 a[32:35], v[128:131], v[140:143], a[32:35]
  v_mfma_f32_16x16x32_bf16 a[36:39], v[128:131], v[144:147], a[36:39]
  s_add_u32 s26, s22, 405504
  buffer_load_dwordx4 v[84:87], v3, s[8:11], s26 offen
  v_mfma_f32_16x16x32_bf16 a[40:43], v[128:131], v[148:151], a[40:43]
  v_mfma_f32_16x16x32_bf16 a[44:47], v[128:131], v[152:155], a[44:47]
  buffer_load_dwordx4 v[88:91], v3, s[8:11], s26 offen offset:1024
  v_mfma_f32_16x16x32_bf16 a[48:51], v[132:135], v[140:143], a[48:51]
  v_mfma_f32_16x16x32_bf16 a[52:55], v[132:135], v[144:147], a[52:55]
  buffer_load_dwordx4 v[92:95], v3, s[8:11], s26 offen offset:2048
  v_mfma_f32_16x16x32_bf16 a[56:59], v[132:135], v[148:151], a[56:59]
  v_mfma_f32_16x16x32_bf16 a[60:63], v[132:135], v[152:155], a[60:63]
  buffer_load_dwordx4 v[96:99], v3, s[8:11], s26 offen offset:3072
  v_mfma_f32_16x16x32_bf16 a[64:67], v[136:139], v[140:143], a[64:67]
  v_mfma_f32_16x16x32_bf16 a[68:71], v[136:139], v[144:147], a[68:71]
  s_add_u32 s26, s26, 4096
  buffer_load_dwordx4 v[100:103], v3, s[8:11], s26 offen
  v_mfma_f32_16x16x32_bf16 a[72:75], v[136:139], v[148:151], a[72:75]
  v_mfma_f32_16x16x32_bf16 a[76:79], v[136:139], v[152:155], a[76:79]
  s_waitcnt vmcnt(27)
  v_mfma_f32_16x16x32_bf16 a[0:3], v[156:159], v[176:179], a[0:3]
  v_mfma_f32_16x16x32_bf16 a[4:7], v[156:159], v[180:183], a[4:7]
  s_add_u32 s25, s24, 49152
  buffer_load_dwordx4 v[140:143], v3, s[8:11], s25 offen sc1
  v_mfma_f32_16x16x32_bf16 a[8:11], v[156:159], v[184:187], a[8:11]
  v_mfma_f32_16x16x32_bf16 a[12:15], v[156:159], v[188:191], a[12:15]
  buffer_load_dwordx4 v[144:147], v3, s[8:11], s25 offen offset:1024 sc1
  v_mfma_f32_16x16x32_bf16 a[16:19], v[160:163], v[176:179], a[16:19]
  v_mfma_f32_16x16x32_bf16 a[20:23], v[160:163], v[180:183], a[20:23]
  buffer_load_dwordx4 v[148:151], v3, s[8:11], s25 offen offset:2048 sc1
  v_mfma_f32_16x16x32_bf16 a[24:27], v[160:163], v[184:187], a[24:27]
  v_mfma_f32_16x16x32_bf16 a[28:31], v[160:163], v[188:191], a[28:31]
  buffer_load_dwordx4 v[152:155], v3, s[8:11], s25 offen offset:3072 sc1
  v_mfma_f32_16x16x32_bf16 a[32:35], v[164:167], v[176:179], a[32:35]
  v_mfma_f32_16x16x32_bf16 a[36:39], v[164:167], v[180:183], a[36:39]
  s_add_u32 s26, s22, 442368
  buffer_load_dwordx4 v[120:123], v3, s[8:11], s26 offen
  v_mfma_f32_16x16x32_bf16 a[40:43], v[164:167], v[184:187], a[40:43]
  v_mfma_f32_16x16x32_bf16 a[44:47], v[164:167], v[188:191], a[44:47]
  buffer_load_dwordx4 v[124:127], v3, s[8:11], s26 offen offset:1024
  v_mfma_f32_16x16x32_bf16 a[48:51], v[168:171], v[176:179], a[48:51]
  v_mfma_f32_16x16x32_bf16 a[52:55], v[168:171], v[180:183], a[52:55]
  buffer_load_dwordx4 v[128:131], v3, s[8:11], s26 offen offset:2048
  v_mfma_f32_16x16x32_bf16 a[56:59], v[168:171], v[184:187], a[56:59]
  v_mfma_f32_16x16x32_bf16 a[60:63], v[168:171], v[188:191], a[60:63]
  buffer_load_dwordx4 v[132:135], v3, s[8:11], s26 offen offset:3072
  v_mfma_f32_16x16x32_bf16 a[64:67], v[172:175], v[176:179], a[64:67]
  v_mfma_f32_16x16x32_bf16 a[68:71], v[172:175], v[180:183], a[68:71]
  s_add_u32 s26, s26, 4096
  buffer_load_dwordx4 v[136:139], v3, s[8:11], s26 offen
  v_mfma_f32_16x16x32_bf16 a[72:75], v[172:175], v[184:187], a[72:75]
  v_mfma_f32_16x16x32_bf16 a[76:79], v[172:175], v[188:191], a[76:79]
  s_waitcnt vmcnt(27)
  v_mfma_f32_16x16x32_bf16 a[0:3], v[192:195], v[212:215], a[0:3]
  s_add_u32 s25, s24, 53248
  buffer_load_dwordx2 v[176:177], v11, s[8:11], s25 offen sc1
  v_mfma_f32_16x16x32_bf16 a[4:7], v[192:195], v[216:219], a[4:7]
  buffer_load_dwordx2 v[178:179], v11, s[8:11], s25 offen offset:512 sc1
  v_mfma_f32_16x16x32_bf16 a[8:11], v[192:195], v[220:223], a[8:11]
  buffer_load_dwordx2 v[180:181], v11, s[8:11], s25 offen offset:1024 sc1
  v_mfma_f32_16x16x32_bf16 a[12:15], v[192:195], v[224:227], a[12:15]
  buffer_load_dwordx2 v[182:183], v11, s[8:11], s25 offen offset:1536 sc1
  v_mfma_f32_16x16x32_bf16 a[16:19], v[196:199], v[212:215], a[16:19]
  v_mfma_f32_16x16x32_bf16 a[20:23], v[196:199], v[216:219], a[20:23]
  buffer_load_dwordx2 v[184:185], v11, s[8:11], s25 offen offset:2048 sc1
  v_mfma_f32_16x16x32_bf16 a[24:27], v[196:199], v[220:223], a[24:27]
  v_mfma_f32_16x16x32_bf16 a[28:31], v[196:199], v[224:227], a[28:31]
  buffer_load_dwordx2 v[186:187], v11, s[8:11], s25 offen offset:2560 sc1
  v_mfma_f32_16x16x32_bf16 a[32:35], v[200:203], v[212:215], a[32:35]
  v_mfma_f32_16x16x32_bf16 a[36:39], v[200:203], v[216:219], a[36:39]
  buffer_load_dwordx2 v[188:189], v11, s[8:11], s25 offen offset:3072 sc1
  v_mfma_f32_16x16x32_bf16 a[40:43], v[200:203], v[220:223], a[40:43]
  v_mfma_f32_16x16x32_bf16 a[44:47], v[200:203], v[224:227], a[44:47]
  buffer_load_dwordx2 v[190:191], v11, s[8:11], s25 offen offset:3584 sc1
  v_mfma_f32_16x16x32_bf16 a[48:51], v[204:207], v[212:215], a[48:51]
  v_mfma_f32_16x16x32_bf16 a[52:55], v[204:207], v[216:219], a[52:55]
  s_add_u32 s26, s22, 479232
  buffer_load_dwordx4 v[156:159], v3, s[8:11], s26 offen
  v_mfma_f32_16x16x32_bf16 a[56:59], v[204:207], v[220:223], a[56:59]
  v_mfma_f32_16x16x32_bf16 a[60:63], v[204:207], v[224:227], a[60:63]
  buffer_load_dwordx4 v[160:163], v3, s[8:11], s26 offen offset:1024
  v_mfma_f32_16x16x32_bf16 a[64:67], v[208:211], v[212:215], a[64:67]
  v_mfma_f32_16x16x32_bf16 a[68:71], v[208:211], v[216:219], a[68:71]
  buffer_load_dwordx4 v[164:167], v3, s[8:11], s26 offen offset:2048
  v_mfma_f32_16x16x32_bf16 a[72:75], v[208:211], v[220:223], a[72:75]
  v_mfma_f32_16x16x32_bf16 a[76:79], v[208:211], v[224:227], a[76:79]
  buffer_load_dwordx4 v[168:171], v3, s[8:11], s26 offen offset:3072
  s_add_u32 s26, s26, 4096
  buffer_load_dwordx4 v[172:175], v3, s[8:11], s26 offen
  s_waitcnt vmcnt(31)
  v_mfma_f32_16x16x32_bf16 a[0:3], v[48:51], v[68:71], a[0:3]
  v_mfma_f32_16x16x32_bf16 a[4:7], v[48:51], v[72:75], a[4:7]
  s_add_u32 s25, s24, 57344
  buffer_load_dwordx4 v[212:215], v3, s[8:11], s25 offen sc1
  v_mfma_f32_16x16x32_bf16 a[8:11], v[48:51], v[76:79], a[8:11]
  v_mfma_f32_16x16x32_bf16 a[12:15], v[48:51], v[80:83], a[12:15]
  buffer_load_dwordx4 v[216:219], v3, s[8:11], s25 offen offset:1024 sc1
  v_mfma_f32_16x16x32_bf16 a[16:19], v[52:55], v[68:71], a[16:19]
  v_mfma_f32_16x16x32_bf16 a[20:23], v[52:55], v[72:75], a[20:23]
  buffer_load_dwordx4 v[220:223], v3, s[8:11], s25 offen offset:2048 sc1
  v_mfma_f32_16x16x32_bf16 a[24:27], v[52:55], v[76:79], a[24:27]
  v_mfma_f32_16x16x32_bf16 a[28:31], v[52:55], v[80:83], a[28:31]
  buffer_load_dwordx4 v[224:227], v3, s[8:11], s25 offen offset:3072 sc1
  v_mfma_f32_16x16x32_bf16 a[32:35], v[56:59], v[68:71], a[32:35]
  v_mfma_f32_16x16x32_bf16 a[36:39], v[56:59], v[72:75], a[36:39]
  s_add_u32 s26, s22, 516096
  buffer_load_dwordx4 v[192:195], v3, s[8:11], s26 offen
  v_mfma_f32_16x16x32_bf16 a[40:43], v[56:59], v[76:79], a[40:43]
  v_mfma_f32_16x16x32_bf16 a[44:47], v[56:59], v[80:83], a[44:47]
  buffer_load_dwordx4 v[196:199], v3, s[8:11], s26 offen offset:1024
  v_mfma_f32_16x16x32_bf16 a[48:51], v[60:63], v[68:71], a[48:51]
  v_mfma_f32_16x16x32_bf16 a[52:55], v[60:63], v[72:75], a[52:55]
  buffer_load_dwordx4 v[200:203], v3, s[8:11], s26 offen offset:2048
  v_mfma_f32_16x16x32_bf16 a[56:59], v[60:63], v[76:79], a[56:59]
  v_mfma_f32_16x16x32_bf16 a[60:63], v[60:63], v[80:83], a[60:63]
  buffer_load_dwordx4 v[204:207], v3, s[8:11], s26 offen offset:3072
  v_mfma_f32_16x16x32_bf16 a[64:67], v[64:67], v[68:71], a[64:67]
  v_mfma_f32_16x16x32_bf16 a[68:71], v[64:67], v[72:75], a[68:71]
  s_add_u32 s26, s26, 4096
  buffer_load_dwordx4 v[208:211], v3, s[8:11], s26 offen
  v_mfma_f32_16x16x32_bf16 a[72:75], v[64:67], v[76:79], a[72:75]
  v_mfma_f32_16x16x32_bf16 a[76:79], v[64:67], v[80:83], a[76:79]
  s_waitcnt vmcnt(31)
  v_mfma_f32_16x16x32_bf16 a[0:3], v[84:87], v[104:107], a[0:3]
  v_mfma_f32_16x16x32_bf16 a[4:7], v[84:87], v[108:111], a[4:7]
  s_add_u32 s25, s24, 61440
  buffer_load_dwordx4 v[68:71], v3, s[8:11], s25 offen sc1
  v_mfma_f32_16x16x32_bf16 a[8:11], v[84:87], v[112:115], a[8:11]
  v_mfma_f32_16x16x32_bf16 a[12:15], v[84:87], v[116:119], a[12:15]
  buffer_load_dwordx4 v[72:75], v3, s[8:11], s25 offen offset:1024 sc1
  v_mfma_f32_16x16x32_bf16 a[16:19], v[88:91], v[104:107], a[16:19]
  v_mfma_f32_16x16x32_bf16 a[20:23], v[88:91], v[108:111], a[20:23]
  buffer_load_dwordx4 v[76:79], v3, s[8:11], s25 offen offset:2048 sc1
  v_mfma_f32_16x16x32_bf16 a[24:27], v[88:91], v[112:115], a[24:27]
  v_mfma_f32_16x16x32_bf16 a[28:31], v[88:91], v[116:119], a[28:31]
  buffer_load_dwordx4 v[80:83], v3, s[8:11], s25 offen offset:3072 sc1
  v_mfma_f32_16x16x32_bf16 a[32:35], v[92:95], v[104:107], a[32:35]
  v_mfma_f32_16x16x32_bf16 a[36:39], v[92:95], v[108:111], a[36:39]
  s_add_u32 s26, s22, 552960
  buffer_load_dwordx4 v[48:51], v3, s[8:11], s26 offen
  v_mfma_f32_16x16x32_bf16 a[40:43], v[92:95], v[112:115], a[40:43]
  v_mfma_f32_16x16x32_bf16 a[44:47], v[92:95], v[116:119], a[44:47]
  buffer_load_dwordx4 v[52:55], v3, s[8:11], s26 offen offset:1024
  v_mfma_f32_16x16x32_bf16 a[48:51], v[96:99], v[104:107], a[48:51]
  v_mfma_f32_16x16x32_bf16 a[52:55], v[96:99], v[108:111], a[52:55]
  buffer_load_dwordx4 v[56:59], v3, s[8:11], s26 offen offset:2048
  v_mfma_f32_16x16x32_bf16 a[56:59], v[96:99], v[112:115], a[56:59]
  v_mfma_f32_16x16x32_bf16 a[60:63], v[96:99], v[116:119], a[60:63]
  buffer_load_dwordx4 v[60:63], v3, s[8:11], s26 offen offset:3072
  v_mfma_f32_16x16x32_bf16 a[64:67], v[100:103], v[104:107], a[64:67]
  v_mfma_f32_16x16x32_bf16 a[68:71], v[100:103], v[108:111], a[68:71]
  s_add_u32 s26, s26, 4096
  buffer_load_dwordx4 v[64:67], v3, s[8:11], s26 offen
  v_mfma_f32_16x16x32_bf16 a[72:75], v[100:103], v[112:115], a[72:75]
  v_mfma_f32_16x16x32_bf16 a[76:79], v[100:103], v[116:119], a[76:79]
  s_waitcnt vmcnt(31)
  v_mfma_f32_16x16x32_bf16 a[0:3], v[120:123], v[140:143], a[0:3]
  v_mfma_f32_16x16x32_bf16 a[4:7], v[120:123], v[144:147], a[4:7]
  s_add_u32 s25, s24, 65536
  buffer_load_dwordx4 v[104:107], v3, s[8:11], s25 offen sc1
  v_mfma_f32_16x16x32_bf16 a[8:11], v[120:123], v[148:151], a[8:11]
  v_mfma_f32_16x16x32_bf16 a[12:15], v[120:123], v[152:155], a[12:15]
  buffer_load_dwordx4 v[108:111], v3, s[8:11], s25 offen offset:1024 sc1
  v_mfma_f32_16x16x32_bf16 a[16:19], v[124:127], v[140:143], a[16:19]
  v_mfma_f32_16x16x32_bf16 a[20:23], v[124:127], v[144:147], a[20:23]
  buffer_load_dwordx4 v[112:115], v3, s[8:11], s25 offen offset:2048 sc1
  v_mfma_f32_16x16x32_bf16 a[24:27], v[124:127], v[148:151], a[24:27]
  v_mfma_f32_16x16x32_bf16 a[28:31], v[124:127], v[152:155], a[28:31]
  buffer_load_dwordx4 v[116:119], v3, s[8:11], s25 offen offset:3072 sc1
  v_mfma_f32_16x16x32_bf16 a[32:35], v[128:131], v[140:143], a[32:35]
  v_mfma_f32_16x16x32_bf16 a[36:39], v[128:131], v[144:147], a[36:39]
  s_add_u32 s26, s22, 589824
  buffer_load_dwordx4 v[84:87], v3, s[8:11], s26 offen
  v_mfma_f32_16x16x32_bf16 a[40:43], v[128:131], v[148:151], a[40:43]
  v_mfma_f32_16x16x32_bf16 a[44:47], v[128:131], v[152:155], a[44:47]
  buffer_load_dwordx4 v[88:91], v3, s[8:11], s26 offen offset:1024
  v_mfma_f32_16x16x32_bf16 a[48:51], v[132:135], v[140:143], a[48:51]
  v_mfma_f32_16x16x32_bf16 a[52:55], v[132:135], v[144:147], a[52:55]
  buffer_load_dwordx4 v[92:95], v3, s[8:11], s26 offen offset:2048
  v_mfma_f32_16x16x32_bf16 a[56:59], v[132:135], v[148:151], a[56:59]
  v_mfma_f32_16x16x32_bf16 a[60:63], v[132:135], v[152:155], a[60:63]
  buffer_load_dwordx4 v[96:99], v3, s[8:11], s26 offen offset:3072
  v_mfma_f32_16x16x32_bf16 a[64:67], v[136:139], v[140:143], a[64:67]
  v_mfma_f32_16x16x32_bf16 a[68:71], v[136:139], v[144:147], a[68:71]
  s_add_u32 s26, s26, 4096
  buffer_load_dwordx4 v[100:103], v3, s[8:11], s26 offen
  v_mfma_f32_16x16x32_bf16 a[72:75], v[136:139], v[148:151], a[72:75]
  v_mfma_f32_16x16x32_bf16 a[76:79], v[136:139], v[152:155], a[76:79]
  s_waitcnt vmcnt(27)
  v_mfma_f32_16x16x32_bf16 a[0:3], v[156:159], v[176:179], a[0:3]
  v_mfma_f32_16x16x32_bf16 a[4:7], v[156:159], v[180:183], a[4:7]
  s_add_u32 s25, s24, 69632
  buffer_load_dwordx4 v[140:143], v3, s[8:11], s25 offen sc1
  v_mfma_f32_16x16x32_bf16 a[8:11], v[156:159], v[184:187], a[8:11]
  v_mfma_f32_16x16x32_bf16 a[12:15], v[156:159], v[188:191], a[12:15]
  buffer_load_dwordx4 v[144:147], v3, s[8:11], s25 offen offset:1024 sc1
  v_mfma_f32_16x16x32_bf16 a[16:19], v[160:163], v[176:179], a[16:19]
  v_mfma_f32_16x16x32_bf16 a[20:23], v[160:163], v[180:183], a[20:23]
  buffer_load_dwordx4 v[148:151], v3, s[8:11], s25 offen offset:2048 sc1
  v_mfma_f32_16x16x32_bf16 a[24:27], v[160:163], v[184:187], a[24:27]
  v_mfma_f32_16x16x32_bf16 a[28:31], v[160:163], v[188:191], a[28:31]
  buffer_load_dwordx4 v[152:155], v3, s[8:11], s25 offen offset:3072 sc1
  v_mfma_f32_16x16x32_bf16 a[32:35], v[164:167], v[176:179], a[32:35]
  v_mfma_f32_16x16x32_bf16 a[36:39], v[164:167], v[180:183], a[36:39]
  s_add_u32 s26, s22, 626688
  buffer_load_dwordx4 v[120:123], v3, s[8:11], s26 offen
  v_mfma_f32_16x16x32_bf16 a[40:43], v[164:167], v[184:187], a[40:43]
  v_mfma_f32_16x16x32_bf16 a[44:47], v[164:167], v[188:191], a[44:47]
  buffer_load_dwordx4 v[124:127], v3, s[8:11], s26 offen offset:1024
  v_mfma_f32_16x16x32_bf16 a[48:51], v[168:171], v[176:179], a[48:51]
  v_mfma_f32_16x16x32_bf16 a[52:55], v[168:171], v[180:183], a[52:55]
  buffer_load_dwordx4 v[128:131], v3, s[8:11], s26 offen offset:2048
  v_mfma_f32_16x16x32_bf16 a[56:59], v[168:171], v[184:187], a[56:59]
  v_mfma_f32_16x16x32_bf16 a[60:63], v[168:171], v[188:191], a[60:63]
  buffer_load_dwordx4 v[132:135], v3, s[8:11], s26 offen offset:3072
  v_mfma_f32_16x16x32_bf16 a[64:67], v[172:175], v[176:179], a[64:67]
  v_mfma_f32_16x16x32_bf16 a[68:71], v[172:175], v[180:183], a[68:71]
  s_add_u32 s26, s26, 4096
  buffer_load_dwordx4 v[136:139], v3, s[8:11], s26 offen
  v_mfma_f32_16x16x32_bf16 a[72:75], v[172:175], v[184:187], a[72:75]
  v_mfma_f32_16x16x32_bf16 a[76:79], v[172:175], v[188:191], a[76:79]
  s_waitcnt vmcnt(27)
  v_mfma_f32_16x16x32_bf16 a[0:3], v[192:195], v[212:215], a[0:3]
  v_mfma_f32_16x16x32_bf16 a[4:7], v[192:195], v[216:219], a[4:7]
  v_mfma_f32_16x16x32_bf16 a[8:11], v[192:195], v[220:223], a[8:11]
  v_mfma_f32_16x16x32_bf16 a[12:15], v[192:195], v[224:227], a[12:15]
  v_mfma_f32_16x16x32_bf16 a[16:19], v[196:199], v[212:215], a[16:19]
  v_mfma_f32_16x16x32_bf16 a[20:23], v[196:199], v[216:219], a[20:23]
  v_mfma_f32_16x16x32_bf16 a[24:27], v[196:199], v[220:223], a[24:27]
  v_mfma_f32_16x16x32_bf16 a[28:31], v[196:199], v[224:227], a[28:31]
  v_mfma_f32_16x16x32_bf16 a[32:35], v[200:203], v[212:215], a[32:35]
  v_mfma_f32_16x16x32_bf16 a[36:39], v[200:203], v[216:219], a[36:39]
  v_mfma_f32_16x16x32_bf16 a[40:43], v[200:203], v[220:223], a[40:43]
  v_mfma_f32_16x16x32_bf16 a[44:47], v[200:203], v[224:227], a[44:47]
  v_mfma_f32_16x16x32_bf16 a[48:51], v[204:207], v[212:215], a[48:51]
  v_mfma_f32_16x16x32_bf16 a[52:55], v[204:207], v[216:219], a[52:55]
  v_mfma_f32_16x16x32_bf16 a[56:59], v[204:207], v[220:223], a[56:59]
  v_mfma_f32_16x16x32_bf16 a[60:63], v[204:207], v[224:227], a[60:63]
  v_mfma_f32_16x16x32_bf16 a[64:67], v[208:211], v[212:215], a[64:67]
  v_mfma_f32_16x16x32_bf16 a[68:71], v[208:211], v[216:219], a[68:71]
  v_mfma_f32_16x16x32_bf16 a[72:75], v[208:211], v[220:223], a[72:75]
  v_mfma_f32_16x16x32_bf16 a[76:79], v[208:211], v[224:227], a[76:79]
  s_waitcnt vmcnt(18)
  v_mfma_f32_16x16x32_bf16 a[0:3], v[48:51], v[68:71], a[0:3]
  v_mfma_f32_16x16x32_bf16 a[4:7], v[48:51], v[72:75], a[4:7]
  v_mfma_f32_16x16x32_bf16 a[8:11], v[48:51], v[76:79], a[8:11]
  v_mfma_f32_16x16x32_bf16 a[12:15], v[48:51], v[80:83], a[12:15]
  v_mfma_f32_16x16x32_bf16 a[16:19], v[52:55], v[68:71], a[16:19]
  v_mfma_f32_16x16x32_bf16 a[20:23], v[52:55], v[72:75], a[20:23]
  v_mfma_f32_16x16x32_bf16 a[24:27], v[52:55], v[76:79], a[24:27]
  v_mfma_f32_16x16x32_bf16 a[28:31], v[52:55], v[80:83], a[28:31]
  v_mfma_f32_16x16x32_bf16 a[32:35], v[56:59], v[68:71], a[32:35]
  v_mfma_f32_16x16x32_bf16 a[36:39], v[56:59], v[72:75], a[36:39]
  v_mfma_f32_16x16x32_bf16 a[40:43], v[56:59], v[76:79], a[40:43]
  v_mfma_f32_16x16x32_bf16 a[44:47], v[56:59], v[80:83], a[44:47]
  v_mfma_f32_16x16x32_bf16 a[48:51], v[60:63], v[68:71], a[48:51]
  v_mfma_f32_16x16x32_bf16 a[52:55], v[60:63], v[72:75], a[52:55]
  v_mfma_f32_16x16x32_bf16 a[56:59], v[60:63], v[76:79], a[56:59]
  v_mfma_f32_16x16x32_bf16 a[60:63], v[60:63], v[80:83], a[60:63]
  v_mfma_f32_16x16x32_bf16 a[64:67], v[64:67], v[68:71], a[64:67]
  v_mfma_f32_16x16x32_bf16 a[68:71], v[64:67], v[72:75], a[68:71]
  v_mfma_f32_16x16x32_bf16 a[72:75], v[64:67], v[76:79], a[72:75]
  v_mfma_f32_16x16x32_bf16 a[76:79], v[64:67], v[80:83], a[76:79]
  s_waitcnt vmcnt(9)
  v_mfma_f32_16x16x32_bf16 a[0:3], v[84:87], v[104:107], a[0:3]
  v_mfma_f32_16x16x32_bf16 a[4:7], v[84:87], v[108:111], a[4:7]
  v_mfma_f32_16x16x32_bf16 a[8:11], v[84:87], v[112:115], a[8:11]
  v_mfma_f32_16x16x32_bf16 a[12:15], v[84:87], v[116:119], a[12:15]
  v_mfma_f32_16x16x32_bf16 a[16:19], v[88:91], v[104:107], a[16:19]
  v_mfma_f32_16x16x32_bf16 a[20:23], v[88:91], v[108:111], a[20:23]
  v_mfma_f32_16x16x32_bf16 a[24:27], v[88:91], v[112:115], a[24:27]
  v_mfma_f32_16x16x32_bf16 a[28:31], v[88:91], v[116:119], a[28:31]
  v_mfma_f32_16x16x32_bf16 a[32:35], v[92:95], v[104:107], a[32:35]
  v_mfma_f32_16x16x32_bf16 a[36:39], v[92:95], v[108:111], a[36:39]
  v_mfma_f32_16x16x32_bf16 a[40:43], v[92:95], v[112:115], a[40:43]
  v_mfma_f32_16x16x32_bf16 a[44:47], v[92:95], v[116:119], a[44:47]
  v_mfma_f32_16x16x32_bf16 a[48:51], v[96:99], v[104:107], a[48:51]
  v_mfma_f32_16x16x32_bf16 a[52:55], v[96:99], v[108:111], a[52:55]
  v_mfma_f32_16x16x32_bf16 a[56:59], v[96:99], v[112:115], a[56:59]
  v_mfma_f32_16x16x32_bf16 a[60:63], v[96:99], v[116:119], a[60:63]
  v_mfma_f32_16x16x32_bf16 a[64:67], v[100:103], v[104:107], a[64:67]
  v_mfma_f32_16x16x32_bf16 a[68:71], v[100:103], v[108:111], a[68:71]
  v_mfma_f32_16x16x32_bf16 a[72:75], v[100:103], v[112:115], a[72:75]
  v_mfma_f32_16x16x32_bf16 a[76:79], v[100:103], v[116:119], a[76:79]
  s_waitcnt vmcnt(0)
  v_mfma_f32_16x16x32_bf16 a[0:3], v[120:123], v[140:143], a[0:3]
  v_mfma_f32_16x16x32_bf16 a[4:7], v[120:123], v[144:147], a[4:7]
  v_mfma_f32_16x16x32_bf16 a[8:11], v[120:123], v[148:151], a[8:11]
  v_mfma_f32_16x16x32_bf16 a[12:15], v[120:123], v[152:155], a[12:15]
  v_mfma_f32_16x16x32_bf16 a[16:19], v[124:127], v[140:143], a[16:19]
  v_mfma_f32_16x16x32_bf16 a[20:23], v[124:127], v[144:147], a[20:23]
  v_mfma_f32_16x16x32_bf16 a[24:27], v[124:127], v[148:151], a[24:27]
  v_mfma_f32_16x16x32_bf16 a[28:31], v[124:127], v[152:155], a[28:31]
  v_mfma_f32_16x16x32_bf16 a[32:35], v[128:131], v[140:143], a[32:35]
  v_mfma_f32_16x16x32_bf16 a[36:39], v[128:131], v[144:147], a[36:39]
  v_mfma_f32_16x16x32_bf16 a[40:43], v[128:131], v[148:151], a[40:43]
  v_mfma_f32_16x16x32_bf16 a[44:47], v[128:131], v[152:155], a[44:47]
  v_mfma_f32_16x16x32_bf16 a[48:51], v[132:135], v[140:143], a[48:51]
  v_mfma_f32_16x16x32_bf16 a[52:55], v[132:135], v[144:147], a[52:55]
  v_mfma_f32_16x16x32_bf16 a[56:59], v[132:135], v[148:151], a[56:59]
  v_mfma_f32_16x16x32_bf16 a[60:63], v[132:135], v[152:155], a[60:63]
  v_mfma_f32_16x16x32_bf16 a[64:67], v[136:139], v[140:143], a[64:67]
  v_mfma_f32_16x16x32_bf16 a[68:71], v[136:139], v[144:147], a[68:71]
  v_mfma_f32_16x16x32_bf16 a[72:75], v[136:139], v[148:151], a[72:75]
  v_mfma_f32_16x16x32_bf16 a[76:79], v[136:139], v[152:155], a[76:79]
  s_mul_i32 s30, s20, 20480
  v_add_u32 v9, s30, v3
  v_accvgpr_read_b32 v48, a0
  v_accvgpr_read_b32 v49, a1
  v_accvgpr_read_b32 v50, a2
  v_accvgpr_read_b32 v51, a3
  ds_write_b128 v9, v[48:51] offset:0
  v_accvgpr_read_b32 v52, a16
  v_accvgpr_read_b32 v53, a17
  v_accvgpr_read_b32 v54, a18
  v_accvgpr_read_b32 v55, a19
  ds_write_b128 v9, v[52:55] offset:1024
  v_accvgpr_read_b32 v56, a32
  v_accvgpr_read_b32 v57, a33
  v_accvgpr_read_b32 v58, a34
  v_accvgpr_read_b32 v59, a35
  ds_write_b128 v9, v[56:59] offset:2048
  v_accvgpr_read_b32 v60, a48
  v_accvgpr_read_b32 v61, a49
  v_accvgpr_read_b32 v62, a50
  v_accvgpr_read_b32 v63, a51
  ds_write_b128 v9, v[60:63] offset:3072
  v_accvgpr_read_b32 v64, a64
  v_accvgpr_read_b32 v65, a65
  v_accvgpr_read_b32 v66, a66
  v_accvgpr_read_b32 v67, a67
  ds_write_b128 v9, v[64:67] offset:4096
  v_accvgpr_read_b32 v68, a4
  v_accvgpr_read_b32 v69, a5
  v_accvgpr_read_b32 v70, a6
  v_accvgpr_read_b32 v71, a7
  ds_write_b128 v9, v[68:71] offset:5120
  v_accvgpr_read_b32 v72, a20
  v_accvgpr_read_b32 v73, a21
  v_accvgpr_read_b32 v74, a22
  v_accvgpr_read_b32 v75, a23
  ds_write_b128 v9, v[72:75] offset:6144
  v_accvgpr_read_b32 v76, a36
  v_accvgpr_read_b32 v77, a37
  v_accvgpr_read_b32 v78, a38
  v_accvgpr_read_b32 v79, a39
  ds_write_b128 v9, v[76:79] offset:7168
  v_accvgpr_read_b32 v80, a52
  v_accvgpr_read_b32 v81, a53
  v_accvgpr_read_b32 v82, a54
  v_accvgpr_read_b32 v83, a55
  ds_write_b128 v9, v[80:83] offset:8192
  v_accvgpr_read_b32 v84, a68
  v_accvgpr_read_b32 v85, a69
  v_accvgpr_read_b32 v86, a70
  v_accvgpr_read_b32 v87, a71
  ds_write_b128 v9, v[84:87] offset:9216
  v_accvgpr_read_b32 v88, a8
  v_accvgpr_read_b32 v89, a9
  v_accvgpr_read_b32 v90, a10
  v_accvgpr_read_b32 v91, a11
  ds_write_b128 v9, v[88:91] offset:10240
  v_accvgpr_read_b32 v92, a24
  v_accvgpr_read_b32 v93, a25
  v_accvgpr_read_b32 v94, a26
  v_accvgpr_read_b32 v95, a27
  ds_write_b128 v9, v[92:95] offset:11264
  v_accvgpr_read_b32 v96, a40
  v_accvgpr_read_b32 v97, a41
  v_accvgpr_read_b32 v98, a42
  v_accvgpr_read_b32 v99, a43
  ds_write_b128 v9, v[96:99] offset:12288
  v_accvgpr_read_b32 v100, a56
  v_accvgpr_read_b32 v101, a57
  v_accvgpr_read_b32 v102, a58
  v_accvgpr_read_b32 v103, a59
  ds_write_b128 v9, v[100:103] offset:13312
  v_accvgpr_read_b32 v104, a72
  v_accvgpr_read_b32 v105, a73
  v_accvgpr_read_b32 v106, a74
  v_accvgpr_read_b32 v107, a75
  ds_write_b128 v9, v[104:107] offset:14336
  v_accvgpr_read_b32 v108, a12
  v_accvgpr_read_b32 v109, a13
  v_accvgpr_read_b32 v110, a14
  v_accvgpr_read_b32 v111, a15
  ds_write_b128 v9, v[108:111] offset:15360
  v_accvgpr_read_b32 v112, a28
  v_accvgpr_read_b32 v113, a29
  v_accvgpr_read_b32 v114, a30
  v_accvgpr_read_b32 v115, a31
  ds_write_b128 v9, v[112:115] offset:16384
  v_accvgpr_read_b32 v116, a44
  v_accvgpr_read_b32 v117, a45
  v_accvgpr_read_b32 v118, a46
  v_accvgpr_read_b32 v119, a47
  ds_write_b128 v9, v[116:119] offset:17408
  v_accvgpr_read_b32 v120, a60
  v_accvgpr_read_b32 v121, a61
  v_accvgpr_read_b32 v122, a62
  v_accvgpr_read_b32 v123, a63
  ds_write_b128 v9, v[120:123] offset:18432
  v_accvgpr_read_b32 v124, a76
  v_accvgpr_read_b32 v125, a77
  v_accvgpr_read_b32 v126, a78
  v_accvgpr_read_b32 v127, a79
  ds_write_b128 v9, v[124:127] offset:19456
  s_waitcnt lgkmcnt(0)
  s_barrier
  s_mul_i32 s30, s20, 5120
  v_add_u32 v9, s30, v3
  v_add_u32 v10, 40960, v9
  ds_read_b128 v[48:51], v9 offset:0
  ds_read_b128 v[52:55], v9 offset:1024
  ds_read_b128 v[56:59], v9 offset:2048
  ds_read_b128 v[60:63], v9 offset:3072
  ds_read_b128 v[64:67], v9 offset:4096
  ds_read_b128 v[68:71], v9 offset:20480
  ds_read_b128 v[72:75], v9 offset:21504
  ds_read_b128 v[76:79], v9 offset:22528
  ds_read_b128 v[80:83], v9 offset:23552
  ds_read_b128 v[84:87], v9 offset:24576
  ds_read_b128 v[88:91], v10 offset:0
  ds_read_b128 v[92:95], v10 offset:1024
  ds_read_b128 v[96:99], v10 offset:2048
  ds_read_b128 v[100:103], v10 offset:3072
  ds_read_b128 v[104:107], v10 offset:4096
  ds_read_b128 v[108:111], v10 offset:20480
  ds_read_b128 v[112:115], v10 offset:21504
  ds_read_b128 v[116:119], v10 offset:22528
  ds_read_b128 v[120:123], v10 offset:23552
  ds_read_b128 v[124:127], v10 offset:24576
  v_lshrrev_b32 v140, 2, v6
  v_and_b32 v141, 3, v1
  v_lshrrev_b32 v142, 1, v7
  v_lshl_add_u32 v142, v142, 2, v140
  v_lshlrev_b32 v142, 1, v142
  s_and_b32 s31, s56, 1
  s_lshl_b32 s31, s31, 3
  s_lshl_b32 s32, s20, 1
  s_add_u32 s31, s31, s32
  v_lshrrev_b32 v143, 1, v141
  v_add_u32 v143, s31, v143
  v_xor_b32 v143, v143, v142
  v_lshl_add_u32 v144, v7, 2, v140
  v_lshlrev_b32 v144, 8, v144
  v_lshl_add_u32 v144, v143, 4, v144
  v_and_b32 v143, 1, v141
  v_lshl_add_u32 v144, v143, 3, v144
  v_add_u32 v144, 81920, v144
  ds_read_b64_tr_b16 v[146:147], v144 offset:0
  ds_read_b64_tr_b16 v[148:149], v144 offset:4096
  ds_read_b64_tr_b16 v[150:151], v144 offset:8192
  ds_read_b64_tr_b16 v[152:153], v144 offset:12288
  ds_read_b64_tr_b16 v[154:155], v144 offset:16384
  s_and_b32 s5, s5, 0xffff
  s_mov_b32 s6, 2359296
  s_mov_b32 s7, 0x20000
  s_lshl_b32 s31, s56, 6
  s_lshl_b32 s32, s20, 4
  s_add_u32 s31, s31, s32
  s_mul_i32 s31, s31, 1152
  s_lshl_b32 s32, s21, 1
  s_add_u32 s31, s31, s32
  v_mul_u32_u24 v145, 1152, v6
  v_lshl_add_u32 v145, v7, 3, v145
  s_waitcnt lgkmcnt(0)
  v_pk_add_f32 v[48:49], v[48:49], v[68:69]
  v_pk_add_f32 v[88:89], v[88:89], v[108:109]
  v_pk_add_f32 v[50:51], v[50:51], v[70:71]
  v_pk_add_f32 v[90:91], v[90:91], v[110:111]
  v_pk_add_f32 v[48:49], v[48:49], v[88:89]
  v_pk_add_f32 v[50:51], v[50:51], v[90:91]
  v_lshlrev_b32 v160, 16, v146
  v_and_b32 v161, 0xffff0000, v146
  v_lshlrev_b32 v162, 16, v147
  v_and_b32 v163, 0xffff0000, v147
  v_pk_fma_f32 v[48:49], v[48:49], v[228:229], v[160:161]
  v_pk_fma_f32 v[50:51], v[50:51], v[230:231], v[162:163]
  v_cvt_pk_bf16_f32 v164, v48, v49
  v_cvt_pk_bf16_f32 v165, v50, v51
  buffer_store_dwordx2 v[164:165], v145, s[4:7], s31 offen
  v_pk_add_f32 v[52:53], v[52:53], v[72:73]
  v_pk_add_f32 v[92:93], v[92:93], v[112:113]
  v_pk_add_f32 v[54:55], v[54:55], v[74:75]
  v_pk_add_f32 v[94:95], v[94:95], v[114:115]
  v_pk_add_f32 v[52:53], v[52:53], v[92:93]
  v_pk_add_f32 v[54:55], v[54:55], v[94:95]
  v_lshlrev_b32 v160, 16, v148
  v_and_b32 v161, 0xffff0000, v148
  v_lshlrev_b32 v162, 16, v149
  v_and_b32 v163, 0xffff0000, v149
  v_pk_fma_f32 v[52:53], v[52:53], v[232:233], v[160:161]
  v_pk_fma_f32 v[54:55], v[54:55], v[234:235], v[162:163]
  v_cvt_pk_bf16_f32 v166, v52, v53
  v_cvt_pk_bf16_f32 v167, v54, v55
  buffer_store_dwordx2 v[166:167], v145, s[4:7], s31 offen offset:32
  v_pk_add_f32 v[56:57], v[56:57], v[76:77]
  v_pk_add_f32 v[96:97], v[96:97], v[116:117]
  v_pk_add_f32 v[58:59], v[58:59], v[78:79]
  v_pk_add_f32 v[98:99], v[98:99], v[118:119]
  v_pk_add_f32 v[56:57], v[56:57], v[96:97]
  v_pk_add_f32 v[58:59], v[58:59], v[98:99]
  v_lshlrev_b32 v160, 16, v150
  v_and_b32 v161, 0xffff0000, v150
  v_lshlrev_b32 v162, 16, v151
  v_and_b32 v163, 0xffff0000, v151
  v_pk_fma_f32 v[56:57], v[56:57], v[236:237], v[160:161]
  v_pk_fma_f32 v[58:59], v[58:59], v[238:239], v[162:163]
  v_cvt_pk_bf16_f32 v164, v56, v57
  v_cvt_pk_bf16_f32 v165, v58, v59
  buffer_store_dwordx2 v[164:165], v145, s[4:7], s31 offen offset:64
  v_pk_add_f32 v[60:61], v[60:61], v[80:81]
  v_pk_add_f32 v[100:101], v[100:101], v[120:121]
  v_pk_add_f32 v[62:63], v[62:63], v[82:83]
  v_pk_add_f32 v[102:103], v[102:103], v[122:123]
  v_pk_add_f32 v[60:61], v[60:61], v[100:101]
  v_pk_add_f32 v[62:63], v[62:63], v[102:103]
  v_lshlrev_b32 v160, 16, v152
  v_and_b32 v161, 0xffff0000, v152
  v_lshlrev_b32 v162, 16, v153
  v_and_b32 v163, 0xffff0000, v153
  v_pk_fma_f32 v[60:61], v[60:61], v[240:241], v[160:161]
  v_pk_fma_f32 v[62:63], v[62:63], v[242:243], v[162:163]
  v_cvt_pk_bf16_f32 v166, v60, v61
  v_cvt_pk_bf16_f32 v167, v62, v63
  buffer_store_dwordx2 v[166:167], v145, s[4:7], s31 offen offset:96
  v_pk_add_f32 v[64:65], v[64:65], v[84:85]
  v_pk_add_f32 v[104:105], v[104:105], v[124:125]
  v_pk_add_f32 v[66:67], v[66:67], v[86:87]
  v_pk_add_f32 v[106:107], v[106:107], v[126:127]
  v_pk_add_f32 v[64:65], v[64:65], v[104:105]
  v_pk_add_f32 v[66:67], v[66:67], v[106:107]
  v_lshlrev_b32 v160, 16, v154
  v_and_b32 v161, 0xffff0000, v154
  v_lshlrev_b32 v162, 16, v155
  v_and_b32 v163, 0xffff0000, v155
  v_pk_fma_f32 v[64:65], v[64:65], v[244:245], v[160:161]
  v_pk_fma_f32 v[66:67], v[66:67], v[246:247], v[162:163]
  v_cvt_pk_bf16_f32 v164, v64, v65
  v_cvt_pk_bf16_f32 v165, v66, v67
  buffer_store_dwordx2 v[164:165], v145, s[4:7], s31 offen offset:128
  s_branch kg_kernel_exit
kg_n4_20:
  s_sub_u32 s23, s57, 4
  s_lshl_b32 s21, s23, 6
  s_add_u32 s21, s21, 320
  s_lshl_b32 s22, s23, 12
  s_add_u32 s22, s22, 20480
  s_mul_i32 s23, s20, 663552
  s_add_u32 s22, s22, s23
  s_add_u32 s22, s22, 23068672
  s_mul_i32 s24, s56, 294912
  s_mul_i32 s23, s20, 73728
  s_add_u32 s24, s24, s23
  s_add_u32 s24, s24, 56623104
  v_lshlrev_b32 v11, 3, v1
  s_add_u32 s26, s22, 0
  buffer_load_dwordx4 v[48:51], v3, s[8:11], s26 offen
  buffer_load_dwordx4 v[52:55], v3, s[8:11], s26 offen offset:1024
  buffer_load_dwordx4 v[56:59], v3, s[8:11], s26 offen offset:2048
  buffer_load_dwordx4 v[60:63], v3, s[8:11], s26 offen offset:3072
  s_add_u32 s26, s22, 36864
  buffer_load_dwordx4 v[84:87], v3, s[8:11], s26 offen
  buffer_load_dwordx4 v[88:91], v3, s[8:11], s26 offen offset:1024
  buffer_load_dwordx4 v[92:95], v3, s[8:11], s26 offen offset:2048
  buffer_load_dwordx4 v[96:99], v3, s[8:11], s26 offen offset:3072
  s_add_u32 s26, s22, 73728
  buffer_load_dwordx4 v[120:123], v3, s[8:11], s26 offen
  buffer_load_dwordx4 v[124:127], v3, s[8:11], s26 offen offset:1024
  buffer_load_dwordx4 v[128:131], v3, s[8:11], s26 offen offset:2048
  buffer_load_dwordx4 v[132:135], v3, s[8:11], s26 offen offset:3072
  s_add_u32 s26, s22, 110592
  buffer_load_dwordx4 v[156:159], v3, s[8:11], s26 offen
  buffer_load_dwordx4 v[160:163], v3, s[8:11], s26 offen offset:1024
  buffer_load_dwordx4 v[164:167], v3, s[8:11], s26 offen offset:2048
  buffer_load_dwordx4 v[168:171], v3, s[8:11], s26 offen offset:3072
  s_lshr_b32 s27, s56, 1
  s_mul_i32 s27, s27, 147456
  s_lshl_b32 s28, s21, 8
  s_add_u32 s27, s27, s28
  s_mul_i32 s28, s20, 4096
  s_add_u32 s27, s27, s28
  s_add_u32 s27, s27, 7340032
  s_add_u32 m0, s28, 81920
  s_nop 0
  buffer_load_dwordx4 v3, s[8:11], s27 offen lds
  buffer_load_dwordx4 v3, s[8:11], s27 offen offset:1024 lds
  buffer_load_dwordx4 v3, s[8:11], s27 offen offset:2048 lds
  buffer_load_dwordx4 v3, s[8:11], s27 offen offset:3072 lds
  v_lshlrev_b32 v8, 4, v7
  s_lshl_b32 s29, s21, 2
  s_add_u32 s29, s29, 11520
  buffer_load_dwordx4 v[228:231], v8, s[8:11], s29 offen
  buffer_load_dwordx4 v[232:235], v8, s[8:11], s29 offen offset:64
  buffer_load_dwordx4 v[236:239], v8, s[8:11], s29 offen offset:128
  buffer_load_dwordx4 v[240:243], v8, s[8:11], s29 offen offset:192
  s_waitcnt vmcnt(24)
  s_barrier
  s_cmp_lg_u32 s20, 0
  s_cbranch_scc1 kg_sig_25
  s_lshl_b32 s90, s16, 8
  s_add_u32 s90, s90, 94208
  v_mov_b32 v250, 1
  v_mov_b32 v251, 0
  s_mov_b64 exec, 1
  buffer_atomic_add v250, v251, s[8:11], s90 offen sc1
  s_mov_b64 exec, -1
kg_sig_25:
  s_cmp_lg_u32 s20, 0
  s_cbranch_scc1 kg_polled_26
  v_mov_b32 v251, 0
  s_lshl_b32 s90, s16, 8
  s_add_u32 s90, s90, 94208
  s_mov_b32 s91, 0x100000
kg_poll_27:
  buffer_load_dword v250, v251, s[8:11], s90 offen sc1
  s_waitcnt vmcnt(0)
  v_readfirstlane_b32 s92, v250
  s_sub_u32 s91, s91, 1
  s_cmp_eq_u32 s91, 0
  s_cbranch_scc1 kg_ok_28
  s_cmp_ge_u32 s92, 16
  s_cbranch_scc1 kg_ok_28
  s_sleep 1
  s_branch kg_poll_27
kg_ok_28:
kg_polled_26:
  s_barrier
  s_add_u32 s25, s24, 0
  buffer_load_dwordx4 v[68:71], v3, s[8:11], s25 offen sc1
  buffer_load_dwordx4 v[72:75], v3, s[8:11], s25 offen offset:1024 sc1
  buffer_load_dwordx4 v[76:79], v3, s[8:11], s25 offen offset:2048 sc1
  buffer_load_dwordx4 v[80:83], v3, s[8:11], s25 offen offset:3072 sc1
  s_add_u32 s25, s24, 4096
  buffer_load_dwordx4 v[104:107], v3, s[8:11], s25 offen sc1
  buffer_load_dwordx4 v[108:111], v3, s[8:11], s25 offen offset:1024 sc1
  buffer_load_dwordx4 v[112:115], v3, s[8:11], s25 offen offset:2048 sc1
  buffer_load_dwordx4 v[116:119], v3, s[8:11], s25 offen offset:3072 sc1
  s_waitcnt vmcnt(4)
  v_mfma_f32_16x16x32_bf16 a[0:3], v[48:51], v[68:71], 0
  s_add_u32 s25, s24, 8192
  buffer_load_dwordx4 v[140:143], v3, s[8:11], s25 offen sc1
  v_mfma_f32_16x16x32_bf16 a[4:7], v[48:51], v[72:75], 0
  buffer_load_dwordx4 v[144:147], v3, s[8:11], s25 offen offset:1024 sc1
  v_mfma_f32_16x16x32_bf16 a[8:11], v[48:51], v[76:79], 0
  buffer_load_dwordx4 v[148:151], v3, s[8:11], s25 offen offset:2048 sc1
  v_mfma_f32_16x16x32_bf16 a[12:15], v[48:51], v[80:83], 0
  buffer_load_dwordx4 v[152:155], v3, s[8:11], s25 offen offset:3072 sc1
  v_mfma_f32_16x16x32_bf16 a[16:19], v[52:55], v[68:71], 0
  s_add_u32 s25, s24, 12288
  buffer_load_dwordx4 v[176:179], v3, s[8:11], s25 offen sc1
  v_mfma_f32_16x16x32_bf16 a[20:23], v[52:55], v[72:75], 0
  buffer_load_dwordx4 v[180:183], v3, s[8:11], s25 offen offset:1024 sc1
  v_mfma_f32_16x16x32_bf16 a[24:27], v[52:55], v[76:79], 0
  buffer_load_dwordx4 v[184:187], v3, s[8:11], s25 offen offset:2048 sc1
  v_mfma_f32_16x16x32_bf16 a[28:31], v[52:55], v[80:83], 0
  buffer_load_dwordx4 v[188:191], v3, s[8:11], s25 offen offset:3072 sc1
  v_mfma_f32_16x16x32_bf16 a[32:35], v[56:59], v[68:71], 0
  s_add_u32 s25, s24, 16384
  buffer_load_dwordx2 v[212:213], v11, s[8:11], s25 offen sc1
  v_mfma_f32_16x16x32_bf16 a[36:39], v[56:59], v[72:75], 0
  buffer_load_dwordx2 v[214:215], v11, s[8:11], s25 offen offset:512 sc1
  v_mfma_f32_16x16x32_bf16 a[40:43], v[56:59], v[76:79], 0
  v_mfma_f32_16x16x32_bf16 a[44:47], v[56:59], v[80:83], 0
  buffer_load_dwordx2 v[216:217], v11, s[8:11], s25 offen offset:1024 sc1
  v_mfma_f32_16x16x32_bf16 a[48:51], v[60:63], v[68:71], 0
  v_mfma_f32_16x16x32_bf16 a[52:55], v[60:63], v[72:75], 0
  buffer_load_dwordx2 v[218:219], v11, s[8:11], s25 offen offset:1536 sc1
  v_mfma_f32_16x16x32_bf16 a[56:59], v[60:63], v[76:79], 0
  v_mfma_f32_16x16x32_bf16 a[60:63], v[60:63], v[80:83], 0
  buffer_load_dwordx2 v[220:221], v11, s[8:11], s25 offen offset:2048 sc1
  buffer_load_dwordx2 v[222:223], v11, s[8:11], s25 offen offset:2560 sc1
  buffer_load_dwordx2 v[224:225], v11, s[8:11], s25 offen offset:3072 sc1
  buffer_load_dwordx2 v[226:227], v11, s[8:11], s25 offen offset:3584 sc1
  s_add_u32 s26, s22, 147456
  buffer_load_dwordx4 v[192:195], v3, s[8:11], s26 offen
  buffer_load_dwordx4 v[196:199], v3, s[8:11], s26 offen offset:1024
  buffer_load_dwordx4 v[200:203], v3, s[8:11], s26 offen offset:2048
  buffer_load_dwordx4 v[204:207], v3, s[8:11], s26 offen offset:3072
  s_waitcnt vmcnt(20)
  v_mfma_f32_16x16x32_bf16 a[0:3], v[84:87], v[104:107], a[0:3]
  v_mfma_f32_16x16x32_bf16 a[4:7], v[84:87], v[108:111], a[4:7]
  s_add_u32 s25, s24, 20480
  buffer_load_dwordx4 v[68:71], v3, s[8:11], s25 offen sc1
  v_mfma_f32_16x16x32_bf16 a[8:11], v[84:87], v[112:115], a[8:11]
  v_mfma_f32_16x16x32_bf16 a[12:15], v[84:87], v[116:119], a[12:15]
  buffer_load_dwordx4 v[72:75], v3, s[8:11], s25 offen offset:1024 sc1
  v_mfma_f32_16x16x32_bf16 a[16:19], v[88:91], v[104:107], a[16:19]
  v_mfma_f32_16x16x32_bf16 a[20:23], v[88:91], v[108:111], a[20:23]
  buffer_load_dwordx4 v[76:79], v3, s[8:11], s25 offen offset:2048 sc1
  v_mfma_f32_16x16x32_bf16 a[24:27], v[88:91], v[112:115], a[24:27]
  v_mfma_f32_16x16x32_bf16 a[28:31], v[88:91], v[116:119], a[28:31]
  buffer_load_dwordx4 v[80:83], v3, s[8:11], s25 offen offset:3072 sc1
  v_mfma_f32_16x16x32_bf16 a[32:35], v[92:95], v[104:107], a[32:35]
  v_mfma_f32_16x16x32_bf16 a[36:39], v[92:95], v[108:111], a[36:39]
  s_add_u32 s26, s22, 184320
  buffer_load_dwordx4 v[48:51], v3, s[8:11], s26 offen
  v_mfma_f32_16x16x32_bf16 a[40:43], v[92:95], v[112:115], a[40:43]
  v_mfma_f32_16x16x32_bf16 a[44:47], v[92:95], v[116:119], a[44:47]
  buffer_load_dwordx4 v[52:55], v3, s[8:11], s26 offen offset:1024
  v_mfma_f32_16x16x32_bf16 a[48:51], v[96:99], v[104:107], a[48:51]
  v_mfma_f32_16x16x32_bf16 a[52:55], v[96:99], v[108:111], a[52:55]
  buffer_load_dwordx4 v[56:59], v3, s[8:11], s26 offen offset:2048
  v_mfma_f32_16x16x32_bf16 a[56:59], v[96:99], v[112:115], a[56:59]
  v_mfma_f32_16x16x32_bf16 a[60:63], v[96:99], v[116:119], a[60:63]
  buffer_load_dwordx4 v[60:63], v3, s[8:11], s26 offen offset:3072
  s_waitcnt vmcnt(24)
  v_mfma_f32_16x16x32_bf16 a[0:3], v[120:123], v[140:143], a[0:3]
  v_mfma_f32_16x16x32_bf16 a[4:7], v[120:123], v[144:147], a[4:7]
  s_add_u32 s25, s24, 24576
  buffer_load_dwordx4 v[104:107], v3, s[8:11], s25 offen sc1
  v_mfma_f32_16x16x32_bf16 a[8:11], v[120:123], v[148:151], a[8:11]
  v_mfma_f32_16x16x32_bf16 a[12:15], v[120:123], v[152:155], a[12:15]
  buffer_load_dwordx4 v[108:111], v3, s[8:11], s25 offen offset:1024 sc1
  v_mfma_f32_16x16x32_bf16 a[16:19], v[124:127], v[140:143], a[16:19]
  v_mfma_f32_16x16x32_bf16 a[20:23], v[124:127], v[144:147], a[20:23]
  buffer_load_dwordx4 v[112:115], v3, s[8:11], s25 offen offset:2048 sc1
  v_mfma_f32_16x16x32_bf16 a[24:27], v[124:127], v[148:151], a[24:27]
  v_mfma_f32_16x16x32_bf16 a[28:31], v[124:127], v[152:155], a[28:31]
  buffer_load_dwordx4 v[116:119], v3, s[8:11], s25 offen offset:3072 sc1
  v_mfma_f32_16x16x32_bf16 a[32:35], v[128:131], v[140:143], a[32:35]
  v_mfma_f32_16x16x32_bf16 a[36:39], v[128:131], v[144:147], a[36:39]
  s_add_u32 s26, s22, 221184
  buffer_load_dwordx4 v[84:87], v3, s[8:11], s26 offen
  v_mfma_f32_16x16x32_bf16 a[40:43], v[128:131], v[148:151], a[40:43]
  v_mfma_f32_16x16x32_bf16 a[44:47], v[128:131], v[152:155], a[44:47]
  buffer_load_dwordx4 v[88:91], v3, s[8:11], s26 offen offset:1024
  v_mfma_f32_16x16x32_bf16 a[48:51], v[132:135], v[140:143], a[48:51]
  v_mfma_f32_16x16x32_bf16 a[52:55], v[132:135], v[144:147], a[52:55]
  buffer_load_dwordx4 v[92:95], v3, s[8:11], s26 offen offset:2048
  v_mfma_f32_16x16x32_bf16 a[56:59], v[132:135], v[148:151], a[56:59]
  v_mfma_f32_16x16x32_bf16 a[60:63], v[132:135], v[152:155], a[60:63]
  buffer_load_dwordx4 v[96:99], v3, s[8:11], s26 offen offset:3072
  s_waitcnt vmcnt(28)
  v_mfma_f32_16x16x32_bf16 a[0:3], v[156:159], v[176:179], a[0:3]
  v_mfma_f32_16x16x32_bf16 a[4:7], v[156:159], v[180:183], a[4:7]
  s_add_u32 s25, s24, 28672
  buffer_load_dwordx4 v[140:143], v3, s[8:11], s25 offen sc1
  v_mfma_f32_16x16x32_bf16 a[8:11], v[156:159], v[184:187], a[8:11]
  v_mfma_f32_16x16x32_bf16 a[12:15], v[156:159], v[188:191], a[12:15]
  buffer_load_dwordx4 v[144:147], v3, s[8:11], s25 offen offset:1024 sc1
  v_mfma_f32_16x16x32_bf16 a[16:19], v[160:163], v[176:179], a[16:19]
  v_mfma_f32_16x16x32_bf16 a[20:23], v[160:163], v[180:183], a[20:23]
  buffer_load_dwordx4 v[148:151], v3, s[8:11], s25 offen offset:2048 sc1
  v_mfma_f32_16x16x32_bf16 a[24:27], v[160:163], v[184:187], a[24:27]
  v_mfma_f32_16x16x32_bf16 a[28:31], v[160:163], v[188:191], a[28:31]
  buffer_load_dwordx4 v[152:155], v3, s[8:11], s25 offen offset:3072 sc1
  v_mfma_f32_16x16x32_bf16 a[32:35], v[164:167], v[176:179], a[32:35]
  v_mfma_f32_16x16x32_bf16 a[36:39], v[164:167], v[180:183], a[36:39]
  s_add_u32 s26, s22, 258048
  buffer_load_dwordx4 v[120:123], v3, s[8:11], s26 offen
  v_mfma_f32_16x16x32_bf16 a[40:43], v[164:167], v[184:187], a[40:43]
  v_mfma_f32_16x16x32_bf16 a[44:47], v[164:167], v[188:191], a[44:47]
  buffer_load_dwordx4 v[124:127], v3, s[8:11], s26 offen offset:1024
  v_mfma_f32_16x16x32_bf16 a[48:51], v[168:171], v[176:179], a[48:51]
  v_mfma_f32_16x16x32_bf16 a[52:55], v[168:171], v[180:183], a[52:55]
  buffer_load_dwordx4 v[128:131], v3, s[8:11], s26 offen offset:2048
  v_mfma_f32_16x16x32_bf16 a[56:59], v[168:171], v[184:187], a[56:59]
  v_mfma_f32_16x16x32_bf16 a[60:63], v[168:171], v[188:191], a[60:63]
  buffer_load_dwordx4 v[132:135], v3, s[8:11], s26 offen offset:3072
  s_waitcnt vmcnt(24)
  v_mfma_f32_16x16x32_bf16 a[0:3], v[192:195], v[212:215], a[0:3]
  v_mfma_f32_16x16x32_bf16 a[4:7], v[192:195], v[216:219], a[4:7]
  s_add_u32 s25, s24, 32768
  buffer_load_dwordx4 v[176:179], v3, s[8:11], s25 offen sc1
  v_mfma_f32_16x16x32_bf16 a[8:11], v[192:195], v[220:223], a[8:11]
  v_mfma_f32_16x16x32_bf16 a[12:15], v[192:195], v[224:227], a[12:15]
  buffer_load_dwordx4 v[180:183], v3, s[8:11], s25 offen offset:1024 sc1
  v_mfma_f32_16x16x32_bf16 a[16:19], v[196:199], v[212:215], a[16:19]
  v_mfma_f32_16x16x32_bf16 a[20:23], v[196:199], v[216:219], a[20:23]
  buffer_load_dwordx4 v[184:187], v3, s[8:11], s25 offen offset:2048 sc1
  v_mfma_f32_16x16x32_bf16 a[24:27], v[196:199], v[220:223], a[24:27]
  v_mfma_f32_16x16x32_bf16 a[28:31], v[196:199], v[224:227], a[28:31]
  buffer_load_dwordx4 v[188:191], v3, s[8:11], s25 offen offset:3072 sc1
  v_mfma_f32_16x16x32_bf16 a[32:35], v[200:203], v[212:215], a[32:35]
  v_mfma_f32_16x16x32_bf16 a[36:39], v[200:203], v[216:219], a[36:39]
  s_add_u32 s26, s22, 294912
  buffer_load_dwordx4 v[156:159], v3, s[8:11], s26 offen
  v_mfma_f32_16x16x32_bf16 a[40:43], v[200:203], v[220:223], a[40:43]
  v_mfma_f32_16x16x32_bf16 a[44:47], v[200:203], v[224:227], a[44:47]
  buffer_load_dwordx4 v[160:163], v3, s[8:11], s26 offen offset:1024
  v_mfma_f32_16x16x32_bf16 a[48:51], v[204:207], v[212:215], a[48:51]
  v_mfma_f32_16x16x32_bf16 a[52:55], v[204:207], v[216:219], a[52:55]
  buffer_load_dwordx4 v[164:167], v3, s[8:11], s26 offen offset:2048
  v_mfma_f32_16x16x32_bf16 a[56:59], v[204:207], v[220:223], a[56:59]
  v_mfma_f32_16x16x32_bf16 a[60:63], v[204:207], v[224:227], a[60:63]
  buffer_load_dwordx4 v[168:171], v3, s[8:11], s26 offen offset:3072
  s_waitcnt vmcnt(24)
  v_mfma_f32_16x16x32_bf16 a[0:3], v[48:51], v[68:71], a[0:3]
  v_mfma_f32_16x16x32_bf16 a[4:7], v[48:51], v[72:75], a[4:7]
  s_add_u32 s25, s24, 36864
  buffer_load_dwordx4 v[212:215], v3, s[8:11], s25 offen sc1
  v_mfma_f32_16x16x32_bf16 a[8:11], v[48:51], v[76:79], a[8:11]
  v_mfma_f32_16x16x32_bf16 a[12:15], v[48:51], v[80:83], a[12:15]
  buffer_load_dwordx4 v[216:219], v3, s[8:11], s25 offen offset:1024 sc1
  v_mfma_f32_16x16x32_bf16 a[16:19], v[52:55], v[68:71], a[16:19]
  v_mfma_f32_16x16x32_bf16 a[20:23], v[52:55], v[72:75], a[20:23]
  buffer_load_dwordx4 v[220:223], v3, s[8:11], s25 offen offset:2048 sc1
  v_mfma_f32_16x16x32_bf16 a[24:27], v[52:55], v[76:79], a[24:27]
  v_mfma_f32_16x16x32_bf16 a[28:31], v[52:55], v[80:83], a[28:31]
  buffer_load_dwordx4 v[224:227], v3, s[8:11], s25 offen offset:3072 sc1
  v_mfma_f32_16x16x32_bf16 a[32:35], v[56:59], v[68:71], a[32:35]
  v_mfma_f32_16x16x32_bf16 a[36:39], v[56:59], v[72:75], a[36:39]
  s_add_u32 s26, s22, 331776
  buffer_load_dwordx4 v[192:195], v3, s[8:11], s26 offen
  v_mfma_f32_16x16x32_bf16 a[40:43], v[56:59], v[76:79], a[40:43]
  v_mfma_f32_16x16x32_bf16 a[44:47], v[56:59], v[80:83], a[44:47]
  buffer_load_dwordx4 v[196:199], v3, s[8:11], s26 offen offset:1024
  v_mfma_f32_16x16x32_bf16 a[48:51], v[60:63], v[68:71], a[48:51]
  v_mfma_f32_16x16x32_bf16 a[52:55], v[60:63], v[72:75], a[52:55]
  buffer_load_dwordx4 v[200:203], v3, s[8:11], s26 offen offset:2048
  v_mfma_f32_16x16x32_bf16 a[56:59], v[60:63], v[76:79], a[56:59]
  v_mfma_f32_16x16x32_bf16 a[60:63], v[60:63], v[80:83], a[60:63]
  buffer_load_dwordx4 v[204:207], v3, s[8:11], s26 offen offset:3072
  s_waitcnt vmcnt(24)
  v_mfma_f32_16x16x32_bf16 a[0:3], v[84:87], v[104:107], a[0:3]
  v_mfma_f32_16x16x32_bf16 a[4:7], v[84:87], v[108:111], a[4:7]
  s_add_u32 s25, s24, 40960
  buffer_load_dwordx4 v[68:71], v3, s[8:11], s25 offen sc1
  v_mfma_f32_16x16x32_bf16 a[8:11], v[84:87], v[112:115], a[8:11]
  v_mfma_f32_16x16x32_bf16 a[12:15], v[84:87], v[116:119], a[12:15]
  buffer_load_dwordx4 v[72:75], v3, s[8:11], s25 offen offset:1024 sc1
  v_mfma_f32_16x16x32_bf16 a[16:19], v[88:91], v[104:107], a[16:19]
  v_mfma_f32_16x16x32_bf16 a[20:23], v[88:91], v[108:111], a[20:23]
  buffer_load_dwordx4 v[76:79], v3, s[8:11], s25 offen offset:2048 sc1
  v_mfma_f32_16x16x32_bf16 a[24:27], v[88:91], v[112:115], a[24:27]
  v_mfma_f32_16x16x32_bf16 a[28:31], v[88:91], v[116:119], a[28:31]
  buffer_load_dwordx4 v[80:83], v3, s[8:11], s25 offen offset:3072 sc1
  v_mfma_f32_16x16x32_bf16 a[32:35], v[92:95], v[104:107], a[32:35]
  v_mfma_f32_16x16x32_bf16 a[36:39], v[92:95], v[108:111], a[36:39]
  s_add_u32 s26, s22, 368640
  buffer_load_dwordx4 v[48:51], v3, s[8:11], s26 offen
  v_mfma_f32_16x16x32_bf16 a[40:43], v[92:95], v[112:115], a[40:43]
  v_mfma_f32_16x16x32_bf16 a[44:47], v[92:95], v[116:119], a[44:47]
  buffer_load_dwordx4 v[52:55], v3, s[8:11], s26 offen offset:1024
  v_mfma_f32_16x16x32_bf16 a[48:51], v[96:99], v[104:107], a[48:51]
  v_mfma_f32_16x16x32_bf16 a[52:55], v[96:99], v[108:111], a[52:55]
  buffer_load_dwordx4 v[56:59], v3, s[8:11], s26 offen offset:2048
  v_mfma_f32_16x16x32_bf16 a[56:59], v[96:99], v[112:115], a[56:59]
  v_mfma_f32_16x16x32_bf16 a[60:63], v[96:99], v[116:119], a[60:63]
  buffer_load_dwordx4 v[60:63], v3, s[8:11], s26 offen offset:3072
  s_waitcnt vmcnt(24)
  v_mfma_f32_16x16x32_bf16 a[0:3], v[120:123], v[140:143], a[0:3]
  v_mfma_f32_16x16x32_bf16 a[4:7], v[120:123], v[144:147], a[4:7]
  s_add_u32 s25, s24, 45056
  buffer_load_dwordx4 v[104:107], v3, s[8:11], s25 offen sc1
  v_mfma_f32_16x16x32_bf16 a[8:11], v[120:123], v[148:151], a[8:11]
  v_mfma_f32_16x16x32_bf16 a[12:15], v[120:123], v[152:155], a[12:15]
  buffer_load_dwordx4 v[108:111], v3, s[8:11], s25 offen offset:1024 sc1
  v_mfma_f32_16x16x32_bf16 a[16:19], v[124:127], v[140:143], a[16:19]
  v_mfma_f32_16x16x32_bf16 a[20:23], v[124:127], v[144:147], a[20:23]
  buffer_load_dwordx4 v[112:115], v3, s[8:11], s25 offen offset:2048 sc1
  v_mfma_f32_16x16x32_bf16 a[24:27], v[124:127], v[148:151], a[24:27]
  v_mfma_f32_16x16x32_bf16 a[28:31], v[124:127], v[152:155], a[28:31]
  buffer_load_dwordx4 v[116:119], v3, s[8:11], s25 offen offset:3072 sc1
  v_mfma_f32_16x16x32_bf16 a[32:35], v[128:131], v[140:143], a[32:35]
  v_mfma_f32_16x16x32_bf16 a[36:39], v[128:131], v[144:147], a[36:39]
  s_add_u32 s26, s22, 405504
  buffer_load_dwordx4 v[84:87], v3, s[8:11], s26 offen
  v_mfma_f32_16x16x32_bf16 a[40:43], v[128:131], v[148:151], a[40:43]
  v_mfma_f32_16x16x32_bf16 a[44:47], v[128:131], v[152:155], a[44:47]
  buffer_load_dwordx4 v[88:91], v3, s[8:11], s26 offen offset:1024
  v_mfma_f32_16x16x32_bf16 a[48:51], v[132:135], v[140:143], a[48:51]
  v_mfma_f32_16x16x32_bf16 a[52:55], v[132:135], v[144:147], a[52:55]
  buffer_load_dwordx4 v[92:95], v3, s[8:11], s26 offen offset:2048
  v_mfma_f32_16x16x32_bf16 a[56:59], v[132:135], v[148:151], a[56:59]
  v_mfma_f32_16x16x32_bf16 a[60:63], v[132:135], v[152:155], a[60:63]
  buffer_load_dwordx4 v[96:99], v3, s[8:11], s26 offen offset:3072
  s_waitcnt vmcnt(24)
  v_mfma_f32_16x16x32_bf16 a[0:3], v[156:159], v[176:179], a[0:3]
  v_mfma_f32_16x16x32_bf16 a[4:7], v[156:159], v[180:183], a[4:7]
  s_add_u32 s25, s24, 49152
  buffer_load_dwordx4 v[140:143], v3, s[8:11], s25 offen sc1
  v_mfma_f32_16x16x32_bf16 a[8:11], v[156:159], v[184:187], a[8:11]
  v_mfma_f32_16x16x32_bf16 a[12:15], v[156:159], v[188:191], a[12:15]
  buffer_load_dwordx4 v[144:147], v3, s[8:11], s25 offen offset:1024 sc1
  v_mfma_f32_16x16x32_bf16 a[16:19], v[160:163], v[176:179], a[16:19]
  v_mfma_f32_16x16x32_bf16 a[20:23], v[160:163], v[180:183], a[20:23]
  buffer_load_dwordx4 v[148:151], v3, s[8:11], s25 offen offset:2048 sc1
  v_mfma_f32_16x16x32_bf16 a[24:27], v[160:163], v[184:187], a[24:27]
  v_mfma_f32_16x16x32_bf16 a[28:31], v[160:163], v[188:191], a[28:31]
  buffer_load_dwordx4 v[152:155], v3, s[8:11], s25 offen offset:3072 sc1
  v_mfma_f32_16x16x32_bf16 a[32:35], v[164:167], v[176:179], a[32:35]
  v_mfma_f32_16x16x32_bf16 a[36:39], v[164:167], v[180:183], a[36:39]
  s_add_u32 s26, s22, 442368
  buffer_load_dwordx4 v[120:123], v3, s[8:11], s26 offen
  v_mfma_f32_16x16x32_bf16 a[40:43], v[164:167], v[184:187], a[40:43]
  v_mfma_f32_16x16x32_bf16 a[44:47], v[164:167], v[188:191], a[44:47]
  buffer_load_dwordx4 v[124:127], v3, s[8:11], s26 offen offset:1024
  v_mfma_f32_16x16x32_bf16 a[48:51], v[168:171], v[176:179], a[48:51]
  v_mfma_f32_16x16x32_bf16 a[52:55], v[168:171], v[180:183], a[52:55]
  buffer_load_dwordx4 v[128:131], v3, s[8:11], s26 offen offset:2048
  v_mfma_f32_16x16x32_bf16 a[56:59], v[168:171], v[184:187], a[56:59]
  v_mfma_f32_16x16x32_bf16 a[60:63], v[168:171], v[188:191], a[60:63]
  buffer_load_dwordx4 v[132:135], v3, s[8:11], s26 offen offset:3072
  s_waitcnt vmcnt(24)
  v_mfma_f32_16x16x32_bf16 a[0:3], v[192:195], v[212:215], a[0:3]
  s_add_u32 s25, s24, 53248
  buffer_load_dwordx2 v[176:177], v11, s[8:11], s25 offen sc1
  v_mfma_f32_16x16x32_bf16 a[4:7], v[192:195], v[216:219], a[4:7]
  buffer_load_dwordx2 v[178:179], v11, s[8:11], s25 offen offset:512 sc1
  v_mfma_f32_16x16x32_bf16 a[8:11], v[192:195], v[220:223], a[8:11]
  v_mfma_f32_16x16x32_bf16 a[12:15], v[192:195], v[224:227], a[12:15]
  buffer_load_dwordx2 v[180:181], v11, s[8:11], s25 offen offset:1024 sc1
  v_mfma_f32_16x16x32_bf16 a[16:19], v[196:199], v[212:215], a[16:19]
  v_mfma_f32_16x16x32_bf16 a[20:23], v[196:199], v[216:219], a[20:23]
  buffer_load_dwordx2 v[182:183], v11, s[8:11], s25 offen offset:1536 sc1
  v_mfma_f32_16x16x32_bf16 a[24:27], v[196:199], v[220:223], a[24:27]
  v_mfma_f32_16x16x32_bf16 a[28:31], v[196:199], v[224:227], a[28:31]
  buffer_load_dwordx2 v[184:185], v11, s[8:11], s25 offen offset:2048 sc1
  v_mfma_f32_16x16x32_bf16 a[32:35], v[200:203], v[212:215], a[32:35]
  v_mfma_f32_16x16x32_bf16 a[36:39], v[200:203], v[216:219], a[36:39]
  buffer_load_dwordx2 v[186:187], v11, s[8:11], s25 offen offset:2560 sc1
  v_mfma_f32_16x16x32_bf16 a[40:43], v[200:203], v[220:223], a[40:43]
  v_mfma_f32_16x16x32_bf16 a[44:47], v[200:203], v[224:227], a[44:47]
  buffer_load_dwordx2 v[188:189], v11, s[8:11], s25 offen offset:3072 sc1
  v_mfma_f32_16x16x32_bf16 a[48:51], v[204:207], v[212:215], a[48:51]
  v_mfma_f32_16x16x32_bf16 a[52:55], v[204:207], v[216:219], a[52:55]
  buffer_load_dwordx2 v[190:191], v11, s[8:11], s25 offen offset:3584 sc1
  v_mfma_f32_16x16x32_bf16 a[56:59], v[204:207], v[220:223], a[56:59]
  v_mfma_f32_16x16x32_bf16 a[60:63], v[204:207], v[224:227], a[60:63]
  s_add_u32 s26, s22, 479232
  buffer_load_dwordx4 v[156:159], v3, s[8:11], s26 offen
  buffer_load_dwordx4 v[160:163], v3, s[8:11], s26 offen offset:1024
  buffer_load_dwordx4 v[164:167], v3, s[8:11], s26 offen offset:2048
  buffer_load_dwordx4 v[168:171], v3, s[8:11], s26 offen offset:3072
  s_waitcnt vmcnt(28)
  v_mfma_f32_16x16x32_bf16 a[0:3], v[48:51], v[68:71], a[0:3]
  v_mfma_f32_16x16x32_bf16 a[4:7], v[48:51], v[72:75], a[4:7]
  s_add_u32 s25, s24, 57344
  buffer_load_dwordx4 v[212:215], v3, s[8:11], s25 offen sc1
  v_mfma_f32_16x16x32_bf16 a[8:11], v[48:51], v[76:79], a[8:11]
  v_mfma_f32_16x16x32_bf16 a[12:15], v[48:51], v[80:83], a[12:15]
  buffer_load_dwordx4 v[216:219], v3, s[8:11], s25 offen offset:1024 sc1
  v_mfma_f32_16x16x32_bf16 a[16:19], v[52:55], v[68:71], a[16:19]
  v_mfma_f32_16x16x32_bf16 a[20:23], v[52:55], v[72:75], a[20:23]
  buffer_load_dwordx4 v[220:223], v3, s[8:11], s25 offen offset:2048 sc1
  v_mfma_f32_16x16x32_bf16 a[24:27], v[52:55], v[76:79], a[24:27]
  v_mfma_f32_16x16x32_bf16 a[28:31], v[52:55], v[80:83], a[28:31]
  buffer_load_dwordx4 v[224:227], v3, s[8:11], s25 offen offset:3072 sc1
  v_mfma_f32_16x16x32_bf16 a[32:35], v[56:59], v[68:71], a[32:35]
  v_mfma_f32_16x16x32_bf16 a[36:39], v[56:59], v[72:75], a[36:39]
  s_add_u32 s26, s22, 516096
  buffer_load_dwordx4 v[192:195], v3, s[8:11], s26 offen
  v_mfma_f32_16x16x32_bf16 a[40:43], v[56:59], v[76:79], a[40:43]
  v_mfma_f32_16x16x32_bf16 a[44:47], v[56:59], v[80:83], a[44:47]
  buffer_load_dwordx4 v[196:199], v3, s[8:11], s26 offen offset:1024
  v_mfma_f32_16x16x32_bf16 a[48:51], v[60:63], v[68:71], a[48:51]
  v_mfma_f32_16x16x32_bf16 a[52:55], v[60:63], v[72:75], a[52:55]
  buffer_load_dwordx4 v[200:203], v3, s[8:11], s26 offen offset:2048
  v_mfma_f32_16x16x32_bf16 a[56:59], v[60:63], v[76:79], a[56:59]
  v_mfma_f32_16x16x32_bf16 a[60:63], v[60:63], v[80:83], a[60:63]
  buffer_load_dwordx4 v[204:207], v3, s[8:11], s26 offen offset:3072
  s_waitcnt vmcnt(28)
  v_mfma_f32_16x16x32_bf16 a[0:3], v[84:87], v[104:107], a[0:3]
  v_mfma_f32_16x16x32_bf16 a[4:7], v[84:87], v[108:111], a[4:7]
  s_add_u32 s25, s24, 61440
  buffer_load_dwordx4 v[68:71], v3, s[8:11], s25 offen sc1
  v_mfma_f32_16x16x32_bf16 a[8:11], v[84:87], v[112:115], a[8:11]
  v_mfma_f32_16x16x32_bf16 a[12:15], v[84:87], v[116:119], a[12:15]
  buffer_load_dwordx4 v[72:75], v3, s[8:11], s25 offen offset:1024 sc1
  v_mfma_f32_16x16x32_bf16 a[16:19], v[88:91], v[104:107], a[16:19]
  v_mfma_f32_16x16x32_bf16 a[20:23], v[88:91], v[108:111], a[20:23]
  buffer_load_dwordx4 v[76:79], v3, s[8:11], s25 offen offset:2048 sc1
  v_mfma_f32_16x16x32_bf16 a[24:27], v[88:91], v[112:115], a[24:27]
  v_mfma_f32_16x16x32_bf16 a[28:31], v[88:91], v[116:119], a[28:31]
  buffer_load_dwordx4 v[80:83], v3, s[8:11], s25 offen offset:3072 sc1
  v_mfma_f32_16x16x32_bf16 a[32:35], v[92:95], v[104:107], a[32:35]
  v_mfma_f32_16x16x32_bf16 a[36:39], v[92:95], v[108:111], a[36:39]
  s_add_u32 s26, s22, 552960
  buffer_load_dwordx4 v[48:51], v3, s[8:11], s26 offen
  v_mfma_f32_16x16x32_bf16 a[40:43], v[92:95], v[112:115], a[40:43]
  v_mfma_f32_16x16x32_bf16 a[44:47], v[92:95], v[116:119], a[44:47]
  buffer_load_dwordx4 v[52:55], v3, s[8:11], s26 offen offset:1024
  v_mfma_f32_16x16x32_bf16 a[48:51], v[96:99], v[104:107], a[48:51]
  v_mfma_f32_16x16x32_bf16 a[52:55], v[96:99], v[108:111], a[52:55]
  buffer_load_dwordx4 v[56:59], v3, s[8:11], s26 offen offset:2048
  v_mfma_f32_16x16x32_bf16 a[56:59], v[96:99], v[112:115], a[56:59]
  v_mfma_f32_16x16x32_bf16 a[60:63], v[96:99], v[116:119], a[60:63]
  buffer_load_dwordx4 v[60:63], v3, s[8:11], s26 offen offset:3072
  s_waitcnt vmcnt(28)
  v_mfma_f32_16x16x32_bf16 a[0:3], v[120:123], v[140:143], a[0:3]
  v_mfma_f32_16x16x32_bf16 a[4:7], v[120:123], v[144:147], a[4:7]
  s_add_u32 s25, s24, 65536
  buffer_load_dwordx4 v[104:107], v3, s[8:11], s25 offen sc1
  v_mfma_f32_16x16x32_bf16 a[8:11], v[120:123], v[148:151], a[8:11]
  v_mfma_f32_16x16x32_bf16 a[12:15], v[120:123], v[152:155], a[12:15]
  buffer_load_dwordx4 v[108:111], v3, s[8:11], s25 offen offset:1024 sc1
  v_mfma_f32_16x16x32_bf16 a[16:19], v[124:127], v[140:143], a[16:19]
  v_mfma_f32_16x16x32_bf16 a[20:23], v[124:127], v[144:147], a[20:23]
  buffer_load_dwordx4 v[112:115], v3, s[8:11], s25 offen offset:2048 sc1
  v_mfma_f32_16x16x32_bf16 a[24:27], v[124:127], v[148:151], a[24:27]
  v_mfma_f32_16x16x32_bf16 a[28:31], v[124:127], v[152:155], a[28:31]
  buffer_load_dwordx4 v[116:119], v3, s[8:11], s25 offen offset:3072 sc1
  v_mfma_f32_16x16x32_bf16 a[32:35], v[128:131], v[140:143], a[32:35]
  v_mfma_f32_16x16x32_bf16 a[36:39], v[128:131], v[144:147], a[36:39]
  s_add_u32 s26, s22, 589824
  buffer_load_dwordx4 v[84:87], v3, s[8:11], s26 offen
  v_mfma_f32_16x16x32_bf16 a[40:43], v[128:131], v[148:151], a[40:43]
  v_mfma_f32_16x16x32_bf16 a[44:47], v[128:131], v[152:155], a[44:47]
  buffer_load_dwordx4 v[88:91], v3, s[8:11], s26 offen offset:1024
  v_mfma_f32_16x16x32_bf16 a[48:51], v[132:135], v[140:143], a[48:51]
  v_mfma_f32_16x16x32_bf16 a[52:55], v[132:135], v[144:147], a[52:55]
  buffer_load_dwordx4 v[92:95], v3, s[8:11], s26 offen offset:2048
  v_mfma_f32_16x16x32_bf16 a[56:59], v[132:135], v[148:151], a[56:59]
  v_mfma_f32_16x16x32_bf16 a[60:63], v[132:135], v[152:155], a[60:63]
  buffer_load_dwordx4 v[96:99], v3, s[8:11], s26 offen offset:3072
  s_waitcnt vmcnt(24)
  v_mfma_f32_16x16x32_bf16 a[0:3], v[156:159], v[176:179], a[0:3]
  v_mfma_f32_16x16x32_bf16 a[4:7], v[156:159], v[180:183], a[4:7]
  s_add_u32 s25, s24, 69632
  buffer_load_dwordx4 v[140:143], v3, s[8:11], s25 offen sc1
  v_mfma_f32_16x16x32_bf16 a[8:11], v[156:159], v[184:187], a[8:11]
  v_mfma_f32_16x16x32_bf16 a[12:15], v[156:159], v[188:191], a[12:15]
  buffer_load_dwordx4 v[144:147], v3, s[8:11], s25 offen offset:1024 sc1
  v_mfma_f32_16x16x32_bf16 a[16:19], v[160:163], v[176:179], a[16:19]
  v_mfma_f32_16x16x32_bf16 a[20:23], v[160:163], v[180:183], a[20:23]
  buffer_load_dwordx4 v[148:151], v3, s[8:11], s25 offen offset:2048 sc1
  v_mfma_f32_16x16x32_bf16 a[24:27], v[160:163], v[184:187], a[24:27]
  v_mfma_f32_16x16x32_bf16 a[28:31], v[160:163], v[188:191], a[28:31]
  buffer_load_dwordx4 v[152:155], v3, s[8:11], s25 offen offset:3072 sc1
  v_mfma_f32_16x16x32_bf16 a[32:35], v[164:167], v[176:179], a[32:35]
  v_mfma_f32_16x16x32_bf16 a[36:39], v[164:167], v[180:183], a[36:39]
  s_add_u32 s26, s22, 626688
  buffer_load_dwordx4 v[120:123], v3, s[8:11], s26 offen
  v_mfma_f32_16x16x32_bf16 a[40:43], v[164:167], v[184:187], a[40:43]
  v_mfma_f32_16x16x32_bf16 a[44:47], v[164:167], v[188:191], a[44:47]
  buffer_load_dwordx4 v[124:127], v3, s[8:11], s26 offen offset:1024
  v_mfma_f32_16x16x32_bf16 a[48:51], v[168:171], v[176:179], a[48:51]
  v_mfma_f32_16x16x32_bf16 a[52:55], v[168:171], v[180:183], a[52:55]
  buffer_load_dwordx4 v[128:131], v3, s[8:11], s26 offen offset:2048
  v_mfma_f32_16x16x32_bf16 a[56:59], v[168:171], v[184:187], a[56:59]
  v_mfma_f32_16x16x32_bf16 a[60:63], v[168:171], v[188:191], a[60:63]
  buffer_load_dwordx4 v[132:135], v3, s[8:11], s26 offen offset:3072
  s_waitcnt vmcnt(24)
  v_mfma_f32_16x16x32_bf16 a[0:3], v[192:195], v[212:215], a[0:3]
  v_mfma_f32_16x16x32_bf16 a[4:7], v[192:195], v[216:219], a[4:7]
  v_mfma_f32_16x16x32_bf16 a[8:11], v[192:195], v[220:223], a[8:11]
  v_mfma_f32_16x16x32_bf16 a[12:15], v[192:195], v[224:227], a[12:15]
  v_mfma_f32_16x16x32_bf16 a[16:19], v[196:199], v[212:215], a[16:19]
  v_mfma_f32_16x16x32_bf16 a[20:23], v[196:199], v[216:219], a[20:23]
  v_mfma_f32_16x16x32_bf16 a[24:27], v[196:199], v[220:223], a[24:27]
  v_mfma_f32_16x16x32_bf16 a[28:31], v[196:199], v[224:227], a[28:31]
  v_mfma_f32_16x16x32_bf16 a[32:35], v[200:203], v[212:215], a[32:35]
  v_mfma_f32_16x16x32_bf16 a[36:39], v[200:203], v[216:219], a[36:39]
  v_mfma_f32_16x16x32_bf16 a[40:43], v[200:203], v[220:223], a[40:43]
  v_mfma_f32_16x16x32_bf16 a[44:47], v[200:203], v[224:227], a[44:47]
  v_mfma_f32_16x16x32_bf16 a[48:51], v[204:207], v[212:215], a[48:51]
  v_mfma_f32_16x16x32_bf16 a[52:55], v[204:207], v[216:219], a[52:55]
  v_mfma_f32_16x16x32_bf16 a[56:59], v[204:207], v[220:223], a[56:59]
  v_mfma_f32_16x16x32_bf16 a[60:63], v[204:207], v[224:227], a[60:63]
  s_waitcnt vmcnt(16)
  v_mfma_f32_16x16x32_bf16 a[0:3], v[48:51], v[68:71], a[0:3]
  v_mfma_f32_16x16x32_bf16 a[4:7], v[48:51], v[72:75], a[4:7]
  v_mfma_f32_16x16x32_bf16 a[8:11], v[48:51], v[76:79], a[8:11]
  v_mfma_f32_16x16x32_bf16 a[12:15], v[48:51], v[80:83], a[12:15]
  v_mfma_f32_16x16x32_bf16 a[16:19], v[52:55], v[68:71], a[16:19]
  v_mfma_f32_16x16x32_bf16 a[20:23], v[52:55], v[72:75], a[20:23]
  v_mfma_f32_16x16x32_bf16 a[24:27], v[52:55], v[76:79], a[24:27]
  v_mfma_f32_16x16x32_bf16 a[28:31], v[52:55], v[80:83], a[28:31]
  v_mfma_f32_16x16x32_bf16 a[32:35], v[56:59], v[68:71], a[32:35]
  v_mfma_f32_16x16x32_bf16 a[36:39], v[56:59], v[72:75], a[36:39]
  v_mfma_f32_16x16x32_bf16 a[40:43], v[56:59], v[76:79], a[40:43]
  v_mfma_f32_16x16x32_bf16 a[44:47], v[56:59], v[80:83], a[44:47]
  v_mfma_f32_16x16x32_bf16 a[48:51], v[60:63], v[68:71], a[48:51]
  v_mfma_f32_16x16x32_bf16 a[52:55], v[60:63], v[72:75], a[52:55]
  v_mfma_f32_16x16x32_bf16 a[56:59], v[60:63], v[76:79], a[56:59]
  v_mfma_f32_16x16x32_bf16 a[60:63], v[60:63], v[80:83], a[60:63]
  s_waitcnt vmcnt(8)
  v_mfma_f32_16x16x32_bf16 a[0:3], v[84:87], v[104:107], a[0:3]
  v_mfma_f32_16x16x32_bf16 a[4:7], v[84:87], v[108:111], a[4:7]
  v_mfma_f32_16x16x32_bf16 a[8:11], v[84:87], v[112:115], a[8:11]
  v_mfma_f32_16x16x32_bf16 a[12:15], v[84:87], v[116:119], a[12:15]
  v_mfma_f32_16x16x32_bf16 a[16:19], v[88:91], v[104:107], a[16:19]
  v_mfma_f32_16x16x32_bf16 a[20:23], v[88:91], v[108:111], a[20:23]
  v_mfma_f32_16x16x32_bf16 a[24:27], v[88:91], v[112:115], a[24:27]
  v_mfma_f32_16x16x32_bf16 a[28:31], v[88:91], v[116:119], a[28:31]
  v_mfma_f32_16x16x32_bf16 a[32:35], v[92:95], v[104:107], a[32:35]
  v_mfma_f32_16x16x32_bf16 a[36:39], v[92:95], v[108:111], a[36:39]
  v_mfma_f32_16x16x32_bf16 a[40:43], v[92:95], v[112:115], a[40:43]
  v_mfma_f32_16x16x32_bf16 a[44:47], v[92:95], v[116:119], a[44:47]
  v_mfma_f32_16x16x32_bf16 a[48:51], v[96:99], v[104:107], a[48:51]
  v_mfma_f32_16x16x32_bf16 a[52:55], v[96:99], v[108:111], a[52:55]
  v_mfma_f32_16x16x32_bf16 a[56:59], v[96:99], v[112:115], a[56:59]
  v_mfma_f32_16x16x32_bf16 a[60:63], v[96:99], v[116:119], a[60:63]
  s_waitcnt vmcnt(0)
  v_mfma_f32_16x16x32_bf16 a[0:3], v[120:123], v[140:143], a[0:3]
  v_mfma_f32_16x16x32_bf16 a[4:7], v[120:123], v[144:147], a[4:7]
  v_mfma_f32_16x16x32_bf16 a[8:11], v[120:123], v[148:151], a[8:11]
  v_mfma_f32_16x16x32_bf16 a[12:15], v[120:123], v[152:155], a[12:15]
  v_mfma_f32_16x16x32_bf16 a[16:19], v[124:127], v[140:143], a[16:19]
  v_mfma_f32_16x16x32_bf16 a[20:23], v[124:127], v[144:147], a[20:23]
  v_mfma_f32_16x16x32_bf16 a[24:27], v[124:127], v[148:151], a[24:27]
  v_mfma_f32_16x16x32_bf16 a[28:31], v[124:127], v[152:155], a[28:31]
  v_mfma_f32_16x16x32_bf16 a[32:35], v[128:131], v[140:143], a[32:35]
  v_mfma_f32_16x16x32_bf16 a[36:39], v[128:131], v[144:147], a[36:39]
  v_mfma_f32_16x16x32_bf16 a[40:43], v[128:131], v[148:151], a[40:43]
  v_mfma_f32_16x16x32_bf16 a[44:47], v[128:131], v[152:155], a[44:47]
  v_mfma_f32_16x16x32_bf16 a[48:51], v[132:135], v[140:143], a[48:51]
  v_mfma_f32_16x16x32_bf16 a[52:55], v[132:135], v[144:147], a[52:55]
  v_mfma_f32_16x16x32_bf16 a[56:59], v[132:135], v[148:151], a[56:59]
  v_mfma_f32_16x16x32_bf16 a[60:63], v[132:135], v[152:155], a[60:63]
  s_mul_i32 s30, s20, 16384
  v_add_u32 v9, s30, v3
  v_accvgpr_read_b32 v48, a0
  v_accvgpr_read_b32 v49, a1
  v_accvgpr_read_b32 v50, a2
  v_accvgpr_read_b32 v51, a3
  ds_write_b128 v9, v[48:51] offset:0
  v_accvgpr_read_b32 v52, a16
  v_accvgpr_read_b32 v53, a17
  v_accvgpr_read_b32 v54, a18
  v_accvgpr_read_b32 v55, a19
  ds_write_b128 v9, v[52:55] offset:1024
  v_accvgpr_read_b32 v56, a32
  v_accvgpr_read_b32 v57, a33
  v_accvgpr_read_b32 v58, a34
  v_accvgpr_read_b32 v59, a35
  ds_write_b128 v9, v[56:59] offset:2048
  v_accvgpr_read_b32 v60, a48
  v_accvgpr_read_b32 v61, a49
  v_accvgpr_read_b32 v62, a50
  v_accvgpr_read_b32 v63, a51
  ds_write_b128 v9, v[60:63] offset:3072
  v_accvgpr_read_b32 v64, a4
  v_accvgpr_read_b32 v65, a5
  v_accvgpr_read_b32 v66, a6
  v_accvgpr_read_b32 v67, a7
  ds_write_b128 v9, v[64:67] offset:4096
  v_accvgpr_read_b32 v68, a20
  v_accvgpr_read_b32 v69, a21
  v_accvgpr_read_b32 v70, a22
  v_accvgpr_read_b32 v71, a23
  ds_write_b128 v9, v[68:71] offset:5120
  v_accvgpr_read_b32 v72, a36
  v_accvgpr_read_b32 v73, a37
  v_accvgpr_read_b32 v74, a38
  v_accvgpr_read_b32 v75, a39
  ds_write_b128 v9, v[72:75] offset:6144
  v_accvgpr_read_b32 v76, a52
  v_accvgpr_read_b32 v77, a53
  v_accvgpr_read_b32 v78, a54
  v_accvgpr_read_b32 v79, a55
  ds_write_b128 v9, v[76:79] offset:7168
  v_accvgpr_read_b32 v80, a8
  v_accvgpr_read_b32 v81, a9
  v_accvgpr_read_b32 v82, a10
  v_accvgpr_read_b32 v83, a11
  ds_write_b128 v9, v[80:83] offset:8192
  v_accvgpr_read_b32 v84, a24
  v_accvgpr_read_b32 v85, a25
  v_accvgpr_read_b32 v86, a26
  v_accvgpr_read_b32 v87, a27
  ds_write_b128 v9, v[84:87] offset:9216
  v_accvgpr_read_b32 v88, a40
  v_accvgpr_read_b32 v89, a41
  v_accvgpr_read_b32 v90, a42
  v_accvgpr_read_b32 v91, a43
  ds_write_b128 v9, v[88:91] offset:10240
  v_accvgpr_read_b32 v92, a56
  v_accvgpr_read_b32 v93, a57
  v_accvgpr_read_b32 v94, a58
  v_accvgpr_read_b32 v95, a59
  ds_write_b128 v9, v[92:95] offset:11264
  v_accvgpr_read_b32 v96, a12
  v_accvgpr_read_b32 v97, a13
  v_accvgpr_read_b32 v98, a14
  v_accvgpr_read_b32 v99, a15
  ds_write_b128 v9, v[96:99] offset:12288
  v_accvgpr_read_b32 v100, a28
  v_accvgpr_read_b32 v101, a29
  v_accvgpr_read_b32 v102, a30
  v_accvgpr_read_b32 v103, a31
  ds_write_b128 v9, v[100:103] offset:13312
  v_accvgpr_read_b32 v104, a44
  v_accvgpr_read_b32 v105, a45
  v_accvgpr_read_b32 v106, a46
  v_accvgpr_read_b32 v107, a47
  ds_write_b128 v9, v[104:107] offset:14336
  v_accvgpr_read_b32 v108, a60
  v_accvgpr_read_b32 v109, a61
  v_accvgpr_read_b32 v110, a62
  v_accvgpr_read_b32 v111, a63
  ds_write_b128 v9, v[108:111] offset:15360
  s_waitcnt lgkmcnt(0)
  s_barrier
  s_mul_i32 s30, s20, 4096
  v_add_u32 v9, s30, v3
  v_add_u32 v10, 32768, v9
  ds_read_b128 v[48:51], v9 offset:0
  ds_read_b128 v[52:55], v9 offset:1024
  ds_read_b128 v[56:59], v9 offset:2048
  ds_read_b128 v[60:63], v9 offset:3072
  ds_read_b128 v[64:67], v9 offset:16384
  ds_read_b128 v[68:71], v9 offset:17408
  ds_read_b128 v[72:75], v9 offset:18432
  ds_read_b128 v[76:79], v9 offset:19456
  ds_read_b128 v[80:83], v10 offset:0
  ds_read_b128 v[84:87], v10 offset:1024
  ds_read_b128 v[88:91], v10 offset:2048
  ds_read_b128 v[92:95], v10 offset:3072
  ds_read_b128 v[96:99], v10 offset:16384
  ds_read_b128 v[100:103], v10 offset:17408
  ds_read_b128 v[104:107], v10 offset:18432
  ds_read_b128 v[108:111], v10 offset:19456
  v_lshrrev_b32 v140, 2, v6
  v_and_b32 v141, 3, v1
  v_lshrrev_b32 v142, 1, v7
  v_lshl_add_u32 v142, v142, 2, v140
  v_lshlrev_b32 v142, 1, v142
  s_and_b32 s31, s56, 1
  s_lshl_b32 s31, s31, 3
  s_lshl_b32 s32, s20, 1
  s_add_u32 s31, s31, s32
  v_lshrrev_b32 v143, 1, v141
  v_add_u32 v143, s31, v143
  v_xor_b32 v143, v143, v142
  v_lshl_add_u32 v144, v7, 2, v140
  v_lshlrev_b32 v144, 8, v144
  v_lshl_add_u32 v144, v143, 4, v144
  v_and_b32 v143, 1, v141
  v_lshl_add_u32 v144, v143, 3, v144
  v_add_u32 v144, 81920, v144
  ds_read_b64_tr_b16 v[146:147], v144 offset:0
  ds_read_b64_tr_b16 v[148:149], v144 offset:4096
  ds_read_b64_tr_b16 v[150:151], v144 offset:8192
  ds_read_b64_tr_b16 v[152:153], v144 offset:12288
  s_and_b32 s5, s5, 0xffff
  s_mov_b32 s6, 2359296
  s_mov_b32 s7, 0x20000
  s_lshl_b32 s31, s56, 6
  s_lshl_b32 s32, s20, 4
  s_add_u32 s31, s31, s32
  s_mul_i32 s31, s31, 1152
  s_lshl_b32 s32, s21, 1
  s_add_u32 s31, s31, s32
  v_mul_u32_u24 v145, 1152, v6
  v_lshl_add_u32 v145, v7, 3, v145
  s_waitcnt lgkmcnt(0)
  v_pk_add_f32 v[48:49], v[48:49], v[64:65]
  v_pk_add_f32 v[80:81], v[80:81], v[96:97]
  v_pk_add_f32 v[50:51], v[50:51], v[66:67]
  v_pk_add_f32 v[82:83], v[82:83], v[98:99]
  v_pk_add_f32 v[48:49], v[48:49], v[80:81]
  v_pk_add_f32 v[50:51], v[50:51], v[82:83]
  v_lshlrev_b32 v160, 16, v146
  v_and_b32 v161, 0xffff0000, v146
  v_lshlrev_b32 v162, 16, v147
  v_and_b32 v163, 0xffff0000, v147
  v_pk_fma_f32 v[48:49], v[48:49], v[228:229], v[160:161]
  v_pk_fma_f32 v[50:51], v[50:51], v[230:231], v[162:163]
  v_cvt_pk_bf16_f32 v164, v48, v49
  v_cvt_pk_bf16_f32 v165, v50, v51
  buffer_store_dwordx2 v[164:165], v145, s[4:7], s31 offen
  v_pk_add_f32 v[52:53], v[52:53], v[68:69]
  v_pk_add_f32 v[84:85], v[84:85], v[100:101]
  v_pk_add_f32 v[54:55], v[54:55], v[70:71]
  v_pk_add_f32 v[86:87], v[86:87], v[102:103]
  v_pk_add_f32 v[52:53], v[52:53], v[84:85]
  v_pk_add_f32 v[54:55], v[54:55], v[86:87]
  v_lshlrev_b32 v160, 16, v148
  v_and_b32 v161, 0xffff0000, v148
  v_lshlrev_b32 v162, 16, v149
  v_and_b32 v163, 0xffff0000, v149
  v_pk_fma_f32 v[52:53], v[52:53], v[232:233], v[160:161]
  v_pk_fma_f32 v[54:55], v[54:55], v[234:235], v[162:163]
  v_cvt_pk_bf16_f32 v166, v52, v53
  v_cvt_pk_bf16_f32 v167, v54, v55
  buffer_store_dwordx2 v[166:167], v145, s[4:7], s31 offen offset:32
  v_pk_add_f32 v[56:57], v[56:57], v[72:73]
  v_pk_add_f32 v[88:89], v[88:89], v[104:105]
  v_pk_add_f32 v[58:59], v[58:59], v[74:75]
  v_pk_add_f32 v[90:91], v[90:91], v[106:107]
  v_pk_add_f32 v[56:57], v[56:57], v[88:89]
  v_pk_add_f32 v[58:59], v[58:59], v[90:91]
  v_lshlrev_b32 v160, 16, v150
  v_and_b32 v161, 0xffff0000, v150
  v_lshlrev_b32 v162, 16, v151
  v_and_b32 v163, 0xffff0000, v151
  v_pk_fma_f32 v[56:57], v[56:57], v[236:237], v[160:161]
  v_pk_fma_f32 v[58:59], v[58:59], v[238:239], v[162:163]
  v_cvt_pk_bf16_f32 v164, v56, v57
  v_cvt_pk_bf16_f32 v165, v58, v59
  buffer_store_dwordx2 v[164:165], v145, s[4:7], s31 offen offset:64
  v_pk_add_f32 v[60:61], v[60:61], v[76:77]
  v_pk_add_f32 v[92:93], v[92:93], v[108:109]
  v_pk_add_f32 v[62:63], v[62:63], v[78:79]
  v_pk_add_f32 v[94:95], v[94:95], v[110:111]
  v_pk_add_f32 v[60:61], v[60:61], v[92:93]
  v_pk_add_f32 v[62:63], v[62:63], v[94:95]
  v_lshlrev_b32 v160, 16, v152
  v_and_b32 v161, 0xffff0000, v152
  v_lshlrev_b32 v162, 16, v153
  v_and_b32 v163, 0xffff0000, v153
  v_pk_fma_f32 v[60:61], v[60:61], v[240:241], v[160:161]
  v_pk_fma_f32 v[62:63], v[62:63], v[242:243], v[162:163]
  v_cvt_pk_bf16_f32 v166, v60, v61
  v_cvt_pk_bf16_f32 v167, v62, v63
  buffer_store_dwordx2 v[166:167], v145, s[4:7], s31 offen offset:96
kg_kernel_exit:
  s_endpgm
kg_kernel_codeend:
.section .rodata,"a"
.p2align 6
.amdhsa_kernel k0_kernel
  .amdhsa_next_free_vgpr 116
  .amdhsa_next_free_sgpr 102
  .amdhsa_accum_offset 116
  .amdhsa_group_segment_fixed_size 0
  .amdhsa_kernarg_size 152
  .amdhsa_user_sgpr_count 2
  .amdhsa_user_sgpr_kernarg_segment_ptr 1
  .amdhsa_system_sgpr_workgroup_id_x 1
.end_amdhsa_kernel
.p2align 6
.amdhsa_kernel k1_kernel
  .amdhsa_next_free_vgpr 128
  .amdhsa_next_free_sgpr 102
  .amdhsa_accum_offset 128
  .amdhsa_group_segment_fixed_size 0
  .amdhsa_kernarg_size 152
  .amdhsa_user_sgpr_count 2
  .amdhsa_user_sgpr_kernarg_segment_ptr 1
  .amdhsa_system_sgpr_workgroup_id_x 1
.end_amdhsa_kernel
.p2align 6
.amdhsa_kernel kg_kernel
  .amdhsa_next_free_vgpr 512
  .amdhsa_next_free_sgpr 102
  .amdhsa_accum_offset 256
  .amdhsa_group_segment_fixed_size 0
  .amdhsa_kernarg_size 152
  .amdhsa_user_sgpr_count 2
  .amdhsa_user_sgpr_kernarg_segment_ptr 1
  .amdhsa_system_sgpr_workgroup_id_x 1
.end_amdhsa_kernel
.p2align 6
```
